```python
import torch

def _softmax(x, axis=-1):
    return torch.softmax(x, dim=axis)
def _gelu(x):
    return torch.nn.functional.gelu(x, approximate="tanh")
def _silu(x):
    return torch.nn.functional.silu(x)
def _sigmoid(x):
    return torch.sigmoid(x)
def _layernorm(x, axis=-1, eps=1e-5):
    m = x.mean(dim=axis, keepdim=True)
    v = x.var(dim=axis, keepdim=True, unbiased=False)
    return (x - m) / torch.sqrt(v + eps)
def _scatter_add(tgt, idx, src, axis=0):
    return tgt.clone().index_add_(axis, idx, src)
def _segment_sum(src, seg, n):
    out = torch.zeros((n,) + src.shape[1:], dtype=src.dtype)
    return out.index_add_(0, seg, src)
def _pad(x, pw):
    flat = tuple(v for pair in reversed(pw) for v in pair)
    return torch.nn.functional.pad(x, flat)

kernel_name = 'sequential_preLN__spectral_gfnet__mixer_s_mlp__prompt'

def setup_inputs():

    _w = (lambda a: (lambda t: t.to(torch.bfloat16) if t.is_floating_point() else t)(torch.as_tensor(a)))
    def _A_setup():
        B, S, D = 1, 2048, 1024
        Df = D // 2 + 1
        return {
            "x": _w((lambda *s: torch.randn(*s, dtype=torch.bfloat16) * 0.05)(B, S, D)),
            "w_r": _w((lambda *s: torch.randn(*s, dtype=torch.bfloat16) * 0.4)(S, Df) * 0.02),
            "w_i": _w((lambda *s: torch.randn(*s, dtype=torch.bfloat16) * 0.4)(S, Df) * 0.02),
        }
    _A_in = _A_setup()

    def _B_setup():
        B, S, D, F = 1, 2048, 1024, 3584
        return {
            "x":  _w((lambda *s: torch.randn(*s, dtype=torch.bfloat16) * 0.05)(B, S, D)),
            "w1": _w((lambda *s: torch.randn(*s, dtype=torch.bfloat16) * 0.8)(D, D) * (D ** -0.5)),
            "w2": _w((lambda *s: torch.randn(*s, dtype=torch.bfloat16) * 0.8)(D, D) * (D ** -0.5)),
            "w3": _w((lambda *s: torch.randn(*s, dtype=torch.bfloat16) * 0.8)(D, F) * (D ** -0.5)),
            "w4": _w((lambda *s: torch.randn(*s, dtype=torch.bfloat16) * 0.8)(F, D) * (F ** -0.5)),
        }
    _B_in = _B_setup()

    return {
        "A_x": _A_in["x"],
        "A_w_r": _A_in["w_r"],
        "A_w_i": _A_in["w_i"],
        "B_x": _B_in["x"],
        "B_w1": _B_in["w1"],
        "B_w2": _B_in["w2"],
        "B_w3": _B_in["w3"],
        "B_w4": _B_in["w4"],
    }

def reference(A_x, A_w_r, A_w_i, B_x, B_w1, B_w2, B_w3, B_w4):
    def _A_ref(x, w_r, w_i):
        B, S, D = x.shape
        X = (lambda x, axes=(-2,-1): torch.fft.rfft2(x.float(), dim=axes))(x, axes=(-2, -1))
        W = w_r + 1j * w_i
        X = X * W
        y = (lambda x, s, axes=(-2,-1): torch.fft.irfft2(x, s=s, dim=axes).to(torch.bfloat16))(X, (S, D), axes=(-2, -1))
        return y

    def _B_ref(x, w1, w2, w3, w4):
        B, S, D = x.shape
        h = _gelu(_layernorm(x, axis=-1) @ w1)
        c = D // 4
        g0 = _pad(h[:, :, 0*c:1*c], ((0, 0), (1, 0), (0, 0)))[:, :S, :]
        g1 = _pad(h[:, :, 1*c:2*c], ((0, 0), (0, 1), (0, 0)))[:, 1:, :]
        g2 = _pad(h[:, :, 2*c:3*c], ((0, 0), (2, 0), (0, 0)))[:, :S, :]
        g3 = _pad(h[:, :, 3*c:   ], ((0, 0), (0, 2), (0, 0)))[:, 2:, :]
        hs = torch.concatenate([g0, g1, g2, g3], axis=-1) @ w2
        x1 = x + hs
        h2 = _gelu(_layernorm(x1, axis=-1) @ w3) @ w4
        return x1 + h2

    x = A_x
    h = x + _A_ref(_layernorm(x, axis=-1), A_w_r, A_w_i)
    h2 = h + _B_ref(_layernorm(h, axis=-1), B_w1, B_w2, B_w3, B_w4)
    return h2
```

```asm
; @launch grid=(256,1,1) block=(256,1,1) lds=151552
.amdgcn_target "amdgcn-amd-amdhsa--gfx950"
.text
.globl sequential_preLN__spectral_gfnet__mixer_s_mlp__prompt_kernel
.p2align 8
.type sequential_preLN__spectral_gfnet__mixer_s_mlp__prompt_kernel,@function
sequential_preLN__spectral_gfnet__mixer_s_mlp__prompt_kernel:
    s_cmp_ge_u32 s2, 256
    s_cbranch_scc1 L_k1_kernel_end
    s_load_dwordx16 s[64:79], s[0:1], 0
    s_load_dwordx4 s[80:83], s[0:1], 64
    s_load_dwordx2 s[84:85], s[0:1], 80
    s_getpc_b64 s[60:61]
L_pc1:
    s_sub_u32 s60, s60, L_pc1-sequential_preLN__spectral_gfnet__mixer_s_mlp__prompt_kernel
    s_subb_u32 s61, s61, 0
    v_lshlrev_b32 v253, 7, v0
    v_min_u32 v253, L_k2_kernel_entry-sequential_preLN__spectral_gfnet__mixer_s_mlp__prompt_kernel-4, v253
    global_load_dword v252, v253, s[60:61]
    v_lshrrev_b32 v1, 6, v0
    s_nop 0
    v_readfirstlane_b32 s32, v1
    s_waitcnt lgkmcnt(0)
    s_mov_b64 s[4:5], s[64:65]
    s_mov_b64 s[8:9], s[66:67]
    s_mov_b64 s[10:11], s[68:69]
    s_mov_b64 s[6:7], s[84:85]
    s_mov_b64 s[44:45], s[72:73]
    v_and_b32 v1, 63, v0
    s_lshr_b32 s33, s2, 5
    s_lshl_b32 s33, s33, 8
    s_and_b32 s34, s2, 31
    s_add_u32 s33, s33, s34
    s_lshl_b32 s34, s32, 6
    s_add_u32 s33, s33, s34
    s_lshl_b32 s33, s33, 11
    v_lshlrev_b32 v6, 4, v1
    v_add_u32 v6, s33, v6
    v_add_u32 v7, 65536, v6
    s_and_b32 s33, s2, 7
    s_lshr_b32 s34, s2, 5
    s_lshl_b32 s34, s34, 3
    s_add_u32 s35, s33, s34
    s_sub_u32 s46, 96, s35
    s_cmp_lt_u32 s34, 32
    s_cselect_b32 s46, s35, s46
    s_cmp_eq_u32 s33, 0
    s_cselect_b32 s34, s35, s46
    s_bfe_u32 s33, s2, 0x20003
    s_lshl_b32 s35, s33, 6
    s_add_u32 s35, s35, s34
    s_lshl_b32 s33, s33, 9
    s_add_u32 s33, s33, s34
    v_and_b32 v2, 1, v0
    v_lshlrev_b32 v2, 8, v2
    v_add_u32 v2, s33, v2
    v_lshrrev_b32 v3, 1, v0
    v_mul_u32_u24 v8, 1026, v2
    v_lshl_add_u32 v8, v3, 3, v8
    v_add_u32 v9, 65664, v8
    v_add_u32 v10, 131328, v8
    v_add_u32 v11, 196992, v8
    s_waitcnt vmcnt(0)
    s_mov_b32 s12, s4
    s_mov_b32 s13, s5
    s_mov_b32 s14, 4194304
    s_mov_b32 s15, 0x20000
    s_mov_b32 s16, s8
    s_mov_b32 s17, s9
    s_mov_b32 s18, 2101248
    s_mov_b32 s19, 0x20000
    s_mov_b32 s20, s10
    s_mov_b32 s21, s11
    s_mov_b32 s22, 2101248
    s_mov_b32 s23, 0x20000
    buffer_load_dwordx4 v[48:51], v6, s[12:15], 0 offen offset:0 nt
    buffer_load_dwordx4 v[52:55], v6, s[12:15], 0 offen offset:1024 nt
    buffer_load_dwordx4 v[56:59], v7, s[12:15], 0 offen offset:0 nt
    buffer_load_dwordx4 v[60:63], v7, s[12:15], 0 offen offset:1024 nt
    buffer_load_dwordx2 v[64:65], v8, s[16:19], 0 offen nt
    buffer_load_dwordx2 v[72:73], v8, s[20:23], 0 offen nt
    buffer_load_dwordx2 v[66:67], v9, s[16:19], 0 offen nt
    buffer_load_dwordx2 v[74:75], v9, s[20:23], 0 offen nt
    buffer_load_dwordx2 v[68:69], v10, s[16:19], 0 offen nt
    buffer_load_dwordx2 v[76:77], v10, s[20:23], 0 offen nt
    buffer_load_dwordx2 v[70:71], v11, s[16:19], 0 offen nt
    buffer_load_dwordx2 v[78:79], v11, s[20:23], 0 offen nt
    v_and_b32 v4, 7, v3
    v_cmp_eq_u32 vcc, 0, v4
    v_lshlrev_b32 v3, 3, v3
    v_sub_u32 v3, 1024, v3
    v_cndmask_b32 v88, 0, -1, vcc
    v_mov_b32 v5, 0x40000000
    v_sub_u32 v4, 2048, v2
    v_and_b32 v4, 0x7ff, v4
    v_mul_u32_u24 v4, 1026, v4
    v_add_u32 v4, v4, v3
    v_cndmask_b32 v12, v5, v4, vcc
    v_sub_u32 v4, 1984, v2
    v_and_b32 v4, 0x7ff, v4
    v_mul_u32_u24 v4, 1026, v4
    v_add_u32 v4, v4, v3
    v_cndmask_b32 v13, v5, v4, vcc
    v_sub_u32 v4, 1920, v2
    v_and_b32 v4, 0x7ff, v4
    v_mul_u32_u24 v4, 1026, v4
    v_add_u32 v4, v4, v3
    v_cndmask_b32 v14, v5, v4, vcc
    v_sub_u32 v4, 1856, v2
    v_and_b32 v4, 0x7ff, v4
    v_mul_u32_u24 v4, 1026, v4
    v_add_u32 v4, v4, v3
    v_cndmask_b32 v15, v5, v4, vcc
    s_add_u32 s24, s6, 73400320
    s_addc_u32 s25, s7, 0
    s_mov_b32 s26, 4194304
    s_mov_b32 s27, 0x20000
    s_add_u32 s28, s6, 78643200
    s_addc_u32 s29, s7, 0
    s_mov_b32 s30, 4194304
    s_mov_b32 s31, 0x20000
    v_and_b32 v90, 31, v1
    v_lshrrev_b32 v91, 5, v1
    v_lshlrev_b32 v2, 3, v91
    v_mul_u32_u24 v4, v2, v90
    v_and_b32 v4, 31, v4
    v_cvt_f32_u32 v4, v4
    v_mul_f32 v4, 0x3d000000, v4
    v_cos_f32 v92, v4
    v_sin_f32 v93, v4
    v_add_u32 v5, 16, v2
    v_mul_u32_u24 v5, v5, v90
    v_and_b32 v5, 31, v5
    v_cvt_f32_u32 v5, v5
    v_mul_f32 v5, 0x3d000000, v5
    v_cos_f32 v108, v5
    v_sin_f32 v109, v5
    v_mul_u32_u24 v4, 1, v90
    v_and_b32 v4, 31, v4
    v_cvt_f32_u32 v4, v4
    v_mul_f32 v4, 0x3d000000, v4
    v_cos_f32 v16, v4
    v_sin_f32 v17, v4
    s_nop 0
    v_pk_mul_f32 v[94:95], v[92:93], v[16:17] op_sel_hi:[1,0]
    v_pk_mul_f32 v[110:111], v[108:109], v[16:17] op_sel_hi:[1,0]
    v_pk_fma_f32 v[94:95], v[92:93], v[16:17], v[94:95] op_sel:[1,1,0] op_sel_hi:[0,1,1] neg_lo:[1,0,0]
    v_pk_fma_f32 v[110:111], v[108:109], v[16:17], v[110:111] op_sel:[1,1,0] op_sel_hi:[0,1,1] neg_lo:[1,0,0]
    v_pk_mul_f32 v[96:97], v[94:95], v[16:17] op_sel_hi:[1,0]
    v_pk_mul_f32 v[112:113], v[110:111], v[16:17] op_sel_hi:[1,0]
    v_pk_fma_f32 v[96:97], v[94:95], v[16:17], v[96:97] op_sel:[1,1,0] op_sel_hi:[0,1,1] neg_lo:[1,0,0]
    v_pk_fma_f32 v[112:113], v[110:111], v[16:17], v[112:113] op_sel:[1,1,0] op_sel_hi:[0,1,1] neg_lo:[1,0,0]
    v_pk_mul_f32 v[98:99], v[96:97], v[16:17] op_sel_hi:[1,0]
    v_pk_mul_f32 v[114:115], v[112:113], v[16:17] op_sel_hi:[1,0]
    v_pk_fma_f32 v[98:99], v[96:97], v[16:17], v[98:99] op_sel:[1,1,0] op_sel_hi:[0,1,1] neg_lo:[1,0,0]
    v_pk_fma_f32 v[114:115], v[112:113], v[16:17], v[114:115] op_sel:[1,1,0] op_sel_hi:[0,1,1] neg_lo:[1,0,0]
    v_pk_mul_f32 v[100:101], v[98:99], v[16:17] op_sel_hi:[1,0]
    v_pk_mul_f32 v[116:117], v[114:115], v[16:17] op_sel_hi:[1,0]
    v_pk_fma_f32 v[100:101], v[98:99], v[16:17], v[100:101] op_sel:[1,1,0] op_sel_hi:[0,1,1] neg_lo:[1,0,0]
    v_pk_fma_f32 v[116:117], v[114:115], v[16:17], v[116:117] op_sel:[1,1,0] op_sel_hi:[0,1,1] neg_lo:[1,0,0]
    v_pk_mul_f32 v[102:103], v[100:101], v[16:17] op_sel_hi:[1,0]
    v_pk_mul_f32 v[118:119], v[116:117], v[16:17] op_sel_hi:[1,0]
    v_pk_fma_f32 v[102:103], v[100:101], v[16:17], v[102:103] op_sel:[1,1,0] op_sel_hi:[0,1,1] neg_lo:[1,0,0]
    v_pk_fma_f32 v[118:119], v[116:117], v[16:17], v[118:119] op_sel:[1,1,0] op_sel_hi:[0,1,1] neg_lo:[1,0,0]
    v_pk_mul_f32 v[104:105], v[102:103], v[16:17] op_sel_hi:[1,0]
    v_pk_mul_f32 v[120:121], v[118:119], v[16:17] op_sel_hi:[1,0]
    v_pk_fma_f32 v[104:105], v[102:103], v[16:17], v[104:105] op_sel:[1,1,0] op_sel_hi:[0,1,1] neg_lo:[1,0,0]
    v_pk_fma_f32 v[120:121], v[118:119], v[16:17], v[120:121] op_sel:[1,1,0] op_sel_hi:[0,1,1] neg_lo:[1,0,0]
    v_pk_mul_f32 v[106:107], v[104:105], v[16:17] op_sel_hi:[1,0]
    v_pk_mul_f32 v[122:123], v[120:121], v[16:17] op_sel_hi:[1,0]
    v_pk_fma_f32 v[106:107], v[104:105], v[16:17], v[106:107] op_sel:[1,1,0] op_sel_hi:[0,1,1] neg_lo:[1,0,0]
    v_pk_fma_f32 v[122:123], v[120:121], v[16:17], v[122:123] op_sel:[1,1,0] op_sel_hi:[0,1,1] neg_lo:[1,0,0]
    v_cvt_pk_bf16_f32 v124, v92, v94
    v_cvt_pk_bf16_f32 v132, -v93, -v95
    v_cvt_pk_bf16_f32 v125, v96, v98
    v_cvt_pk_bf16_f32 v133, -v97, -v99
    v_cvt_pk_bf16_f32 v126, v100, v102
    v_cvt_pk_bf16_f32 v134, -v101, -v103
    v_cvt_pk_bf16_f32 v127, v104, v106
    v_cvt_pk_bf16_f32 v135, -v105, -v107
    v_cvt_pk_bf16_f32 v128, v108, v110
    v_cvt_pk_bf16_f32 v136, -v109, -v111
    v_cvt_pk_bf16_f32 v129, v112, v114
    v_cvt_pk_bf16_f32 v137, -v113, -v115
    v_cvt_pk_bf16_f32 v130, v116, v118
    v_cvt_pk_bf16_f32 v138, -v117, -v119
    v_cvt_pk_bf16_f32 v131, v120, v122
    v_cvt_pk_bf16_f32 v139, -v121, -v123
    v_cmp_eq_u32 vcc, 0, v90
    v_mov_b32 v3, 0x200
    s_nop 0
    v_cndmask_b32 v3, v90, v3, vcc
    v_lshlrev_b32 v2, 2, v91
    v_mul_u32_u24 v92, v2, v3
    v_and_b32 v92, 1023, v92
    v_cvt_f32_u32 v92, v92
    v_mul_f32 v92, 0x3a800000, v92
    v_cos_f32 v140, v92
    v_sin_f32 v156, v92
    v_add_u32 v93, 1, v2
    v_mul_u32_u24 v93, v93, v3
    v_and_b32 v93, 1023, v93
    v_cvt_f32_u32 v93, v93
    v_mul_f32 v93, 0x3a800000, v93
    v_cos_f32 v141, v93
    v_sin_f32 v157, v93
    v_mul_u32_u24 v94, 2, v3
    v_and_b32 v94, 1023, v94
    v_cvt_f32_u32 v94, v94
    v_mul_f32 v94, 0x3a800000, v94
    v_cos_f32 v96, v94
    v_sin_f32 v97, v94
    v_mul_u32_u24 v95, 8, v3
    v_and_b32 v95, 1023, v95
    v_cvt_f32_u32 v95, v95
    v_mul_f32 v95, 0x3a800000, v95
    v_cos_f32 v98, v95
    v_sin_f32 v99, v95
    v_pk_mul_f32 v[100:101], v[156:157], v[96:97] op_sel:[0,1] op_sel_hi:[1,1]
    v_pk_mul_f32 v[158:159], v[156:157], v[96:97] op_sel_hi:[1,0]
    v_pk_fma_f32 v[158:159], v[140:141], v[96:97], v[158:159] op_sel:[0,1,0] op_sel_hi:[1,1,1]
    v_pk_fma_f32 v[142:143], v[140:141], v[96:97], v[100:101] op_sel_hi:[1,0,1] neg_lo:[0,0,1] neg_hi:[0,0,1]
    v_pk_mul_f32 v[100:101], v[156:157], v[98:99] op_sel:[0,1] op_sel_hi:[1,1]
    v_pk_mul_f32 v[102:103], v[158:159], v[98:99] op_sel:[0,1] op_sel_hi:[1,1]
    v_pk_mul_f32 v[160:161], v[156:157], v[98:99] op_sel_hi:[1,0]
    v_pk_mul_f32 v[162:163], v[158:159], v[98:99] op_sel_hi:[1,0]
    v_pk_fma_f32 v[160:161], v[140:141], v[98:99], v[160:161] op_sel:[0,1,0] op_sel_hi:[1,1,1]
    v_pk_fma_f32 v[162:163], v[142:143], v[98:99], v[162:163] op_sel:[0,1,0] op_sel_hi:[1,1,1]
    v_pk_fma_f32 v[144:145], v[140:141], v[98:99], v[100:101] op_sel_hi:[1,0,1] neg_lo:[0,0,1] neg_hi:[0,0,1]
    v_pk_fma_f32 v[146:147], v[142:143], v[98:99], v[102:103] op_sel_hi:[1,0,1] neg_lo:[0,0,1] neg_hi:[0,0,1]
    v_pk_mul_f32 v[100:101], v[160:161], v[98:99] op_sel:[0,1] op_sel_hi:[1,1]
    v_pk_mul_f32 v[102:103], v[162:163], v[98:99] op_sel:[0,1] op_sel_hi:[1,1]
    v_pk_mul_f32 v[164:165], v[160:161], v[98:99] op_sel_hi:[1,0]
    v_pk_mul_f32 v[166:167], v[162:163], v[98:99] op_sel_hi:[1,0]
    v_pk_fma_f32 v[164:165], v[144:145], v[98:99], v[164:165] op_sel:[0,1,0] op_sel_hi:[1,1,1]
    v_pk_fma_f32 v[166:167], v[146:147], v[98:99], v[166:167] op_sel:[0,1,0] op_sel_hi:[1,1,1]
    v_pk_fma_f32 v[148:149], v[144:145], v[98:99], v[100:101] op_sel_hi:[1,0,1] neg_lo:[0,0,1] neg_hi:[0,0,1]
    v_pk_fma_f32 v[150:151], v[146:147], v[98:99], v[102:103] op_sel_hi:[1,0,1] neg_lo:[0,0,1] neg_hi:[0,0,1]
    v_pk_mul_f32 v[100:101], v[164:165], v[98:99] op_sel:[0,1] op_sel_hi:[1,1]
    v_pk_mul_f32 v[102:103], v[166:167], v[98:99] op_sel:[0,1] op_sel_hi:[1,1]
    v_pk_mul_f32 v[168:169], v[164:165], v[98:99] op_sel_hi:[1,0]
    v_pk_mul_f32 v[170:171], v[166:167], v[98:99] op_sel_hi:[1,0]
    v_pk_fma_f32 v[168:169], v[148:149], v[98:99], v[168:169] op_sel:[0,1,0] op_sel_hi:[1,1,1]
    v_pk_fma_f32 v[170:171], v[150:151], v[98:99], v[170:171] op_sel:[0,1,0] op_sel_hi:[1,1,1]
    v_pk_fma_f32 v[152:153], v[148:149], v[98:99], v[100:101] op_sel_hi:[1,0,1] neg_lo:[0,0,1] neg_hi:[0,0,1]
    v_pk_fma_f32 v[154:155], v[150:151], v[98:99], v[102:103] op_sel_hi:[1,0,1] neg_lo:[0,0,1] neg_hi:[0,0,1]
    v_lshrrev_b32 v3, 1, v90
    v_and_b32 v4, 1, v90
    v_lshlrev_b32 v4, 3, v4
    v_mad_u32_u24 v18, v2, v3, v4
    v_and_b32 v18, 31, v18
    v_cvt_f32_u32 v18, v18
    v_mul_f32 v18, 0x3d000000, v18
    v_cos_f32 v92, v18
    v_sin_f32 v93, v18
    v_add_u32 v19, 8, v2
    v_mad_u32_u24 v19, v19, v3, v4
    v_and_b32 v19, 31, v19
    v_cvt_f32_u32 v19, v19
    v_mul_f32 v19, 0x3d000000, v19
    v_cos_f32 v100, v19
    v_sin_f32 v101, v19
    v_add_u32 v18, 16, v2
    v_mad_u32_u24 v18, v18, v3, v4
    v_and_b32 v18, 31, v18
    v_cvt_f32_u32 v18, v18
    v_mul_f32 v18, 0x3d000000, v18
    v_cos_f32 v108, v18
    v_sin_f32 v109, v18
    v_add_u32 v19, 24, v2
    v_mad_u32_u24 v19, v19, v3, v4
    v_and_b32 v19, 31, v19
    v_cvt_f32_u32 v19, v19
    v_mul_f32 v19, 0x3d000000, v19
    v_cos_f32 v116, v19
    v_sin_f32 v117, v19
    v_mul_u32_u24 v18, 1, v3
    v_and_b32 v18, 31, v18
    v_cvt_f32_u32 v18, v18
    v_mul_f32 v18, 0x3d000000, v18
    v_cos_f32 v16, v18
    v_sin_f32 v17, v18
    s_nop 0
    v_pk_mul_f32 v[94:95], v[92:93], v[16:17] op_sel_hi:[1,0]
    v_pk_mul_f32 v[102:103], v[100:101], v[16:17] op_sel_hi:[1,0]
    v_pk_mul_f32 v[110:111], v[108:109], v[16:17] op_sel_hi:[1,0]
    v_pk_mul_f32 v[118:119], v[116:117], v[16:17] op_sel_hi:[1,0]
    v_pk_fma_f32 v[94:95], v[92:93], v[16:17], v[94:95] op_sel:[1,1,0] op_sel_hi:[0,1,1] neg_lo:[1,0,0]
    v_pk_fma_f32 v[102:103], v[100:101], v[16:17], v[102:103] op_sel:[1,1,0] op_sel_hi:[0,1,1] neg_lo:[1,0,0]
    v_pk_fma_f32 v[110:111], v[108:109], v[16:17], v[110:111] op_sel:[1,1,0] op_sel_hi:[0,1,1] neg_lo:[1,0,0]
    v_pk_fma_f32 v[118:119], v[116:117], v[16:17], v[118:119] op_sel:[1,1,0] op_sel_hi:[0,1,1] neg_lo:[1,0,0]
    v_pk_mul_f32 v[96:97], v[94:95], v[16:17] op_sel_hi:[1,0]
    v_pk_mul_f32 v[104:105], v[102:103], v[16:17] op_sel_hi:[1,0]
    v_pk_mul_f32 v[112:113], v[110:111], v[16:17] op_sel_hi:[1,0]
    v_pk_mul_f32 v[120:121], v[118:119], v[16:17] op_sel_hi:[1,0]
    v_pk_fma_f32 v[96:97], v[94:95], v[16:17], v[96:97] op_sel:[1,1,0] op_sel_hi:[0,1,1] neg_lo:[1,0,0]
    v_pk_fma_f32 v[104:105], v[102:103], v[16:17], v[104:105] op_sel:[1,1,0] op_sel_hi:[0,1,1] neg_lo:[1,0,0]
    v_pk_fma_f32 v[112:113], v[110:111], v[16:17], v[112:113] op_sel:[1,1,0] op_sel_hi:[0,1,1] neg_lo:[1,0,0]
    v_pk_fma_f32 v[120:121], v[118:119], v[16:17], v[120:121] op_sel:[1,1,0] op_sel_hi:[0,1,1] neg_lo:[1,0,0]
    v_pk_mul_f32 v[98:99], v[96:97], v[16:17] op_sel_hi:[1,0]
    v_pk_mul_f32 v[106:107], v[104:105], v[16:17] op_sel_hi:[1,0]
    v_pk_mul_f32 v[114:115], v[112:113], v[16:17] op_sel_hi:[1,0]
    v_pk_mul_f32 v[122:123], v[120:121], v[16:17] op_sel_hi:[1,0]
    v_pk_fma_f32 v[98:99], v[96:97], v[16:17], v[98:99] op_sel:[1,1,0] op_sel_hi:[0,1,1] neg_lo:[1,0,0]
    v_pk_fma_f32 v[106:107], v[104:105], v[16:17], v[106:107] op_sel:[1,1,0] op_sel_hi:[0,1,1] neg_lo:[1,0,0]
    v_pk_fma_f32 v[114:115], v[112:113], v[16:17], v[114:115] op_sel:[1,1,0] op_sel_hi:[0,1,1] neg_lo:[1,0,0]
    v_pk_fma_f32 v[122:123], v[120:121], v[16:17], v[122:123] op_sel:[1,1,0] op_sel_hi:[0,1,1] neg_lo:[1,0,0]
    v_cvt_pk_bf16_f32 v172, v92, v93
    v_cvt_pk_bf16_f32 v173, v94, v95
    v_cvt_pk_bf16_f32 v174, v96, v97
    v_cvt_pk_bf16_f32 v175, v98, v99
    v_cvt_pk_bf16_f32 v176, v100, v101
    v_cvt_pk_bf16_f32 v177, v102, v103
    v_cvt_pk_bf16_f32 v178, v104, v105
    v_cvt_pk_bf16_f32 v179, v106, v107
    v_cvt_pk_bf16_f32 v180, v108, v109
    v_cvt_pk_bf16_f32 v181, v110, v111
    v_cvt_pk_bf16_f32 v182, v112, v113
    v_cvt_pk_bf16_f32 v183, v114, v115
    v_cvt_pk_bf16_f32 v184, v116, v117
    v_cvt_pk_bf16_f32 v185, v118, v119
    v_cvt_pk_bf16_f32 v186, v120, v121
    v_cvt_pk_bf16_f32 v187, v122, v123
    v_cmp_eq_u32 vcc, 0, v1
    s_nop 1
    v_cndmask_b32 v188, 1.0, 0.5, vcc
    s_lshl_b32 s33, s32, 12
    s_add_u32 s33, s33, 16384
    v_lshlrev_b32 v189, 4, v1
    v_add_u32 v189, s33, v189
    v_lshlrev_b32 v190, 9, v91
    v_bfe_u32 v2, v1, 2, 2
    v_lshl_add_u32 v190, v2, 6, v190
    v_bfe_u32 v2, v1, 4, 1
    v_lshl_add_u32 v190, v2, 5, v190
    v_and_b32 v2, 3, v1
    v_lshl_add_u32 v190, v2, 3, v190
    v_add_u32 v190, s33, v190
    v_lshlrev_b32 v191, 5, v90
    v_lshl_add_u32 v191, v91, 11, v191
    s_lshl_b32 s33, s32, 3
    v_add_u32 v191, s33, v191
    v_lshlrev_b32 v192, 4, v0
    v_lshrrev_b32 v2, 3, v0
    v_mul_u32_u24 v2, 32768, v2
    v_and_b32 v3, 7, v0
    v_lshl_add_u32 v2, v3, 4, v2
    s_lshl_b32 s33, s2, 7
    v_add_u32 v193, s33, v2
    v_lshrrev_b32 v2, 1, v0
    v_and_b32 v3, 3, v2
    v_lshlrev_b32 v2, 7, v2
    v_lshl_add_u32 v2, v3, 5, v2
    v_and_b32 v3, 1, v0
    v_lshl_add_u32 v2, v3, 4, v2
    v_add_u32 v195, 32768, v2
    v_lshrrev_b32 v2, 3, v0
    v_and_b32 v2, 3, v2
    v_lshlrev_b32 v2, 5, v2
    v_xor_b32 v194, v193, v2
    s_sub_u32 s33, s35, s2
    s_lshl_b32 s33, s33, 7
    v_add_u32 v194, s33, v194
    buffer_load_ushort v80, v12, s[16:19], 0 offen nt
    buffer_load_ushort v84, v12, s[20:23], 0 offen nt
    buffer_load_ushort v81, v13, s[16:19], 0 offen nt
    buffer_load_ushort v85, v13, s[20:23], 0 offen nt
    buffer_load_ushort v82, v14, s[16:19], 0 offen nt
    buffer_load_ushort v86, v14, s[20:23], 0 offen nt
    buffer_load_ushort v83, v15, s[16:19], 0 offen nt
    buffer_load_ushort v87, v15, s[20:23], 0 offen nt
    s_getpc_b64 s[60:61]
L_pc2:
    s_add_u32 s60, s60, L_k2_kernel_entry-L_pc2
    s_addc_u32 s61, s61, 0
    s_lshr_b32 s62, s2, 3
    s_and_b32 s62, s62, 7
    s_lshl_b32 s62, s62, 2
    s_add_u32 s62, s62, s32
    s_mul_i32 s62, s62, 1024
    v_and_b32 v4, 63, v0
    v_lshlrev_b32 v4, 7, v4
    v_add_u32 v4, s62, v4
    v_min_u32 v4, L_k3_kernel_entry-L_k2_kernel_entry-4, v4
    s_mov_b64 exec, 255
    global_load_dword v196, v4, s[60:61]
    s_mov_b64 exec, -1
    s_waitcnt vmcnt(20)
    v_lshlrev_b32 v16, 16, v48
    v_and_b32 v17, 0xffff0000, v48
    v_lshlrev_b32 v18, 16, v49
    v_and_b32 v19, 0xffff0000, v49
    v_lshlrev_b32 v20, 16, v50
    v_and_b32 v21, 0xffff0000, v50
    v_lshlrev_b32 v22, 16, v51
    v_and_b32 v23, 0xffff0000, v51
    s_waitcnt vmcnt(19)
    v_lshlrev_b32 v24, 16, v52
    v_and_b32 v25, 0xffff0000, v52
    v_lshlrev_b32 v26, 16, v53
    v_and_b32 v27, 0xffff0000, v53
    v_lshlrev_b32 v28, 16, v54
    v_and_b32 v29, 0xffff0000, v54
    v_lshlrev_b32 v30, 16, v55
    v_and_b32 v31, 0xffff0000, v55
    s_waitcnt vmcnt(18)
    v_lshlrev_b32 v32, 16, v56
    v_and_b32 v33, 0xffff0000, v56
    v_lshlrev_b32 v34, 16, v57
    v_and_b32 v35, 0xffff0000, v57
    v_lshlrev_b32 v36, 16, v58
    v_and_b32 v37, 0xffff0000, v58
    v_lshlrev_b32 v38, 16, v59
    v_and_b32 v39, 0xffff0000, v59
    s_waitcnt vmcnt(17)
    v_lshlrev_b32 v40, 16, v60
    v_and_b32 v41, 0xffff0000, v60
    v_lshlrev_b32 v42, 16, v61
    v_and_b32 v43, 0xffff0000, v61
    v_lshlrev_b32 v44, 16, v62
    v_and_b32 v45, 0xffff0000, v62
    v_lshlrev_b32 v46, 16, v63
    v_and_b32 v47, 0xffff0000, v63
    v_pk_add_f32 v[198:199], v[16:17], v[18:19]
    v_pk_add_f32 v[198:199], v[198:199], v[20:21]
    v_pk_add_f32 v[198:199], v[198:199], v[22:23]
    v_pk_add_f32 v[198:199], v[198:199], v[24:25]
    v_pk_add_f32 v[198:199], v[198:199], v[26:27]
    v_pk_add_f32 v[198:199], v[198:199], v[28:29]
    v_pk_add_f32 v[198:199], v[198:199], v[30:31]
    v_pk_add_f32 v[200:201], v[32:33], v[34:35]
    v_pk_add_f32 v[200:201], v[200:201], v[36:37]
    v_pk_add_f32 v[200:201], v[200:201], v[38:39]
    v_pk_add_f32 v[200:201], v[200:201], v[40:41]
    v_pk_add_f32 v[200:201], v[200:201], v[42:43]
    v_pk_add_f32 v[200:201], v[200:201], v[44:45]
    v_pk_add_f32 v[200:201], v[200:201], v[46:47]
    v_add_f32 v198, v198, v199
    v_add_f32 v200, v200, v201
    s_nop 0
    v_add_f32_dpp v198, v198, v198 row_shr:1 row_mask:0xf bank_mask:0xf
    v_add_f32_dpp v200, v200, v200 row_shr:1 row_mask:0xf bank_mask:0xf
    s_nop 0
    v_add_f32_dpp v198, v198, v198 row_shr:2 row_mask:0xf bank_mask:0xf
    v_add_f32_dpp v200, v200, v200 row_shr:2 row_mask:0xf bank_mask:0xf
    s_nop 0
    v_add_f32_dpp v198, v198, v198 row_shr:4 row_mask:0xf bank_mask:0xf
    v_add_f32_dpp v200, v200, v200 row_shr:4 row_mask:0xf bank_mask:0xf
    s_nop 0
    v_add_f32_dpp v198, v198, v198 row_shr:8 row_mask:0xf bank_mask:0xf
    v_add_f32_dpp v200, v200, v200 row_shr:8 row_mask:0xf bank_mask:0xf
    s_nop 0
    v_add_f32_dpp v198, v198, v198 row_bcast:15 row_mask:0xa bank_mask:0xf
    v_add_f32_dpp v200, v200, v200 row_bcast:15 row_mask:0xa bank_mask:0xf
    s_nop 0
    v_add_f32_dpp v198, v198, v198 row_bcast:31 row_mask:0xc bank_mask:0xf
    v_add_f32_dpp v200, v200, v200 row_bcast:31 row_mask:0xc bank_mask:0xf
    v_readlane_b32 s36, v198, 63
    v_readlane_b32 s38, v200, 63
    s_nop 0
    v_mov_b32 v198, s36
    v_mov_b32 v200, s38
    v_mul_f32 v198, 0x3a800000, v198
    v_mul_f32 v200, 0x3a800000, v200
    v_pk_add_f32 v[16:17], v[16:17], v[198:199] op_sel_hi:[1,0] neg_lo:[0,1] neg_hi:[0,1]
    v_pk_add_f32 v[18:19], v[18:19], v[198:199] op_sel_hi:[1,0] neg_lo:[0,1] neg_hi:[0,1]
    v_pk_add_f32 v[20:21], v[20:21], v[198:199] op_sel_hi:[1,0] neg_lo:[0,1] neg_hi:[0,1]
    v_pk_add_f32 v[22:23], v[22:23], v[198:199] op_sel_hi:[1,0] neg_lo:[0,1] neg_hi:[0,1]
    v_pk_add_f32 v[24:25], v[24:25], v[198:199] op_sel_hi:[1,0] neg_lo:[0,1] neg_hi:[0,1]
    v_pk_add_f32 v[26:27], v[26:27], v[198:199] op_sel_hi:[1,0] neg_lo:[0,1] neg_hi:[0,1]
    v_pk_add_f32 v[28:29], v[28:29], v[198:199] op_sel_hi:[1,0] neg_lo:[0,1] neg_hi:[0,1]
    v_pk_add_f32 v[30:31], v[30:31], v[198:199] op_sel_hi:[1,0] neg_lo:[0,1] neg_hi:[0,1]
    v_pk_add_f32 v[32:33], v[32:33], v[200:201] op_sel_hi:[1,0] neg_lo:[0,1] neg_hi:[0,1]
    v_pk_add_f32 v[34:35], v[34:35], v[200:201] op_sel_hi:[1,0] neg_lo:[0,1] neg_hi:[0,1]
    v_pk_add_f32 v[36:37], v[36:37], v[200:201] op_sel_hi:[1,0] neg_lo:[0,1] neg_hi:[0,1]
    v_pk_add_f32 v[38:39], v[38:39], v[200:201] op_sel_hi:[1,0] neg_lo:[0,1] neg_hi:[0,1]
    v_pk_add_f32 v[40:41], v[40:41], v[200:201] op_sel_hi:[1,0] neg_lo:[0,1] neg_hi:[0,1]
    v_pk_add_f32 v[42:43], v[42:43], v[200:201] op_sel_hi:[1,0] neg_lo:[0,1] neg_hi:[0,1]
    v_pk_add_f32 v[44:45], v[44:45], v[200:201] op_sel_hi:[1,0] neg_lo:[0,1] neg_hi:[0,1]
    v_pk_add_f32 v[46:47], v[46:47], v[200:201] op_sel_hi:[1,0] neg_lo:[0,1] neg_hi:[0,1]
    v_pk_mul_f32 v[202:203], v[16:17], v[16:17]
    v_pk_fma_f32 v[202:203], v[18:19], v[18:19], v[202:203]
    v_pk_fma_f32 v[202:203], v[20:21], v[20:21], v[202:203]
    v_pk_fma_f32 v[202:203], v[22:23], v[22:23], v[202:203]
    v_pk_fma_f32 v[202:203], v[24:25], v[24:25], v[202:203]
    v_pk_fma_f32 v[202:203], v[26:27], v[26:27], v[202:203]
    v_pk_fma_f32 v[202:203], v[28:29], v[28:29], v[202:203]
    v_pk_fma_f32 v[202:203], v[30:31], v[30:31], v[202:203]
    v_pk_mul_f32 v[204:205], v[32:33], v[32:33]
    v_pk_fma_f32 v[204:205], v[34:35], v[34:35], v[204:205]
    v_pk_fma_f32 v[204:205], v[36:37], v[36:37], v[204:205]
    v_pk_fma_f32 v[204:205], v[38:39], v[38:39], v[204:205]
    v_pk_fma_f32 v[204:205], v[40:41], v[40:41], v[204:205]
    v_pk_fma_f32 v[204:205], v[42:43], v[42:43], v[204:205]
    v_pk_fma_f32 v[204:205], v[44:45], v[44:45], v[204:205]
    v_pk_fma_f32 v[204:205], v[46:47], v[46:47], v[204:205]
    v_add_f32 v202, v202, v203
    v_add_f32 v204, v204, v205
    s_nop 0
    v_add_f32_dpp v202, v202, v202 row_shr:1 row_mask:0xf bank_mask:0xf
    v_add_f32_dpp v204, v204, v204 row_shr:1 row_mask:0xf bank_mask:0xf
    s_nop 0
    v_add_f32_dpp v202, v202, v202 row_shr:2 row_mask:0xf bank_mask:0xf
    v_add_f32_dpp v204, v204, v204 row_shr:2 row_mask:0xf bank_mask:0xf
    s_nop 0
    v_add_f32_dpp v202, v202, v202 row_shr:4 row_mask:0xf bank_mask:0xf
    v_add_f32_dpp v204, v204, v204 row_shr:4 row_mask:0xf bank_mask:0xf
    s_nop 0
    v_add_f32_dpp v202, v202, v202 row_shr:8 row_mask:0xf bank_mask:0xf
    v_add_f32_dpp v204, v204, v204 row_shr:8 row_mask:0xf bank_mask:0xf
    s_nop 0
    v_add_f32_dpp v202, v202, v202 row_bcast:15 row_mask:0xa bank_mask:0xf
    v_add_f32_dpp v204, v204, v204 row_bcast:15 row_mask:0xa bank_mask:0xf
    s_nop 0
    v_add_f32_dpp v202, v202, v202 row_bcast:31 row_mask:0xc bank_mask:0xf
    v_add_f32_dpp v204, v204, v204 row_bcast:31 row_mask:0xc bank_mask:0xf
    v_readlane_b32 s40, v202, 63
    v_readlane_b32 s42, v204, 63
    s_nop 0
    v_mov_b32 v202, s40
    v_mul_f32 v202, 0x3a800000, v202
    v_add_f32 v198, 0x3727c5ac, v202
    v_rsq_f32 v198, v198
    v_mov_b32 v204, s42
    v_mul_f32 v204, 0x3a800000, v204
    v_add_f32 v200, 0x3727c5ac, v204
    v_rsq_f32 v200, v200
    v_pk_mul_f32 v[16:17], v[16:17], v[198:199] op_sel_hi:[1,0]
    v_pk_mul_f32 v[18:19], v[18:19], v[198:199] op_sel_hi:[1,0]
    v_pk_mul_f32 v[20:21], v[20:21], v[198:199] op_sel_hi:[1,0]
    v_pk_mul_f32 v[22:23], v[22:23], v[198:199] op_sel_hi:[1,0]
    v_pk_mul_f32 v[24:25], v[24:25], v[198:199] op_sel_hi:[1,0]
    v_pk_mul_f32 v[26:27], v[26:27], v[198:199] op_sel_hi:[1,0]
    v_pk_mul_f32 v[28:29], v[28:29], v[198:199] op_sel_hi:[1,0]
    v_pk_mul_f32 v[30:31], v[30:31], v[198:199] op_sel_hi:[1,0]
    v_pk_mul_f32 v[32:33], v[32:33], v[200:201] op_sel_hi:[1,0]
    v_pk_mul_f32 v[34:35], v[34:35], v[200:201] op_sel_hi:[1,0]
    v_pk_mul_f32 v[36:37], v[36:37], v[200:201] op_sel_hi:[1,0]
    v_pk_mul_f32 v[38:39], v[38:39], v[200:201] op_sel_hi:[1,0]
    v_pk_mul_f32 v[40:41], v[40:41], v[200:201] op_sel_hi:[1,0]
    v_pk_mul_f32 v[42:43], v[42:43], v[200:201] op_sel_hi:[1,0]
    v_pk_mul_f32 v[44:45], v[44:45], v[200:201] op_sel_hi:[1,0]
    v_pk_mul_f32 v[46:47], v[46:47], v[200:201] op_sel_hi:[1,0]
    v_cvt_pk_bf16_f32 v48, v16, v17
    v_cvt_pk_bf16_f32 v49, v18, v19
    v_cvt_pk_bf16_f32 v50, v20, v21
    v_cvt_pk_bf16_f32 v51, v22, v23
    v_cvt_pk_bf16_f32 v52, v24, v25
    v_cvt_pk_bf16_f32 v53, v26, v27
    v_cvt_pk_bf16_f32 v54, v28, v29
    v_cvt_pk_bf16_f32 v55, v30, v31
    ds_write_b128 v189, v[48:51] offset:0
    ds_write_b128 v189, v[52:55] offset:1024
    v_cvt_pk_bf16_f32 v56, v32, v33
    v_cvt_pk_bf16_f32 v57, v34, v35
    v_cvt_pk_bf16_f32 v58, v36, v37
    v_cvt_pk_bf16_f32 v59, v38, v39
    v_cvt_pk_bf16_f32 v60, v40, v41
    v_cvt_pk_bf16_f32 v61, v42, v43
    v_cvt_pk_bf16_f32 v62, v44, v45
    v_cvt_pk_bf16_f32 v63, v46, v47
    ds_write_b128 v189, v[56:59] offset:2048
    ds_write_b128 v189, v[60:63] offset:3072
    s_waitcnt lgkmcnt(0)
    ds_read_b64_tr_b16 v[48:49], v190 offset:0
    ds_read_b64_tr_b16 v[50:51], v190 offset:256
    ds_read_b64_tr_b16 v[52:53], v190 offset:1024
    ds_read_b64_tr_b16 v[54:55], v190 offset:1280
    ds_read_b64_tr_b16 v[56:57], v190 offset:2048
    ds_read_b64_tr_b16 v[58:59], v190 offset:2304
    ds_read_b64_tr_b16 v[60:61], v190 offset:3072
    ds_read_b64_tr_b16 v[62:63], v190 offset:3328
    s_waitcnt lgkmcnt(6)
    v_mfma_f32_32x32x16_bf16 v[16:31], v[48:51], v[124:127], 0
    v_mfma_f32_32x32x16_bf16 v[206:221], v[48:51], v[132:135], 0
    s_waitcnt lgkmcnt(4)
    v_mfma_f32_32x32x16_bf16 v[16:31], v[52:55], v[128:131], v[16:31]
    v_mfma_f32_32x32x16_bf16 v[206:221], v[52:55], v[136:139], v[206:221]
    s_waitcnt lgkmcnt(2)
    v_mfma_f32_32x32x16_bf16 v[32:47], v[56:59], v[124:127], 0
    v_mfma_f32_32x32x16_bf16 v[222:237], v[56:59], v[132:135], 0
    s_waitcnt lgkmcnt(0)
    v_mfma_f32_32x32x16_bf16 v[32:47], v[60:63], v[128:131], v[32:47]
    v_mfma_f32_32x32x16_bf16 v[222:237], v[60:63], v[136:139], v[222:237]
    s_nop 5
    v_pk_mul_f32 v[92:93], v[206:207], v[156:157]
    v_pk_mul_f32 v[94:95], v[208:209], v[158:159]
    v_pk_mul_f32 v[96:97], v[210:211], v[160:161]
    v_pk_mul_f32 v[98:99], v[212:213], v[162:163]
    v_pk_mul_f32 v[100:101], v[214:215], v[164:165]
    v_pk_mul_f32 v[102:103], v[216:217], v[166:167]
    v_pk_mul_f32 v[104:105], v[218:219], v[168:169]
    v_pk_mul_f32 v[106:107], v[220:221], v[170:171]
    v_pk_mul_f32 v[206:207], v[206:207], v[140:141]
    v_pk_mul_f32 v[208:209], v[208:209], v[142:143]
    v_pk_mul_f32 v[210:211], v[210:211], v[144:145]
    v_pk_mul_f32 v[212:213], v[212:213], v[146:147]
    v_pk_mul_f32 v[214:215], v[214:215], v[148:149]
    v_pk_mul_f32 v[216:217], v[216:217], v[150:151]
    v_pk_mul_f32 v[218:219], v[218:219], v[152:153]
    v_pk_mul_f32 v[220:221], v[220:221], v[154:155]
    v_pk_fma_f32 v[206:207], v[16:17], v[156:157], v[206:207] neg_lo:[1,0,0] neg_hi:[1,0,0]
    v_pk_fma_f32 v[208:209], v[18:19], v[158:159], v[208:209] neg_lo:[1,0,0] neg_hi:[1,0,0]
    v_pk_fma_f32 v[210:211], v[20:21], v[160:161], v[210:211] neg_lo:[1,0,0] neg_hi:[1,0,0]
    v_pk_fma_f32 v[212:213], v[22:23], v[162:163], v[212:213] neg_lo:[1,0,0] neg_hi:[1,0,0]
    v_pk_fma_f32 v[214:215], v[24:25], v[164:165], v[214:215] neg_lo:[1,0,0] neg_hi:[1,0,0]
    v_pk_fma_f32 v[216:217], v[26:27], v[166:167], v[216:217] neg_lo:[1,0,0] neg_hi:[1,0,0]
    v_pk_fma_f32 v[218:219], v[28:29], v[168:169], v[218:219] neg_lo:[1,0,0] neg_hi:[1,0,0]
    v_pk_fma_f32 v[220:221], v[30:31], v[170:171], v[220:221] neg_lo:[1,0,0] neg_hi:[1,0,0]
    v_pk_fma_f32 v[16:17], v[16:17], v[140:141], v[92:93]
    v_pk_fma_f32 v[18:19], v[18:19], v[142:143], v[94:95]
    v_pk_fma_f32 v[20:21], v[20:21], v[144:145], v[96:97]
    v_pk_fma_f32 v[22:23], v[22:23], v[146:147], v[98:99]
    v_pk_fma_f32 v[24:25], v[24:25], v[148:149], v[100:101]
    v_pk_fma_f32 v[26:27], v[26:27], v[150:151], v[102:103]
    v_pk_fma_f32 v[28:29], v[28:29], v[152:153], v[104:105]
    v_pk_fma_f32 v[30:31], v[30:31], v[154:155], v[106:107]
    v_cvt_pk_bf16_f32 v108, v16, v206
    v_cvt_pk_bf16_f32 v109, v17, v207
    v_cvt_pk_bf16_f32 v110, v18, v208
    v_cvt_pk_bf16_f32 v111, v19, v209
    v_cvt_pk_bf16_f32 v112, v20, v210
    v_cvt_pk_bf16_f32 v113, v21, v211
    v_cvt_pk_bf16_f32 v114, v22, v212
    v_cvt_pk_bf16_f32 v115, v23, v213
    v_cvt_pk_bf16_f32 v116, v24, v214
    v_cvt_pk_bf16_f32 v117, v25, v215
    v_cvt_pk_bf16_f32 v118, v26, v216
    v_cvt_pk_bf16_f32 v119, v27, v217
    v_cvt_pk_bf16_f32 v120, v28, v218
    v_cvt_pk_bf16_f32 v121, v29, v219
    v_cvt_pk_bf16_f32 v122, v30, v220
    v_cvt_pk_bf16_f32 v123, v31, v221
    v_mfma_f32_32x32x16_bf16 v[16:31], v[172:175], v[108:111], 0
    v_mfma_f32_32x32x16_bf16 v[16:31], v[176:179], v[112:115], v[16:31]
    v_mfma_f32_32x32x16_bf16 v[16:31], v[180:183], v[116:119], v[16:31]
    v_mfma_f32_32x32x16_bf16 v[16:31], v[184:187], v[120:123], v[16:31]
    v_pk_mul_f32 v[92:93], v[222:223], v[156:157]
    v_pk_mul_f32 v[94:95], v[224:225], v[158:159]
    v_pk_mul_f32 v[96:97], v[226:227], v[160:161]
    v_pk_mul_f32 v[98:99], v[228:229], v[162:163]
    v_pk_mul_f32 v[100:101], v[230:231], v[164:165]
    v_pk_mul_f32 v[102:103], v[232:233], v[166:167]
    v_pk_mul_f32 v[104:105], v[234:235], v[168:169]
    v_pk_mul_f32 v[106:107], v[236:237], v[170:171]
    v_pk_mul_f32 v[222:223], v[222:223], v[140:141]
    v_pk_mul_f32 v[224:225], v[224:225], v[142:143]
    v_pk_mul_f32 v[226:227], v[226:227], v[144:145]
    v_pk_mul_f32 v[228:229], v[228:229], v[146:147]
    v_pk_mul_f32 v[230:231], v[230:231], v[148:149]
    v_pk_mul_f32 v[232:233], v[232:233], v[150:151]
    v_pk_mul_f32 v[234:235], v[234:235], v[152:153]
    v_pk_mul_f32 v[236:237], v[236:237], v[154:155]
    v_pk_fma_f32 v[222:223], v[32:33], v[156:157], v[222:223] neg_lo:[1,0,0] neg_hi:[1,0,0]
    v_pk_fma_f32 v[224:225], v[34:35], v[158:159], v[224:225] neg_lo:[1,0,0] neg_hi:[1,0,0]
    v_pk_fma_f32 v[226:227], v[36:37], v[160:161], v[226:227] neg_lo:[1,0,0] neg_hi:[1,0,0]
    v_pk_fma_f32 v[228:229], v[38:39], v[162:163], v[228:229] neg_lo:[1,0,0] neg_hi:[1,0,0]
    v_pk_fma_f32 v[230:231], v[40:41], v[164:165], v[230:231] neg_lo:[1,0,0] neg_hi:[1,0,0]
    v_pk_fma_f32 v[232:233], v[42:43], v[166:167], v[232:233] neg_lo:[1,0,0] neg_hi:[1,0,0]
    v_pk_fma_f32 v[234:235], v[44:45], v[168:169], v[234:235] neg_lo:[1,0,0] neg_hi:[1,0,0]
    v_pk_fma_f32 v[236:237], v[46:47], v[170:171], v[236:237] neg_lo:[1,0,0] neg_hi:[1,0,0]
    v_pk_fma_f32 v[32:33], v[32:33], v[140:141], v[92:93]
    v_pk_fma_f32 v[34:35], v[34:35], v[142:143], v[94:95]
    v_pk_fma_f32 v[36:37], v[36:37], v[144:145], v[96:97]
    v_pk_fma_f32 v[38:39], v[38:39], v[146:147], v[98:99]
    v_pk_fma_f32 v[40:41], v[40:41], v[148:149], v[100:101]
    v_pk_fma_f32 v[42:43], v[42:43], v[150:151], v[102:103]
    v_pk_fma_f32 v[44:45], v[44:45], v[152:153], v[104:105]
    v_pk_fma_f32 v[46:47], v[46:47], v[154:155], v[106:107]
    v_cvt_pk_bf16_f32 v48, v32, v222
    v_cvt_pk_bf16_f32 v49, v33, v223
    v_cvt_pk_bf16_f32 v50, v34, v224
    v_cvt_pk_bf16_f32 v51, v35, v225
    v_cvt_pk_bf16_f32 v52, v36, v226
    v_cvt_pk_bf16_f32 v53, v37, v227
    v_cvt_pk_bf16_f32 v54, v38, v228
    v_cvt_pk_bf16_f32 v55, v39, v229
    v_cvt_pk_bf16_f32 v56, v40, v230
    v_cvt_pk_bf16_f32 v57, v41, v231
    v_cvt_pk_bf16_f32 v58, v42, v232
    v_cvt_pk_bf16_f32 v59, v43, v233
    v_cvt_pk_bf16_f32 v60, v44, v234
    v_cvt_pk_bf16_f32 v61, v45, v235
    v_cvt_pk_bf16_f32 v62, v46, v236
    v_cvt_pk_bf16_f32 v63, v47, v237
    v_mfma_f32_32x32x16_bf16 v[32:47], v[172:175], v[48:51], 0
    v_mfma_f32_32x32x16_bf16 v[32:47], v[176:179], v[52:55], v[32:47]
    v_mfma_f32_32x32x16_bf16 v[32:47], v[180:183], v[56:59], v[32:47]
    v_mfma_f32_32x32x16_bf16 v[32:47], v[184:187], v[60:63], v[32:47]
    v_mul_f32 v16, v188, v16
    v_mul_f32 v17, v188, v17
    v_cvt_pk_bf16_f32 v206, v16, v17
    v_cvt_pk_bf16_f32 v208, v18, v19
    v_cvt_pk_bf16_f32 v210, v20, v21
    v_cvt_pk_bf16_f32 v212, v22, v23
    v_cvt_pk_bf16_f32 v214, v24, v25
    v_cvt_pk_bf16_f32 v216, v26, v27
    v_cvt_pk_bf16_f32 v218, v28, v29
    v_cvt_pk_bf16_f32 v220, v30, v31
    s_nop 1
    v_mul_f32 v32, v188, v32
    v_mul_f32 v33, v188, v33
    v_cvt_pk_bf16_f32 v207, v32, v33
    v_cvt_pk_bf16_f32 v209, v34, v35
    v_cvt_pk_bf16_f32 v211, v36, v37
    v_cvt_pk_bf16_f32 v213, v38, v39
    v_cvt_pk_bf16_f32 v215, v40, v41
    v_cvt_pk_bf16_f32 v217, v42, v43
    v_cvt_pk_bf16_f32 v219, v44, v45
    v_cvt_pk_bf16_f32 v221, v46, v47
    ds_write_b64 v191, v[206:207] offset:0
    ds_write_b64 v191, v[208:209] offset:1024
    ds_write_b64 v191, v[210:211] offset:4096
    ds_write_b64 v191, v[212:213] offset:5120
    ds_write_b64 v191, v[214:215] offset:8192
    ds_write_b64 v191, v[216:217] offset:9216
    ds_write_b64 v191, v[218:219] offset:12288
    ds_write_b64 v191, v[220:221] offset:13312
    s_mov_b32 s33, 0x05040100
    s_mov_b32 s34, 0x07060302
    s_waitcnt vmcnt(15)
    v_perm_b32 v222, v72, v64, s33
    v_perm_b32 v226, v72, v64, s34
    v_perm_b32 v230, v73, v65, s33
    v_perm_b32 v234, v73, v65, s34
    s_waitcnt vmcnt(7)
    v_xor_b32 v84, 0x8000, v84
    v_lshl_or_b32 v80, v84, 16, v80
    v_bfi_b32 v222, v88, v80, v222
    v_perm_b32 v223, v74, v66, s33
    v_perm_b32 v227, v74, v66, s34
    v_perm_b32 v231, v75, v67, s33
    v_perm_b32 v235, v75, v67, s34
    s_waitcnt vmcnt(5)
    v_xor_b32 v85, 0x8000, v85
    v_lshl_or_b32 v81, v85, 16, v81
    v_bfi_b32 v223, v88, v81, v223
    v_perm_b32 v224, v76, v68, s33
    v_perm_b32 v228, v76, v68, s34
    v_perm_b32 v232, v77, v69, s33
    v_perm_b32 v236, v77, v69, s34
    s_waitcnt vmcnt(3)
    v_xor_b32 v86, 0x8000, v86
    v_lshl_or_b32 v82, v86, 16, v82
    v_bfi_b32 v224, v88, v82, v224
    v_perm_b32 v225, v78, v70, s33
    v_perm_b32 v229, v78, v70, s34
    v_perm_b32 v233, v79, v71, s33
    v_perm_b32 v237, v79, v71, s34
    s_waitcnt vmcnt(1)
    v_xor_b32 v87, 0x8000, v87
    v_lshl_or_b32 v83, v87, 16, v83
    v_bfi_b32 v225, v88, v83, v225
    ds_write_b128 v195, v[222:225]
    v_xor_b32 v2, 32, v195
    ds_write_b128 v2, v[226:229]
    v_xor_b32 v2, 64, v195
    ds_write_b128 v2, v[230:233]
    v_xor_b32 v2, 96, v195
    ds_write_b128 v2, v[234:237]
    s_waitcnt lgkmcnt(0)
    s_barrier
    ds_read_b128 v[108:111], v192 offset:0
    ds_read_b128 v[112:115], v192 offset:4096
    ds_read_b128 v[116:119], v192 offset:8192
    ds_read_b128 v[120:123], v192 offset:12288
    ds_read_b128 v[48:51], v192 offset:32768
    ds_read_b128 v[52:55], v192 offset:36864
    ds_read_b128 v[56:59], v192 offset:40960
    ds_read_b128 v[60:63], v192 offset:45056
    s_mov_b32 s33, 0
    s_waitcnt lgkmcnt(7)
    buffer_store_dwordx4 v[108:111], v193, s[24:27], s33 offen sc1
    s_waitcnt lgkmcnt(3)
    buffer_store_dwordx4 v[48:51], v194, s[28:31], s33 offen sc1
    s_add_u32 s33, s33, 1048576
    buffer_store_dwordx4 v[112:115], v193, s[24:27], s33 offen sc1
    s_waitcnt lgkmcnt(2)
    buffer_store_dwordx4 v[52:55], v194, s[28:31], s33 offen sc1
    s_add_u32 s33, s33, 1048576
    buffer_store_dwordx4 v[116:119], v193, s[24:27], s33 offen sc1
    s_waitcnt lgkmcnt(1)
    buffer_store_dwordx4 v[56:59], v194, s[28:31], s33 offen sc1
    s_add_u32 s33, s33, 1048576
    buffer_store_dwordx4 v[120:123], v193, s[24:27], s33 offen sc1
    s_waitcnt lgkmcnt(0)
    buffer_store_dwordx4 v[60:63], v194, s[28:31], s33 offen sc1
    s_add_u32 s48, s6, 47448064
    s_addc_u32 s49, s7, 0
    s_mov_b32 s50, 32768
    s_mov_b32 s51, 0x20000
    v_mov_b32 v92, 0
    v_mov_b32 v93, 0
    v_mov_b32 v94, 0
    v_mov_b32 v95, 0
    s_lshl_b32 s33, s2, 7
    v_lshlrev_b32 v2, 4, v0
    v_cmp_gt_u32 vcc, 8, v0
    v_mov_b32 v3, 0x40000000
    s_nop 0
    v_cndmask_b32 v2, v3, v2, vcc
    buffer_store_dwordx4 v[92:95], v2, s[48:51], s33 offen sc1
    s_add_u32 s52, s6, 47513600
    s_addc_u32 s53, s7, 0
    s_mov_b32 s54, 32768
    s_mov_b32 s55, 0x20000
    s_lshl_b32 s33, s2, 8
    buffer_store_dwordx4 v[92:95], v2, s[52:55], s33 offen sc1
    s_waitcnt vmcnt(0)
    s_barrier
    s_and_b32 s90, s2, 15
    s_lshl_b32 s90, s90, 4
    s_mov_b32 s96, s82
    s_mov_b32 s97, s83
    s_mov_b32 s98, 256
    s_mov_b32 s99, 0x20000
    s_cmp_eq_u32 s32, 0
    s_cselect_b32 s98, s98, 0
    v_mov_b32 v2, s90
    v_mov_b32 v3, 1
    s_mov_b64 exec, 1
    buffer_atomic_add v3, v2, s[96:99], 0 offen sc1
    s_mov_b64 exec, -1
L_k2_kernel_entry:
    v_mbcnt_lo_u32_b32 v0, -1, 0
    v_mbcnt_hi_u32_b32 v0, -1, v0
    v_lshl_add_u32 v0, s32, 6, v0
    s_mov_b64 s[6:7], s[84:85]
    s_mov_b64 s[4:5], s[76:77]
    s_mov_b64 s[46:47], s[74:75]
    s_mov_b64 s[44:45], s[72:73]
    v_and_b32 v1, 63, v0
    v_and_b32 v6, 15, v1
    v_lshrrev_b32 v7, 4, v1
    s_lshr_b32 s33, s2, 4
    s_lshl_b32 s33, s33, 3
    s_and_b32 s34, s2, 7
    s_add_u32 s33, s33, s34
    s_bfe_u32 s34, s2, 0x10003
    s_lshl_b32 s35, s33, 1
    s_add_u32 s35, s35, s34
    s_mul_i32 s33, s33, 32768
    s_lshl_b32 s34, s34, 6
    s_add_u32 s33, s33, s34
    v_lshrrev_b32 v2, 2, v1
    v_lshrrev_b32 v3, 4, v1
    v_xor_b32 v3, v3, v1
    v_and_b32 v3, 3, v3
    v_lshlrev_b32 v2, 7, v2
    v_lshl_add_u32 v2, v3, 4, v2
    s_lshl_b32 s34, s32, 13
    s_add_u32 s34, s34, s33
    v_add_u32 v8, s34, v2
    s_waitcnt vmcnt(0)
    s_add_u32 s12, s6, 73400320
    s_addc_u32 s13, s7, 0
    s_mov_b32 s14, 4194304
    s_mov_b32 s15, 0x20000
    s_add_u32 s16, s6, 78643200
    s_addc_u32 s17, s7, 0
    s_mov_b32 s18, 4194304
    s_mov_b32 s19, 0x20000
    s_getpc_b64 s[60:61]
L_pc3:
    s_add_u32 s60, s60, L_k3_kernel_entry-L_pc3
    s_addc_u32 s61, s61, 0
    s_lshr_b32 s62, s2, 3
    s_and_b32 s62, s62, 7
    s_lshl_b32 s62, s62, 2
    s_add_u32 s62, s62, s32
    s_mul_i32 s62, s62, 1024
    v_and_b32 v4, 63, v0
    v_lshlrev_b32 v4, 7, v4
    v_add_u32 v4, s62, v4
    v_min_u32 v4, L_g1_kernel_entry-L_k3_kernel_entry-4, v4
    s_mov_b64 exec, 255
    global_load_dword v10, v4, s[60:61]
    s_mov_b64 exec, -1
    s_add_u32 s20, s6, 83886080
    s_addc_u32 s21, s7, 0
    s_mov_b32 s22, 4194304
    s_mov_b32 s23, 0x20000
    s_lshl_b32 s33, s32, 4
    v_add_u32 v44, s33, v6
    v_lshlrev_b32 v45, 2, v7
    v_add_u32 v46, 32, v45
    v_add_u32 v28, 0, v45
    v_mul_u32_u24 v28, v28, v44
    v_and_b32 v28, 63, v28
    v_cvt_f32_u32 v28, v28
    v_mul_f32 v28, 0x3c800000, v28
    v_cos_f32 v29, v28
    v_sin_f32 v30, v28
    s_nop 0
    v_cvt_pk_bf16_f32 v52, v29, v30
    v_cvt_pk_bf16_f32 v68, -v30, v29
    v_add_u32 v31, 1, v45
    v_mul_u32_u24 v31, v31, v44
    v_and_b32 v31, 63, v31
    v_cvt_f32_u32 v31, v31
    v_mul_f32 v31, 0x3c800000, v31
    v_cos_f32 v32, v31
    v_sin_f32 v33, v31
    s_nop 0
    v_cvt_pk_bf16_f32 v53, v32, v33
    v_cvt_pk_bf16_f32 v69, -v33, v32
    v_add_u32 v34, 2, v45
    v_mul_u32_u24 v34, v34, v44
    v_and_b32 v34, 63, v34
    v_cvt_f32_u32 v34, v34
    v_mul_f32 v34, 0x3c800000, v34
    v_cos_f32 v35, v34
    v_sin_f32 v36, v34
    s_nop 0
    v_cvt_pk_bf16_f32 v54, v35, v36
    v_cvt_pk_bf16_f32 v70, -v36, v35
    v_add_u32 v37, 3, v45
    v_mul_u32_u24 v37, v37, v44
    v_and_b32 v37, 63, v37
    v_cvt_f32_u32 v37, v37
    v_mul_f32 v37, 0x3c800000, v37
    v_cos_f32 v38, v37
    v_sin_f32 v39, v37
    s_nop 0
    v_cvt_pk_bf16_f32 v55, v38, v39
    v_cvt_pk_bf16_f32 v71, -v39, v38
    v_add_u32 v28, 16, v45
    v_mul_u32_u24 v28, v28, v44
    v_and_b32 v28, 63, v28
    v_cvt_f32_u32 v28, v28
    v_mul_f32 v28, 0x3c800000, v28
    v_cos_f32 v29, v28
    v_sin_f32 v30, v28
    s_nop 0
    v_cvt_pk_bf16_f32 v56, v29, v30
    v_cvt_pk_bf16_f32 v72, -v30, v29
    v_add_u32 v31, 17, v45
    v_mul_u32_u24 v31, v31, v44
    v_and_b32 v31, 63, v31
    v_cvt_f32_u32 v31, v31
    v_mul_f32 v31, 0x3c800000, v31
    v_cos_f32 v32, v31
    v_sin_f32 v33, v31
    s_nop 0
    v_cvt_pk_bf16_f32 v57, v32, v33
    v_cvt_pk_bf16_f32 v73, -v33, v32
    v_add_u32 v34, 18, v45
    v_mul_u32_u24 v34, v34, v44
    v_and_b32 v34, 63, v34
    v_cvt_f32_u32 v34, v34
    v_mul_f32 v34, 0x3c800000, v34
    v_cos_f32 v35, v34
    v_sin_f32 v36, v34
    s_nop 0
    v_cvt_pk_bf16_f32 v58, v35, v36
    v_cvt_pk_bf16_f32 v74, -v36, v35
    v_add_u32 v37, 19, v45
    v_mul_u32_u24 v37, v37, v44
    v_and_b32 v37, 63, v37
    v_cvt_f32_u32 v37, v37
    v_mul_f32 v37, 0x3c800000, v37
    v_cos_f32 v38, v37
    v_sin_f32 v39, v37
    s_nop 0
    v_cvt_pk_bf16_f32 v59, v38, v39
    v_cvt_pk_bf16_f32 v75, -v39, v38
    v_add_u32 v28, 32, v45
    v_mul_u32_u24 v28, v28, v44
    v_and_b32 v28, 63, v28
    v_cvt_f32_u32 v28, v28
    v_mul_f32 v28, 0x3c800000, v28
    v_cos_f32 v29, v28
    v_sin_f32 v30, v28
    s_nop 0
    v_cvt_pk_bf16_f32 v60, v29, v30
    v_cvt_pk_bf16_f32 v76, -v30, v29
    v_add_u32 v31, 33, v45
    v_mul_u32_u24 v31, v31, v44
    v_and_b32 v31, 63, v31
    v_cvt_f32_u32 v31, v31
    v_mul_f32 v31, 0x3c800000, v31
    v_cos_f32 v32, v31
    v_sin_f32 v33, v31
    s_nop 0
    v_cvt_pk_bf16_f32 v61, v32, v33
    v_cvt_pk_bf16_f32 v77, -v33, v32
    v_add_u32 v34, 34, v45
    v_mul_u32_u24 v34, v34, v44
    v_and_b32 v34, 63, v34
    v_cvt_f32_u32 v34, v34
    v_mul_f32 v34, 0x3c800000, v34
    v_cos_f32 v35, v34
    v_sin_f32 v36, v34
    s_nop 0
    v_cvt_pk_bf16_f32 v62, v35, v36
    v_cvt_pk_bf16_f32 v78, -v36, v35
    v_add_u32 v37, 35, v45
    v_mul_u32_u24 v37, v37, v44
    v_and_b32 v37, 63, v37
    v_cvt_f32_u32 v37, v37
    v_mul_f32 v37, 0x3c800000, v37
    v_cos_f32 v38, v37
    v_sin_f32 v39, v37
    s_nop 0
    v_cvt_pk_bf16_f32 v63, v38, v39
    v_cvt_pk_bf16_f32 v79, -v39, v38
    v_add_u32 v28, 48, v45
    v_mul_u32_u24 v28, v28, v44
    v_and_b32 v28, 63, v28
    v_cvt_f32_u32 v28, v28
    v_mul_f32 v28, 0x3c800000, v28
    v_cos_f32 v29, v28
    v_sin_f32 v30, v28
    s_nop 0
    v_cvt_pk_bf16_f32 v64, v29, v30
    v_cvt_pk_bf16_f32 v80, -v30, v29
    v_add_u32 v31, 49, v45
    v_mul_u32_u24 v31, v31, v44
    v_and_b32 v31, 63, v31
    v_cvt_f32_u32 v31, v31
    v_mul_f32 v31, 0x3c800000, v31
    v_cos_f32 v32, v31
    v_sin_f32 v33, v31
    s_nop 0
    v_cvt_pk_bf16_f32 v65, v32, v33
    v_cvt_pk_bf16_f32 v81, -v33, v32
    v_add_u32 v34, 50, v45
    v_mul_u32_u24 v34, v34, v44
    v_and_b32 v34, 63, v34
    v_cvt_f32_u32 v34, v34
    v_mul_f32 v34, 0x3c800000, v34
    v_cos_f32 v35, v34
    v_sin_f32 v36, v34
    s_nop 0
    v_cvt_pk_bf16_f32 v66, v35, v36
    v_cvt_pk_bf16_f32 v82, -v36, v35
    v_add_u32 v37, 51, v45
    v_mul_u32_u24 v37, v37, v44
    v_and_b32 v37, 63, v37
    v_cvt_f32_u32 v37, v37
    v_mul_f32 v37, 0x3c800000, v37
    v_cos_f32 v38, v37
    v_sin_f32 v39, v37
    s_nop 0
    v_cvt_pk_bf16_f32 v67, v38, v39
    v_cvt_pk_bf16_f32 v83, -v39, v38
    v_add_u32 v28, 0, v45
    v_mul_u32_u24 v28, v28, v44
    v_and_b32 v28, 2047, v28
    v_cvt_f32_u32 v28, v28
    v_mul_f32 v28, 0x3a000000, v28
    v_cos_f32 v84, v28
    v_sin_f32 v92, v28
    v_add_u32 v29, 1, v45
    v_mul_u32_u24 v29, v29, v44
    v_and_b32 v29, 2047, v29
    v_cvt_f32_u32 v29, v29
    v_mul_f32 v29, 0x3a000000, v29
    v_cos_f32 v85, v29
    v_sin_f32 v93, v29
    v_add_u32 v30, 2, v45
    v_mul_u32_u24 v30, v30, v44
    v_and_b32 v30, 2047, v30
    v_cvt_f32_u32 v30, v30
    v_mul_f32 v30, 0x3a000000, v30
    v_cos_f32 v86, v30
    v_sin_f32 v94, v30
    v_add_u32 v31, 3, v45
    v_mul_u32_u24 v31, v31, v44
    v_and_b32 v31, 2047, v31
    v_cvt_f32_u32 v31, v31
    v_mul_f32 v31, 0x3a000000, v31
    v_cos_f32 v87, v31
    v_sin_f32 v95, v31
    v_add_u32 v28, 16, v45
    v_mul_u32_u24 v28, v28, v44
    v_and_b32 v28, 2047, v28
    v_cvt_f32_u32 v28, v28
    v_mul_f32 v28, 0x3a000000, v28
    v_cos_f32 v88, v28
    v_sin_f32 v96, v28
    v_add_u32 v29, 17, v45
    v_mul_u32_u24 v29, v29, v44
    v_and_b32 v29, 2047, v29
    v_cvt_f32_u32 v29, v29
    v_mul_f32 v29, 0x3a000000, v29
    v_cos_f32 v89, v29
    v_sin_f32 v97, v29
    v_add_u32 v30, 18, v45
    v_mul_u32_u24 v30, v30, v44
    v_and_b32 v30, 2047, v30
    v_cvt_f32_u32 v30, v30
    v_mul_f32 v30, 0x3a000000, v30
    v_cos_f32 v90, v30
    v_sin_f32 v98, v30
    v_add_u32 v31, 19, v45
    v_mul_u32_u24 v31, v31, v44
    v_and_b32 v31, 2047, v31
    v_cvt_f32_u32 v31, v31
    v_mul_f32 v31, 0x3a000000, v31
    v_cos_f32 v91, v31
    v_sin_f32 v99, v31
    v_add_u32 v28, 0, v45
    v_mul_u32_u24 v28, v28, v6
    v_and_b32 v28, 31, v28
    v_cvt_f32_u32 v28, v28
    v_mul_f32 v28, 0x3d000000, v28
    v_cos_f32 v29, v28
    v_sin_f32 v30, v28
    s_nop 0
    v_cvt_pk_bf16_f32 v100, v29, v30
    v_cvt_pk_bf16_f32 v116, -v30, v29
    v_add_u32 v31, 1, v45
    v_mul_u32_u24 v31, v31, v6
    v_and_b32 v31, 31, v31
    v_cvt_f32_u32 v31, v31
    v_mul_f32 v31, 0x3d000000, v31
    v_cos_f32 v32, v31
    v_sin_f32 v33, v31
    s_nop 0
    v_cvt_pk_bf16_f32 v101, v32, v33
    v_cvt_pk_bf16_f32 v117, -v33, v32
    v_add_u32 v34, 2, v45
    v_mul_u32_u24 v34, v34, v6
    v_and_b32 v34, 31, v34
    v_cvt_f32_u32 v34, v34
    v_mul_f32 v34, 0x3d000000, v34
    v_cos_f32 v35, v34
    v_sin_f32 v36, v34
    s_nop 0
    v_cvt_pk_bf16_f32 v102, v35, v36
    v_cvt_pk_bf16_f32 v118, -v36, v35
    v_add_u32 v37, 3, v45
    v_mul_u32_u24 v37, v37, v6
    v_and_b32 v37, 31, v37
    v_cvt_f32_u32 v37, v37
    v_mul_f32 v37, 0x3d000000, v37
    v_cos_f32 v38, v37
    v_sin_f32 v39, v37
    s_nop 0
    v_cvt_pk_bf16_f32 v103, v38, v39
    v_cvt_pk_bf16_f32 v119, -v39, v38
    v_add_u32 v28, 16, v45
    v_mul_u32_u24 v28, v28, v6
    v_and_b32 v28, 31, v28
    v_cvt_f32_u32 v28, v28
    v_mul_f32 v28, 0x3d000000, v28
    v_cos_f32 v29, v28
    v_sin_f32 v30, v28
    s_nop 0
    v_cvt_pk_bf16_f32 v104, v29, v30
    v_cvt_pk_bf16_f32 v120, -v30, v29
    v_add_u32 v31, 17, v45
    v_mul_u32_u24 v31, v31, v6
    v_and_b32 v31, 31, v31
    v_cvt_f32_u32 v31, v31
    v_mul_f32 v31, 0x3d000000, v31
    v_cos_f32 v32, v31
    v_sin_f32 v33, v31
    s_nop 0
    v_cvt_pk_bf16_f32 v105, v32, v33
    v_cvt_pk_bf16_f32 v121, -v33, v32
    v_add_u32 v34, 18, v45
    v_mul_u32_u24 v34, v34, v6
    v_and_b32 v34, 31, v34
    v_cvt_f32_u32 v34, v34
    v_mul_f32 v34, 0x3d000000, v34
    v_cos_f32 v35, v34
    v_sin_f32 v36, v34
    s_nop 0
    v_cvt_pk_bf16_f32 v106, v35, v36
    v_cvt_pk_bf16_f32 v122, -v36, v35
    v_add_u32 v37, 19, v45
    v_mul_u32_u24 v37, v37, v6
    v_and_b32 v37, 31, v37
    v_cvt_f32_u32 v37, v37
    v_mul_f32 v37, 0x3d000000, v37
    v_cos_f32 v38, v37
    v_sin_f32 v39, v37
    s_nop 0
    v_cvt_pk_bf16_f32 v107, v38, v39
    v_cvt_pk_bf16_f32 v123, -v39, v38
    v_add_u32 v2, 16, v6
    v_add_u32 v28, 0, v45
    v_mul_u32_u24 v28, v28, v2
    v_and_b32 v28, 31, v28
    v_cvt_f32_u32 v28, v28
    v_mul_f32 v28, 0x3d000000, v28
    v_cos_f32 v29, v28
    v_sin_f32 v30, v28
    s_nop 0
    v_cvt_pk_bf16_f32 v108, v29, v30
    v_cvt_pk_bf16_f32 v124, -v30, v29
    v_add_u32 v31, 1, v45
    v_mul_u32_u24 v31, v31, v2
    v_and_b32 v31, 31, v31
    v_cvt_f32_u32 v31, v31
    v_mul_f32 v31, 0x3d000000, v31
    v_cos_f32 v32, v31
    v_sin_f32 v33, v31
    s_nop 0
    v_cvt_pk_bf16_f32 v109, v32, v33
    v_cvt_pk_bf16_f32 v125, -v33, v32
    v_add_u32 v34, 2, v45
    v_mul_u32_u24 v34, v34, v2
    v_and_b32 v34, 31, v34
    v_cvt_f32_u32 v34, v34
    v_mul_f32 v34, 0x3d000000, v34
    v_cos_f32 v35, v34
    v_sin_f32 v36, v34
    s_nop 0
    v_cvt_pk_bf16_f32 v110, v35, v36
    v_cvt_pk_bf16_f32 v126, -v36, v35
    v_add_u32 v37, 3, v45
    v_mul_u32_u24 v37, v37, v2
    v_and_b32 v37, 31, v37
    v_cvt_f32_u32 v37, v37
    v_mul_f32 v37, 0x3d000000, v37
    v_cos_f32 v38, v37
    v_sin_f32 v39, v37
    s_nop 0
    v_cvt_pk_bf16_f32 v111, v38, v39
    v_cvt_pk_bf16_f32 v127, -v39, v38
    v_add_u32 v28, 16, v45
    v_mul_u32_u24 v28, v28, v2
    v_and_b32 v28, 31, v28
    v_cvt_f32_u32 v28, v28
    v_mul_f32 v28, 0x3d000000, v28
    v_cos_f32 v29, v28
    v_sin_f32 v30, v28
    s_nop 0
    v_cvt_pk_bf16_f32 v112, v29, v30
    v_cvt_pk_bf16_f32 v128, -v30, v29
    v_add_u32 v31, 17, v45
    v_mul_u32_u24 v31, v31, v2
    v_and_b32 v31, 31, v31
    v_cvt_f32_u32 v31, v31
    v_mul_f32 v31, 0x3d000000, v31
    v_cos_f32 v32, v31
    v_sin_f32 v33, v31
    s_nop 0
    v_cvt_pk_bf16_f32 v113, v32, v33
    v_cvt_pk_bf16_f32 v129, -v33, v32
    v_add_u32 v34, 18, v45
    v_mul_u32_u24 v34, v34, v2
    v_and_b32 v34, 31, v34
    v_cvt_f32_u32 v34, v34
    v_mul_f32 v34, 0x3d000000, v34
    v_cos_f32 v35, v34
    v_sin_f32 v36, v34
    s_nop 0
    v_cvt_pk_bf16_f32 v114, v35, v36
    v_cvt_pk_bf16_f32 v130, -v36, v35
    v_add_u32 v37, 19, v45
    v_mul_u32_u24 v37, v37, v2
    v_and_b32 v37, 31, v37
    v_cvt_f32_u32 v37, v37
    v_mul_f32 v37, 0x3d000000, v37
    v_cos_f32 v38, v37
    v_sin_f32 v39, v37
    s_nop 0
    v_cvt_pk_bf16_f32 v115, v38, v39
    v_cvt_pk_bf16_f32 v131, -v39, v38
    v_add_u32 v3, s33, v45
    v_add_u32 v28, 0, v3
    v_mul_u32_u24 v28, v28, v6
    v_and_b32 v28, 2047, v28
    v_cvt_f32_u32 v28, v28
    v_mul_f32 v28, 0x3a000000, v28
    v_cos_f32 v132, v28
    v_sin_f32 v140, v28
    v_add_u32 v29, 1, v3
    v_mul_u32_u24 v29, v29, v6
    v_and_b32 v29, 2047, v29
    v_cvt_f32_u32 v29, v29
    v_mul_f32 v29, 0x3a000000, v29
    v_cos_f32 v133, v29
    v_sin_f32 v141, v29
    v_add_u32 v30, 2, v3
    v_mul_u32_u24 v30, v30, v6
    v_and_b32 v30, 2047, v30
    v_cvt_f32_u32 v30, v30
    v_mul_f32 v30, 0x3a000000, v30
    v_cos_f32 v134, v30
    v_sin_f32 v142, v30
    v_add_u32 v31, 3, v3
    v_mul_u32_u24 v31, v31, v6
    v_and_b32 v31, 2047, v31
    v_cvt_f32_u32 v31, v31
    v_mul_f32 v31, 0x3a000000, v31
    v_cos_f32 v135, v31
    v_sin_f32 v143, v31
    v_add_u32 v28, 0, v3
    v_mul_u32_u24 v28, v28, v2
    v_and_b32 v28, 2047, v28
    v_cvt_f32_u32 v28, v28
    v_mul_f32 v28, 0x3a000000, v28
    v_cos_f32 v136, v28
    v_sin_f32 v144, v28
    v_add_u32 v29, 1, v3
    v_mul_u32_u24 v29, v29, v2
    v_and_b32 v29, 2047, v29
    v_cvt_f32_u32 v29, v29
    v_mul_f32 v29, 0x3a000000, v29
    v_cos_f32 v137, v29
    v_sin_f32 v145, v29
    v_add_u32 v30, 2, v3
    v_mul_u32_u24 v30, v30, v2
    v_and_b32 v30, 2047, v30
    v_cvt_f32_u32 v30, v30
    v_mul_f32 v30, 0x3a000000, v30
    v_cos_f32 v138, v30
    v_sin_f32 v146, v30
    v_add_u32 v31, 3, v3
    v_mul_u32_u24 v31, v31, v2
    v_and_b32 v31, 2047, v31
    v_cvt_f32_u32 v31, v31
    v_mul_f32 v31, 0x3a000000, v31
    v_cos_f32 v139, v31
    v_sin_f32 v147, v31
    v_lshlrev_b32 v148, 4, v1
    s_lshl_b32 s33, s32, 10
    s_add_u32 s33, s33, 16384
    v_add_u32 v149, s33, v148
    v_lshrrev_b32 v2, 2, v6
    v_and_b32 v3, 1, v7
    v_xor_b32 v2, v2, v3
    v_lshlrev_b32 v2, 4, v2
    v_lshl_add_u32 v2, v6, 6, v2
    v_lshrrev_b32 v3, 1, v7
    v_lshl_add_u32 v152, v3, 11, v2
    v_xor_b32 v153, 32, v152
    s_lshl_b32 s33, s32, 10
    s_add_u32 s33, s33, 32768
    v_lshl_add_u32 v154, v3, 12, v2
    v_add_u32 v154, s33, v154
    v_xor_b32 v155, 32, v154
    s_lshl_b32 s33, s32, 12
    v_lshlrev_b32 v2, 2, v3
    v_and_b32 v3, 1, v7
    v_or_b32 v2, v2, v3
    v_and_b32 v3, 7, v6
    v_xor_b32 v2, v2, v3
    v_lshlrev_b32 v2, 4, v2
    v_lshl_add_u32 v2, v6, 8, v2
    v_add_u32 v156, s33, v2
    v_and_b32 v2, 7, v1
    v_xor_b32 v2, v2, v7
    v_lshlrev_b32 v2, 4, v2
    v_lshrrev_b32 v3, 3, v1
    v_lshl_add_u32 v2, v3, 7, v2
    v_add_u32 v158, s33, v2
    v_xor_b32 v159, 64, v158
    s_mul_i32 s34, s35, 16384
    s_add_u32 s33, s33, s34
    v_add_u32 v150, s33, v148
    v_and_b32 v2, 15, v1
    v_lshlrev_b32 v2, 4, v2
    v_mov_b32 v4, 16
    s_mov_b32 s96, s82
    s_mov_b32 s97, s83
    s_mov_b32 s98, 256
    s_mov_b32 s99, 0x20000
    s_mov_b32 s91, 0x80000
    s_nop 4
    s_cmp_lg_u32 s32, 0
    s_cbranch_scc1 L_k2_kernel_go
L_k2_kernel_poll:
    buffer_load_dword v3, v2, s[96:99], 0 offen sc1
    s_sub_u32 s91, s91, 1
    s_waitcnt vmcnt(0)
    v_cmp_le_u32 vcc, v4, v3
    s_nop 4
    s_cmp_eq_u64 vcc, -1
    s_cbranch_scc1 L_k2_kernel_go
    s_cmp_lg_u32 s91, 0
    s_cbranch_scc1 L_k2_kernel_poll
L_k2_kernel_go:
    s_nop 4
    s_barrier
    s_lshl_b32 s33, s32, 12
    s_add_u32 m0, s33, 0
    s_mov_b32 s34, 0
    buffer_load_dwordx4 v8, s[12:15], s34 offen offset:0 sc1 lds
    s_add_u32 s34, s34, 1024
    buffer_load_dwordx4 v8, s[12:15], s34 offen offset:1024 sc1 lds
    s_add_u32 s34, s34, 1024
    buffer_load_dwordx4 v8, s[12:15], s34 offen offset:2048 sc1 lds
    s_add_u32 s34, s34, 1024
    buffer_load_dwordx4 v8, s[12:15], s34 offen offset:3072 sc1 lds
    s_add_u32 m0, s33, 32768
    s_mov_b32 s34, 0
    buffer_load_dwordx4 v8, s[16:19], s34 offen offset:0 sc1 lds
    s_add_u32 s34, s34, 1024
    buffer_load_dwordx4 v8, s[16:19], s34 offen offset:1024 sc1 lds
    s_add_u32 s34, s34, 1024
    buffer_load_dwordx4 v8, s[16:19], s34 offen offset:2048 sc1 lds
    s_add_u32 s34, s34, 1024
    buffer_load_dwordx4 v8, s[16:19], s34 offen offset:3072 sc1 lds
    s_waitcnt vmcnt(4)
    s_barrier
    ds_read_b128 a[0:3], v152 offset:0
    ds_read_b128 a[16:19], v152 offset:1024
    ds_read_b128 a[4:7], v152 offset:4096
    ds_read_b128 a[20:23], v152 offset:5120
    ds_read_b128 a[8:11], v152 offset:8192
    ds_read_b128 a[24:27], v152 offset:9216
    ds_read_b128 a[12:15], v152 offset:12288
    ds_read_b128 a[28:31], v152 offset:13312
    s_waitcnt lgkmcnt(7)
    v_mfma_f32_16x16x32_bf16 v[160:163], a[0:3], v[52:55], 0
    v_mfma_f32_16x16x32_bf16 v[176:179], a[0:3], v[68:71], 0
    s_waitcnt lgkmcnt(6)
    v_mfma_f32_16x16x32_bf16 v[164:167], a[16:19], v[52:55], 0
    v_mfma_f32_16x16x32_bf16 v[180:183], a[16:19], v[68:71], 0
    s_waitcnt lgkmcnt(5)
    v_mfma_f32_16x16x32_bf16 v[160:163], a[4:7], v[56:59], v[160:163]
    v_mfma_f32_16x16x32_bf16 v[176:179], a[4:7], v[72:75], v[176:179]
    s_waitcnt lgkmcnt(4)
    v_mfma_f32_16x16x32_bf16 v[164:167], a[20:23], v[56:59], v[164:167]
    v_mfma_f32_16x16x32_bf16 v[180:183], a[20:23], v[72:75], v[180:183]
    s_waitcnt lgkmcnt(3)
    v_mfma_f32_16x16x32_bf16 v[160:163], a[8:11], v[60:63], v[160:163]
    v_mfma_f32_16x16x32_bf16 v[176:179], a[8:11], v[76:79], v[176:179]
    s_waitcnt lgkmcnt(2)
    v_mfma_f32_16x16x32_bf16 v[164:167], a[24:27], v[60:63], v[164:167]
    v_mfma_f32_16x16x32_bf16 v[180:183], a[24:27], v[76:79], v[180:183]
    s_waitcnt lgkmcnt(1)
    v_mfma_f32_16x16x32_bf16 v[160:163], a[12:15], v[64:67], v[160:163]
    v_mfma_f32_16x16x32_bf16 v[176:179], a[12:15], v[80:83], v[176:179]
    s_waitcnt lgkmcnt(0)
    v_mfma_f32_16x16x32_bf16 v[164:167], a[28:31], v[64:67], v[164:167]
    v_mfma_f32_16x16x32_bf16 v[180:183], a[28:31], v[80:83], v[180:183]
    ds_read_b128 a[32:35], v153 offset:0
    ds_read_b128 a[48:51], v153 offset:1024
    ds_read_b128 a[36:39], v153 offset:4096
    ds_read_b128 a[52:55], v153 offset:5120
    ds_read_b128 a[40:43], v153 offset:8192
    ds_read_b128 a[56:59], v153 offset:9216
    ds_read_b128 a[44:47], v153 offset:12288
    ds_read_b128 a[60:63], v153 offset:13312
    s_waitcnt lgkmcnt(7)
    v_mfma_f32_16x16x32_bf16 v[168:171], a[32:35], v[52:55], 0
    v_mfma_f32_16x16x32_bf16 v[184:187], a[32:35], v[68:71], 0
    s_waitcnt lgkmcnt(6)
    v_mfma_f32_16x16x32_bf16 v[172:175], a[48:51], v[52:55], 0
    v_mfma_f32_16x16x32_bf16 v[188:191], a[48:51], v[68:71], 0
    s_waitcnt lgkmcnt(5)
    v_mfma_f32_16x16x32_bf16 v[168:171], a[36:39], v[56:59], v[168:171]
    v_mfma_f32_16x16x32_bf16 v[184:187], a[36:39], v[72:75], v[184:187]
    s_waitcnt lgkmcnt(4)
    v_mfma_f32_16x16x32_bf16 v[172:175], a[52:55], v[56:59], v[172:175]
    v_mfma_f32_16x16x32_bf16 v[188:191], a[52:55], v[72:75], v[188:191]
    s_waitcnt lgkmcnt(3)
    v_mfma_f32_16x16x32_bf16 v[168:171], a[40:43], v[60:63], v[168:171]
    v_mfma_f32_16x16x32_bf16 v[184:187], a[40:43], v[76:79], v[184:187]
    s_waitcnt lgkmcnt(2)
    v_mfma_f32_16x16x32_bf16 v[172:175], a[56:59], v[60:63], v[172:175]
    v_mfma_f32_16x16x32_bf16 v[188:191], a[56:59], v[76:79], v[188:191]
    s_waitcnt lgkmcnt(1)
    v_mfma_f32_16x16x32_bf16 v[168:171], a[44:47], v[64:67], v[168:171]
    v_mfma_f32_16x16x32_bf16 v[184:187], a[44:47], v[80:83], v[184:187]
    s_waitcnt lgkmcnt(0)
    v_mfma_f32_16x16x32_bf16 v[172:175], a[60:63], v[64:67], v[172:175]
    v_mfma_f32_16x16x32_bf16 v[188:191], a[60:63], v[80:83], v[188:191]
    s_mov_b32 s48, s44
    s_mov_b32 s49, s45
    s_mov_b32 s50, 2097152
    s_mov_b32 s51, 0x20000
    s_and_b32 s33, s2, 15
    s_lshl_b32 s33, s33, 17
    s_lshr_b32 s34, s2, 4
    s_lshl_b32 s34, s34, 7
    s_add_u32 s33, s33, s34
    s_lshl_b32 s34, s32, 15
    s_add_u32 s33, s33, s34
    v_lshrrev_b32 v9, 3, v1
    v_and_b32 v4, 6, v9
    v_xor_b32 v4, v4, v1
    v_and_b32 v4, 7, v4
    v_lshlrev_b32 v9, 11, v9
    v_lshl_add_u32 v9, v4, 4, v9
    s_lshl_b32 s34, s32, 11
    s_add_u32 m0, s34, 74752
    s_nop 0
    buffer_load_dwordx4 v9, s[48:51], s33 offen nt lds
    s_add_u32 s33, s33, 15360
    buffer_load_dwordx4 v9, s[48:51], s33 offen offset:1024 nt lds
    s_mov_b32 s56, s46
    s_mov_b32 s57, s47
    s_mov_b32 s58, 2097152
    s_mov_b32 s59, 0x20000
    s_and_b32 s33, s2, 15
    s_lshl_b32 s33, s33, 17
    s_lshr_b32 s34, s2, 4
    s_lshl_b32 s34, s34, 7
    s_add_u32 s33, s33, s34
    s_lshl_b32 s34, s32, 15
    s_add_u32 s33, s33, s34
    v_lshrrev_b32 v9, 3, v1
    v_and_b32 v4, 6, v9
    v_xor_b32 v4, v4, v1
    v_and_b32 v4, 7, v4
    v_lshlrev_b32 v9, 11, v9
    v_lshl_add_u32 v9, v4, 4, v9
    s_lshl_b32 s34, s32, 11
    s_add_u32 m0, s34, 66560
    s_nop 0
    buffer_load_dwordx4 v9, s[56:59], s33 offen nt lds
    s_add_u32 s33, s33, 15360
    buffer_load_dwordx4 v9, s[56:59], s33 offen offset:1024 nt lds
    s_mov_b32 s92, s76
    s_mov_b32 s93, s77
    s_mov_b32 s94, 2457600
    s_mov_b32 s95, 0x20000
    s_mul_i32 s91, s2, 9600
    s_add_u32 s91, s91, 0
    v_lshl_add_u32 v4, s32, 6, v1
    v_lshlrev_b32 v4, 7, v4
    v_cmp_gt_u32 vcc, 9600, v4
    s_nop 1
    v_cndmask_b32 v4, -16, v4, vcc
    v_min_u32 v4, 0x40000000, v4
    buffer_load_dword v252, v4, s[92:95], s91 offen
    s_waitcnt vmcnt(5)
    s_barrier
    ds_read_b128 v[12:15], v154 offset:0
    ds_read_b128 v[16:19], v154 offset:8192
    ds_read_b128 v[20:23], v155 offset:0
    ds_read_b128 v[24:27], v155 offset:8192
    v_pk_mul_f32 v[28:29], v[176:177], v[92:93]
    v_pk_mul_f32 v[30:31], v[178:179], v[94:95]
    v_pk_mul_f32 v[32:33], v[180:181], v[96:97]
    v_pk_mul_f32 v[34:35], v[182:183], v[98:99]
    v_pk_mul_f32 v[176:177], v[176:177], v[84:85]
    v_pk_mul_f32 v[178:179], v[178:179], v[86:87]
    v_pk_mul_f32 v[180:181], v[180:181], v[88:89]
    v_pk_mul_f32 v[182:183], v[182:183], v[90:91]
    v_pk_fma_f32 v[176:177], v[160:161], v[92:93], v[176:177] neg_lo:[1,0,0] neg_hi:[1,0,0]
    v_pk_fma_f32 v[178:179], v[162:163], v[94:95], v[178:179] neg_lo:[1,0,0] neg_hi:[1,0,0]
    v_pk_fma_f32 v[180:181], v[164:165], v[96:97], v[180:181] neg_lo:[1,0,0] neg_hi:[1,0,0]
    v_pk_fma_f32 v[182:183], v[166:167], v[98:99], v[182:183] neg_lo:[1,0,0] neg_hi:[1,0,0]
    v_pk_fma_f32 v[160:161], v[160:161], v[84:85], v[28:29]
    v_pk_fma_f32 v[162:163], v[162:163], v[86:87], v[30:31]
    v_pk_fma_f32 v[164:165], v[164:165], v[88:89], v[32:33]
    v_pk_fma_f32 v[166:167], v[166:167], v[90:91], v[34:35]
    v_cvt_pk_bf16_f32 v192, v160, v176
    v_cvt_pk_bf16_f32 v193, v161, v177
    v_cvt_pk_bf16_f32 v194, v162, v178
    v_cvt_pk_bf16_f32 v195, v163, v179
    v_cvt_pk_bf16_f32 v196, v164, v180
    v_cvt_pk_bf16_f32 v197, v165, v181
    v_cvt_pk_bf16_f32 v198, v166, v182
    v_cvt_pk_bf16_f32 v199, v167, v183
    v_mfma_f32_16x16x32_bf16 v[160:163], v[100:103], v[192:195], 0
    v_mfma_f32_16x16x32_bf16 v[176:179], v[116:119], v[192:195], 0
    v_mfma_f32_16x16x32_bf16 v[164:167], v[108:111], v[192:195], 0
    v_mfma_f32_16x16x32_bf16 v[180:183], v[124:127], v[192:195], 0
    v_mfma_f32_16x16x32_bf16 v[160:163], v[104:107], v[196:199], v[160:163]
    v_mfma_f32_16x16x32_bf16 v[176:179], v[120:123], v[196:199], v[176:179]
    v_mfma_f32_16x16x32_bf16 v[164:167], v[112:115], v[196:199], v[164:167]
    v_mfma_f32_16x16x32_bf16 v[180:183], v[128:131], v[196:199], v[180:183]
    v_pk_mul_f32 v[28:29], v[184:185], v[92:93]
    v_pk_mul_f32 v[30:31], v[186:187], v[94:95]
    v_pk_mul_f32 v[32:33], v[188:189], v[96:97]
    v_pk_mul_f32 v[34:35], v[190:191], v[98:99]
    v_pk_mul_f32 v[184:185], v[184:185], v[84:85]
    v_pk_mul_f32 v[186:187], v[186:187], v[86:87]
    v_pk_mul_f32 v[188:189], v[188:189], v[88:89]
    v_pk_mul_f32 v[190:191], v[190:191], v[90:91]
    v_pk_fma_f32 v[184:185], v[168:169], v[92:93], v[184:185] neg_lo:[1,0,0] neg_hi:[1,0,0]
    v_pk_fma_f32 v[186:187], v[170:171], v[94:95], v[186:187] neg_lo:[1,0,0] neg_hi:[1,0,0]
    v_pk_fma_f32 v[188:189], v[172:173], v[96:97], v[188:189] neg_lo:[1,0,0] neg_hi:[1,0,0]
    v_pk_fma_f32 v[190:191], v[174:175], v[98:99], v[190:191] neg_lo:[1,0,0] neg_hi:[1,0,0]
    v_pk_fma_f32 v[168:169], v[168:169], v[84:85], v[28:29]
    v_pk_fma_f32 v[170:171], v[170:171], v[86:87], v[30:31]
    v_pk_fma_f32 v[172:173], v[172:173], v[88:89], v[32:33]
    v_pk_fma_f32 v[174:175], v[174:175], v[90:91], v[34:35]
    v_cvt_pk_bf16_f32 v200, v168, v184
    v_cvt_pk_bf16_f32 v201, v169, v185
    v_cvt_pk_bf16_f32 v202, v170, v186
    v_cvt_pk_bf16_f32 v203, v171, v187
    v_cvt_pk_bf16_f32 v204, v172, v188
    v_cvt_pk_bf16_f32 v205, v173, v189
    v_cvt_pk_bf16_f32 v206, v174, v190
    v_cvt_pk_bf16_f32 v207, v175, v191
    v_mfma_f32_16x16x32_bf16 v[168:171], v[100:103], v[200:203], 0
    v_mfma_f32_16x16x32_bf16 v[184:187], v[116:119], v[200:203], 0
    v_mfma_f32_16x16x32_bf16 v[172:175], v[108:111], v[200:203], 0
    v_mfma_f32_16x16x32_bf16 v[188:191], v[124:127], v[200:203], 0
    v_mfma_f32_16x16x32_bf16 v[168:171], v[104:107], v[204:207], v[168:171]
    v_mfma_f32_16x16x32_bf16 v[184:187], v[120:123], v[204:207], v[184:187]
    v_mfma_f32_16x16x32_bf16 v[172:175], v[112:115], v[204:207], v[172:175]
    v_mfma_f32_16x16x32_bf16 v[188:191], v[128:131], v[204:207], v[188:191]
    s_waitcnt lgkmcnt(3)
    v_lshlrev_b32 v208, 16, v12
    v_and_b32 v216, 0xffff0000, v12
    v_lshlrev_b32 v209, 16, v13
    v_and_b32 v217, 0xffff0000, v13
    v_lshlrev_b32 v210, 16, v14
    v_and_b32 v218, 0xffff0000, v14
    v_lshlrev_b32 v211, 16, v15
    v_and_b32 v219, 0xffff0000, v15
    s_waitcnt lgkmcnt(2)
    v_lshlrev_b32 v212, 16, v16
    v_and_b32 v220, 0xffff0000, v16
    v_lshlrev_b32 v213, 16, v17
    v_and_b32 v221, 0xffff0000, v17
    v_lshlrev_b32 v214, 16, v18
    v_and_b32 v222, 0xffff0000, v18
    v_lshlrev_b32 v215, 16, v19
    v_and_b32 v223, 0xffff0000, v19
    v_pk_mul_f32 v[28:29], v[176:177], v[216:217]
    v_pk_mul_f32 v[30:31], v[178:179], v[218:219]
    v_pk_mul_f32 v[32:33], v[180:181], v[220:221]
    v_pk_mul_f32 v[34:35], v[182:183], v[222:223]
    v_pk_mul_f32 v[176:177], v[176:177], v[208:209]
    v_pk_mul_f32 v[178:179], v[178:179], v[210:211]
    v_pk_mul_f32 v[180:181], v[180:181], v[212:213]
    v_pk_mul_f32 v[182:183], v[182:183], v[214:215]
    v_pk_fma_f32 v[176:177], v[160:161], v[216:217], v[176:177]
    v_pk_fma_f32 v[178:179], v[162:163], v[218:219], v[178:179]
    v_pk_fma_f32 v[180:181], v[164:165], v[220:221], v[180:181]
    v_pk_fma_f32 v[182:183], v[166:167], v[222:223], v[182:183]
    v_pk_fma_f32 v[160:161], v[160:161], v[208:209], v[28:29] neg_lo:[0,0,1] neg_hi:[0,0,1]
    v_pk_fma_f32 v[162:163], v[162:163], v[210:211], v[30:31] neg_lo:[0,0,1] neg_hi:[0,0,1]
    v_pk_fma_f32 v[164:165], v[164:165], v[212:213], v[32:33] neg_lo:[0,0,1] neg_hi:[0,0,1]
    v_pk_fma_f32 v[166:167], v[166:167], v[214:215], v[34:35] neg_lo:[0,0,1] neg_hi:[0,0,1]
    v_cvt_pk_bf16_f32 v192, v160, -v176
    v_cvt_pk_bf16_f32 v193, v161, -v177
    v_cvt_pk_bf16_f32 v194, v162, -v178
    v_cvt_pk_bf16_f32 v195, v163, -v179
    v_cvt_pk_bf16_f32 v196, v164, -v180
    v_cvt_pk_bf16_f32 v197, v165, -v181
    v_cvt_pk_bf16_f32 v198, v166, -v182
    v_cvt_pk_bf16_f32 v199, v167, -v183
    v_mfma_f32_16x16x32_bf16 v[160:163], v[192:195], v[100:103], 0
    v_mfma_f32_16x16x32_bf16 v[176:179], v[192:195], v[116:119], 0
    v_mfma_f32_16x16x32_bf16 v[164:167], v[192:195], v[108:111], 0
    v_mfma_f32_16x16x32_bf16 v[180:183], v[192:195], v[124:127], 0
    v_mfma_f32_16x16x32_bf16 v[160:163], v[196:199], v[104:107], v[160:163]
    v_mfma_f32_16x16x32_bf16 v[176:179], v[196:199], v[120:123], v[176:179]
    v_mfma_f32_16x16x32_bf16 v[164:167], v[196:199], v[112:115], v[164:167]
    v_mfma_f32_16x16x32_bf16 v[180:183], v[196:199], v[128:131], v[180:183]
    s_waitcnt lgkmcnt(1)
    v_lshlrev_b32 v208, 16, v20
    v_and_b32 v216, 0xffff0000, v20
    v_lshlrev_b32 v209, 16, v21
    v_and_b32 v217, 0xffff0000, v21
    v_lshlrev_b32 v210, 16, v22
    v_and_b32 v218, 0xffff0000, v22
    v_lshlrev_b32 v211, 16, v23
    v_and_b32 v219, 0xffff0000, v23
    s_waitcnt lgkmcnt(0)
    v_lshlrev_b32 v212, 16, v24
    v_and_b32 v220, 0xffff0000, v24
    v_lshlrev_b32 v213, 16, v25
    v_and_b32 v221, 0xffff0000, v25
    v_lshlrev_b32 v214, 16, v26
    v_and_b32 v222, 0xffff0000, v26
    v_lshlrev_b32 v215, 16, v27
    v_and_b32 v223, 0xffff0000, v27
    v_pk_mul_f32 v[28:29], v[184:185], v[216:217]
    v_pk_mul_f32 v[30:31], v[186:187], v[218:219]
    v_pk_mul_f32 v[32:33], v[188:189], v[220:221]
    v_pk_mul_f32 v[34:35], v[190:191], v[222:223]
    v_pk_mul_f32 v[184:185], v[184:185], v[208:209]
    v_pk_mul_f32 v[186:187], v[186:187], v[210:211]
    v_pk_mul_f32 v[188:189], v[188:189], v[212:213]
    v_pk_mul_f32 v[190:191], v[190:191], v[214:215]
    v_pk_fma_f32 v[184:185], v[168:169], v[216:217], v[184:185]
    v_pk_fma_f32 v[186:187], v[170:171], v[218:219], v[186:187]
    v_pk_fma_f32 v[188:189], v[172:173], v[220:221], v[188:189]
    v_pk_fma_f32 v[190:191], v[174:175], v[222:223], v[190:191]
    v_pk_fma_f32 v[168:169], v[168:169], v[208:209], v[28:29] neg_lo:[0,0,1] neg_hi:[0,0,1]
    v_pk_fma_f32 v[170:171], v[170:171], v[210:211], v[30:31] neg_lo:[0,0,1] neg_hi:[0,0,1]
    v_pk_fma_f32 v[172:173], v[172:173], v[212:213], v[32:33] neg_lo:[0,0,1] neg_hi:[0,0,1]
    v_pk_fma_f32 v[174:175], v[174:175], v[214:215], v[34:35] neg_lo:[0,0,1] neg_hi:[0,0,1]
    v_cvt_pk_bf16_f32 v200, v168, -v184
    v_cvt_pk_bf16_f32 v201, v169, -v185
    v_cvt_pk_bf16_f32 v202, v170, -v186
    v_cvt_pk_bf16_f32 v203, v171, -v187
    v_cvt_pk_bf16_f32 v204, v172, -v188
    v_cvt_pk_bf16_f32 v205, v173, -v189
    v_cvt_pk_bf16_f32 v206, v174, -v190
    v_cvt_pk_bf16_f32 v207, v175, -v191
    v_mfma_f32_16x16x32_bf16 v[168:171], v[200:203], v[100:103], 0
    v_mfma_f32_16x16x32_bf16 v[184:187], v[200:203], v[116:119], 0
    v_mfma_f32_16x16x32_bf16 v[172:175], v[200:203], v[108:111], 0
    v_mfma_f32_16x16x32_bf16 v[188:191], v[200:203], v[124:127], 0
    v_mfma_f32_16x16x32_bf16 v[168:171], v[204:207], v[104:107], v[168:171]
    v_mfma_f32_16x16x32_bf16 v[184:187], v[204:207], v[120:123], v[184:187]
    v_mfma_f32_16x16x32_bf16 v[172:175], v[204:207], v[112:115], v[172:175]
    v_mfma_f32_16x16x32_bf16 v[188:191], v[204:207], v[128:131], v[188:191]
    v_pk_mul_f32 v[28:29], v[176:177], v[140:141]
    v_pk_mul_f32 v[30:31], v[178:179], v[142:143]
    v_pk_mul_f32 v[32:33], v[180:181], v[144:145]
    v_pk_mul_f32 v[34:35], v[182:183], v[146:147]
    v_pk_mul_f32 v[176:177], v[176:177], v[132:133]
    v_pk_mul_f32 v[178:179], v[178:179], v[134:135]
    v_pk_mul_f32 v[180:181], v[180:181], v[136:137]
    v_pk_mul_f32 v[182:183], v[182:183], v[138:139]
    v_pk_fma_f32 v[176:177], v[160:161], v[140:141], v[176:177] neg_lo:[1,0,0] neg_hi:[1,0,0]
    v_pk_fma_f32 v[178:179], v[162:163], v[142:143], v[178:179] neg_lo:[1,0,0] neg_hi:[1,0,0]
    v_pk_fma_f32 v[180:181], v[164:165], v[144:145], v[180:181] neg_lo:[1,0,0] neg_hi:[1,0,0]
    v_pk_fma_f32 v[182:183], v[166:167], v[146:147], v[182:183] neg_lo:[1,0,0] neg_hi:[1,0,0]
    v_pk_fma_f32 v[160:161], v[160:161], v[132:133], v[28:29]
    v_pk_fma_f32 v[162:163], v[162:163], v[134:135], v[30:31]
    v_pk_fma_f32 v[164:165], v[164:165], v[136:137], v[32:33]
    v_pk_fma_f32 v[166:167], v[166:167], v[138:139], v[34:35]
    v_cvt_pk_bf16_f32 v192, v160, v176
    v_cvt_pk_bf16_f32 v193, v161, v177
    v_cvt_pk_bf16_f32 v194, v162, v178
    v_cvt_pk_bf16_f32 v195, v163, v179
    v_cvt_pk_bf16_f32 v196, v164, v180
    v_cvt_pk_bf16_f32 v197, v165, v181
    v_cvt_pk_bf16_f32 v198, v166, v182
    v_cvt_pk_bf16_f32 v199, v167, v183
    ds_write_b128 v149, v[192:195] offset:0
    ds_write_b128 v149, v[196:199] offset:8192
    v_pk_mul_f32 v[28:29], v[184:185], v[140:141]
    v_pk_mul_f32 v[30:31], v[186:187], v[142:143]
    v_pk_mul_f32 v[32:33], v[188:189], v[144:145]
    v_pk_mul_f32 v[34:35], v[190:191], v[146:147]
    v_pk_mul_f32 v[184:185], v[184:185], v[132:133]
    v_pk_mul_f32 v[186:187], v[186:187], v[134:135]
    v_pk_mul_f32 v[188:189], v[188:189], v[136:137]
    v_pk_mul_f32 v[190:191], v[190:191], v[138:139]
    v_pk_fma_f32 v[184:185], v[168:169], v[140:141], v[184:185] neg_lo:[1,0,0] neg_hi:[1,0,0]
    v_pk_fma_f32 v[186:187], v[170:171], v[142:143], v[186:187] neg_lo:[1,0,0] neg_hi:[1,0,0]
    v_pk_fma_f32 v[188:189], v[172:173], v[144:145], v[188:189] neg_lo:[1,0,0] neg_hi:[1,0,0]
    v_pk_fma_f32 v[190:191], v[174:175], v[146:147], v[190:191] neg_lo:[1,0,0] neg_hi:[1,0,0]
    v_pk_fma_f32 v[168:169], v[168:169], v[132:133], v[28:29]
    v_pk_fma_f32 v[170:171], v[170:171], v[134:135], v[30:31]
    v_pk_fma_f32 v[172:173], v[172:173], v[136:137], v[32:33]
    v_pk_fma_f32 v[174:175], v[174:175], v[138:139], v[34:35]
    v_cvt_pk_bf16_f32 v200, v168, v184
    v_cvt_pk_bf16_f32 v201, v169, v185
    v_cvt_pk_bf16_f32 v202, v170, v186
    v_cvt_pk_bf16_f32 v203, v171, v187
    v_cvt_pk_bf16_f32 v204, v172, v188
    v_cvt_pk_bf16_f32 v205, v173, v189
    v_cvt_pk_bf16_f32 v206, v174, v190
    v_cvt_pk_bf16_f32 v207, v175, v191
    ds_write_b128 v149, v[200:203] offset:4096
    ds_write_b128 v149, v[204:207] offset:12288
    s_waitcnt lgkmcnt(0)
    s_barrier
    ds_read_b128 a[0:3], v148 offset:16384
    ds_read_b128 a[16:19], v148 offset:24576
    ds_read_b128 a[4:7], v148 offset:17408
    ds_read_b128 a[20:23], v148 offset:25600
    ds_read_b128 a[8:11], v148 offset:18432
    ds_read_b128 a[24:27], v148 offset:26624
    ds_read_b128 a[12:15], v148 offset:19456
    ds_read_b128 a[28:31], v148 offset:27648
    s_waitcnt lgkmcnt(7)
    v_mfma_f32_16x16x32_bf16 v[160:163], a[0:3], v[52:55], 0
    v_mfma_f32_16x16x32_bf16 v[176:179], a[0:3], v[68:71], 0
    s_waitcnt lgkmcnt(6)
    v_mfma_f32_16x16x32_bf16 v[164:167], a[16:19], v[52:55], 0
    v_mfma_f32_16x16x32_bf16 v[180:183], a[16:19], v[68:71], 0
    s_waitcnt lgkmcnt(5)
    v_mfma_f32_16x16x32_bf16 v[160:163], a[4:7], v[56:59], v[160:163]
    v_mfma_f32_16x16x32_bf16 v[176:179], a[4:7], v[72:75], v[176:179]
    s_waitcnt lgkmcnt(4)
    v_mfma_f32_16x16x32_bf16 v[164:167], a[20:23], v[56:59], v[164:167]
    v_mfma_f32_16x16x32_bf16 v[180:183], a[20:23], v[72:75], v[180:183]
    s_waitcnt lgkmcnt(3)
    v_mfma_f32_16x16x32_bf16 v[160:163], a[8:11], v[60:63], v[160:163]
    v_mfma_f32_16x16x32_bf16 v[176:179], a[8:11], v[76:79], v[176:179]
    s_waitcnt lgkmcnt(2)
    v_mfma_f32_16x16x32_bf16 v[164:167], a[24:27], v[60:63], v[164:167]
    v_mfma_f32_16x16x32_bf16 v[180:183], a[24:27], v[76:79], v[180:183]
    s_waitcnt lgkmcnt(1)
    v_mfma_f32_16x16x32_bf16 v[160:163], a[12:15], v[64:67], v[160:163]
    v_mfma_f32_16x16x32_bf16 v[176:179], a[12:15], v[80:83], v[176:179]
    s_waitcnt lgkmcnt(0)
    v_mfma_f32_16x16x32_bf16 v[164:167], a[28:31], v[64:67], v[164:167]
    v_mfma_f32_16x16x32_bf16 v[180:183], a[28:31], v[80:83], v[180:183]
    ds_read_b128 a[32:35], v148 offset:20480
    ds_read_b128 a[48:51], v148 offset:28672
    ds_read_b128 a[36:39], v148 offset:21504
    ds_read_b128 a[52:55], v148 offset:29696
    ds_read_b128 a[40:43], v148 offset:22528
    ds_read_b128 a[56:59], v148 offset:30720
    ds_read_b128 a[44:47], v148 offset:23552
    ds_read_b128 a[60:63], v148 offset:31744
    s_waitcnt lgkmcnt(7)
    v_mfma_f32_16x16x32_bf16 v[168:171], a[32:35], v[52:55], 0
    v_mfma_f32_16x16x32_bf16 v[184:187], a[32:35], v[68:71], 0
    s_waitcnt lgkmcnt(6)
    v_mfma_f32_16x16x32_bf16 v[172:175], a[48:51], v[52:55], 0
    v_mfma_f32_16x16x32_bf16 v[188:191], a[48:51], v[68:71], 0
    s_waitcnt lgkmcnt(5)
    v_mfma_f32_16x16x32_bf16 v[168:171], a[36:39], v[56:59], v[168:171]
    v_mfma_f32_16x16x32_bf16 v[184:187], a[36:39], v[72:75], v[184:187]
    s_waitcnt lgkmcnt(4)
    v_mfma_f32_16x16x32_bf16 v[172:175], a[52:55], v[56:59], v[172:175]
    v_mfma_f32_16x16x32_bf16 v[188:191], a[52:55], v[72:75], v[188:191]
    s_waitcnt lgkmcnt(3)
    v_mfma_f32_16x16x32_bf16 v[168:171], a[40:43], v[60:63], v[168:171]
    v_mfma_f32_16x16x32_bf16 v[184:187], a[40:43], v[76:79], v[184:187]
    s_waitcnt lgkmcnt(2)
    v_mfma_f32_16x16x32_bf16 v[172:175], a[56:59], v[60:63], v[172:175]
    v_mfma_f32_16x16x32_bf16 v[188:191], a[56:59], v[76:79], v[188:191]
    s_waitcnt lgkmcnt(1)
    v_mfma_f32_16x16x32_bf16 v[168:171], a[44:47], v[64:67], v[168:171]
    v_mfma_f32_16x16x32_bf16 v[184:187], a[44:47], v[80:83], v[184:187]
    s_waitcnt lgkmcnt(0)
    v_mfma_f32_16x16x32_bf16 v[172:175], a[60:63], v[64:67], v[172:175]
    v_mfma_f32_16x16x32_bf16 v[188:191], a[60:63], v[80:83], v[188:191]
    v_cvt_pk_bf16_f32 v192, v160, v176
    v_cvt_pk_bf16_f32 v193, v161, v177
    v_cvt_pk_bf16_f32 v194, v162, v178
    v_cvt_pk_bf16_f32 v195, v163, v179
    v_cvt_pk_bf16_f32 v196, v164, v180
    v_cvt_pk_bf16_f32 v197, v165, v181
    v_cvt_pk_bf16_f32 v198, v166, v182
    v_cvt_pk_bf16_f32 v199, v167, v183
    ds_write_b128 v156, v[192:195] offset:0
    ds_write_b128 v156, v[196:199] offset:128
    v_cvt_pk_bf16_f32 v200, v168, v184
    v_cvt_pk_bf16_f32 v201, v169, v185
    v_cvt_pk_bf16_f32 v202, v170, v186
    v_cvt_pk_bf16_f32 v203, v171, v187
    v_cvt_pk_bf16_f32 v204, v172, v188
    v_cvt_pk_bf16_f32 v205, v173, v189
    v_cvt_pk_bf16_f32 v206, v174, v190
    v_cvt_pk_bf16_f32 v207, v175, v191
    v_xor_b32 v156, 32, v156
    ds_write_b128 v156, v[200:203] offset:0
    ds_write_b128 v156, v[204:207] offset:128
    s_waitcnt lgkmcnt(0)
    ds_read_b128 v[12:15], v158 offset:0
    ds_read_b128 v[16:19], v159 offset:1024
    ds_read_b128 v[20:23], v158 offset:2048
    ds_read_b128 v[24:27], v159 offset:3072
    s_waitcnt lgkmcnt(3)
    buffer_store_dwordx4 v[12:15], v150, s[20:23], 0 offen offset:0 sc1
    s_waitcnt lgkmcnt(2)
    buffer_store_dwordx4 v[16:19], v150, s[20:23], 0 offen offset:1024 sc1
    s_waitcnt lgkmcnt(1)
    buffer_store_dwordx4 v[20:23], v150, s[20:23], 0 offen offset:2048 sc1
    s_waitcnt lgkmcnt(0)
    buffer_store_dwordx4 v[24:27], v150, s[20:23], 0 offen offset:3072 sc1
    s_waitcnt vmcnt(0)
    s_barrier
    s_and_b32 s90, s2, 15
    s_lshl_b32 s90, s90, 8
    s_add_u32 s96, s84, 47513600
    s_addc_u32 s97, s85, 0
    s_mov_b32 s98, 32768
    s_mov_b32 s99, 0x20000
    s_cmp_eq_u32 s32, 0
    s_cselect_b32 s98, s98, 0
    v_mov_b32 v2, s90
    v_mov_b32 v3, 1
    s_mov_b64 exec, 1
    buffer_atomic_add v3, v2, s[96:99], 0 offen sc1
    s_mov_b64 exec, -1
L_k3_kernel_entry:
    v_mbcnt_lo_u32_b32 v0, -1, 0
    v_mbcnt_hi_u32_b32 v0, -1, v0
    v_lshl_add_u32 v0, s32, 6, v0
    s_mov_b64 s[4:5], s[64:65]
    s_mov_b64 s[6:7], s[84:85]
    v_and_b32 v1, 63, v0
    v_and_b32 v6, 31, v1
    v_lshrrev_b32 v7, 5, v1
    s_and_b32 s33, s2, 7
    s_lshl_b32 s33, s33, 8
    s_lshr_b32 s34, s2, 3
    s_lshl_b32 s34, s34, 3
    s_add_u32 s35, s33, s34
    v_lshrrev_b32 v2, 2, v1
    v_mul_u32_u24 v2, 16384, v2
    v_and_b32 v3, 3, v1
    v_lshl_add_u32 v2, v3, 4, v2
    s_lshl_b32 s33, s35, 3
    s_mul_i32 s34, s32, 1048576
    s_add_u32 s33, s33, s34
    v_add_u32 v8, s33, v2
    s_lshl_b32 s33, s32, 1
    s_add_u32 s35, s35, s33
    s_lshl_b32 s33, s35, 11
    v_lshrrev_b32 v2, 4, v1
    v_xor_b32 v2, v2, v1
    v_lshlrev_b32 v9, 4, v2
    v_add_u32 v9, s33, v9
    s_waitcnt vmcnt(0)
    s_add_u32 s16, s6, 83886080
    s_addc_u32 s17, s7, 0
    s_mov_b32 s18, 4194304
    s_mov_b32 s19, 0x20000
    s_mov_b32 s12, s4
    s_mov_b32 s13, s5
    s_mov_b32 s14, 4194304
    s_mov_b32 s15, 0x20000
    s_lshl_b32 s33, s32, 12
    s_add_u32 m0, s33, 16384
    s_nop 0
    buffer_load_dwordx4 v9, s[12:15], 0 offen offset:0 nt lds
    buffer_load_dwordx4 v9, s[12:15], 0 offen offset:1024 nt lds
    buffer_load_dwordx4 v9, s[12:15], 0 offen offset:2048 nt lds
    buffer_load_dwordx4 v9, s[12:15], 0 offen offset:3072 nt lds
    s_add_u32 s48, s6, 48234496
    s_addc_u32 s49, s7, 0
    s_mov_b32 s50, 2097152
    s_mov_b32 s51, 0x20000
    v_lshrrev_b32 v4, 2, v1
    v_bfe_u32 v5, v4, 1, 2
    s_and_b32 s33, s32, 1
    s_lshl_b32 s33, s33, 1
    v_xor_b32 v5, s33, v5
    v_lshlrev_b32 v4, 7, v4
    v_lshl_add_u32 v4, v5, 5, v4
    v_and_b32 v5, 3, v1
    v_lshl_add_u32 v4, v5, 3, v4
    s_lshr_b32 s33, s32, 1
    s_lshl_b32 s33, s33, 12
    s_add_u32 s33, s33, 74752
    v_add_u32 v4, s33, v4
    v_xor_b32 v5, 32, v4
    ds_read_b64_tr_b16 a[0:1], v4 offset:0
    ds_read_b64_tr_b16 a[2:3], v4 offset:2048
    ds_read_b64_tr_b16 a[4:5], v5 offset:0
    ds_read_b64_tr_b16 a[6:7], v5 offset:2048
    s_lshl_b32 s33, s2, 2
    s_add_u32 s33, s33, s32
    s_lshl_b32 s33, s33, 11
    v_lshlrev_b32 v4, 4, v1
    s_waitcnt lgkmcnt(2)
    buffer_store_dwordx4 a[0:3], v4, s[48:51], s33 offen offset:0 sc1
    s_waitcnt lgkmcnt(0)
    buffer_store_dwordx4 a[4:7], v4, s[48:51], s33 offen offset:1024 sc1
    s_add_u32 s56, s6, 50331648
    s_addc_u32 s57, s7, 0
    s_mov_b32 s58, 2097152
    s_mov_b32 s59, 0x20000
    v_lshrrev_b32 v4, 2, v1
    v_bfe_u32 v5, v4, 1, 2
    s_and_b32 s33, s32, 1
    s_lshl_b32 s33, s33, 1
    v_xor_b32 v5, s33, v5
    v_lshlrev_b32 v4, 7, v4
    v_lshl_add_u32 v4, v5, 5, v4
    v_and_b32 v5, 3, v1
    v_lshl_add_u32 v4, v5, 3, v4
    s_lshr_b32 s33, s32, 1
    s_lshl_b32 s33, s33, 12
    s_add_u32 s33, s33, 66560
    v_add_u32 v4, s33, v4
    v_xor_b32 v5, 32, v4
    ds_read_b64_tr_b16 a[8:9], v4 offset:0
    ds_read_b64_tr_b16 a[10:11], v4 offset:2048
    ds_read_b64_tr_b16 a[12:13], v5 offset:0
    ds_read_b64_tr_b16 a[14:15], v5 offset:2048
    s_lshl_b32 s33, s2, 2
    s_add_u32 s33, s33, s32
    s_lshl_b32 s33, s33, 11
    v_lshlrev_b32 v4, 4, v1
    s_waitcnt lgkmcnt(2)
    buffer_store_dwordx4 a[8:11], v4, s[56:59], s33 offen offset:0 sc1
    s_waitcnt lgkmcnt(0)
    buffer_store_dwordx4 a[12:15], v4, s[56:59], s33 offen offset:1024 sc1
    s_add_u32 s20, s6, 12582912
    s_addc_u32 s21, s7, 0
    s_mov_b32 s22, 4194304
    s_mov_b32 s23, 0x20000
    s_add_u32 s24, s6, 16777216
    s_addc_u32 s25, s7, 0
    s_mov_b32 s26, 4194304
    s_mov_b32 s27, 0x20000
    s_add_u32 s28, s6, 46137344
    s_addc_u32 s29, s7, 0
    s_mov_b32 s30, 8192
    s_mov_b32 s31, 0x20000
    v_lshlrev_b32 v58, 2, v7
    v_add_u32 v26, 0, v58
    v_mul_u32_u24 v26, v26, v6
    v_and_b32 v26, 31, v26
    v_cvt_f32_u32 v26, v26
    v_mul_f32 v26, 0x3d000000, v26
    v_cos_f32 v27, v26
    v_sin_f32 v28, v26
    s_nop 0
    v_cvt_pk_bf16_f32 v60, v27, v28
    v_cvt_pk_bf16_f32 v68, -v28, v27
    v_add_u32 v29, 1, v58
    v_mul_u32_u24 v29, v29, v6
    v_and_b32 v29, 31, v29
    v_cvt_f32_u32 v29, v29
    v_mul_f32 v29, 0x3d000000, v29
    v_cos_f32 v30, v29
    v_sin_f32 v31, v29
    s_nop 0
    v_cvt_pk_bf16_f32 v61, v30, v31
    v_cvt_pk_bf16_f32 v69, -v31, v30
    v_add_u32 v32, 2, v58
    v_mul_u32_u24 v32, v32, v6
    v_and_b32 v32, 31, v32
    v_cvt_f32_u32 v32, v32
    v_mul_f32 v32, 0x3d000000, v32
    v_cos_f32 v33, v32
    v_sin_f32 v34, v32
    s_nop 0
    v_cvt_pk_bf16_f32 v62, v33, v34
    v_cvt_pk_bf16_f32 v70, -v34, v33
    v_add_u32 v35, 3, v58
    v_mul_u32_u24 v35, v35, v6
    v_and_b32 v35, 31, v35
    v_cvt_f32_u32 v35, v35
    v_mul_f32 v35, 0x3d000000, v35
    v_cos_f32 v36, v35
    v_sin_f32 v37, v35
    s_nop 0
    v_cvt_pk_bf16_f32 v63, v36, v37
    v_cvt_pk_bf16_f32 v71, -v37, v36
    v_add_u32 v26, 8, v58
    v_mul_u32_u24 v26, v26, v6
    v_and_b32 v26, 31, v26
    v_cvt_f32_u32 v26, v26
    v_mul_f32 v26, 0x3d000000, v26
    v_cos_f32 v27, v26
    v_sin_f32 v28, v26
    s_nop 0
    v_cvt_pk_bf16_f32 v64, v27, v28
    v_cvt_pk_bf16_f32 v72, -v28, v27
    v_add_u32 v29, 9, v58
    v_mul_u32_u24 v29, v29, v6
    v_and_b32 v29, 31, v29
    v_cvt_f32_u32 v29, v29
    v_mul_f32 v29, 0x3d000000, v29
    v_cos_f32 v30, v29
    v_sin_f32 v31, v29
    s_nop 0
    v_cvt_pk_bf16_f32 v65, v30, v31
    v_cvt_pk_bf16_f32 v73, -v31, v30
    v_add_u32 v32, 10, v58
    v_mul_u32_u24 v32, v32, v6
    v_and_b32 v32, 31, v32
    v_cvt_f32_u32 v32, v32
    v_mul_f32 v32, 0x3d000000, v32
    v_cos_f32 v33, v32
    v_sin_f32 v34, v32
    s_nop 0
    v_cvt_pk_bf16_f32 v66, v33, v34
    v_cvt_pk_bf16_f32 v74, -v34, v33
    v_add_u32 v35, 11, v58
    v_mul_u32_u24 v35, v35, v6
    v_and_b32 v35, 31, v35
    v_cvt_f32_u32 v35, v35
    v_mul_f32 v35, 0x3d000000, v35
    v_cos_f32 v36, v35
    v_sin_f32 v37, v35
    s_nop 0
    v_cvt_pk_bf16_f32 v67, v36, v37
    v_cvt_pk_bf16_f32 v75, -v37, v36
    v_add_u32 v26, 0, v58
    v_mul_u32_u24 v26, v26, v6
    v_and_b32 v26, 1023, v26
    v_cvt_f32_u32 v26, v26
    v_mul_f32 v26, 0x3a800000, v26
    v_cos_f32 v76, v26
    v_sin_f32 v92, v26
    v_add_u32 v27, 1, v58
    v_mul_u32_u24 v27, v27, v6
    v_and_b32 v27, 1023, v27
    v_cvt_f32_u32 v27, v27
    v_mul_f32 v27, 0x3a800000, v27
    v_cos_f32 v77, v27
    v_sin_f32 v93, v27
    v_add_u32 v28, 2, v58
    v_mul_u32_u24 v28, v28, v6
    v_and_b32 v28, 1023, v28
    v_cvt_f32_u32 v28, v28
    v_mul_f32 v28, 0x3a800000, v28
    v_cos_f32 v78, v28
    v_sin_f32 v94, v28
    v_add_u32 v29, 3, v58
    v_mul_u32_u24 v29, v29, v6
    v_and_b32 v29, 1023, v29
    v_cvt_f32_u32 v29, v29
    v_mul_f32 v29, 0x3a800000, v29
    v_cos_f32 v79, v29
    v_sin_f32 v95, v29
    v_add_u32 v26, 8, v58
    v_mul_u32_u24 v26, v26, v6
    v_and_b32 v26, 1023, v26
    v_cvt_f32_u32 v26, v26
    v_mul_f32 v26, 0x3a800000, v26
    v_cos_f32 v80, v26
    v_sin_f32 v96, v26
    v_add_u32 v27, 9, v58
    v_mul_u32_u24 v27, v27, v6
    v_and_b32 v27, 1023, v27
    v_cvt_f32_u32 v27, v27
    v_mul_f32 v27, 0x3a800000, v27
    v_cos_f32 v81, v27
    v_sin_f32 v97, v27
    v_add_u32 v28, 10, v58
    v_mul_u32_u24 v28, v28, v6
    v_and_b32 v28, 1023, v28
    v_cvt_f32_u32 v28, v28
    v_mul_f32 v28, 0x3a800000, v28
    v_cos_f32 v82, v28
    v_sin_f32 v98, v28
    v_add_u32 v29, 11, v58
    v_mul_u32_u24 v29, v29, v6
    v_and_b32 v29, 1023, v29
    v_cvt_f32_u32 v29, v29
    v_mul_f32 v29, 0x3a800000, v29
    v_cos_f32 v83, v29
    v_sin_f32 v99, v29
    v_add_u32 v26, 16, v58
    v_mul_u32_u24 v26, v26, v6
    v_and_b32 v26, 1023, v26
    v_cvt_f32_u32 v26, v26
    v_mul_f32 v26, 0x3a800000, v26
    v_cos_f32 v84, v26
    v_sin_f32 v100, v26
    v_add_u32 v27, 17, v58
    v_mul_u32_u24 v27, v27, v6
    v_and_b32 v27, 1023, v27
    v_cvt_f32_u32 v27, v27
    v_mul_f32 v27, 0x3a800000, v27
    v_cos_f32 v85, v27
    v_sin_f32 v101, v27
    v_add_u32 v28, 18, v58
    v_mul_u32_u24 v28, v28, v6
    v_and_b32 v28, 1023, v28
    v_cvt_f32_u32 v28, v28
    v_mul_f32 v28, 0x3a800000, v28
    v_cos_f32 v86, v28
    v_sin_f32 v102, v28
    v_add_u32 v29, 19, v58
    v_mul_u32_u24 v29, v29, v6
    v_and_b32 v29, 1023, v29
    v_cvt_f32_u32 v29, v29
    v_mul_f32 v29, 0x3a800000, v29
    v_cos_f32 v87, v29
    v_sin_f32 v103, v29
    v_add_u32 v26, 24, v58
    v_mul_u32_u24 v26, v26, v6
    v_and_b32 v26, 1023, v26
    v_cvt_f32_u32 v26, v26
    v_mul_f32 v26, 0x3a800000, v26
    v_cos_f32 v88, v26
    v_sin_f32 v104, v26
    v_add_u32 v27, 25, v58
    v_mul_u32_u24 v27, v27, v6
    v_and_b32 v27, 1023, v27
    v_cvt_f32_u32 v27, v27
    v_mul_f32 v27, 0x3a800000, v27
    v_cos_f32 v89, v27
    v_sin_f32 v105, v27
    v_add_u32 v28, 26, v58
    v_mul_u32_u24 v28, v28, v6
    v_and_b32 v28, 1023, v28
    v_cvt_f32_u32 v28, v28
    v_mul_f32 v28, 0x3a800000, v28
    v_cos_f32 v90, v28
    v_sin_f32 v106, v28
    v_add_u32 v29, 27, v58
    v_mul_u32_u24 v29, v29, v6
    v_and_b32 v29, 1023, v29
    v_cvt_f32_u32 v29, v29
    v_mul_f32 v29, 0x3a800000, v29
    v_cos_f32 v91, v29
    v_sin_f32 v107, v29
    v_and_b32 v2, 1, v6
    v_cmp_eq_u32 vcc, 1, v2
    s_nop 1
    v_cndmask_b32 v2, 1.0, -1.0, vcc
    v_cmp_eq_u32 vcc, 0, v7
    s_nop 1
    v_cndmask_b32 v76, v76, v2, vcc
    v_add_u32 v26, 0, v58
    v_mul_u32_u24 v26, v26, v6
    v_and_b32 v26, 31, v26
    v_cvt_f32_u32 v26, v26
    v_mul_f32 v26, 0x3d000000, v26
    v_cos_f32 v27, v26
    v_sin_f32 v28, v26
    s_nop 0
    v_cvt_pk_bf16_f32 v108, v27, v28
    v_add_u32 v29, 1, v58
    v_mul_u32_u24 v29, v29, v6
    v_and_b32 v29, 31, v29
    v_cvt_f32_u32 v29, v29
    v_mul_f32 v29, 0x3d000000, v29
    v_cos_f32 v30, v29
    v_sin_f32 v31, v29
    s_nop 0
    v_cvt_pk_bf16_f32 v109, v30, v31
    v_add_u32 v32, 2, v58
    v_mul_u32_u24 v32, v32, v6
    v_and_b32 v32, 31, v32
    v_cvt_f32_u32 v32, v32
    v_mul_f32 v32, 0x3d000000, v32
    v_cos_f32 v33, v32
    v_sin_f32 v34, v32
    s_nop 0
    v_cvt_pk_bf16_f32 v110, v33, v34
    v_add_u32 v35, 3, v58
    v_mul_u32_u24 v35, v35, v6
    v_and_b32 v35, 31, v35
    v_cvt_f32_u32 v35, v35
    v_mul_f32 v35, 0x3d000000, v35
    v_cos_f32 v36, v35
    v_sin_f32 v37, v35
    s_nop 0
    v_cvt_pk_bf16_f32 v111, v36, v37
    v_add_u32 v26, 8, v58
    v_mul_u32_u24 v26, v26, v6
    v_and_b32 v26, 31, v26
    v_cvt_f32_u32 v26, v26
    v_mul_f32 v26, 0x3d000000, v26
    v_cos_f32 v27, v26
    v_sin_f32 v28, v26
    s_nop 0
    v_cvt_pk_bf16_f32 v112, v27, v28
    v_add_u32 v29, 9, v58
    v_mul_u32_u24 v29, v29, v6
    v_and_b32 v29, 31, v29
    v_cvt_f32_u32 v29, v29
    v_mul_f32 v29, 0x3d000000, v29
    v_cos_f32 v30, v29
    v_sin_f32 v31, v29
    s_nop 0
    v_cvt_pk_bf16_f32 v113, v30, v31
    v_add_u32 v32, 10, v58
    v_mul_u32_u24 v32, v32, v6
    v_and_b32 v32, 31, v32
    v_cvt_f32_u32 v32, v32
    v_mul_f32 v32, 0x3d000000, v32
    v_cos_f32 v33, v32
    v_sin_f32 v34, v32
    s_nop 0
    v_cvt_pk_bf16_f32 v114, v33, v34
    v_add_u32 v35, 11, v58
    v_mul_u32_u24 v35, v35, v6
    v_and_b32 v35, 31, v35
    v_cvt_f32_u32 v35, v35
    v_mul_f32 v35, 0x3d000000, v35
    v_cos_f32 v36, v35
    v_sin_f32 v37, v35
    s_nop 0
    v_cvt_pk_bf16_f32 v115, v36, v37
    v_add_u32 v26, 16, v58
    v_mul_u32_u24 v26, v26, v6
    v_and_b32 v26, 31, v26
    v_cvt_f32_u32 v26, v26
    v_mul_f32 v26, 0x3d000000, v26
    v_cos_f32 v27, v26
    v_sin_f32 v28, v26
    s_nop 0
    v_cvt_pk_bf16_f32 v116, v27, v28
    v_add_u32 v29, 17, v58
    v_mul_u32_u24 v29, v29, v6
    v_and_b32 v29, 31, v29
    v_cvt_f32_u32 v29, v29
    v_mul_f32 v29, 0x3d000000, v29
    v_cos_f32 v30, v29
    v_sin_f32 v31, v29
    s_nop 0
    v_cvt_pk_bf16_f32 v117, v30, v31
    v_add_u32 v32, 18, v58
    v_mul_u32_u24 v32, v32, v6
    v_and_b32 v32, 31, v32
    v_cvt_f32_u32 v32, v32
    v_mul_f32 v32, 0x3d000000, v32
    v_cos_f32 v33, v32
    v_sin_f32 v34, v32
    s_nop 0
    v_cvt_pk_bf16_f32 v118, v33, v34
    v_add_u32 v35, 19, v58
    v_mul_u32_u24 v35, v35, v6
    v_and_b32 v35, 31, v35
    v_cvt_f32_u32 v35, v35
    v_mul_f32 v35, 0x3d000000, v35
    v_cos_f32 v36, v35
    v_sin_f32 v37, v35
    s_nop 0
    v_cvt_pk_bf16_f32 v119, v36, v37
    v_add_u32 v26, 24, v58
    v_mul_u32_u24 v26, v26, v6
    v_and_b32 v26, 31, v26
    v_cvt_f32_u32 v26, v26
    v_mul_f32 v26, 0x3d000000, v26
    v_cos_f32 v27, v26
    v_sin_f32 v28, v26
    s_nop 0
    v_cvt_pk_bf16_f32 v120, v27, v28
    v_add_u32 v29, 25, v58
    v_mul_u32_u24 v29, v29, v6
    v_and_b32 v29, 31, v29
    v_cvt_f32_u32 v29, v29
    v_mul_f32 v29, 0x3d000000, v29
    v_cos_f32 v30, v29
    v_sin_f32 v31, v29
    s_nop 0
    v_cvt_pk_bf16_f32 v121, v30, v31
    v_add_u32 v32, 26, v58
    v_mul_u32_u24 v32, v32, v6
    v_and_b32 v32, 31, v32
    v_cvt_f32_u32 v32, v32
    v_mul_f32 v32, 0x3d000000, v32
    v_cos_f32 v33, v32
    v_sin_f32 v34, v32
    s_nop 0
    v_cvt_pk_bf16_f32 v122, v33, v34
    v_add_u32 v35, 27, v58
    v_mul_u32_u24 v35, v35, v6
    v_and_b32 v35, 31, v35
    v_cvt_f32_u32 v35, v35
    v_mul_f32 v35, 0x3d000000, v35
    v_cos_f32 v36, v35
    v_sin_f32 v37, v35
    s_nop 0
    v_cvt_pk_bf16_f32 v123, v36, v37
    v_lshlrev_b32 v124, 5, v6
    v_lshl_add_u32 v124, v7, 12, v124
    s_lshl_b32 s33, s32, 3
    v_add_u32 v124, s33, v124
    s_lshl_b32 s33, s32, 12
    s_add_u32 s33, s33, 16384
    v_lshlrev_b32 v2, 6, v6
    v_lshl_add_u32 v2, v7, 3, v2
    v_add_u32 v2, s33, v2
    v_bfe_u32 v3, v6, 2, 2
    v_xor_b32 v4, 0, v3
    v_lshl_add_u32 v126, v4, 4, v2
    v_xor_b32 v4, 1, v3
    v_lshl_add_u32 v127, v4, 4, v2
    v_xor_b32 v4, 2, v3
    v_lshl_add_u32 v128, v4, 4, v2
    v_xor_b32 v4, 3, v3
    v_lshl_add_u32 v129, v4, 4, v2
    s_lshl_b32 s33, s32, 1
    v_and_b32 v2, 7, v6
    v_xor_b32 v2, s33, v2
    v_lshlrev_b32 v2, 4, v2
    v_lshl_add_u32 v2, v6, 9, v2
    v_lshl_add_u32 v2, v7, 7, v2
    v_add_u32 v130, 32768, v2
    v_xor_b32 v131, 16, v130
    v_lshrrev_b32 v2, 5, v0
    v_xor_b32 v2, v2, v0
    v_and_b32 v2, 7, v2
    v_lshlrev_b32 v2, 4, v2
    v_lshrrev_b32 v3, 3, v0
    v_lshl_add_u32 v2, v3, 7, v2
    v_add_u32 v132, 32768, v2
    s_lshr_b32 s33, s35, 4
    s_lshl_b32 s33, s33, 15
    s_and_b32 s34, s35, 8
    s_lshl_b32 s34, s34, 4
    s_add_u32 s33, s33, s34
    v_and_b32 v2, 7, v0
    v_lshlrev_b32 v2, 4, v2
    v_lshl_add_u32 v2, v3, 8, v2
    v_add_u32 v125, s33, v2
    s_getpc_b64 s[60:61]
L_pc4:
    s_add_u32 s60, s60, L_g1_kernel_entry-L_pc4
    s_addc_u32 s61, s61, 0
    s_lshr_b32 s62, s2, 3
    s_and_b32 s62, s62, 7
    s_lshl_b32 s62, s62, 2
    s_add_u32 s62, s62, s32
    s_mul_i32 s62, s62, 1024
    v_and_b32 v4, 63, v0
    v_lshlrev_b32 v4, 7, v4
    v_add_u32 v4, s62, v4
    v_min_u32 v4, L_g2_kernel_entry-L_g1_kernel_entry-4, v4
    s_mov_b64 exec, 255
    global_load_dword v133, v4, s[60:61]
    s_mov_b64 exec, -1
    v_and_b32 v2, 15, v1
    v_lshlrev_b32 v2, 8, v2
    v_mov_b32 v4, 16
    s_add_u32 s96, s84, 47513600
    s_addc_u32 s97, s85, 0
    s_mov_b32 s98, 32768
    s_mov_b32 s99, 0x20000
    s_mov_b32 s91, 0x80000
    s_nop 4
    s_cmp_lg_u32 s32, 0
    s_cbranch_scc1 L_k3_kernel_go
L_k3_kernel_poll:
    buffer_load_dword v3, v2, s[96:99], 0 offen sc1
    s_sub_u32 s91, s91, 1
    s_waitcnt vmcnt(0)
    v_cmp_le_u32 vcc, v4, v3
    s_nop 4
    s_cmp_eq_u64 vcc, -1
    s_cbranch_scc1 L_k3_kernel_go
    s_cmp_lg_u32 s91, 0
    s_cbranch_scc1 L_k3_kernel_poll
L_k3_kernel_go:
    s_nop 4
    s_barrier
    s_lshl_b32 s33, s32, 12
    s_mov_b32 m0, s33
    s_mov_b32 s34, 0
    buffer_load_dwordx4 v8, s[16:19], s34 offen offset:0 sc1 lds
    s_add_u32 s34, s34, 261120
    buffer_load_dwordx4 v8, s[16:19], s34 offen offset:1024 sc1 lds
    s_add_u32 s34, s34, 261120
    buffer_load_dwordx4 v8, s[16:19], s34 offen offset:2048 sc1 lds
    s_add_u32 s34, s34, 261120
    buffer_load_dwordx4 v8, s[16:19], s34 offen offset:3072 sc1 lds
    s_waitcnt vmcnt(0)
    s_barrier
    s_lshr_b32 s90, s2, 4
    s_add_u32 s90, s90, 112
    s_lshl_b32 s90, s90, 8
    s_add_u32 s96, s84, 47513600
    s_addc_u32 s97, s85, 0
    s_mov_b32 s98, 32768
    s_mov_b32 s99, 0x20000
    s_cmp_eq_u32 s32, 0
    s_cselect_b32 s98, s98, 0
    v_mov_b32 v2, s90
    v_mov_b32 v3, 1
    s_mov_b64 exec, 1
    buffer_atomic_add v3, v2, s[96:99], 0 offen sc1
    s_mov_b64 exec, -1
    s_mov_b32 s92, s76
    s_mov_b32 s93, s77
    s_mov_b32 s94, 4915200
    s_mov_b32 s95, 0x20000
    s_mul_i32 s91, s2, 9600
    s_add_u32 s91, s91, 2457600
    v_lshl_add_u32 v4, s32, 6, v1
    v_lshlrev_b32 v4, 7, v4
    v_cmp_gt_u32 vcc, 9600, v4
    s_nop 1
    v_cndmask_b32 v4, -16, v4, vcc
    v_min_u32 v4, 0x40000000, v4
    buffer_load_dword v252, v4, s[92:95], s91 offen
    ds_read_b64 v[134:135], v124 offset:0
    ds_read_b64 v[136:137], v124 offset:1024
    ds_read_b64 v[138:139], v124 offset:2048
    ds_read_b64 v[140:141], v124 offset:3072
    ds_read_b64 v[142:143], v124 offset:8192
    ds_read_b64 v[144:145], v124 offset:9216
    ds_read_b64 v[146:147], v124 offset:10240
    ds_read_b64 v[148:149], v124 offset:11264
    s_waitcnt lgkmcnt(7)
    v_mov_b32 v150, v134
    v_mov_b32 v158, v135
    s_waitcnt lgkmcnt(6)
    v_mov_b32 v151, v136
    v_mov_b32 v159, v137
    s_waitcnt lgkmcnt(5)
    v_mov_b32 v152, v138
    v_mov_b32 v160, v139
    s_waitcnt lgkmcnt(4)
    v_mov_b32 v153, v140
    v_mov_b32 v161, v141
    s_waitcnt lgkmcnt(3)
    v_mov_b32 v154, v142
    v_mov_b32 v162, v143
    s_waitcnt lgkmcnt(2)
    v_mov_b32 v155, v144
    v_mov_b32 v163, v145
    s_waitcnt lgkmcnt(1)
    v_mov_b32 v156, v146
    v_mov_b32 v164, v147
    s_waitcnt lgkmcnt(0)
    v_mov_b32 v157, v148
    v_mov_b32 v165, v149
    v_mfma_f32_32x32x16_bf16 v[166:181], v[150:153], v[60:63], 0
    v_mfma_f32_32x32x16_bf16 v[198:213], v[150:153], v[68:71], 0
    v_mfma_f32_32x32x16_bf16 v[166:181], v[154:157], v[64:67], v[166:181]
    v_mfma_f32_32x32x16_bf16 v[198:213], v[154:157], v[72:75], v[198:213]
    v_mfma_f32_32x32x16_bf16 v[182:197], v[158:161], v[60:63], 0
    v_mfma_f32_32x32x16_bf16 v[214:229], v[158:161], v[68:71], 0
    v_mfma_f32_32x32x16_bf16 v[182:197], v[162:165], v[64:67], v[182:197]
    v_mfma_f32_32x32x16_bf16 v[214:229], v[162:165], v[72:75], v[214:229]
    s_nop 7
    v_pk_mul_f32 v[26:27], v[198:199], v[92:93]
    v_pk_mul_f32 v[28:29], v[200:201], v[94:95]
    v_pk_mul_f32 v[30:31], v[202:203], v[96:97]
    v_pk_mul_f32 v[32:33], v[204:205], v[98:99]
    v_pk_mul_f32 v[34:35], v[206:207], v[100:101]
    v_pk_mul_f32 v[36:37], v[208:209], v[102:103]
    v_pk_mul_f32 v[38:39], v[210:211], v[104:105]
    v_pk_mul_f32 v[40:41], v[212:213], v[106:107]
    v_pk_mul_f32 v[198:199], v[198:199], v[76:77]
    v_pk_mul_f32 v[200:201], v[200:201], v[78:79]
    v_pk_mul_f32 v[202:203], v[202:203], v[80:81]
    v_pk_mul_f32 v[204:205], v[204:205], v[82:83]
    v_pk_mul_f32 v[206:207], v[206:207], v[84:85]
    v_pk_mul_f32 v[208:209], v[208:209], v[86:87]
    v_pk_mul_f32 v[210:211], v[210:211], v[88:89]
    v_pk_mul_f32 v[212:213], v[212:213], v[90:91]
    v_pk_fma_f32 v[198:199], v[166:167], v[92:93], v[198:199] neg_lo:[1,0,0] neg_hi:[1,0,0]
    v_pk_fma_f32 v[200:201], v[168:169], v[94:95], v[200:201] neg_lo:[1,0,0] neg_hi:[1,0,0]
    v_pk_fma_f32 v[202:203], v[170:171], v[96:97], v[202:203] neg_lo:[1,0,0] neg_hi:[1,0,0]
    v_pk_fma_f32 v[204:205], v[172:173], v[98:99], v[204:205] neg_lo:[1,0,0] neg_hi:[1,0,0]
    v_pk_fma_f32 v[206:207], v[174:175], v[100:101], v[206:207] neg_lo:[1,0,0] neg_hi:[1,0,0]
    v_pk_fma_f32 v[208:209], v[176:177], v[102:103], v[208:209] neg_lo:[1,0,0] neg_hi:[1,0,0]
    v_pk_fma_f32 v[210:211], v[178:179], v[104:105], v[210:211] neg_lo:[1,0,0] neg_hi:[1,0,0]
    v_pk_fma_f32 v[212:213], v[180:181], v[106:107], v[212:213] neg_lo:[1,0,0] neg_hi:[1,0,0]
    v_pk_fma_f32 v[166:167], v[166:167], v[76:77], v[26:27]
    v_pk_fma_f32 v[168:169], v[168:169], v[78:79], v[28:29]
    v_pk_fma_f32 v[170:171], v[170:171], v[80:81], v[30:31]
    v_pk_fma_f32 v[172:173], v[172:173], v[82:83], v[32:33]
    v_pk_fma_f32 v[174:175], v[174:175], v[84:85], v[34:35]
    v_pk_fma_f32 v[176:177], v[176:177], v[86:87], v[36:37]
    v_pk_fma_f32 v[178:179], v[178:179], v[88:89], v[38:39]
    v_pk_fma_f32 v[180:181], v[180:181], v[90:91], v[40:41]
    v_cvt_pk_bf16_f32 v134, v166, v198
    v_cvt_pk_bf16_f32 v135, v167, v199
    v_cvt_pk_bf16_f32 v136, v168, v200
    v_cvt_pk_bf16_f32 v137, v169, v201
    v_cvt_pk_bf16_f32 v138, v170, v202
    v_cvt_pk_bf16_f32 v139, v171, v203
    v_cvt_pk_bf16_f32 v140, v172, v204
    v_cvt_pk_bf16_f32 v141, v173, v205
    v_cvt_pk_bf16_f32 v142, v174, v206
    v_cvt_pk_bf16_f32 v143, v175, v207
    v_cvt_pk_bf16_f32 v144, v176, v208
    v_cvt_pk_bf16_f32 v145, v177, v209
    v_cvt_pk_bf16_f32 v146, v178, v210
    v_cvt_pk_bf16_f32 v147, v179, v211
    v_cvt_pk_bf16_f32 v148, v180, v212
    v_cvt_pk_bf16_f32 v149, v181, v213
    v_mfma_f32_32x32x16_bf16 v[166:181], v[134:137], v[108:111], 0
    v_mfma_f32_32x32x16_bf16 v[166:181], v[138:141], v[112:115], v[166:181]
    v_mfma_f32_32x32x16_bf16 v[166:181], v[142:145], v[116:119], v[166:181]
    v_mfma_f32_32x32x16_bf16 v[166:181], v[146:149], v[120:123], v[166:181]
    v_pk_mul_f32 v[26:27], v[214:215], v[92:93]
    v_pk_mul_f32 v[28:29], v[216:217], v[94:95]
    v_pk_mul_f32 v[30:31], v[218:219], v[96:97]
    v_pk_mul_f32 v[32:33], v[220:221], v[98:99]
    v_pk_mul_f32 v[34:35], v[222:223], v[100:101]
    v_pk_mul_f32 v[36:37], v[224:225], v[102:103]
    v_pk_mul_f32 v[38:39], v[226:227], v[104:105]
    v_pk_mul_f32 v[40:41], v[228:229], v[106:107]
    v_pk_mul_f32 v[214:215], v[214:215], v[76:77]
    v_pk_mul_f32 v[216:217], v[216:217], v[78:79]
    v_pk_mul_f32 v[218:219], v[218:219], v[80:81]
    v_pk_mul_f32 v[220:221], v[220:221], v[82:83]
    v_pk_mul_f32 v[222:223], v[222:223], v[84:85]
    v_pk_mul_f32 v[224:225], v[224:225], v[86:87]
    v_pk_mul_f32 v[226:227], v[226:227], v[88:89]
    v_pk_mul_f32 v[228:229], v[228:229], v[90:91]
    v_pk_fma_f32 v[214:215], v[182:183], v[92:93], v[214:215] neg_lo:[1,0,0] neg_hi:[1,0,0]
    v_pk_fma_f32 v[216:217], v[184:185], v[94:95], v[216:217] neg_lo:[1,0,0] neg_hi:[1,0,0]
    v_pk_fma_f32 v[218:219], v[186:187], v[96:97], v[218:219] neg_lo:[1,0,0] neg_hi:[1,0,0]
    v_pk_fma_f32 v[220:221], v[188:189], v[98:99], v[220:221] neg_lo:[1,0,0] neg_hi:[1,0,0]
    v_pk_fma_f32 v[222:223], v[190:191], v[100:101], v[222:223] neg_lo:[1,0,0] neg_hi:[1,0,0]
    v_pk_fma_f32 v[224:225], v[192:193], v[102:103], v[224:225] neg_lo:[1,0,0] neg_hi:[1,0,0]
    v_pk_fma_f32 v[226:227], v[194:195], v[104:105], v[226:227] neg_lo:[1,0,0] neg_hi:[1,0,0]
    v_pk_fma_f32 v[228:229], v[196:197], v[106:107], v[228:229] neg_lo:[1,0,0] neg_hi:[1,0,0]
    v_pk_fma_f32 v[182:183], v[182:183], v[76:77], v[26:27]
    v_pk_fma_f32 v[184:185], v[184:185], v[78:79], v[28:29]
    v_pk_fma_f32 v[186:187], v[186:187], v[80:81], v[30:31]
    v_pk_fma_f32 v[188:189], v[188:189], v[82:83], v[32:33]
    v_pk_fma_f32 v[190:191], v[190:191], v[84:85], v[34:35]
    v_pk_fma_f32 v[192:193], v[192:193], v[86:87], v[36:37]
    v_pk_fma_f32 v[194:195], v[194:195], v[88:89], v[38:39]
    v_pk_fma_f32 v[196:197], v[196:197], v[90:91], v[40:41]
    v_cvt_pk_bf16_f32 v230, v182, v214
    v_cvt_pk_bf16_f32 v231, v183, v215
    v_cvt_pk_bf16_f32 v232, v184, v216
    v_cvt_pk_bf16_f32 v233, v185, v217
    v_cvt_pk_bf16_f32 v234, v186, v218
    v_cvt_pk_bf16_f32 v235, v187, v219
    v_cvt_pk_bf16_f32 v236, v188, v220
    v_cvt_pk_bf16_f32 v237, v189, v221
    v_cvt_pk_bf16_f32 v238, v190, v222
    v_cvt_pk_bf16_f32 v239, v191, v223
    v_cvt_pk_bf16_f32 v240, v192, v224
    v_cvt_pk_bf16_f32 v241, v193, v225
    v_cvt_pk_bf16_f32 v242, v194, v226
    v_cvt_pk_bf16_f32 v243, v195, v227
    v_cvt_pk_bf16_f32 v244, v196, v228
    v_cvt_pk_bf16_f32 v245, v197, v229
    v_mfma_f32_32x32x16_bf16 v[182:197], v[230:233], v[108:111], 0
    v_mfma_f32_32x32x16_bf16 v[182:197], v[234:237], v[112:115], v[182:197]
    v_mfma_f32_32x32x16_bf16 v[182:197], v[238:241], v[116:119], v[182:197]
    v_mfma_f32_32x32x16_bf16 v[182:197], v[242:245], v[120:123], v[182:197]
    ds_read_b64 v[10:11], v126 offset:0
    ds_read_b64 v[12:13], v127 offset:0
    ds_read_b64 v[14:15], v128 offset:0
    ds_read_b64 v[16:17], v129 offset:0
    ds_read_b64 v[18:19], v126 offset:2048
    ds_read_b64 v[20:21], v127 offset:2048
    ds_read_b64 v[22:23], v128 offset:2048
    ds_read_b64 v[24:25], v129 offset:2048
    s_mov_b32 s44, 0x35800000
    s_waitcnt lgkmcnt(7)
    v_lshlrev_b32 v198, 16, v10
    v_and_b32 v199, 0xffff0000, v10
    v_lshlrev_b32 v200, 16, v11
    v_and_b32 v201, 0xffff0000, v11
    s_waitcnt lgkmcnt(6)
    v_lshlrev_b32 v202, 16, v12
    v_and_b32 v203, 0xffff0000, v12
    v_lshlrev_b32 v204, 16, v13
    v_and_b32 v205, 0xffff0000, v13
    s_waitcnt lgkmcnt(5)
    v_lshlrev_b32 v206, 16, v14
    v_and_b32 v207, 0xffff0000, v14
    v_lshlrev_b32 v208, 16, v15
    v_and_b32 v209, 0xffff0000, v15
    s_waitcnt lgkmcnt(4)
    v_lshlrev_b32 v210, 16, v16
    v_and_b32 v211, 0xffff0000, v16
    v_lshlrev_b32 v212, 16, v17
    v_and_b32 v213, 0xffff0000, v17
    s_waitcnt lgkmcnt(3)
    v_lshlrev_b32 v214, 16, v18
    v_and_b32 v215, 0xffff0000, v18
    v_lshlrev_b32 v216, 16, v19
    v_and_b32 v217, 0xffff0000, v19
    s_waitcnt lgkmcnt(2)
    v_lshlrev_b32 v218, 16, v20
    v_and_b32 v219, 0xffff0000, v20
    v_lshlrev_b32 v220, 16, v21
    v_and_b32 v221, 0xffff0000, v21
    s_waitcnt lgkmcnt(1)
    v_lshlrev_b32 v222, 16, v22
    v_and_b32 v223, 0xffff0000, v22
    v_lshlrev_b32 v224, 16, v23
    v_and_b32 v225, 0xffff0000, v23
    s_waitcnt lgkmcnt(0)
    v_lshlrev_b32 v226, 16, v24
    v_and_b32 v227, 0xffff0000, v24
    v_lshlrev_b32 v228, 16, v25
    v_and_b32 v229, 0xffff0000, v25
    v_pk_fma_f32 v[198:199], v[166:167], s[44:45], v[198:199] op_sel_hi:[1,0,1]
    v_pk_fma_f32 v[200:201], v[168:169], s[44:45], v[200:201] op_sel_hi:[1,0,1]
    v_pk_fma_f32 v[202:203], v[170:171], s[44:45], v[202:203] op_sel_hi:[1,0,1]
    v_pk_fma_f32 v[204:205], v[172:173], s[44:45], v[204:205] op_sel_hi:[1,0,1]
    v_pk_fma_f32 v[206:207], v[174:175], s[44:45], v[206:207] op_sel_hi:[1,0,1]
    v_pk_fma_f32 v[208:209], v[176:177], s[44:45], v[208:209] op_sel_hi:[1,0,1]
    v_pk_fma_f32 v[210:211], v[178:179], s[44:45], v[210:211] op_sel_hi:[1,0,1]
    v_pk_fma_f32 v[212:213], v[180:181], s[44:45], v[212:213] op_sel_hi:[1,0,1]
    v_pk_fma_f32 v[214:215], v[182:183], s[44:45], v[214:215] op_sel_hi:[1,0,1]
    v_pk_fma_f32 v[216:217], v[184:185], s[44:45], v[216:217] op_sel_hi:[1,0,1]
    v_pk_fma_f32 v[218:219], v[186:187], s[44:45], v[218:219] op_sel_hi:[1,0,1]
    v_pk_fma_f32 v[220:221], v[188:189], s[44:45], v[220:221] op_sel_hi:[1,0,1]
    v_pk_fma_f32 v[222:223], v[190:191], s[44:45], v[222:223] op_sel_hi:[1,0,1]
    v_pk_fma_f32 v[224:225], v[192:193], s[44:45], v[224:225] op_sel_hi:[1,0,1]
    v_pk_fma_f32 v[226:227], v[194:195], s[44:45], v[226:227] op_sel_hi:[1,0,1]
    v_pk_fma_f32 v[228:229], v[196:197], s[44:45], v[228:229] op_sel_hi:[1,0,1]
    v_cvt_pk_bf16_f32 v26, v198, v199
    v_cvt_pk_bf16_f32 v27, v200, v201
    v_cvt_pk_bf16_f32 v28, v206, v207
    v_cvt_pk_bf16_f32 v29, v208, v209
    ds_write_b128 v130, v[26:29] offset:0
    v_cvt_pk_bf16_f32 v30, v202, v203
    v_cvt_pk_bf16_f32 v31, v204, v205
    v_cvt_pk_bf16_f32 v32, v210, v211
    v_cvt_pk_bf16_f32 v33, v212, v213
    ds_write_b128 v130, v[30:33] offset:256
    v_cvt_pk_bf16_f32 v34, v214, v215
    v_cvt_pk_bf16_f32 v35, v216, v217
    v_cvt_pk_bf16_f32 v36, v222, v223
    v_cvt_pk_bf16_f32 v37, v224, v225
    ds_write_b128 v131, v[34:37] offset:0
    v_cvt_pk_bf16_f32 v38, v218, v219
    v_cvt_pk_bf16_f32 v39, v220, v221
    v_cvt_pk_bf16_f32 v40, v226, v227
    v_cvt_pk_bf16_f32 v41, v228, v229
    ds_write_b128 v131, v[38:41] offset:256
    v_pk_add_f32 v[150:151], v[198:199], v[200:201]
    v_pk_add_f32 v[150:151], v[150:151], v[202:203]
    v_pk_add_f32 v[150:151], v[150:151], v[204:205]
    v_pk_add_f32 v[150:151], v[150:151], v[206:207]
    v_pk_add_f32 v[150:151], v[150:151], v[208:209]
    v_pk_add_f32 v[150:151], v[150:151], v[210:211]
    v_pk_add_f32 v[150:151], v[150:151], v[212:213]
    v_pk_add_f32 v[152:153], v[214:215], v[216:217]
    v_pk_add_f32 v[152:153], v[152:153], v[218:219]
    v_pk_add_f32 v[152:153], v[152:153], v[220:221]
    v_pk_add_f32 v[152:153], v[152:153], v[222:223]
    v_pk_add_f32 v[152:153], v[152:153], v[224:225]
    v_pk_add_f32 v[152:153], v[152:153], v[226:227]
    v_pk_add_f32 v[152:153], v[152:153], v[228:229]
    v_add_f32 v150, v150, v151
    v_add_f32 v152, v152, v153
    s_nop 0
    v_add_f32_dpp v150, v150, v150 row_shr:1 row_mask:0xf bank_mask:0xf
    v_add_f32_dpp v152, v152, v152 row_shr:1 row_mask:0xf bank_mask:0xf
    s_nop 0
    v_add_f32_dpp v150, v150, v150 row_shr:2 row_mask:0xf bank_mask:0xf
    v_add_f32_dpp v152, v152, v152 row_shr:2 row_mask:0xf bank_mask:0xf
    s_nop 0
    v_add_f32_dpp v150, v150, v150 row_shr:4 row_mask:0xf bank_mask:0xf
    v_add_f32_dpp v152, v152, v152 row_shr:4 row_mask:0xf bank_mask:0xf
    s_nop 0
    v_add_f32_dpp v150, v150, v150 row_shr:8 row_mask:0xf bank_mask:0xf
    v_add_f32_dpp v152, v152, v152 row_shr:8 row_mask:0xf bank_mask:0xf
    s_nop 0
    v_add_f32_dpp v150, v150, v150 row_bcast:15 row_mask:0xa bank_mask:0xf
    v_add_f32_dpp v152, v152, v152 row_bcast:15 row_mask:0xa bank_mask:0xf
    s_nop 0
    v_add_f32_dpp v150, v150, v150 row_bcast:31 row_mask:0xc bank_mask:0xf
    v_add_f32_dpp v152, v152, v152 row_bcast:31 row_mask:0xc bank_mask:0xf
    v_readlane_b32 s36, v150, 63
    v_readlane_b32 s38, v152, 63
    s_nop 0
    v_mov_b32 v150, s36
    v_mov_b32 v152, s38
    v_mul_f32 v150, 0x3a800000, v150
    v_mul_f32 v152, 0x3a800000, v152
    v_pk_add_f32 v[198:199], v[198:199], v[150:151] op_sel_hi:[1,0] neg_lo:[0,1] neg_hi:[0,1]
    v_pk_add_f32 v[200:201], v[200:201], v[150:151] op_sel_hi:[1,0] neg_lo:[0,1] neg_hi:[0,1]
    v_pk_add_f32 v[202:203], v[202:203], v[150:151] op_sel_hi:[1,0] neg_lo:[0,1] neg_hi:[0,1]
    v_pk_add_f32 v[204:205], v[204:205], v[150:151] op_sel_hi:[1,0] neg_lo:[0,1] neg_hi:[0,1]
    v_pk_add_f32 v[206:207], v[206:207], v[150:151] op_sel_hi:[1,0] neg_lo:[0,1] neg_hi:[0,1]
    v_pk_add_f32 v[208:209], v[208:209], v[150:151] op_sel_hi:[1,0] neg_lo:[0,1] neg_hi:[0,1]
    v_pk_add_f32 v[210:211], v[210:211], v[150:151] op_sel_hi:[1,0] neg_lo:[0,1] neg_hi:[0,1]
    v_pk_add_f32 v[212:213], v[212:213], v[150:151] op_sel_hi:[1,0] neg_lo:[0,1] neg_hi:[0,1]
    v_pk_add_f32 v[214:215], v[214:215], v[152:153] op_sel_hi:[1,0] neg_lo:[0,1] neg_hi:[0,1]
    v_pk_add_f32 v[216:217], v[216:217], v[152:153] op_sel_hi:[1,0] neg_lo:[0,1] neg_hi:[0,1]
    v_pk_add_f32 v[218:219], v[218:219], v[152:153] op_sel_hi:[1,0] neg_lo:[0,1] neg_hi:[0,1]
    v_pk_add_f32 v[220:221], v[220:221], v[152:153] op_sel_hi:[1,0] neg_lo:[0,1] neg_hi:[0,1]
    v_pk_add_f32 v[222:223], v[222:223], v[152:153] op_sel_hi:[1,0] neg_lo:[0,1] neg_hi:[0,1]
    v_pk_add_f32 v[224:225], v[224:225], v[152:153] op_sel_hi:[1,0] neg_lo:[0,1] neg_hi:[0,1]
    v_pk_add_f32 v[226:227], v[226:227], v[152:153] op_sel_hi:[1,0] neg_lo:[0,1] neg_hi:[0,1]
    v_pk_add_f32 v[228:229], v[228:229], v[152:153] op_sel_hi:[1,0] neg_lo:[0,1] neg_hi:[0,1]
    v_pk_mul_f32 v[154:155], v[198:199], v[198:199]
    v_pk_fma_f32 v[154:155], v[200:201], v[200:201], v[154:155]
    v_pk_fma_f32 v[154:155], v[202:203], v[202:203], v[154:155]
    v_pk_fma_f32 v[154:155], v[204:205], v[204:205], v[154:155]
    v_pk_fma_f32 v[154:155], v[206:207], v[206:207], v[154:155]
    v_pk_fma_f32 v[154:155], v[208:209], v[208:209], v[154:155]
    v_pk_fma_f32 v[154:155], v[210:211], v[210:211], v[154:155]
    v_pk_fma_f32 v[154:155], v[212:213], v[212:213], v[154:155]
    v_pk_mul_f32 v[156:157], v[214:215], v[214:215]
    v_pk_fma_f32 v[156:157], v[216:217], v[216:217], v[156:157]
    v_pk_fma_f32 v[156:157], v[218:219], v[218:219], v[156:157]
    v_pk_fma_f32 v[156:157], v[220:221], v[220:221], v[156:157]
    v_pk_fma_f32 v[156:157], v[222:223], v[222:223], v[156:157]
    v_pk_fma_f32 v[156:157], v[224:225], v[224:225], v[156:157]
    v_pk_fma_f32 v[156:157], v[226:227], v[226:227], v[156:157]
    v_pk_fma_f32 v[156:157], v[228:229], v[228:229], v[156:157]
    v_add_f32 v154, v154, v155
    v_add_f32 v156, v156, v157
    s_nop 0
    v_add_f32_dpp v154, v154, v154 row_shr:1 row_mask:0xf bank_mask:0xf
    v_add_f32_dpp v156, v156, v156 row_shr:1 row_mask:0xf bank_mask:0xf
    s_nop 0
    v_add_f32_dpp v154, v154, v154 row_shr:2 row_mask:0xf bank_mask:0xf
    v_add_f32_dpp v156, v156, v156 row_shr:2 row_mask:0xf bank_mask:0xf
    s_nop 0
    v_add_f32_dpp v154, v154, v154 row_shr:4 row_mask:0xf bank_mask:0xf
    v_add_f32_dpp v156, v156, v156 row_shr:4 row_mask:0xf bank_mask:0xf
    s_nop 0
    v_add_f32_dpp v154, v154, v154 row_shr:8 row_mask:0xf bank_mask:0xf
    v_add_f32_dpp v156, v156, v156 row_shr:8 row_mask:0xf bank_mask:0xf
    s_nop 0
    v_add_f32_dpp v154, v154, v154 row_bcast:15 row_mask:0xa bank_mask:0xf
    v_add_f32_dpp v156, v156, v156 row_bcast:15 row_mask:0xa bank_mask:0xf
    s_nop 0
    v_add_f32_dpp v154, v154, v154 row_bcast:31 row_mask:0xc bank_mask:0xf
    v_add_f32_dpp v156, v156, v156 row_bcast:31 row_mask:0xc bank_mask:0xf
    v_readlane_b32 s40, v154, 63
    v_readlane_b32 s42, v156, 63
    s_nop 0
    v_mov_b32 v154, s40
    v_mul_f32 v154, 0x3a800000, v154
    v_add_f32 v150, 0x3727c5ac, v154
    v_rsq_f32 v150, v150
    v_mov_b32 v156, s42
    v_mul_f32 v156, 0x3a800000, v156
    v_add_f32 v152, 0x3727c5ac, v156
    v_rsq_f32 v152, v152
    v_pk_mul_f32 v[198:199], v[198:199], v[150:151] op_sel_hi:[1,0]
    v_pk_mul_f32 v[200:201], v[200:201], v[150:151] op_sel_hi:[1,0]
    v_pk_mul_f32 v[202:203], v[202:203], v[150:151] op_sel_hi:[1,0]
    v_pk_mul_f32 v[204:205], v[204:205], v[150:151] op_sel_hi:[1,0]
    v_pk_mul_f32 v[206:207], v[206:207], v[150:151] op_sel_hi:[1,0]
    v_pk_mul_f32 v[208:209], v[208:209], v[150:151] op_sel_hi:[1,0]
    v_pk_mul_f32 v[210:211], v[210:211], v[150:151] op_sel_hi:[1,0]
    v_pk_mul_f32 v[212:213], v[212:213], v[150:151] op_sel_hi:[1,0]
    v_pk_mul_f32 v[214:215], v[214:215], v[152:153] op_sel_hi:[1,0]
    v_pk_mul_f32 v[216:217], v[216:217], v[152:153] op_sel_hi:[1,0]
    v_pk_mul_f32 v[218:219], v[218:219], v[152:153] op_sel_hi:[1,0]
    v_pk_mul_f32 v[220:221], v[220:221], v[152:153] op_sel_hi:[1,0]
    v_pk_mul_f32 v[222:223], v[222:223], v[152:153] op_sel_hi:[1,0]
    v_pk_mul_f32 v[224:225], v[224:225], v[152:153] op_sel_hi:[1,0]
    v_pk_mul_f32 v[226:227], v[226:227], v[152:153] op_sel_hi:[1,0]
    v_pk_mul_f32 v[228:229], v[228:229], v[152:153] op_sel_hi:[1,0]
    v_cvt_pk_bf16_f32 v42, v198, v199
    v_cvt_pk_bf16_f32 v43, v200, v201
    v_cvt_pk_bf16_f32 v44, v206, v207
    v_cvt_pk_bf16_f32 v45, v208, v209
    ds_write_b128 v130, v[42:45] offset:16384
    v_cvt_pk_bf16_f32 v46, v202, v203
    v_cvt_pk_bf16_f32 v47, v204, v205
    v_cvt_pk_bf16_f32 v48, v210, v211
    v_cvt_pk_bf16_f32 v49, v212, v213
    ds_write_b128 v130, v[46:49] offset:16640
    v_cvt_pk_bf16_f32 v50, v214, v215
    v_cvt_pk_bf16_f32 v51, v216, v217
    v_cvt_pk_bf16_f32 v52, v222, v223
    v_cvt_pk_bf16_f32 v53, v224, v225
    ds_write_b128 v131, v[50:53] offset:16384
    v_cvt_pk_bf16_f32 v54, v218, v219
    v_cvt_pk_bf16_f32 v55, v220, v221
    v_cvt_pk_bf16_f32 v56, v226, v227
    v_cvt_pk_bf16_f32 v57, v228, v229
    ds_write_b128 v131, v[54:57] offset:16640
    s_waitcnt lgkmcnt(0)
    s_barrier
    s_lshr_b32 s90, s2, 4
    s_add_u32 s90, s90, 112
    s_lshl_b32 s90, s90, 8
    s_add_u32 s96, s84, 47513600
    s_addc_u32 s97, s85, 0
    s_mov_b32 s98, 32768
    s_mov_b32 s99, 0x20000
    v_mov_b32 v2, s90
    buffer_load_dword v251, v2, s[96:99], 0 offen sc1
    ds_read_b128 v[182:185], v132 offset:16384
    ds_read_b128 v[186:189], v132 offset:20480
    ds_read_b128 v[190:193], v132 offset:24576
    ds_read_b128 v[194:197], v132 offset:28672
    s_mov_b32 s33, 0
    s_waitcnt lgkmcnt(3)
    buffer_store_dwordx4 v[182:185], v125, s[24:27], s33 offen sc1
    s_add_u32 s33, s33, 8192
    s_waitcnt lgkmcnt(2)
    buffer_store_dwordx4 v[186:189], v125, s[24:27], s33 offen sc1
    s_add_u32 s33, s33, 8192
    s_waitcnt lgkmcnt(1)
    buffer_store_dwordx4 v[190:193], v125, s[24:27], s33 offen sc1
    s_add_u32 s33, s33, 8192
    s_waitcnt lgkmcnt(0)
    buffer_store_dwordx4 v[194:197], v125, s[24:27], s33 offen sc1
    v_mul_f32 v150, v150, v150
    v_mul_f32 v150, v150, v154
    v_add_f32 v150, 0x3727c5ac, v150
    v_rsq_f32 v150, v150
    v_mul_f32 v152, v152, v152
    v_mul_f32 v152, v152, v156
    v_add_f32 v152, 0x3727c5ac, v152
    v_rsq_f32 v152, v152
    s_nop 0
    v_mov_b32 v151, v152
    s_lshl_b32 s33, s35, 2
    v_mov_b32 v2, s33
    s_mov_b64 exec, 1
    buffer_store_dwordx2 v[150:151], v2, s[28:31], 0 offen sc1
    s_mov_b64 exec, -1
    ds_read_b128 v[232:235], v132 offset:0
    ds_read_b128 v[236:239], v132 offset:4096
    ds_read_b128 v[240:243], v132 offset:8192
    ds_read_b128 v[244:247], v132 offset:12288
    v_mov_b32 v248, v125
    s_add_u32 s52, s6, 12582912
    s_addc_u32 s53, s7, 0
    s_mov_b32 s54, 4194304
    s_mov_b32 s55, 0x20000
    s_waitcnt lgkmcnt(0)
    s_waitcnt vmcnt(0)
    s_barrier
    s_lshr_b32 s90, s35, 7
    s_add_u32 s90, s90, 16
    s_lshl_b32 s90, s90, 8
    s_add_u32 s96, s84, 47513600
    s_addc_u32 s97, s85, 0
    s_mov_b32 s98, 32768
    s_mov_b32 s99, 0x20000
    s_cmp_eq_u32 s32, 0
    s_cselect_b32 s98, s98, 0
    v_mov_b32 v2, s90
    v_mov_b32 v3, 1
    s_mov_b64 exec, 1
    buffer_atomic_add v3, v2, s[96:99], 0 offen sc1
    s_mov_b64 exec, -1
L_g1_kernel_entry:
    v_mbcnt_lo_u32_b32 v0, -1, 0
    v_mbcnt_hi_u32_b32 v0, -1, v0
    v_lshl_add_u32 v0, s32, 6, v0
    s_mov_b64 s[4:5], s[72:73]
    s_mov_b64 s[6:7], s[84:85]
    v_and_b32 v0, 63, v0
    s_and_b32 s38, s2, 7
    s_lshr_b32 s39, s2, 3
    s_and_b32 s33, s39, 1
    s_lshl_b32 s38, s38, 1
    s_add_u32 s33, s33, s38
    s_lshr_b32 s34, s39, 1
    s_mul_i32 s33, s33, 8
    s_mul_i32 s38, s32, 2
    s_add_u32 s33, s33, s38
    s_mul_i32 s38, s33, 32768
    v_lshlrev_b32 v1, 4, v0
    v_add_u32 v1, s38, v1
    v_add_u32 v2, 32768, v1
    s_mul_i32 s37, s32, 2048
    s_mul_i32 s38, s34, 131072
    s_add_u32 s38, s38, s37
    v_lshlrev_b32 v250, 4, v0
    v_add_u32 v250, s38, v250
    s_mov_b32 s35, 0
    s_mov_b32 s36, 0
    s_add_u32 s16, s6, 48234496
    s_addc_u32 s17, s7, 0
    s_mov_b32 s18, 2097152
    s_mov_b32 s19, 0x20000
    s_add_u32 s12, s6, 16777216
    s_addc_u32 s13, s7, 0
    s_mov_b32 s14, 4194304
    s_mov_b32 s15, 0x20000
    v_readfirstlane_b32 s90, v251
    s_mov_b32 s91, 0x80000
    s_add_u32 s38, s34, 112
    s_lshl_b32 s38, s38, 8
    v_mov_b32 v38, s38
    s_add_u32 s96, s84, 47513600
    s_addc_u32 s97, s85, 0
    s_mov_b32 s98, 32768
    s_mov_b32 s99, 0x20000
    s_nop 4
L_g1_kernel_wpoll:
    s_cmp_ge_u32 s90, 16
    s_cbranch_scc1 L_g1_kernel_wgo
    buffer_load_dword v251, v38, s[96:99], 0 offen sc1
    s_sub_u32 s91, s91, 1
    s_waitcnt vmcnt(0)
    v_readfirstlane_b32 s90, v251
    s_cmp_lg_u32 s91, 0
    s_cbranch_scc1 L_g1_kernel_wpoll
L_g1_kernel_wgo:
    s_nop 4
    s_add_u32 m0, s37, 0
    s_nop 0
    buffer_load_dwordx4 v250, s[16:19], s36 offen sc1 lds
    buffer_load_dwordx4 v250, s[16:19], s36 offen offset:1024 sc1 lds
    s_add_u32 s36, s36, 8192
    s_add_u32 m0, s37, 8192
    s_nop 0
    buffer_load_dwordx4 v250, s[16:19], s36 offen sc1 lds
    buffer_load_dwordx4 v250, s[16:19], s36 offen offset:1024 sc1 lds
    s_add_u32 s36, s36, 8192
    s_add_u32 m0, s37, 16384
    s_nop 0
    buffer_load_dwordx4 v250, s[16:19], s36 offen sc1 lds
    buffer_load_dwordx4 v250, s[16:19], s36 offen offset:1024 sc1 lds
    s_add_u32 s36, s36, 8192
    s_add_u32 m0, s37, 24576
    s_nop 0
    buffer_load_dwordx4 v250, s[16:19], s36 offen sc1 lds
    buffer_load_dwordx4 v250, s[16:19], s36 offen offset:1024 sc1 lds
    s_add_u32 s36, s36, 8192
    s_add_u32 m0, s37, 32768
    s_nop 0
    buffer_load_dwordx4 v250, s[16:19], s36 offen sc1 lds
    buffer_load_dwordx4 v250, s[16:19], s36 offen offset:1024 sc1 lds
    s_add_u32 s36, s36, 8192
    s_add_u32 m0, s37, 40960
    s_nop 0
    buffer_load_dwordx4 v250, s[16:19], s36 offen sc1 lds
    buffer_load_dwordx4 v250, s[16:19], s36 offen offset:1024 sc1 lds
    s_add_u32 s36, s36, 8192
    s_add_u32 m0, s37, 49152
    s_nop 0
    buffer_load_dwordx4 v250, s[16:19], s36 offen sc1 lds
    buffer_load_dwordx4 v250, s[16:19], s36 offen offset:1024 sc1 lds
    s_add_u32 s36, s36, 8192
    s_add_u32 m0, s37, 57344
    s_nop 0
    buffer_load_dwordx4 v250, s[16:19], s36 offen sc1 lds
    buffer_load_dwordx4 v250, s[16:19], s36 offen offset:1024 sc1 lds
    s_add_u32 s36, s36, 8192
    v_lshlrev_b32 v3, 4, v0
    v_add_u32 v4, 65536, v3
    s_mov_b32 s44, 0xc0135761
    s_mov_b32 s46, 0xbdd2d3e8
    s_mov_b32 s48, 1.0
    v_mov_b32 v72, s44
    s_add_u32 s20, s6, 20971520
    s_addc_u32 s21, s7, 0
    s_mov_b32 s22, 4194304
    s_mov_b32 s23, 0x20000
    s_add_u32 s24, s6, 46137344
    s_addc_u32 s25, s7, 0
    s_mov_b32 s26, 8192
    s_mov_b32 s27, 0x20000
    v_and_b32 v74, 15, v0
    s_lshl_b32 s38, s33, 4
    v_add_u32 v74, s38, v74
    v_lshlrev_b32 v82, 2, v74
    s_lshr_b32 s38, s34, 2
    s_lshr_b32 s28, s38, 1
    s_add_u32 s28, s28, 1
    s_sub_u32 s39, 0, s28
    s_and_b32 s38, s38, 1
    s_cmp_eq_u32 s38, 1
    s_cselect_b32 s28, s39, s28
    s_lshl_b32 s39, s34, 11
    v_add_u32 v75, s28, v74
    v_cmp_gt_u32 vcc, 0x800, v75
    s_nop 1
    v_cndmask_b32 v85, 0, -1, vcc
    v_and_b32 v75, 0x7ff, v75
    v_lshrrev_b32 v76, 4, v75
    v_lshlrev_b32 v76, 15, v76
    v_and_b32 v75, 15, v75
    v_lshl_add_u32 v76, v75, 4, v76
    v_and_b32 v75, 48, v0
    v_lshl_add_u32 v76, v75, 4, v76
    v_add_u32 v83, s39, v76
    v_add_u32 v75, s28, v74
    v_add_u32 v75, 16, v75
    v_cmp_gt_u32 vcc, 0x800, v75
    s_nop 1
    v_cndmask_b32 v86, 0, -1, vcc
    v_and_b32 v75, 0x7ff, v75
    v_lshrrev_b32 v76, 4, v75
    v_lshlrev_b32 v76, 15, v76
    v_and_b32 v75, 15, v75
    v_lshl_add_u32 v76, v75, 4, v76
    v_and_b32 v75, 48, v0
    v_lshl_add_u32 v76, v75, 4, v76
    v_add_u32 v84, s39, v76
    s_lshr_b32 s38, s33, 3
    s_add_u32 s38, s38, 16
    s_lshl_b32 s38, s38, 8
    v_mov_b32 v38, s38
    v_mov_b32 v40, 16
    s_add_u32 s96, s84, 47513600
    s_addc_u32 s97, s85, 0
    s_mov_b32 s98, 32768
    s_mov_b32 s99, 0x20000
    s_cmp_eq_u32 s32, 0
    s_cselect_b32 s98, s98, 0
    buffer_load_dword v39, v38, s[96:99], 0 offen sc1
    s_add_u32 m0, s37, 65536
    s_nop 0
    buffer_load_dwordx4 v250, s[16:19], s36 offen sc1 lds
    buffer_load_dwordx4 v250, s[16:19], s36 offen offset:1024 sc1 lds
    s_add_u32 s36, s36, 8192
    s_add_u32 m0, s37, 73728
    s_nop 0
    buffer_load_dwordx4 v250, s[16:19], s36 offen sc1 lds
    buffer_load_dwordx4 v250, s[16:19], s36 offen offset:1024 sc1 lds
    s_add_u32 s36, s36, 8192
    s_add_u32 m0, s37, 81920
    s_nop 0
    buffer_load_dwordx4 v250, s[16:19], s36 offen sc1 lds
    buffer_load_dwordx4 v250, s[16:19], s36 offen offset:1024 sc1 lds
    s_add_u32 s36, s36, 8192
    s_add_u32 m0, s37, 90112
    s_nop 0
    buffer_load_dwordx4 v250, s[16:19], s36 offen sc1 lds
    buffer_load_dwordx4 v250, s[16:19], s36 offen offset:1024 sc1 lds
    s_add_u32 s36, s36, 8192
    s_add_u32 m0, s37, 98304
    s_nop 0
    buffer_load_dwordx4 v250, s[16:19], s36 offen sc1 lds
    buffer_load_dwordx4 v250, s[16:19], s36 offen offset:1024 sc1 lds
    s_add_u32 s36, s36, 8192
    s_waitcnt vmcnt(10)
    v_cmp_le_u32 vcc, v40, v39
    s_mov_b32 s91, 0x80000
    s_nop 4
    s_cmp_lg_u32 s32, 0
    s_cbranch_scc1 L_g1_kernel_go
    s_cmp_eq_u64 vcc, -1
    s_cbranch_scc1 L_g1_kernel_go
L_g1_kernel_poll:
    buffer_load_dword v39, v38, s[96:99], 0 offen sc1
    s_sub_u32 s91, s91, 1
    s_waitcnt vmcnt(0)
    v_cmp_le_u32 vcc, v40, v39
    s_nop 4
    s_cmp_eq_u64 vcc, -1
    s_cbranch_scc1 L_g1_kernel_go
    s_cmp_lg_u32 s91, 0
    s_cbranch_scc1 L_g1_kernel_poll
L_g1_kernel_go:
    s_nop 4
    s_barrier
    buffer_load_dwordx4 a[0:3], v1, s[12:15], s35 offen sc1
    buffer_load_dwordx4 a[4:7], v2, s[12:15], s35 offen sc1
    buffer_load_dwordx4 a[8:11], v1, s[12:15], s35 offen offset:1024 sc1
    buffer_load_dwordx4 a[12:15], v2, s[12:15], s35 offen offset:1024 sc1
    buffer_load_dwordx4 a[16:19], v1, s[12:15], s35 offen offset:2048 sc1
    buffer_load_dwordx4 a[20:23], v2, s[12:15], s35 offen offset:2048 sc1
    buffer_load_dwordx4 a[24:27], v1, s[12:15], s35 offen offset:3072 sc1
    buffer_load_dwordx4 a[28:31], v2, s[12:15], s35 offen offset:3072 sc1
    s_add_u32 s35, s35, 4096
    buffer_load_dwordx4 a[32:35], v1, s[12:15], s35 offen sc1
    buffer_load_dwordx4 a[36:39], v2, s[12:15], s35 offen sc1
    buffer_load_dwordx4 a[40:43], v1, s[12:15], s35 offen offset:1024 sc1
    buffer_load_dwordx4 a[44:47], v2, s[12:15], s35 offen offset:1024 sc1
    s_barrier
    ds_read_b128 v[6:9], v3 offset:0
    ds_read_b128 v[10:13], v3 offset:1024
    ds_read_b128 v[14:17], v3 offset:2048
    ds_read_b128 v[18:21], v3 offset:3072
    ds_read_b128 v[22:25], v3 offset:4096
    ds_read_b128 v[26:29], v3 offset:5120
    ds_read_b128 v[30:33], v3 offset:6144
    ds_read_b128 v[34:37], v3 offset:7168
    s_barrier
    s_waitcnt vmcnt(11) lgkmcnt(7)
    v_mfma_f32_16x16x32_bf16 v[38:41], v[6:9], a[0:3], 0
    buffer_load_dwordx4 a[48:51], v1, s[12:15], s35 offen offset:2048 sc1
    s_waitcnt vmcnt(11)
    v_mfma_f32_16x16x32_bf16 v[54:57], v[6:9], a[4:7], 0
    ds_read_b128 v[6:9], v3 offset:8192
    s_waitcnt lgkmcnt(7)
    v_mfma_f32_16x16x32_bf16 v[42:45], v[10:13], a[0:3], 0
    buffer_load_dwordx4 a[52:55], v2, s[12:15], s35 offen offset:2048 sc1
    v_mfma_f32_16x16x32_bf16 v[58:61], v[10:13], a[4:7], 0
    ds_read_b128 v[10:13], v3 offset:9216
    s_waitcnt lgkmcnt(7)
    v_mfma_f32_16x16x32_bf16 v[46:49], v[14:17], a[0:3], 0
    buffer_load_dwordx4 a[56:59], v1, s[12:15], s35 offen offset:3072 sc1
    v_mfma_f32_16x16x32_bf16 v[62:65], v[14:17], a[4:7], 0
    ds_read_b128 v[14:17], v3 offset:10240
    s_waitcnt lgkmcnt(7)
    v_mfma_f32_16x16x32_bf16 v[50:53], v[18:21], a[0:3], 0
    buffer_load_dwordx4 a[60:63], v2, s[12:15], s35 offen offset:3072 sc1
    s_add_u32 s35, s35, 4096
    v_mfma_f32_16x16x32_bf16 v[66:69], v[18:21], a[4:7], 0
    ds_read_b128 v[18:21], v3 offset:11264
    s_waitcnt vmcnt(13) lgkmcnt(7)
    v_mfma_f32_16x16x32_bf16 v[38:41], v[22:25], a[8:11], v[38:41]
    buffer_load_dwordx4 a[0:3], v1, s[12:15], s35 offen sc1
    s_waitcnt vmcnt(13)
    v_mfma_f32_16x16x32_bf16 v[54:57], v[22:25], a[12:15], v[54:57]
    ds_read_b128 v[22:25], v3 offset:12288
    s_waitcnt lgkmcnt(7)
    v_mfma_f32_16x16x32_bf16 v[42:45], v[26:29], a[8:11], v[42:45]
    buffer_load_dwordx4 a[4:7], v2, s[12:15], s35 offen sc1
    v_mfma_f32_16x16x32_bf16 v[58:61], v[26:29], a[12:15], v[58:61]
    ds_read_b128 v[26:29], v3 offset:13312
    s_waitcnt lgkmcnt(7)
    v_mfma_f32_16x16x32_bf16 v[46:49], v[30:33], a[8:11], v[46:49]
    v_mfma_f32_16x16x32_bf16 v[62:65], v[30:33], a[12:15], v[62:65]
    ds_read_b128 v[30:33], v3 offset:14336
    s_waitcnt lgkmcnt(7)
    v_mfma_f32_16x16x32_bf16 v[50:53], v[34:37], a[8:11], v[50:53]
    v_mfma_f32_16x16x32_bf16 v[66:69], v[34:37], a[12:15], v[66:69]
    ds_read_b128 v[34:37], v3 offset:15360
    s_barrier
    s_waitcnt vmcnt(13) lgkmcnt(7)
    v_mfma_f32_16x16x32_bf16 v[38:41], v[6:9], a[16:19], v[38:41]
    buffer_load_dwordx4 a[8:11], v1, s[12:15], s35 offen offset:1024 sc1
    s_waitcnt vmcnt(13)
    v_mfma_f32_16x16x32_bf16 v[54:57], v[6:9], a[20:23], v[54:57]
    ds_read_b128 v[6:9], v3 offset:16384
    s_waitcnt lgkmcnt(7)
    v_mfma_f32_16x16x32_bf16 v[42:45], v[10:13], a[16:19], v[42:45]
    buffer_load_dwordx4 a[12:15], v2, s[12:15], s35 offen offset:1024 sc1
    v_mfma_f32_16x16x32_bf16 v[58:61], v[10:13], a[20:23], v[58:61]
    ds_read_b128 v[10:13], v3 offset:17408
    s_waitcnt lgkmcnt(7)
    v_mfma_f32_16x16x32_bf16 v[46:49], v[14:17], a[16:19], v[46:49]
    v_mfma_f32_16x16x32_bf16 v[62:65], v[14:17], a[20:23], v[62:65]
    ds_read_b128 v[14:17], v3 offset:18432
    s_waitcnt lgkmcnt(7)
    v_mfma_f32_16x16x32_bf16 v[50:53], v[18:21], a[16:19], v[50:53]
    v_mfma_f32_16x16x32_bf16 v[66:69], v[18:21], a[20:23], v[66:69]
    ds_read_b128 v[18:21], v3 offset:19456
    s_waitcnt vmcnt(13) lgkmcnt(7)
    v_mfma_f32_16x16x32_bf16 v[38:41], v[22:25], a[24:27], v[38:41]
    buffer_load_dwordx4 a[16:19], v1, s[12:15], s35 offen offset:2048 sc1
    s_waitcnt vmcnt(13)
    v_mfma_f32_16x16x32_bf16 v[54:57], v[22:25], a[28:31], v[54:57]
    ds_read_b128 v[22:25], v3 offset:20480
    s_waitcnt lgkmcnt(7)
    v_mfma_f32_16x16x32_bf16 v[42:45], v[26:29], a[24:27], v[42:45]
    buffer_load_dwordx4 a[20:23], v2, s[12:15], s35 offen offset:2048 sc1
    v_mfma_f32_16x16x32_bf16 v[58:61], v[26:29], a[28:31], v[58:61]
    ds_read_b128 v[26:29], v3 offset:21504
    s_waitcnt lgkmcnt(7)
    v_mfma_f32_16x16x32_bf16 v[46:49], v[30:33], a[24:27], v[46:49]
    v_mfma_f32_16x16x32_bf16 v[62:65], v[30:33], a[28:31], v[62:65]
    ds_read_b128 v[30:33], v3 offset:22528
    s_waitcnt lgkmcnt(7)
    v_mfma_f32_16x16x32_bf16 v[50:53], v[34:37], a[24:27], v[50:53]
    v_mfma_f32_16x16x32_bf16 v[66:69], v[34:37], a[28:31], v[66:69]
    ds_read_b128 v[34:37], v3 offset:23552
    s_barrier
    s_waitcnt vmcnt(13) lgkmcnt(7)
    v_mfma_f32_16x16x32_bf16 v[38:41], v[6:9], a[32:35], v[38:41]
    buffer_load_dwordx4 a[24:27], v1, s[12:15], s35 offen offset:3072 sc1
    s_waitcnt vmcnt(13)
    v_mfma_f32_16x16x32_bf16 v[54:57], v[6:9], a[36:39], v[54:57]
    ds_read_b128 v[6:9], v3 offset:24576
    s_waitcnt lgkmcnt(7)
    v_mfma_f32_16x16x32_bf16 v[42:45], v[10:13], a[32:35], v[42:45]
    buffer_load_dwordx4 a[28:31], v2, s[12:15], s35 offen offset:3072 sc1
    s_add_u32 s35, s35, 4096
    v_mfma_f32_16x16x32_bf16 v[58:61], v[10:13], a[36:39], v[58:61]
    ds_read_b128 v[10:13], v3 offset:25600
    s_waitcnt lgkmcnt(7)
    v_mfma_f32_16x16x32_bf16 v[46:49], v[14:17], a[32:35], v[46:49]
    v_mfma_f32_16x16x32_bf16 v[62:65], v[14:17], a[36:39], v[62:65]
    ds_read_b128 v[14:17], v3 offset:26624
    s_waitcnt lgkmcnt(7)
    v_mfma_f32_16x16x32_bf16 v[50:53], v[18:21], a[32:35], v[50:53]
    v_mfma_f32_16x16x32_bf16 v[66:69], v[18:21], a[36:39], v[66:69]
    ds_read_b128 v[18:21], v3 offset:27648
    s_waitcnt vmcnt(13) lgkmcnt(7)
    v_mfma_f32_16x16x32_bf16 v[38:41], v[22:25], a[40:43], v[38:41]
    buffer_load_dwordx4 a[32:35], v1, s[12:15], s35 offen sc1
    s_waitcnt vmcnt(13)
    v_mfma_f32_16x16x32_bf16 v[54:57], v[22:25], a[44:47], v[54:57]
    ds_read_b128 v[22:25], v3 offset:28672
    s_waitcnt lgkmcnt(7)
    v_mfma_f32_16x16x32_bf16 v[42:45], v[26:29], a[40:43], v[42:45]
    buffer_load_dwordx4 a[36:39], v2, s[12:15], s35 offen sc1
    v_mfma_f32_16x16x32_bf16 v[58:61], v[26:29], a[44:47], v[58:61]
    ds_read_b128 v[26:29], v3 offset:29696
    s_waitcnt lgkmcnt(7)
    v_mfma_f32_16x16x32_bf16 v[46:49], v[30:33], a[40:43], v[46:49]
    v_mfma_f32_16x16x32_bf16 v[62:65], v[30:33], a[44:47], v[62:65]
    ds_read_b128 v[30:33], v3 offset:30720
    s_waitcnt lgkmcnt(7)
    v_mfma_f32_16x16x32_bf16 v[50:53], v[34:37], a[40:43], v[50:53]
    v_mfma_f32_16x16x32_bf16 v[66:69], v[34:37], a[44:47], v[66:69]
    ds_read_b128 v[34:37], v3 offset:31744
    s_barrier
    s_waitcnt vmcnt(13) lgkmcnt(7)
    v_mfma_f32_16x16x32_bf16 v[38:41], v[6:9], a[48:51], v[38:41]
    buffer_load_dwordx4 a[40:43], v1, s[12:15], s35 offen offset:1024 sc1
    s_waitcnt vmcnt(13)
    v_mfma_f32_16x16x32_bf16 v[54:57], v[6:9], a[52:55], v[54:57]
    ds_read_b128 v[6:9], v3 offset:32768
    s_waitcnt lgkmcnt(7)
    v_mfma_f32_16x16x32_bf16 v[42:45], v[10:13], a[48:51], v[42:45]
    buffer_load_dwordx4 a[44:47], v2, s[12:15], s35 offen offset:1024 sc1
    v_mfma_f32_16x16x32_bf16 v[58:61], v[10:13], a[52:55], v[58:61]
    ds_read_b128 v[10:13], v3 offset:33792
    s_waitcnt lgkmcnt(7)
    v_mfma_f32_16x16x32_bf16 v[46:49], v[14:17], a[48:51], v[46:49]
    v_mfma_f32_16x16x32_bf16 v[62:65], v[14:17], a[52:55], v[62:65]
    ds_read_b128 v[14:17], v3 offset:34816
    s_waitcnt lgkmcnt(7)
    v_mfma_f32_16x16x32_bf16 v[50:53], v[18:21], a[48:51], v[50:53]
    v_mfma_f32_16x16x32_bf16 v[66:69], v[18:21], a[52:55], v[66:69]
    ds_read_b128 v[18:21], v3 offset:35840
    s_waitcnt vmcnt(13) lgkmcnt(7)
    v_mfma_f32_16x16x32_bf16 v[38:41], v[22:25], a[56:59], v[38:41]
    buffer_load_dwordx4 a[48:51], v1, s[12:15], s35 offen offset:2048 sc1
    s_waitcnt vmcnt(13)
    v_mfma_f32_16x16x32_bf16 v[54:57], v[22:25], a[60:63], v[54:57]
    ds_read_b128 v[22:25], v3 offset:36864
    s_waitcnt lgkmcnt(7)
    v_mfma_f32_16x16x32_bf16 v[42:45], v[26:29], a[56:59], v[42:45]
    buffer_load_dwordx4 a[52:55], v2, s[12:15], s35 offen offset:2048 sc1
    v_mfma_f32_16x16x32_bf16 v[58:61], v[26:29], a[60:63], v[58:61]
    ds_read_b128 v[26:29], v3 offset:37888
    s_waitcnt lgkmcnt(7)
    v_mfma_f32_16x16x32_bf16 v[46:49], v[30:33], a[56:59], v[46:49]
    v_mfma_f32_16x16x32_bf16 v[62:65], v[30:33], a[60:63], v[62:65]
    ds_read_b128 v[30:33], v3 offset:38912
    s_waitcnt lgkmcnt(7)
    v_mfma_f32_16x16x32_bf16 v[50:53], v[34:37], a[56:59], v[50:53]
    v_mfma_f32_16x16x32_bf16 v[66:69], v[34:37], a[60:63], v[66:69]
    ds_read_b128 v[34:37], v3 offset:39936
    s_barrier
    s_waitcnt vmcnt(13) lgkmcnt(7)
    v_mfma_f32_16x16x32_bf16 v[38:41], v[6:9], a[0:3], v[38:41]
    buffer_load_dwordx4 a[56:59], v1, s[12:15], s35 offen offset:3072 sc1
    s_waitcnt vmcnt(13)
    v_mfma_f32_16x16x32_bf16 v[54:57], v[6:9], a[4:7], v[54:57]
    ds_read_b128 v[6:9], v3 offset:40960
    s_waitcnt lgkmcnt(7)
    v_mfma_f32_16x16x32_bf16 v[42:45], v[10:13], a[0:3], v[42:45]
    buffer_load_dwordx4 a[60:63], v2, s[12:15], s35 offen offset:3072 sc1
    s_add_u32 s35, s35, 4096
    v_mfma_f32_16x16x32_bf16 v[58:61], v[10:13], a[4:7], v[58:61]
    ds_read_b128 v[10:13], v3 offset:41984
    s_waitcnt lgkmcnt(7)
    v_mfma_f32_16x16x32_bf16 v[46:49], v[14:17], a[0:3], v[46:49]
    v_mfma_f32_16x16x32_bf16 v[62:65], v[14:17], a[4:7], v[62:65]
    ds_read_b128 v[14:17], v3 offset:43008
    s_waitcnt lgkmcnt(7)
    v_mfma_f32_16x16x32_bf16 v[50:53], v[18:21], a[0:3], v[50:53]
    v_mfma_f32_16x16x32_bf16 v[66:69], v[18:21], a[4:7], v[66:69]
    ds_read_b128 v[18:21], v3 offset:44032
    s_waitcnt vmcnt(13) lgkmcnt(7)
    v_mfma_f32_16x16x32_bf16 v[38:41], v[22:25], a[8:11], v[38:41]
    s_add_u32 m0, s37, 106496
    s_nop 0
    buffer_load_dwordx4 v250, s[16:19], s36 offen sc1 lds
    s_waitcnt vmcnt(13)
    v_mfma_f32_16x16x32_bf16 v[54:57], v[22:25], a[12:15], v[54:57]
    ds_read_b128 v[22:25], v3 offset:45056
    s_waitcnt lgkmcnt(7)
    v_mfma_f32_16x16x32_bf16 v[42:45], v[26:29], a[8:11], v[42:45]
    buffer_load_dwordx4 v250, s[16:19], s36 offen offset:1024 sc1 lds
    s_add_u32 s36, s36, 8192
    v_mfma_f32_16x16x32_bf16 v[58:61], v[26:29], a[12:15], v[58:61]
    ds_read_b128 v[26:29], v3 offset:46080
    s_waitcnt lgkmcnt(7)
    v_mfma_f32_16x16x32_bf16 v[46:49], v[30:33], a[8:11], v[46:49]
    buffer_load_dwordx4 a[0:3], v1, s[12:15], s35 offen sc1
    v_mfma_f32_16x16x32_bf16 v[62:65], v[30:33], a[12:15], v[62:65]
    ds_read_b128 v[30:33], v3 offset:47104
    s_waitcnt lgkmcnt(7)
    v_mfma_f32_16x16x32_bf16 v[50:53], v[34:37], a[8:11], v[50:53]
    buffer_load_dwordx4 a[4:7], v2, s[12:15], s35 offen sc1
    v_mfma_f32_16x16x32_bf16 v[66:69], v[34:37], a[12:15], v[66:69]
    ds_read_b128 v[34:37], v3 offset:48128
    s_barrier
    s_waitcnt vmcnt(15) lgkmcnt(7)
    v_mfma_f32_16x16x32_bf16 v[38:41], v[6:9], a[16:19], v[38:41]
    s_add_u32 m0, s37, 114688
    s_nop 0
    buffer_load_dwordx4 v250, s[16:19], s36 offen sc1 lds
    s_waitcnt vmcnt(15)
    v_mfma_f32_16x16x32_bf16 v[54:57], v[6:9], a[20:23], v[54:57]
    ds_read_b128 v[6:9], v3 offset:49152
    s_waitcnt lgkmcnt(7)
    v_mfma_f32_16x16x32_bf16 v[42:45], v[10:13], a[16:19], v[42:45]
    buffer_load_dwordx4 v250, s[16:19], s36 offen offset:1024 sc1 lds
    s_add_u32 s36, s36, 8192
    v_mfma_f32_16x16x32_bf16 v[58:61], v[10:13], a[20:23], v[58:61]
    ds_read_b128 v[10:13], v3 offset:50176
    s_waitcnt lgkmcnt(7)
    v_mfma_f32_16x16x32_bf16 v[46:49], v[14:17], a[16:19], v[46:49]
    buffer_load_dwordx4 a[8:11], v1, s[12:15], s35 offen offset:1024 sc1
    v_mfma_f32_16x16x32_bf16 v[62:65], v[14:17], a[20:23], v[62:65]
    ds_read_b128 v[14:17], v3 offset:51200
    s_waitcnt lgkmcnt(7)
    v_mfma_f32_16x16x32_bf16 v[50:53], v[18:21], a[16:19], v[50:53]
    buffer_load_dwordx4 a[12:15], v2, s[12:15], s35 offen offset:1024 sc1
    v_mfma_f32_16x16x32_bf16 v[66:69], v[18:21], a[20:23], v[66:69]
    ds_read_b128 v[18:21], v3 offset:52224
    s_waitcnt vmcnt(17) lgkmcnt(7)
    v_mfma_f32_16x16x32_bf16 v[38:41], v[22:25], a[24:27], v[38:41]
    s_add_u32 m0, s37, 122880
    s_nop 0
    buffer_load_dwordx4 v250, s[16:19], s36 offen sc1 lds
    s_waitcnt vmcnt(17)
    v_mfma_f32_16x16x32_bf16 v[54:57], v[22:25], a[28:31], v[54:57]
    ds_read_b128 v[22:25], v3 offset:53248
    s_waitcnt lgkmcnt(7)
    v_mfma_f32_16x16x32_bf16 v[42:45], v[26:29], a[24:27], v[42:45]
    buffer_load_dwordx4 v250, s[16:19], s36 offen offset:1024 sc1 lds
    s_add_u32 s36, s36, 8192
    v_mfma_f32_16x16x32_bf16 v[58:61], v[26:29], a[28:31], v[58:61]
    ds_read_b128 v[26:29], v3 offset:54272
    s_waitcnt lgkmcnt(7)
    v_mfma_f32_16x16x32_bf16 v[46:49], v[30:33], a[24:27], v[46:49]
    buffer_load_dwordx4 a[16:19], v1, s[12:15], s35 offen offset:2048 sc1
    v_mfma_f32_16x16x32_bf16 v[62:65], v[30:33], a[28:31], v[62:65]
    ds_read_b128 v[30:33], v3 offset:55296
    s_waitcnt lgkmcnt(7)
    v_mfma_f32_16x16x32_bf16 v[50:53], v[34:37], a[24:27], v[50:53]
    buffer_load_dwordx4 a[20:23], v2, s[12:15], s35 offen offset:2048 sc1
    v_mfma_f32_16x16x32_bf16 v[66:69], v[34:37], a[28:31], v[66:69]
    ds_read_b128 v[34:37], v3 offset:56320
    s_barrier
    s_waitcnt vmcnt(19) lgkmcnt(7)
    v_mfma_f32_16x16x32_bf16 v[38:41], v[6:9], a[32:35], v[38:41]
    buffer_load_dwordx4 a[24:27], v1, s[12:15], s35 offen offset:3072 sc1
    s_waitcnt vmcnt(19)
    v_mfma_f32_16x16x32_bf16 v[54:57], v[6:9], a[36:39], v[54:57]
    ds_read_b128 v[6:9], v3 offset:57344
    s_waitcnt lgkmcnt(7)
    v_mfma_f32_16x16x32_bf16 v[42:45], v[10:13], a[32:35], v[42:45]
    buffer_load_dwordx4 a[28:31], v2, s[12:15], s35 offen offset:3072 sc1
    s_add_u32 s35, s35, 4096
    v_mfma_f32_16x16x32_bf16 v[58:61], v[10:13], a[36:39], v[58:61]
    ds_read_b128 v[10:13], v3 offset:58368
    s_waitcnt lgkmcnt(7)
    v_mfma_f32_16x16x32_bf16 v[46:49], v[14:17], a[32:35], v[46:49]
    v_mfma_f32_16x16x32_bf16 v[62:65], v[14:17], a[36:39], v[62:65]
    ds_read_b128 v[14:17], v3 offset:59392
    s_waitcnt lgkmcnt(7)
    v_mfma_f32_16x16x32_bf16 v[50:53], v[18:21], a[32:35], v[50:53]
    v_mfma_f32_16x16x32_bf16 v[66:69], v[18:21], a[36:39], v[66:69]
    ds_read_b128 v[18:21], v3 offset:60416
    s_waitcnt vmcnt(19) lgkmcnt(7)
    v_mfma_f32_16x16x32_bf16 v[38:41], v[22:25], a[40:43], v[38:41]
    buffer_load_dwordx4 a[32:35], v1, s[12:15], s35 offen sc1
    s_waitcnt vmcnt(19)
    v_mfma_f32_16x16x32_bf16 v[54:57], v[22:25], a[44:47], v[54:57]
    ds_read_b128 v[22:25], v3 offset:61440
    s_waitcnt lgkmcnt(7)
    v_mfma_f32_16x16x32_bf16 v[42:45], v[26:29], a[40:43], v[42:45]
    buffer_load_dwordx4 a[36:39], v2, s[12:15], s35 offen sc1
    v_mfma_f32_16x16x32_bf16 v[58:61], v[26:29], a[44:47], v[58:61]
    ds_read_b128 v[26:29], v3 offset:62464
    s_waitcnt lgkmcnt(7)
    v_mfma_f32_16x16x32_bf16 v[46:49], v[30:33], a[40:43], v[46:49]
    v_mfma_f32_16x16x32_bf16 v[62:65], v[30:33], a[44:47], v[62:65]
    ds_read_b128 v[30:33], v3 offset:63488
    s_waitcnt lgkmcnt(7)
    v_mfma_f32_16x16x32_bf16 v[50:53], v[34:37], a[40:43], v[50:53]
    v_mfma_f32_16x16x32_bf16 v[66:69], v[34:37], a[44:47], v[66:69]
    ds_read_b128 v[34:37], v3 offset:64512
    s_barrier
    s_waitcnt vmcnt(19) lgkmcnt(7)
    v_mfma_f32_16x16x32_bf16 v[38:41], v[6:9], a[48:51], v[38:41]
    buffer_load_dwordx4 a[40:43], v1, s[12:15], s35 offen offset:1024 sc1
    s_waitcnt vmcnt(19)
    v_mfma_f32_16x16x32_bf16 v[54:57], v[6:9], a[52:55], v[54:57]
    ds_read_b128 v[6:9], v4 offset:0
    s_waitcnt lgkmcnt(7)
    v_mfma_f32_16x16x32_bf16 v[42:45], v[10:13], a[48:51], v[42:45]
    buffer_load_dwordx4 a[44:47], v2, s[12:15], s35 offen offset:1024 sc1
    v_mfma_f32_16x16x32_bf16 v[58:61], v[10:13], a[52:55], v[58:61]
    ds_read_b128 v[10:13], v4 offset:1024
    s_waitcnt lgkmcnt(7)
    v_mfma_f32_16x16x32_bf16 v[46:49], v[14:17], a[48:51], v[46:49]
    v_mfma_f32_16x16x32_bf16 v[62:65], v[14:17], a[52:55], v[62:65]
    ds_read_b128 v[14:17], v4 offset:2048
    s_waitcnt lgkmcnt(7)
    v_mfma_f32_16x16x32_bf16 v[50:53], v[18:21], a[48:51], v[50:53]
    v_mfma_f32_16x16x32_bf16 v[66:69], v[18:21], a[52:55], v[66:69]
    ds_read_b128 v[18:21], v4 offset:3072
    s_waitcnt vmcnt(19) lgkmcnt(7)
    v_mfma_f32_16x16x32_bf16 v[38:41], v[22:25], a[56:59], v[38:41]
    buffer_load_dwordx4 a[48:51], v1, s[12:15], s35 offen offset:2048 sc1
    s_waitcnt vmcnt(19)
    v_mfma_f32_16x16x32_bf16 v[54:57], v[22:25], a[60:63], v[54:57]
    ds_read_b128 v[22:25], v4 offset:4096
    s_waitcnt lgkmcnt(7)
    v_mfma_f32_16x16x32_bf16 v[42:45], v[26:29], a[56:59], v[42:45]
    buffer_load_dwordx4 a[52:55], v2, s[12:15], s35 offen offset:2048 sc1
    v_mfma_f32_16x16x32_bf16 v[58:61], v[26:29], a[60:63], v[58:61]
    ds_read_b128 v[26:29], v4 offset:5120
    s_waitcnt lgkmcnt(7)
    v_mfma_f32_16x16x32_bf16 v[46:49], v[30:33], a[56:59], v[46:49]
    v_mfma_f32_16x16x32_bf16 v[62:65], v[30:33], a[60:63], v[62:65]
    ds_read_b128 v[30:33], v4 offset:6144
    s_waitcnt lgkmcnt(7)
    v_mfma_f32_16x16x32_bf16 v[50:53], v[34:37], a[56:59], v[50:53]
    v_mfma_f32_16x16x32_bf16 v[66:69], v[34:37], a[60:63], v[66:69]
    ds_read_b128 v[34:37], v4 offset:7168
    s_barrier
    s_waitcnt vmcnt(17) lgkmcnt(7)
    v_mfma_f32_16x16x32_bf16 v[38:41], v[6:9], a[0:3], v[38:41]
    buffer_load_dwordx4 a[56:59], v1, s[12:15], s35 offen offset:3072 sc1
    s_waitcnt vmcnt(17)
    v_mfma_f32_16x16x32_bf16 v[54:57], v[6:9], a[4:7], v[54:57]
    ds_read_b128 v[6:9], v4 offset:8192
    s_waitcnt lgkmcnt(7)
    v_mfma_f32_16x16x32_bf16 v[42:45], v[10:13], a[0:3], v[42:45]
    buffer_load_dwordx4 a[60:63], v2, s[12:15], s35 offen offset:3072 sc1
    s_add_u32 s35, s35, 4096
    v_mfma_f32_16x16x32_bf16 v[58:61], v[10:13], a[4:7], v[58:61]
    ds_read_b128 v[10:13], v4 offset:9216
    s_waitcnt lgkmcnt(7)
    v_mfma_f32_16x16x32_bf16 v[46:49], v[14:17], a[0:3], v[46:49]
    v_mfma_f32_16x16x32_bf16 v[62:65], v[14:17], a[4:7], v[62:65]
    ds_read_b128 v[14:17], v4 offset:10240
    s_waitcnt lgkmcnt(7)
    v_mfma_f32_16x16x32_bf16 v[50:53], v[18:21], a[0:3], v[50:53]
    v_mfma_f32_16x16x32_bf16 v[66:69], v[18:21], a[4:7], v[66:69]
    ds_read_b128 v[18:21], v4 offset:11264
    s_waitcnt vmcnt(15) lgkmcnt(7)
    v_mfma_f32_16x16x32_bf16 v[38:41], v[22:25], a[8:11], v[38:41]
    buffer_load_dwordx4 a[0:3], v1, s[12:15], s35 offen sc1
    s_waitcnt vmcnt(15)
    v_mfma_f32_16x16x32_bf16 v[54:57], v[22:25], a[12:15], v[54:57]
    ds_read_b128 v[22:25], v4 offset:12288
    s_waitcnt lgkmcnt(7)
    v_mfma_f32_16x16x32_bf16 v[42:45], v[26:29], a[8:11], v[42:45]
    buffer_load_dwordx4 a[4:7], v2, s[12:15], s35 offen sc1
    v_mfma_f32_16x16x32_bf16 v[58:61], v[26:29], a[12:15], v[58:61]
    ds_read_b128 v[26:29], v4 offset:13312
    s_waitcnt lgkmcnt(7)
    v_mfma_f32_16x16x32_bf16 v[46:49], v[30:33], a[8:11], v[46:49]
    v_mfma_f32_16x16x32_bf16 v[62:65], v[30:33], a[12:15], v[62:65]
    ds_read_b128 v[30:33], v4 offset:14336
    s_waitcnt lgkmcnt(7)
    v_mfma_f32_16x16x32_bf16 v[50:53], v[34:37], a[8:11], v[50:53]
    v_mfma_f32_16x16x32_bf16 v[66:69], v[34:37], a[12:15], v[66:69]
    ds_read_b128 v[34:37], v4 offset:15360
    s_barrier
    s_waitcnt vmcnt(13) lgkmcnt(7)
    v_mfma_f32_16x16x32_bf16 v[38:41], v[6:9], a[16:19], v[38:41]
    buffer_load_dwordx4 a[8:11], v1, s[12:15], s35 offen offset:1024 sc1
    s_waitcnt vmcnt(13)
    v_mfma_f32_16x16x32_bf16 v[54:57], v[6:9], a[20:23], v[54:57]
    ds_read_b128 v[6:9], v4 offset:16384
    s_waitcnt lgkmcnt(7)
    v_mfma_f32_16x16x32_bf16 v[42:45], v[10:13], a[16:19], v[42:45]
    buffer_load_dwordx4 a[12:15], v2, s[12:15], s35 offen offset:1024 sc1
    v_mfma_f32_16x16x32_bf16 v[58:61], v[10:13], a[20:23], v[58:61]
    ds_read_b128 v[10:13], v4 offset:17408
    s_waitcnt lgkmcnt(7)
    v_mfma_f32_16x16x32_bf16 v[46:49], v[14:17], a[16:19], v[46:49]
    v_mfma_f32_16x16x32_bf16 v[62:65], v[14:17], a[20:23], v[62:65]
    ds_read_b128 v[14:17], v4 offset:18432
    s_waitcnt lgkmcnt(7)
    v_mfma_f32_16x16x32_bf16 v[50:53], v[18:21], a[16:19], v[50:53]
    v_mfma_f32_16x16x32_bf16 v[66:69], v[18:21], a[20:23], v[66:69]
    ds_read_b128 v[18:21], v4 offset:19456
    s_waitcnt vmcnt(13) lgkmcnt(7)
    v_mfma_f32_16x16x32_bf16 v[38:41], v[22:25], a[24:27], v[38:41]
    buffer_load_dwordx4 a[16:19], v1, s[12:15], s35 offen offset:2048 sc1
    s_waitcnt vmcnt(13)
    v_mfma_f32_16x16x32_bf16 v[54:57], v[22:25], a[28:31], v[54:57]
    ds_read_b128 v[22:25], v4 offset:20480
    s_waitcnt lgkmcnt(7)
    v_mfma_f32_16x16x32_bf16 v[42:45], v[26:29], a[24:27], v[42:45]
    buffer_load_dwordx4 a[20:23], v2, s[12:15], s35 offen offset:2048 sc1
    v_mfma_f32_16x16x32_bf16 v[58:61], v[26:29], a[28:31], v[58:61]
    ds_read_b128 v[26:29], v4 offset:21504
    s_waitcnt lgkmcnt(7)
    v_mfma_f32_16x16x32_bf16 v[46:49], v[30:33], a[24:27], v[46:49]
    v_mfma_f32_16x16x32_bf16 v[62:65], v[30:33], a[28:31], v[62:65]
    ds_read_b128 v[30:33], v4 offset:22528
    s_waitcnt lgkmcnt(7)
    v_mfma_f32_16x16x32_bf16 v[50:53], v[34:37], a[24:27], v[50:53]
    v_mfma_f32_16x16x32_bf16 v[66:69], v[34:37], a[28:31], v[66:69]
    ds_read_b128 v[34:37], v4 offset:23552
    s_barrier
    s_waitcnt vmcnt(13) lgkmcnt(7)
    v_mfma_f32_16x16x32_bf16 v[38:41], v[6:9], a[32:35], v[38:41]
    buffer_load_dwordx4 a[24:27], v1, s[12:15], s35 offen offset:3072 sc1
    s_waitcnt vmcnt(13)
    v_mfma_f32_16x16x32_bf16 v[54:57], v[6:9], a[36:39], v[54:57]
    ds_read_b128 v[6:9], v4 offset:24576
    s_waitcnt lgkmcnt(7)
    v_mfma_f32_16x16x32_bf16 v[42:45], v[10:13], a[32:35], v[42:45]
    buffer_load_dwordx4 a[28:31], v2, s[12:15], s35 offen offset:3072 sc1
    s_add_u32 s35, s35, 4096
    v_mfma_f32_16x16x32_bf16 v[58:61], v[10:13], a[36:39], v[58:61]
    ds_read_b128 v[10:13], v4 offset:25600
    s_waitcnt lgkmcnt(7)
    v_mfma_f32_16x16x32_bf16 v[46:49], v[14:17], a[32:35], v[46:49]
    v_mfma_f32_16x16x32_bf16 v[62:65], v[14:17], a[36:39], v[62:65]
    ds_read_b128 v[14:17], v4 offset:26624
    s_waitcnt lgkmcnt(7)
    v_mfma_f32_16x16x32_bf16 v[50:53], v[18:21], a[32:35], v[50:53]
    v_mfma_f32_16x16x32_bf16 v[66:69], v[18:21], a[36:39], v[66:69]
    ds_read_b128 v[18:21], v4 offset:27648
    s_waitcnt vmcnt(13) lgkmcnt(7)
    v_mfma_f32_16x16x32_bf16 v[38:41], v[22:25], a[40:43], v[38:41]
    buffer_load_dwordx4 a[32:35], v1, s[12:15], s35 offen sc1
    s_waitcnt vmcnt(13)
    v_mfma_f32_16x16x32_bf16 v[54:57], v[22:25], a[44:47], v[54:57]
    ds_read_b128 v[22:25], v4 offset:28672
    s_waitcnt lgkmcnt(7)
    v_mfma_f32_16x16x32_bf16 v[42:45], v[26:29], a[40:43], v[42:45]
    buffer_load_dwordx4 a[36:39], v2, s[12:15], s35 offen sc1
    v_mfma_f32_16x16x32_bf16 v[58:61], v[26:29], a[44:47], v[58:61]
    ds_read_b128 v[26:29], v4 offset:29696
    s_waitcnt lgkmcnt(7)
    v_mfma_f32_16x16x32_bf16 v[46:49], v[30:33], a[40:43], v[46:49]
    v_mfma_f32_16x16x32_bf16 v[62:65], v[30:33], a[44:47], v[62:65]
    ds_read_b128 v[30:33], v4 offset:30720
    s_waitcnt lgkmcnt(7)
    v_mfma_f32_16x16x32_bf16 v[50:53], v[34:37], a[40:43], v[50:53]
    v_mfma_f32_16x16x32_bf16 v[66:69], v[34:37], a[44:47], v[66:69]
    ds_read_b128 v[34:37], v4 offset:31744
    s_barrier
    s_waitcnt vmcnt(13) lgkmcnt(7)
    v_mfma_f32_16x16x32_bf16 v[38:41], v[6:9], a[48:51], v[38:41]
    buffer_load_dwordx4 a[40:43], v1, s[12:15], s35 offen offset:1024 sc1
    s_waitcnt vmcnt(13)
    v_mfma_f32_16x16x32_bf16 v[54:57], v[6:9], a[52:55], v[54:57]
    ds_read_b128 v[6:9], v4 offset:32768
    s_waitcnt lgkmcnt(7)
    v_mfma_f32_16x16x32_bf16 v[42:45], v[10:13], a[48:51], v[42:45]
    buffer_load_dwordx4 a[44:47], v2, s[12:15], s35 offen offset:1024 sc1
    v_mfma_f32_16x16x32_bf16 v[58:61], v[10:13], a[52:55], v[58:61]
    ds_read_b128 v[10:13], v4 offset:33792
    s_waitcnt lgkmcnt(7)
    v_mfma_f32_16x16x32_bf16 v[46:49], v[14:17], a[48:51], v[46:49]
    v_mfma_f32_16x16x32_bf16 v[62:65], v[14:17], a[52:55], v[62:65]
    ds_read_b128 v[14:17], v4 offset:34816
    s_waitcnt lgkmcnt(7)
    v_mfma_f32_16x16x32_bf16 v[50:53], v[18:21], a[48:51], v[50:53]
    v_mfma_f32_16x16x32_bf16 v[66:69], v[18:21], a[52:55], v[66:69]
    ds_read_b128 v[18:21], v4 offset:35840
    s_waitcnt vmcnt(13) lgkmcnt(7)
    v_mfma_f32_16x16x32_bf16 v[38:41], v[22:25], a[56:59], v[38:41]
    buffer_load_dwordx4 a[48:51], v1, s[12:15], s35 offen offset:2048 sc1
    s_waitcnt vmcnt(13)
    v_mfma_f32_16x16x32_bf16 v[54:57], v[22:25], a[60:63], v[54:57]
    ds_read_b128 v[22:25], v4 offset:36864
    s_waitcnt lgkmcnt(7)
    v_mfma_f32_16x16x32_bf16 v[42:45], v[26:29], a[56:59], v[42:45]
    buffer_load_dwordx4 a[52:55], v2, s[12:15], s35 offen offset:2048 sc1
    v_mfma_f32_16x16x32_bf16 v[58:61], v[26:29], a[60:63], v[58:61]
    ds_read_b128 v[26:29], v4 offset:37888
    s_waitcnt lgkmcnt(7)
    v_mfma_f32_16x16x32_bf16 v[46:49], v[30:33], a[56:59], v[46:49]
    v_mfma_f32_16x16x32_bf16 v[62:65], v[30:33], a[60:63], v[62:65]
    ds_read_b128 v[30:33], v4 offset:38912
    s_waitcnt lgkmcnt(7)
    v_mfma_f32_16x16x32_bf16 v[50:53], v[34:37], a[56:59], v[50:53]
    v_mfma_f32_16x16x32_bf16 v[66:69], v[34:37], a[60:63], v[66:69]
    ds_read_b128 v[34:37], v4 offset:39936
    s_barrier
    s_waitcnt vmcnt(13) lgkmcnt(7)
    v_mfma_f32_16x16x32_bf16 v[38:41], v[6:9], a[0:3], v[38:41]
    buffer_load_dwordx4 a[56:59], v1, s[12:15], s35 offen offset:3072 sc1
    s_waitcnt vmcnt(13)
    v_mfma_f32_16x16x32_bf16 v[54:57], v[6:9], a[4:7], v[54:57]
    ds_read_b128 v[6:9], v4 offset:40960
    s_waitcnt lgkmcnt(7)
    v_mfma_f32_16x16x32_bf16 v[42:45], v[10:13], a[0:3], v[42:45]
    buffer_load_dwordx4 a[60:63], v2, s[12:15], s35 offen offset:3072 sc1
    s_add_u32 s35, s35, 4096
    v_mfma_f32_16x16x32_bf16 v[58:61], v[10:13], a[4:7], v[58:61]
    ds_read_b128 v[10:13], v4 offset:41984
    s_waitcnt lgkmcnt(7)
    v_mfma_f32_16x16x32_bf16 v[46:49], v[14:17], a[0:3], v[46:49]
    v_mfma_f32_16x16x32_bf16 v[62:65], v[14:17], a[4:7], v[62:65]
    ds_read_b128 v[14:17], v4 offset:43008
    s_waitcnt lgkmcnt(7)
    v_mfma_f32_16x16x32_bf16 v[50:53], v[18:21], a[0:3], v[50:53]
    v_mfma_f32_16x16x32_bf16 v[66:69], v[18:21], a[4:7], v[66:69]
    ds_read_b128 v[18:21], v4 offset:44032
    s_waitcnt vmcnt(13) lgkmcnt(7)
    v_mfma_f32_16x16x32_bf16 v[38:41], v[22:25], a[8:11], v[38:41]
    s_waitcnt vmcnt(12)
    v_mfma_f32_16x16x32_bf16 v[54:57], v[22:25], a[12:15], v[54:57]
    ds_read_b128 v[22:25], v4 offset:45056
    s_waitcnt lgkmcnt(7)
    v_mfma_f32_16x16x32_bf16 v[42:45], v[26:29], a[8:11], v[42:45]
    v_mfma_f32_16x16x32_bf16 v[58:61], v[26:29], a[12:15], v[58:61]
    ds_read_b128 v[26:29], v4 offset:46080
    s_waitcnt lgkmcnt(7)
    v_mfma_f32_16x16x32_bf16 v[46:49], v[30:33], a[8:11], v[46:49]
    v_mfma_f32_16x16x32_bf16 v[62:65], v[30:33], a[12:15], v[62:65]
    ds_read_b128 v[30:33], v4 offset:47104
    s_waitcnt lgkmcnt(7)
    v_mfma_f32_16x16x32_bf16 v[50:53], v[34:37], a[8:11], v[50:53]
    v_mfma_f32_16x16x32_bf16 v[66:69], v[34:37], a[12:15], v[66:69]
    ds_read_b128 v[34:37], v4 offset:48128
    s_barrier
    buffer_load_dword v78, v82, s[24:27], 0 offen offset:0 sc1
    buffer_load_dword v80, v82, s[24:27], 0 offen offset:64 sc1
    s_getpc_b64 s[60:61]
L_pc5:
    s_add_u32 s60, s60, L_g2_kernel_entry-L_pc5
    s_addc_u32 s61, s61, 0
    s_lshr_b32 s62, s2, 3
    s_and_b32 s62, s62, 7
    s_lshl_b32 s62, s62, 2
    s_add_u32 s62, s62, s32
    s_mul_i32 s62, s62, 1024
    v_and_b32 v88, 63, v0
    v_lshlrev_b32 v88, 7, v88
    v_add_u32 v88, s62, v88
    v_min_u32 v88, L_g3_kernel_entry-L_g2_kernel_entry-4, v88
    s_mov_b64 exec, 255
    global_load_dword v87, v88, s[60:61]
    s_mov_b64 exec, -1
    s_mov_b32 s56, 0
    buffer_store_dwordx4 v[232:235], v248, s[52:55], s56 offen sc1
    s_add_u32 s56, s56, 8192
    buffer_store_dwordx4 v[236:239], v248, s[52:55], s56 offen sc1
    s_add_u32 s56, s56, 8192
    buffer_store_dwordx4 v[240:243], v248, s[52:55], s56 offen sc1
    s_add_u32 s56, s56, 8192
    buffer_store_dwordx4 v[244:247], v248, s[52:55], s56 offen sc1
    s_waitcnt vmcnt(18) lgkmcnt(7)
    v_mfma_f32_16x16x32_bf16 v[38:41], v[6:9], a[16:19], v[38:41]
    s_waitcnt vmcnt(17)
    v_mfma_f32_16x16x32_bf16 v[54:57], v[6:9], a[20:23], v[54:57]
    ds_read_b128 v[6:9], v4 offset:49152
    s_waitcnt lgkmcnt(7)
    v_mfma_f32_16x16x32_bf16 v[42:45], v[10:13], a[16:19], v[42:45]
    v_mfma_f32_16x16x32_bf16 v[58:61], v[10:13], a[20:23], v[58:61]
    ds_read_b128 v[10:13], v4 offset:50176
    s_waitcnt lgkmcnt(7)
    v_mfma_f32_16x16x32_bf16 v[46:49], v[14:17], a[16:19], v[46:49]
    v_mfma_f32_16x16x32_bf16 v[62:65], v[14:17], a[20:23], v[62:65]
    ds_read_b128 v[14:17], v4 offset:51200
    s_waitcnt lgkmcnt(7)
    v_mfma_f32_16x16x32_bf16 v[50:53], v[18:21], a[16:19], v[50:53]
    v_mfma_f32_16x16x32_bf16 v[66:69], v[18:21], a[20:23], v[66:69]
    ds_read_b128 v[18:21], v4 offset:52224
    s_waitcnt vmcnt(16) lgkmcnt(7)
    v_mfma_f32_16x16x32_bf16 v[38:41], v[22:25], a[24:27], v[38:41]
    s_waitcnt vmcnt(15)
    v_mfma_f32_16x16x32_bf16 v[54:57], v[22:25], a[28:31], v[54:57]
    ds_read_b128 v[22:25], v4 offset:53248
    s_waitcnt lgkmcnt(7)
    v_mfma_f32_16x16x32_bf16 v[42:45], v[26:29], a[24:27], v[42:45]
    v_mfma_f32_16x16x32_bf16 v[58:61], v[26:29], a[28:31], v[58:61]
    ds_read_b128 v[26:29], v4 offset:54272
    s_waitcnt lgkmcnt(7)
    v_mfma_f32_16x16x32_bf16 v[46:49], v[30:33], a[24:27], v[46:49]
    v_mfma_f32_16x16x32_bf16 v[62:65], v[30:33], a[28:31], v[62:65]
    ds_read_b128 v[30:33], v4 offset:55296
    s_waitcnt lgkmcnt(7)
    v_mfma_f32_16x16x32_bf16 v[50:53], v[34:37], a[24:27], v[50:53]
    v_mfma_f32_16x16x32_bf16 v[66:69], v[34:37], a[28:31], v[66:69]
    ds_read_b128 v[34:37], v4 offset:56320
    s_barrier
    s_waitcnt vmcnt(14) lgkmcnt(7)
    v_mfma_f32_16x16x32_bf16 v[38:41], v[6:9], a[32:35], v[38:41]
    s_waitcnt vmcnt(13)
    v_mfma_f32_16x16x32_bf16 v[54:57], v[6:9], a[36:39], v[54:57]
    ds_read_b128 v[6:9], v4 offset:57344
    s_waitcnt lgkmcnt(7)
    v_mfma_f32_16x16x32_bf16 v[42:45], v[10:13], a[32:35], v[42:45]
    v_mfma_f32_16x16x32_bf16 v[58:61], v[10:13], a[36:39], v[58:61]
    ds_read_b128 v[10:13], v4 offset:58368
    s_waitcnt lgkmcnt(7)
    v_mfma_f32_16x16x32_bf16 v[46:49], v[14:17], a[32:35], v[46:49]
    v_mfma_f32_16x16x32_bf16 v[62:65], v[14:17], a[36:39], v[62:65]
    ds_read_b128 v[14:17], v4 offset:59392
    s_waitcnt lgkmcnt(7)
    v_mfma_f32_16x16x32_bf16 v[50:53], v[18:21], a[32:35], v[50:53]
    v_mfma_f32_16x16x32_bf16 v[66:69], v[18:21], a[36:39], v[66:69]
    ds_read_b128 v[18:21], v4 offset:60416
    s_waitcnt vmcnt(12) lgkmcnt(7)
    v_mfma_f32_16x16x32_bf16 v[38:41], v[22:25], a[40:43], v[38:41]
    s_waitcnt vmcnt(11)
    v_mfma_f32_16x16x32_bf16 v[54:57], v[22:25], a[44:47], v[54:57]
    ds_read_b128 v[22:25], v4 offset:61440
    s_waitcnt lgkmcnt(7)
    v_mfma_f32_16x16x32_bf16 v[42:45], v[26:29], a[40:43], v[42:45]
    v_mfma_f32_16x16x32_bf16 v[58:61], v[26:29], a[44:47], v[58:61]
    ds_read_b128 v[26:29], v4 offset:62464
    s_waitcnt lgkmcnt(7)
    v_mfma_f32_16x16x32_bf16 v[46:49], v[30:33], a[40:43], v[46:49]
    v_mfma_f32_16x16x32_bf16 v[62:65], v[30:33], a[44:47], v[62:65]
    ds_read_b128 v[30:33], v4 offset:63488
    s_waitcnt lgkmcnt(7)
    v_mfma_f32_16x16x32_bf16 v[50:53], v[34:37], a[40:43], v[50:53]
    v_mfma_f32_16x16x32_bf16 v[66:69], v[34:37], a[44:47], v[66:69]
    ds_read_b128 v[34:37], v4 offset:64512
    s_waitcnt vmcnt(10) lgkmcnt(7)
    v_mfma_f32_16x16x32_bf16 v[38:41], v[6:9], a[48:51], v[38:41]
    s_waitcnt vmcnt(9)
    v_mfma_f32_16x16x32_bf16 v[54:57], v[6:9], a[52:55], v[54:57]
    s_waitcnt lgkmcnt(6)
    v_mfma_f32_16x16x32_bf16 v[42:45], v[10:13], a[48:51], v[42:45]
    v_mfma_f32_16x16x32_bf16 v[58:61], v[10:13], a[52:55], v[58:61]
    s_waitcnt lgkmcnt(5)
    v_mfma_f32_16x16x32_bf16 v[46:49], v[14:17], a[48:51], v[46:49]
    v_mfma_f32_16x16x32_bf16 v[62:65], v[14:17], a[52:55], v[62:65]
    s_waitcnt lgkmcnt(4)
    v_mfma_f32_16x16x32_bf16 v[50:53], v[18:21], a[48:51], v[50:53]
    v_mfma_f32_16x16x32_bf16 v[66:69], v[18:21], a[52:55], v[66:69]
    s_waitcnt vmcnt(8) lgkmcnt(3)
    v_mfma_f32_16x16x32_bf16 v[38:41], v[22:25], a[56:59], v[38:41]
    s_waitcnt vmcnt(7)
    v_mfma_f32_16x16x32_bf16 v[54:57], v[22:25], a[60:63], v[54:57]
    s_waitcnt lgkmcnt(2)
    v_mfma_f32_16x16x32_bf16 v[42:45], v[26:29], a[56:59], v[42:45]
    v_mfma_f32_16x16x32_bf16 v[58:61], v[26:29], a[60:63], v[58:61]
    s_waitcnt lgkmcnt(1)
    v_mfma_f32_16x16x32_bf16 v[46:49], v[30:33], a[56:59], v[46:49]
    v_mfma_f32_16x16x32_bf16 v[62:65], v[30:33], a[60:63], v[62:65]
    s_waitcnt lgkmcnt(0)
    v_mfma_f32_16x16x32_bf16 v[50:53], v[34:37], a[56:59], v[50:53]
    v_mfma_f32_16x16x32_bf16 v[66:69], v[34:37], a[60:63], v[66:69]
    s_waitcnt vmcnt(6)
    v_pk_mul_f32 v[38:39], v[38:39], v[78:79] op_sel_hi:[1,0]
    v_pk_mul_f32 v[40:41], v[40:41], v[78:79] op_sel_hi:[1,0]
    v_pk_mul_f32 v[42:43], v[42:43], v[78:79] op_sel_hi:[1,0]
    v_pk_mul_f32 v[44:45], v[44:45], v[78:79] op_sel_hi:[1,0]
    v_pk_mul_f32 v[46:47], v[46:47], v[78:79] op_sel_hi:[1,0]
    v_pk_mul_f32 v[48:49], v[48:49], v[78:79] op_sel_hi:[1,0]
    v_pk_mul_f32 v[50:51], v[50:51], v[78:79] op_sel_hi:[1,0]
    v_pk_mul_f32 v[52:53], v[52:53], v[78:79] op_sel_hi:[1,0]
    v_pk_mul_f32 v[88:89], v[38:39], v[38:39]
    v_pk_mul_f32 v[90:91], v[40:41], v[40:41]
    v_pk_mul_f32 v[92:93], v[42:43], v[42:43]
    v_pk_mul_f32 v[94:95], v[44:45], v[44:45]
    v_pk_mul_f32 v[96:97], v[46:47], v[46:47]
    v_pk_mul_f32 v[98:99], v[48:49], v[48:49]
    v_pk_mul_f32 v[100:101], v[50:51], v[50:51]
    v_pk_mul_f32 v[102:103], v[52:53], v[52:53]
    v_pk_fma_f32 v[88:89], v[88:89], s[46:47], v[72:73] op_sel_hi:[1,0,0]
    v_pk_fma_f32 v[90:91], v[90:91], s[46:47], v[72:73] op_sel_hi:[1,0,0]
    v_pk_fma_f32 v[92:93], v[92:93], s[46:47], v[72:73] op_sel_hi:[1,0,0]
    v_pk_fma_f32 v[94:95], v[94:95], s[46:47], v[72:73] op_sel_hi:[1,0,0]
    v_pk_fma_f32 v[96:97], v[96:97], s[46:47], v[72:73] op_sel_hi:[1,0,0]
    v_pk_fma_f32 v[98:99], v[98:99], s[46:47], v[72:73] op_sel_hi:[1,0,0]
    v_pk_fma_f32 v[100:101], v[100:101], s[46:47], v[72:73] op_sel_hi:[1,0,0]
    v_pk_fma_f32 v[102:103], v[102:103], s[46:47], v[72:73] op_sel_hi:[1,0,0]
    v_pk_mul_f32 v[88:89], v[88:89], v[38:39]
    v_pk_mul_f32 v[90:91], v[90:91], v[40:41]
    v_pk_mul_f32 v[92:93], v[92:93], v[42:43]
    v_pk_mul_f32 v[94:95], v[94:95], v[44:45]
    v_pk_mul_f32 v[96:97], v[96:97], v[46:47]
    v_pk_mul_f32 v[98:99], v[98:99], v[48:49]
    v_pk_mul_f32 v[100:101], v[100:101], v[50:51]
    v_pk_mul_f32 v[102:103], v[102:103], v[52:53]
    v_exp_f32 v88, v88
    v_exp_f32 v89, v89
    v_exp_f32 v90, v90
    v_exp_f32 v91, v91
    v_exp_f32 v92, v92
    v_exp_f32 v93, v93
    v_exp_f32 v94, v94
    v_exp_f32 v95, v95
    v_exp_f32 v96, v96
    v_exp_f32 v97, v97
    v_exp_f32 v98, v98
    v_exp_f32 v99, v99
    v_exp_f32 v100, v100
    v_exp_f32 v101, v101
    v_exp_f32 v102, v102
    v_exp_f32 v103, v103
    v_pk_add_f32 v[88:89], v[88:89], s[48:49] op_sel_hi:[1,0]
    v_pk_add_f32 v[90:91], v[90:91], s[48:49] op_sel_hi:[1,0]
    v_pk_add_f32 v[92:93], v[92:93], s[48:49] op_sel_hi:[1,0]
    v_pk_add_f32 v[94:95], v[94:95], s[48:49] op_sel_hi:[1,0]
    v_pk_add_f32 v[96:97], v[96:97], s[48:49] op_sel_hi:[1,0]
    v_pk_add_f32 v[98:99], v[98:99], s[48:49] op_sel_hi:[1,0]
    v_pk_add_f32 v[100:101], v[100:101], s[48:49] op_sel_hi:[1,0]
    v_pk_add_f32 v[102:103], v[102:103], s[48:49] op_sel_hi:[1,0]
    v_rcp_f32 v88, v88
    v_rcp_f32 v89, v89
    v_rcp_f32 v90, v90
    v_rcp_f32 v91, v91
    v_rcp_f32 v92, v92
    v_rcp_f32 v93, v93
    v_rcp_f32 v94, v94
    v_rcp_f32 v95, v95
    v_rcp_f32 v96, v96
    v_rcp_f32 v97, v97
    v_rcp_f32 v98, v98
    v_rcp_f32 v99, v99
    v_rcp_f32 v100, v100
    v_rcp_f32 v101, v101
    v_rcp_f32 v102, v102
    v_rcp_f32 v103, v103
    v_pk_mul_f32 v[38:39], v[88:89], v[38:39]
    v_pk_mul_f32 v[40:41], v[90:91], v[40:41]
    v_pk_mul_f32 v[42:43], v[92:93], v[42:43]
    v_pk_mul_f32 v[44:45], v[94:95], v[44:45]
    v_pk_mul_f32 v[46:47], v[96:97], v[46:47]
    v_pk_mul_f32 v[48:49], v[98:99], v[48:49]
    v_pk_mul_f32 v[50:51], v[100:101], v[50:51]
    v_pk_mul_f32 v[52:53], v[102:103], v[52:53]
    v_cvt_pk_bf16_f32 v104, v38, v39
    v_cvt_pk_bf16_f32 v105, v40, v41
    v_cvt_pk_bf16_f32 v106, v42, v43
    v_cvt_pk_bf16_f32 v107, v44, v45
    v_and_b32 v104, v85, v104
    v_and_b32 v105, v85, v105
    v_and_b32 v106, v85, v106
    v_and_b32 v107, v85, v107
    buffer_store_dwordx4 v[104:107], v83, s[20:23], 0 offen offset:0 sc1
    v_cvt_pk_bf16_f32 v108, v46, v47
    v_cvt_pk_bf16_f32 v109, v48, v49
    v_cvt_pk_bf16_f32 v110, v50, v51
    v_cvt_pk_bf16_f32 v111, v52, v53
    v_and_b32 v108, v85, v108
    v_and_b32 v109, v85, v109
    v_and_b32 v110, v85, v110
    v_and_b32 v111, v85, v111
    buffer_store_dwordx4 v[108:111], v83, s[20:23], 0 offen offset:1024 sc1
    s_waitcnt vmcnt(7)
    v_pk_mul_f32 v[54:55], v[54:55], v[80:81] op_sel_hi:[1,0]
    v_pk_mul_f32 v[56:57], v[56:57], v[80:81] op_sel_hi:[1,0]
    v_pk_mul_f32 v[58:59], v[58:59], v[80:81] op_sel_hi:[1,0]
    v_pk_mul_f32 v[60:61], v[60:61], v[80:81] op_sel_hi:[1,0]
    v_pk_mul_f32 v[62:63], v[62:63], v[80:81] op_sel_hi:[1,0]
    v_pk_mul_f32 v[64:65], v[64:65], v[80:81] op_sel_hi:[1,0]
    v_pk_mul_f32 v[66:67], v[66:67], v[80:81] op_sel_hi:[1,0]
    v_pk_mul_f32 v[68:69], v[68:69], v[80:81] op_sel_hi:[1,0]
    v_pk_mul_f32 v[88:89], v[54:55], v[54:55]
    v_pk_mul_f32 v[90:91], v[56:57], v[56:57]
    v_pk_mul_f32 v[92:93], v[58:59], v[58:59]
    v_pk_mul_f32 v[94:95], v[60:61], v[60:61]
    v_pk_mul_f32 v[96:97], v[62:63], v[62:63]
    v_pk_mul_f32 v[98:99], v[64:65], v[64:65]
    v_pk_mul_f32 v[100:101], v[66:67], v[66:67]
    v_pk_mul_f32 v[102:103], v[68:69], v[68:69]
    v_pk_fma_f32 v[88:89], v[88:89], s[46:47], v[72:73] op_sel_hi:[1,0,0]
    v_pk_fma_f32 v[90:91], v[90:91], s[46:47], v[72:73] op_sel_hi:[1,0,0]
    v_pk_fma_f32 v[92:93], v[92:93], s[46:47], v[72:73] op_sel_hi:[1,0,0]
    v_pk_fma_f32 v[94:95], v[94:95], s[46:47], v[72:73] op_sel_hi:[1,0,0]
    v_pk_fma_f32 v[96:97], v[96:97], s[46:47], v[72:73] op_sel_hi:[1,0,0]
    v_pk_fma_f32 v[98:99], v[98:99], s[46:47], v[72:73] op_sel_hi:[1,0,0]
    v_pk_fma_f32 v[100:101], v[100:101], s[46:47], v[72:73] op_sel_hi:[1,0,0]
    v_pk_fma_f32 v[102:103], v[102:103], s[46:47], v[72:73] op_sel_hi:[1,0,0]
    v_pk_mul_f32 v[88:89], v[88:89], v[54:55]
    v_pk_mul_f32 v[90:91], v[90:91], v[56:57]
    v_pk_mul_f32 v[92:93], v[92:93], v[58:59]
    v_pk_mul_f32 v[94:95], v[94:95], v[60:61]
    v_pk_mul_f32 v[96:97], v[96:97], v[62:63]
    v_pk_mul_f32 v[98:99], v[98:99], v[64:65]
    v_pk_mul_f32 v[100:101], v[100:101], v[66:67]
    v_pk_mul_f32 v[102:103], v[102:103], v[68:69]
    v_exp_f32 v88, v88
    v_exp_f32 v89, v89
    v_exp_f32 v90, v90
    v_exp_f32 v91, v91
    v_exp_f32 v92, v92
    v_exp_f32 v93, v93
    v_exp_f32 v94, v94
    v_exp_f32 v95, v95
    v_exp_f32 v96, v96
    v_exp_f32 v97, v97
    v_exp_f32 v98, v98
    v_exp_f32 v99, v99
    v_exp_f32 v100, v100
    v_exp_f32 v101, v101
    v_exp_f32 v102, v102
    v_exp_f32 v103, v103
    v_pk_add_f32 v[88:89], v[88:89], s[48:49] op_sel_hi:[1,0]
    v_pk_add_f32 v[90:91], v[90:91], s[48:49] op_sel_hi:[1,0]
    v_pk_add_f32 v[92:93], v[92:93], s[48:49] op_sel_hi:[1,0]
    v_pk_add_f32 v[94:95], v[94:95], s[48:49] op_sel_hi:[1,0]
    v_pk_add_f32 v[96:97], v[96:97], s[48:49] op_sel_hi:[1,0]
    v_pk_add_f32 v[98:99], v[98:99], s[48:49] op_sel_hi:[1,0]
    v_pk_add_f32 v[100:101], v[100:101], s[48:49] op_sel_hi:[1,0]
    v_pk_add_f32 v[102:103], v[102:103], s[48:49] op_sel_hi:[1,0]
    v_rcp_f32 v88, v88
    v_rcp_f32 v89, v89
    v_rcp_f32 v90, v90
    v_rcp_f32 v91, v91
    v_rcp_f32 v92, v92
    v_rcp_f32 v93, v93
    v_rcp_f32 v94, v94
    v_rcp_f32 v95, v95
    v_rcp_f32 v96, v96
    v_rcp_f32 v97, v97
    v_rcp_f32 v98, v98
    v_rcp_f32 v99, v99
    v_rcp_f32 v100, v100
    v_rcp_f32 v101, v101
    v_rcp_f32 v102, v102
    v_rcp_f32 v103, v103
    v_pk_mul_f32 v[54:55], v[88:89], v[54:55]
    v_pk_mul_f32 v[56:57], v[90:91], v[56:57]
    v_pk_mul_f32 v[58:59], v[92:93], v[58:59]
    v_pk_mul_f32 v[60:61], v[94:95], v[60:61]
    v_pk_mul_f32 v[62:63], v[96:97], v[62:63]
    v_pk_mul_f32 v[64:65], v[98:99], v[64:65]
    v_pk_mul_f32 v[66:67], v[100:101], v[66:67]
    v_pk_mul_f32 v[68:69], v[102:103], v[68:69]
    v_cvt_pk_bf16_f32 v112, v54, v55
    v_cvt_pk_bf16_f32 v113, v56, v57
    v_cvt_pk_bf16_f32 v114, v58, v59
    v_cvt_pk_bf16_f32 v115, v60, v61
    v_and_b32 v112, v86, v112
    v_and_b32 v113, v86, v113
    v_and_b32 v114, v86, v114
    v_and_b32 v115, v86, v115
    buffer_store_dwordx4 v[112:115], v84, s[20:23], 0 offen offset:0 sc1
    v_cvt_pk_bf16_f32 v116, v62, v63
    v_cvt_pk_bf16_f32 v117, v64, v65
    v_cvt_pk_bf16_f32 v118, v66, v67
    v_cvt_pk_bf16_f32 v119, v68, v69
    v_and_b32 v116, v86, v116
    v_and_b32 v117, v86, v117
    v_and_b32 v118, v86, v118
    v_and_b32 v119, v86, v119
    buffer_store_dwordx4 v[116:119], v84, s[20:23], 0 offen offset:1024 sc1
    s_mov_b32 s92, s76
    s_mov_b32 s93, s77
    s_mov_b32 s94, 7340032
    s_mov_b32 s95, 0x20000
    s_cmp_eq_u32 s32, 0
    s_cselect_b32 s94, 0, s94
    s_mul_i32 s91, s2, 9472
    s_add_u32 s91, s91, 4915200
    v_lshl_add_u32 v40, s32, 6, v0
    v_subrev_u32 v40, 64, v40
    v_lshlrev_b32 v40, 7, v40
    v_cmp_gt_u32 vcc, 9472, v40
    s_nop 1
    v_cndmask_b32 v253, -16, v40, vcc
    v_min_u32 v253, 0x40000000, v253
    buffer_load_dword v252, v253, s[92:95], s91 offen
    s_waitcnt vmcnt(1)
    s_barrier
    s_lshr_b32 s90, s33, 3
    s_lshl_b32 s90, s90, 1
    s_bfe_u32 s38, s34, 0x10002
    s_add_u32 s90, s90, s38
    s_add_u32 s90, s90, 32
    s_lshl_b32 s90, s90, 8
    s_add_u32 s96, s84, 47513600
    s_addc_u32 s97, s85, 0
    s_mov_b32 s98, 32768
    s_mov_b32 s99, 0x20000
    s_cmp_eq_u32 s32, 0
    s_cselect_b32 s98, s98, 0
    v_mov_b32 v38, s90
    v_mov_b32 v39, 1
    s_mov_b64 exec, 1
    buffer_atomic_add v39, v38, s[96:99], 0 offen sc1
    s_mov_b64 exec, -1
L_g2_kernel_entry:
    v_mbcnt_lo_u32_b32 v0, -1, 0
    v_mbcnt_hi_u32_b32 v0, -1, v0
    v_lshl_add_u32 v0, s32, 6, v0
    s_mov_b64 s[4:5], s[74:75]
    s_mov_b64 s[6:7], s[84:85]
    v_and_b32 v0, 63, v0
    s_and_b32 s38, s2, 7
    s_lshr_b32 s39, s2, 3
    s_and_b32 s33, s39, 1
    s_lshl_b32 s38, s38, 1
    s_add_u32 s33, s33, s38
    s_lshr_b32 s34, s39, 1
    s_mul_i32 s33, s33, 8
    s_mul_i32 s38, s32, 2
    s_add_u32 s33, s33, s38
    s_mul_i32 s38, s33, 32768
    v_lshlrev_b32 v1, 4, v0
    v_add_u32 v1, s38, v1
    v_add_u32 v2, 32768, v1
    s_mul_i32 s37, s32, 2048
    s_mul_i32 s38, s34, 131072
    s_add_u32 s38, s38, s37
    v_lshlrev_b32 v250, 4, v0
    v_add_u32 v250, s38, v250
    s_mov_b32 s35, 0
    s_mov_b32 s36, 0
    s_add_u32 s16, s6, 50331648
    s_addc_u32 s17, s7, 0
    s_mov_b32 s18, 2097152
    s_mov_b32 s19, 0x20000
    s_add_u32 s12, s6, 20971520
    s_addc_u32 s13, s7, 0
    s_mov_b32 s14, 4194304
    s_mov_b32 s15, 0x20000
    s_add_u32 m0, s37, 0
    s_nop 0
    buffer_load_dwordx4 v250, s[16:19], s36 offen sc1 lds
    buffer_load_dwordx4 v250, s[16:19], s36 offen offset:1024 sc1 lds
    s_add_u32 s36, s36, 8192
    s_add_u32 m0, s37, 8192
    s_nop 0
    buffer_load_dwordx4 v250, s[16:19], s36 offen sc1 lds
    buffer_load_dwordx4 v250, s[16:19], s36 offen offset:1024 sc1 lds
    s_add_u32 s36, s36, 8192
    s_add_u32 m0, s37, 16384
    s_nop 0
    buffer_load_dwordx4 v250, s[16:19], s36 offen sc1 lds
    buffer_load_dwordx4 v250, s[16:19], s36 offen offset:1024 sc1 lds
    s_add_u32 s36, s36, 8192
    s_add_u32 m0, s37, 24576
    s_nop 0
    buffer_load_dwordx4 v250, s[16:19], s36 offen sc1 lds
    buffer_load_dwordx4 v250, s[16:19], s36 offen offset:1024 sc1 lds
    s_add_u32 s36, s36, 8192
    s_add_u32 m0, s37, 32768
    s_nop 0
    buffer_load_dwordx4 v250, s[16:19], s36 offen sc1 lds
    buffer_load_dwordx4 v250, s[16:19], s36 offen offset:1024 sc1 lds
    s_add_u32 s36, s36, 8192
    s_add_u32 m0, s37, 40960
    s_nop 0
    buffer_load_dwordx4 v250, s[16:19], s36 offen sc1 lds
    buffer_load_dwordx4 v250, s[16:19], s36 offen offset:1024 sc1 lds
    s_add_u32 s36, s36, 8192
    s_add_u32 m0, s37, 49152
    s_nop 0
    buffer_load_dwordx4 v250, s[16:19], s36 offen sc1 lds
    buffer_load_dwordx4 v250, s[16:19], s36 offen offset:1024 sc1 lds
    s_add_u32 s36, s36, 8192
    s_add_u32 m0, s37, 57344
    s_nop 0
    buffer_load_dwordx4 v250, s[16:19], s36 offen sc1 lds
    buffer_load_dwordx4 v250, s[16:19], s36 offen offset:1024 sc1 lds
    s_add_u32 s36, s36, 8192
    v_lshlrev_b32 v3, 4, v0
    v_add_u32 v4, 65536, v3
    s_mov_b32 s44, 0xc0135761
    s_mov_b32 s46, 0xbdd2d3e8
    s_mov_b32 s48, 1.0
    v_mov_b32 v72, s44
    s_lshl_b32 s38, s33, 15
    s_lshl_b32 s39, s34, 11
    s_add_u32 s38, s38, s39
    v_lshlrev_b32 v77, 4, v0
    v_add_u32 v77, s38, v77
    v_add_u32 v78, 32768, v77
    s_add_u32 s20, s6, 25165824
    s_addc_u32 s21, s7, 0
    s_mov_b32 s22, 4194304
    s_mov_b32 s23, 0x20000
    s_add_u32 s24, s6, 16777216
    s_addc_u32 s25, s7, 0
    s_mov_b32 s26, 4194304
    s_mov_b32 s27, 0x20000
    s_add_u32 s28, s6, 46202880
    s_addc_u32 s29, s7, 0
    s_mov_b32 s30, 262144
    s_mov_b32 s31, 0x20000
    s_lshl_b32 s38, s33, 11
    s_lshl_b32 s39, s34, 7
    s_add_u32 s38, s38, s39
    v_and_b32 v74, 15, v0
    v_lshlrev_b32 v74, 3, v74
    v_add_u32 v70, s38, v74
    s_lshr_b32 s38, s33, 3
    v_min_u32 v39, 3, v0
    v_lshrrev_b32 v38, 1, v39
    v_and_b32 v39, 1, v39
    v_lshlrev_b32 v40, 1, v39
    v_add_u32 v40, -1, v40
    v_mul_i32_i24 v38, v38, v40
    v_add_u32 v38, s38, v38
    v_and_b32 v38, 15, v38
    v_lshl_add_u32 v38, v38, 1, v39
    v_add_u32 v38, 32, v38
    v_lshlrev_b32 v38, 8, v38
    v_mov_b32 v40, 8
    s_add_u32 s96, s84, 47513600
    s_addc_u32 s97, s85, 0
    s_mov_b32 s98, 32768
    s_mov_b32 s99, 0x20000
    s_cmp_eq_u32 s32, 0
    s_cselect_b32 s98, s98, 0
    buffer_load_dword v39, v38, s[96:99], 0 offen sc1
    s_add_u32 m0, s37, 65536
    s_nop 0
    buffer_load_dwordx4 v250, s[16:19], s36 offen sc1 lds
    buffer_load_dwordx4 v250, s[16:19], s36 offen offset:1024 sc1 lds
    s_add_u32 s36, s36, 8192
    s_add_u32 m0, s37, 73728
    s_nop 0
    buffer_load_dwordx4 v250, s[16:19], s36 offen sc1 lds
    buffer_load_dwordx4 v250, s[16:19], s36 offen offset:1024 sc1 lds
    s_add_u32 s36, s36, 8192
    s_add_u32 m0, s37, 81920
    s_nop 0
    buffer_load_dwordx4 v250, s[16:19], s36 offen sc1 lds
    buffer_load_dwordx4 v250, s[16:19], s36 offen offset:1024 sc1 lds
    s_add_u32 s36, s36, 8192
    s_add_u32 m0, s37, 90112
    s_nop 0
    buffer_load_dwordx4 v250, s[16:19], s36 offen sc1 lds
    buffer_load_dwordx4 v250, s[16:19], s36 offen offset:1024 sc1 lds
    s_add_u32 s36, s36, 8192
    s_add_u32 m0, s37, 98304
    s_nop 0
    buffer_load_dwordx4 v250, s[16:19], s36 offen sc1 lds
    buffer_load_dwordx4 v250, s[16:19], s36 offen offset:1024 sc1 lds
    s_add_u32 s36, s36, 8192
    s_waitcnt vmcnt(10)
    v_cmp_le_u32 vcc, v40, v39
    s_mov_b32 s91, 0x80000
    s_nop 4
    s_cmp_lg_u32 s32, 0
    s_cbranch_scc1 L_g2_kernel_go
    s_cmp_eq_u64 vcc, -1
    s_cbranch_scc1 L_g2_kernel_go
L_g2_kernel_poll:
    buffer_load_dword v39, v38, s[96:99], 0 offen sc1
    s_sub_u32 s91, s91, 1
    s_waitcnt vmcnt(0)
    v_cmp_le_u32 vcc, v40, v39
    s_nop 4
    s_cmp_eq_u64 vcc, -1
    s_cbranch_scc1 L_g2_kernel_go
    s_cmp_lg_u32 s91, 0
    s_cbranch_scc1 L_g2_kernel_poll
L_g2_kernel_go:
    s_nop 4
    s_barrier
    buffer_load_dwordx4 a[0:3], v1, s[12:15], s35 offen sc1
    buffer_load_dwordx4 a[4:7], v2, s[12:15], s35 offen sc1
    buffer_load_dwordx4 a[8:11], v1, s[12:15], s35 offen offset:1024 sc1
    buffer_load_dwordx4 a[12:15], v2, s[12:15], s35 offen offset:1024 sc1
    buffer_load_dwordx4 a[16:19], v1, s[12:15], s35 offen offset:2048 sc1
    buffer_load_dwordx4 a[20:23], v2, s[12:15], s35 offen offset:2048 sc1
    buffer_load_dwordx4 a[24:27], v1, s[12:15], s35 offen offset:3072 sc1
    buffer_load_dwordx4 a[28:31], v2, s[12:15], s35 offen offset:3072 sc1
    s_add_u32 s35, s35, 4096
    buffer_load_dwordx4 a[32:35], v1, s[12:15], s35 offen sc1
    buffer_load_dwordx4 a[36:39], v2, s[12:15], s35 offen sc1
    buffer_load_dwordx4 a[40:43], v1, s[12:15], s35 offen offset:1024 sc1
    buffer_load_dwordx4 a[44:47], v2, s[12:15], s35 offen offset:1024 sc1
    s_barrier
    ds_read_b128 v[6:9], v3 offset:0
    ds_read_b128 v[10:13], v3 offset:1024
    ds_read_b128 v[14:17], v3 offset:2048
    ds_read_b128 v[18:21], v3 offset:3072
    ds_read_b128 v[22:25], v3 offset:4096
    ds_read_b128 v[26:29], v3 offset:5120
    ds_read_b128 v[30:33], v3 offset:6144
    ds_read_b128 v[34:37], v3 offset:7168
    s_barrier
    s_waitcnt vmcnt(11) lgkmcnt(7)
    v_mfma_f32_16x16x32_bf16 v[38:41], v[6:9], a[0:3], 0
    buffer_load_dwordx4 a[48:51], v1, s[12:15], s35 offen offset:2048 sc1
    s_waitcnt vmcnt(11)
    v_mfma_f32_16x16x32_bf16 v[54:57], v[6:9], a[4:7], 0
    ds_read_b128 v[6:9], v3 offset:8192
    s_waitcnt lgkmcnt(7)
    v_mfma_f32_16x16x32_bf16 v[42:45], v[10:13], a[0:3], 0
    buffer_load_dwordx4 a[52:55], v2, s[12:15], s35 offen offset:2048 sc1
    v_mfma_f32_16x16x32_bf16 v[58:61], v[10:13], a[4:7], 0
    ds_read_b128 v[10:13], v3 offset:9216
    s_waitcnt lgkmcnt(7)
    v_mfma_f32_16x16x32_bf16 v[46:49], v[14:17], a[0:3], 0
    buffer_load_dwordx4 a[56:59], v1, s[12:15], s35 offen offset:3072 sc1
    v_mfma_f32_16x16x32_bf16 v[62:65], v[14:17], a[4:7], 0
    ds_read_b128 v[14:17], v3 offset:10240
    s_waitcnt lgkmcnt(7)
    v_mfma_f32_16x16x32_bf16 v[50:53], v[18:21], a[0:3], 0
    buffer_load_dwordx4 a[60:63], v2, s[12:15], s35 offen offset:3072 sc1
    s_add_u32 s35, s35, 4096
    v_mfma_f32_16x16x32_bf16 v[66:69], v[18:21], a[4:7], 0
    ds_read_b128 v[18:21], v3 offset:11264
    s_waitcnt vmcnt(13) lgkmcnt(7)
    v_mfma_f32_16x16x32_bf16 v[38:41], v[22:25], a[8:11], v[38:41]
    buffer_load_dwordx4 a[0:3], v1, s[12:15], s35 offen sc1
    s_waitcnt vmcnt(13)
    v_mfma_f32_16x16x32_bf16 v[54:57], v[22:25], a[12:15], v[54:57]
    ds_read_b128 v[22:25], v3 offset:12288
    s_waitcnt lgkmcnt(7)
    v_mfma_f32_16x16x32_bf16 v[42:45], v[26:29], a[8:11], v[42:45]
    buffer_load_dwordx4 a[4:7], v2, s[12:15], s35 offen sc1
    v_mfma_f32_16x16x32_bf16 v[58:61], v[26:29], a[12:15], v[58:61]
    ds_read_b128 v[26:29], v3 offset:13312
    s_waitcnt lgkmcnt(7)
    v_mfma_f32_16x16x32_bf16 v[46:49], v[30:33], a[8:11], v[46:49]
    v_mfma_f32_16x16x32_bf16 v[62:65], v[30:33], a[12:15], v[62:65]
    ds_read_b128 v[30:33], v3 offset:14336
    s_waitcnt lgkmcnt(7)
    v_mfma_f32_16x16x32_bf16 v[50:53], v[34:37], a[8:11], v[50:53]
    v_mfma_f32_16x16x32_bf16 v[66:69], v[34:37], a[12:15], v[66:69]
    ds_read_b128 v[34:37], v3 offset:15360
    s_barrier
    s_waitcnt vmcnt(13) lgkmcnt(7)
    v_mfma_f32_16x16x32_bf16 v[38:41], v[6:9], a[16:19], v[38:41]
    buffer_load_dwordx4 a[8:11], v1, s[12:15], s35 offen offset:1024 sc1
    s_waitcnt vmcnt(13)
    v_mfma_f32_16x16x32_bf16 v[54:57], v[6:9], a[20:23], v[54:57]
    ds_read_b128 v[6:9], v3 offset:16384
    s_waitcnt lgkmcnt(7)
    v_mfma_f32_16x16x32_bf16 v[42:45], v[10:13], a[16:19], v[42:45]
    buffer_load_dwordx4 a[12:15], v2, s[12:15], s35 offen offset:1024 sc1
    v_mfma_f32_16x16x32_bf16 v[58:61], v[10:13], a[20:23], v[58:61]
    ds_read_b128 v[10:13], v3 offset:17408
    s_waitcnt lgkmcnt(7)
    v_mfma_f32_16x16x32_bf16 v[46:49], v[14:17], a[16:19], v[46:49]
    v_mfma_f32_16x16x32_bf16 v[62:65], v[14:17], a[20:23], v[62:65]
    ds_read_b128 v[14:17], v3 offset:18432
    s_waitcnt lgkmcnt(7)
    v_mfma_f32_16x16x32_bf16 v[50:53], v[18:21], a[16:19], v[50:53]
    v_mfma_f32_16x16x32_bf16 v[66:69], v[18:21], a[20:23], v[66:69]
    ds_read_b128 v[18:21], v3 offset:19456
    s_waitcnt vmcnt(13) lgkmcnt(7)
    v_mfma_f32_16x16x32_bf16 v[38:41], v[22:25], a[24:27], v[38:41]
    buffer_load_dwordx4 a[16:19], v1, s[12:15], s35 offen offset:2048 sc1
    s_waitcnt vmcnt(13)
    v_mfma_f32_16x16x32_bf16 v[54:57], v[22:25], a[28:31], v[54:57]
    ds_read_b128 v[22:25], v3 offset:20480
    s_waitcnt lgkmcnt(7)
    v_mfma_f32_16x16x32_bf16 v[42:45], v[26:29], a[24:27], v[42:45]
    buffer_load_dwordx4 a[20:23], v2, s[12:15], s35 offen offset:2048 sc1
    v_mfma_f32_16x16x32_bf16 v[58:61], v[26:29], a[28:31], v[58:61]
    ds_read_b128 v[26:29], v3 offset:21504
    s_waitcnt lgkmcnt(7)
    v_mfma_f32_16x16x32_bf16 v[46:49], v[30:33], a[24:27], v[46:49]
    v_mfma_f32_16x16x32_bf16 v[62:65], v[30:33], a[28:31], v[62:65]
    ds_read_b128 v[30:33], v3 offset:22528
    s_waitcnt lgkmcnt(7)
    v_mfma_f32_16x16x32_bf16 v[50:53], v[34:37], a[24:27], v[50:53]
    v_mfma_f32_16x16x32_bf16 v[66:69], v[34:37], a[28:31], v[66:69]
    ds_read_b128 v[34:37], v3 offset:23552
    s_barrier
    s_waitcnt vmcnt(13) lgkmcnt(7)
    v_mfma_f32_16x16x32_bf16 v[38:41], v[6:9], a[32:35], v[38:41]
    buffer_load_dwordx4 a[24:27], v1, s[12:15], s35 offen offset:3072 sc1
    s_waitcnt vmcnt(13)
    v_mfma_f32_16x16x32_bf16 v[54:57], v[6:9], a[36:39], v[54:57]
    ds_read_b128 v[6:9], v3 offset:24576
    s_waitcnt lgkmcnt(7)
    v_mfma_f32_16x16x32_bf16 v[42:45], v[10:13], a[32:35], v[42:45]
    buffer_load_dwordx4 a[28:31], v2, s[12:15], s35 offen offset:3072 sc1
    s_add_u32 s35, s35, 4096
    v_mfma_f32_16x16x32_bf16 v[58:61], v[10:13], a[36:39], v[58:61]
    ds_read_b128 v[10:13], v3 offset:25600
    s_waitcnt lgkmcnt(7)
    v_mfma_f32_16x16x32_bf16 v[46:49], v[14:17], a[32:35], v[46:49]
    v_mfma_f32_16x16x32_bf16 v[62:65], v[14:17], a[36:39], v[62:65]
    ds_read_b128 v[14:17], v3 offset:26624
    s_waitcnt lgkmcnt(7)
    v_mfma_f32_16x16x32_bf16 v[50:53], v[18:21], a[32:35], v[50:53]
    v_mfma_f32_16x16x32_bf16 v[66:69], v[18:21], a[36:39], v[66:69]
    ds_read_b128 v[18:21], v3 offset:27648
    s_waitcnt vmcnt(13) lgkmcnt(7)
    v_mfma_f32_16x16x32_bf16 v[38:41], v[22:25], a[40:43], v[38:41]
    buffer_load_dwordx4 a[32:35], v1, s[12:15], s35 offen sc1
    s_waitcnt vmcnt(13)
    v_mfma_f32_16x16x32_bf16 v[54:57], v[22:25], a[44:47], v[54:57]
    ds_read_b128 v[22:25], v3 offset:28672
    s_waitcnt lgkmcnt(7)
    v_mfma_f32_16x16x32_bf16 v[42:45], v[26:29], a[40:43], v[42:45]
    buffer_load_dwordx4 a[36:39], v2, s[12:15], s35 offen sc1
    v_mfma_f32_16x16x32_bf16 v[58:61], v[26:29], a[44:47], v[58:61]
    ds_read_b128 v[26:29], v3 offset:29696
    s_waitcnt lgkmcnt(7)
    v_mfma_f32_16x16x32_bf16 v[46:49], v[30:33], a[40:43], v[46:49]
    v_mfma_f32_16x16x32_bf16 v[62:65], v[30:33], a[44:47], v[62:65]
    ds_read_b128 v[30:33], v3 offset:30720
    s_waitcnt lgkmcnt(7)
    v_mfma_f32_16x16x32_bf16 v[50:53], v[34:37], a[40:43], v[50:53]
    v_mfma_f32_16x16x32_bf16 v[66:69], v[34:37], a[44:47], v[66:69]
    ds_read_b128 v[34:37], v3 offset:31744
    s_barrier
    s_waitcnt vmcnt(13) lgkmcnt(7)
    v_mfma_f32_16x16x32_bf16 v[38:41], v[6:9], a[48:51], v[38:41]
    buffer_load_dwordx4 a[40:43], v1, s[12:15], s35 offen offset:1024 sc1
    s_waitcnt vmcnt(13)
    v_mfma_f32_16x16x32_bf16 v[54:57], v[6:9], a[52:55], v[54:57]
    ds_read_b128 v[6:9], v3 offset:32768
    s_waitcnt lgkmcnt(7)
    v_mfma_f32_16x16x32_bf16 v[42:45], v[10:13], a[48:51], v[42:45]
    buffer_load_dwordx4 a[44:47], v2, s[12:15], s35 offen offset:1024 sc1
    v_mfma_f32_16x16x32_bf16 v[58:61], v[10:13], a[52:55], v[58:61]
    ds_read_b128 v[10:13], v3 offset:33792
    s_waitcnt lgkmcnt(7)
    v_mfma_f32_16x16x32_bf16 v[46:49], v[14:17], a[48:51], v[46:49]
    v_mfma_f32_16x16x32_bf16 v[62:65], v[14:17], a[52:55], v[62:65]
    ds_read_b128 v[14:17], v3 offset:34816
    s_waitcnt lgkmcnt(7)
    v_mfma_f32_16x16x32_bf16 v[50:53], v[18:21], a[48:51], v[50:53]
    v_mfma_f32_16x16x32_bf16 v[66:69], v[18:21], a[52:55], v[66:69]
    ds_read_b128 v[18:21], v3 offset:35840
    s_waitcnt vmcnt(13) lgkmcnt(7)
    v_mfma_f32_16x16x32_bf16 v[38:41], v[22:25], a[56:59], v[38:41]
    buffer_load_dwordx4 a[48:51], v1, s[12:15], s35 offen offset:2048 sc1
    s_waitcnt vmcnt(13)
    v_mfma_f32_16x16x32_bf16 v[54:57], v[22:25], a[60:63], v[54:57]
    ds_read_b128 v[22:25], v3 offset:36864
    s_waitcnt lgkmcnt(7)
    v_mfma_f32_16x16x32_bf16 v[42:45], v[26:29], a[56:59], v[42:45]
    buffer_load_dwordx4 a[52:55], v2, s[12:15], s35 offen offset:2048 sc1
    v_mfma_f32_16x16x32_bf16 v[58:61], v[26:29], a[60:63], v[58:61]
    ds_read_b128 v[26:29], v3 offset:37888
    s_waitcnt lgkmcnt(7)
    v_mfma_f32_16x16x32_bf16 v[46:49], v[30:33], a[56:59], v[46:49]
    v_mfma_f32_16x16x32_bf16 v[62:65], v[30:33], a[60:63], v[62:65]
    ds_read_b128 v[30:33], v3 offset:38912
    s_waitcnt lgkmcnt(7)
    v_mfma_f32_16x16x32_bf16 v[50:53], v[34:37], a[56:59], v[50:53]
    v_mfma_f32_16x16x32_bf16 v[66:69], v[34:37], a[60:63], v[66:69]
    ds_read_b128 v[34:37], v3 offset:39936
    s_barrier
    s_waitcnt vmcnt(13) lgkmcnt(7)
    v_mfma_f32_16x16x32_bf16 v[38:41], v[6:9], a[0:3], v[38:41]
    buffer_load_dwordx4 a[56:59], v1, s[12:15], s35 offen offset:3072 sc1
    s_waitcnt vmcnt(13)
    v_mfma_f32_16x16x32_bf16 v[54:57], v[6:9], a[4:7], v[54:57]
    ds_read_b128 v[6:9], v3 offset:40960
    s_waitcnt lgkmcnt(7)
    v_mfma_f32_16x16x32_bf16 v[42:45], v[10:13], a[0:3], v[42:45]
    buffer_load_dwordx4 a[60:63], v2, s[12:15], s35 offen offset:3072 sc1
    s_add_u32 s35, s35, 4096
    v_mfma_f32_16x16x32_bf16 v[58:61], v[10:13], a[4:7], v[58:61]
    ds_read_b128 v[10:13], v3 offset:41984
    s_waitcnt lgkmcnt(7)
    v_mfma_f32_16x16x32_bf16 v[46:49], v[14:17], a[0:3], v[46:49]
    v_mfma_f32_16x16x32_bf16 v[62:65], v[14:17], a[4:7], v[62:65]
    ds_read_b128 v[14:17], v3 offset:43008
    s_waitcnt lgkmcnt(7)
    v_mfma_f32_16x16x32_bf16 v[50:53], v[18:21], a[0:3], v[50:53]
    v_mfma_f32_16x16x32_bf16 v[66:69], v[18:21], a[4:7], v[66:69]
    ds_read_b128 v[18:21], v3 offset:44032
    s_waitcnt vmcnt(13) lgkmcnt(7)
    v_mfma_f32_16x16x32_bf16 v[38:41], v[22:25], a[8:11], v[38:41]
    s_add_u32 m0, s37, 106496
    s_nop 0
    buffer_load_dwordx4 v250, s[16:19], s36 offen sc1 lds
    s_waitcnt vmcnt(13)
    v_mfma_f32_16x16x32_bf16 v[54:57], v[22:25], a[12:15], v[54:57]
    ds_read_b128 v[22:25], v3 offset:45056
    s_waitcnt lgkmcnt(7)
    v_mfma_f32_16x16x32_bf16 v[42:45], v[26:29], a[8:11], v[42:45]
    buffer_load_dwordx4 v250, s[16:19], s36 offen offset:1024 sc1 lds
    s_add_u32 s36, s36, 8192
    v_mfma_f32_16x16x32_bf16 v[58:61], v[26:29], a[12:15], v[58:61]
    ds_read_b128 v[26:29], v3 offset:46080
    s_waitcnt lgkmcnt(7)
    v_mfma_f32_16x16x32_bf16 v[46:49], v[30:33], a[8:11], v[46:49]
    buffer_load_dwordx4 a[0:3], v1, s[12:15], s35 offen sc1
    v_mfma_f32_16x16x32_bf16 v[62:65], v[30:33], a[12:15], v[62:65]
    ds_read_b128 v[30:33], v3 offset:47104
    s_waitcnt lgkmcnt(7)
    v_mfma_f32_16x16x32_bf16 v[50:53], v[34:37], a[8:11], v[50:53]
    buffer_load_dwordx4 a[4:7], v2, s[12:15], s35 offen sc1
    v_mfma_f32_16x16x32_bf16 v[66:69], v[34:37], a[12:15], v[66:69]
    ds_read_b128 v[34:37], v3 offset:48128
    s_barrier
    s_waitcnt vmcnt(15) lgkmcnt(7)
    v_mfma_f32_16x16x32_bf16 v[38:41], v[6:9], a[16:19], v[38:41]
    s_add_u32 m0, s37, 114688
    s_nop 0
    buffer_load_dwordx4 v250, s[16:19], s36 offen sc1 lds
    s_waitcnt vmcnt(15)
    v_mfma_f32_16x16x32_bf16 v[54:57], v[6:9], a[20:23], v[54:57]
    ds_read_b128 v[6:9], v3 offset:49152
    s_waitcnt lgkmcnt(7)
    v_mfma_f32_16x16x32_bf16 v[42:45], v[10:13], a[16:19], v[42:45]
    buffer_load_dwordx4 v250, s[16:19], s36 offen offset:1024 sc1 lds
    s_add_u32 s36, s36, 8192
    v_mfma_f32_16x16x32_bf16 v[58:61], v[10:13], a[20:23], v[58:61]
    ds_read_b128 v[10:13], v3 offset:50176
    s_waitcnt lgkmcnt(7)
    v_mfma_f32_16x16x32_bf16 v[46:49], v[14:17], a[16:19], v[46:49]
    buffer_load_dwordx4 a[8:11], v1, s[12:15], s35 offen offset:1024 sc1
    v_mfma_f32_16x16x32_bf16 v[62:65], v[14:17], a[20:23], v[62:65]
    ds_read_b128 v[14:17], v3 offset:51200
    s_waitcnt lgkmcnt(7)
    v_mfma_f32_16x16x32_bf16 v[50:53], v[18:21], a[16:19], v[50:53]
    buffer_load_dwordx4 a[12:15], v2, s[12:15], s35 offen offset:1024 sc1
    v_mfma_f32_16x16x32_bf16 v[66:69], v[18:21], a[20:23], v[66:69]
    ds_read_b128 v[18:21], v3 offset:52224
    s_waitcnt vmcnt(17) lgkmcnt(7)
    v_mfma_f32_16x16x32_bf16 v[38:41], v[22:25], a[24:27], v[38:41]
    s_add_u32 m0, s37, 122880
    s_nop 0
    buffer_load_dwordx4 v250, s[16:19], s36 offen sc1 lds
    s_waitcnt vmcnt(17)
    v_mfma_f32_16x16x32_bf16 v[54:57], v[22:25], a[28:31], v[54:57]
    ds_read_b128 v[22:25], v3 offset:53248
    s_waitcnt lgkmcnt(7)
    v_mfma_f32_16x16x32_bf16 v[42:45], v[26:29], a[24:27], v[42:45]
    buffer_load_dwordx4 v250, s[16:19], s36 offen offset:1024 sc1 lds
    s_add_u32 s36, s36, 8192
    v_mfma_f32_16x16x32_bf16 v[58:61], v[26:29], a[28:31], v[58:61]
    ds_read_b128 v[26:29], v3 offset:54272
    s_waitcnt lgkmcnt(7)
    v_mfma_f32_16x16x32_bf16 v[46:49], v[30:33], a[24:27], v[46:49]
    buffer_load_dwordx4 a[16:19], v1, s[12:15], s35 offen offset:2048 sc1
    v_mfma_f32_16x16x32_bf16 v[62:65], v[30:33], a[28:31], v[62:65]
    ds_read_b128 v[30:33], v3 offset:55296
    s_waitcnt lgkmcnt(7)
    v_mfma_f32_16x16x32_bf16 v[50:53], v[34:37], a[24:27], v[50:53]
    buffer_load_dwordx4 a[20:23], v2, s[12:15], s35 offen offset:2048 sc1
    v_mfma_f32_16x16x32_bf16 v[66:69], v[34:37], a[28:31], v[66:69]
    ds_read_b128 v[34:37], v3 offset:56320
    s_barrier
    s_waitcnt vmcnt(19) lgkmcnt(7)
    v_mfma_f32_16x16x32_bf16 v[38:41], v[6:9], a[32:35], v[38:41]
    buffer_load_dwordx4 a[24:27], v1, s[12:15], s35 offen offset:3072 sc1
    s_waitcnt vmcnt(19)
    v_mfma_f32_16x16x32_bf16 v[54:57], v[6:9], a[36:39], v[54:57]
    ds_read_b128 v[6:9], v3 offset:57344
    s_waitcnt lgkmcnt(7)
    v_mfma_f32_16x16x32_bf16 v[42:45], v[10:13], a[32:35], v[42:45]
    buffer_load_dwordx4 a[28:31], v2, s[12:15], s35 offen offset:3072 sc1
    s_add_u32 s35, s35, 4096
    v_mfma_f32_16x16x32_bf16 v[58:61], v[10:13], a[36:39], v[58:61]
    ds_read_b128 v[10:13], v3 offset:58368
    s_waitcnt lgkmcnt(7)
    v_mfma_f32_16x16x32_bf16 v[46:49], v[14:17], a[32:35], v[46:49]
    v_mfma_f32_16x16x32_bf16 v[62:65], v[14:17], a[36:39], v[62:65]
    ds_read_b128 v[14:17], v3 offset:59392
    s_waitcnt lgkmcnt(7)
    v_mfma_f32_16x16x32_bf16 v[50:53], v[18:21], a[32:35], v[50:53]
    v_mfma_f32_16x16x32_bf16 v[66:69], v[18:21], a[36:39], v[66:69]
    ds_read_b128 v[18:21], v3 offset:60416
    s_waitcnt vmcnt(19) lgkmcnt(7)
    v_mfma_f32_16x16x32_bf16 v[38:41], v[22:25], a[40:43], v[38:41]
    buffer_load_dwordx4 a[32:35], v1, s[12:15], s35 offen sc1
    s_waitcnt vmcnt(19)
    v_mfma_f32_16x16x32_bf16 v[54:57], v[22:25], a[44:47], v[54:57]
    ds_read_b128 v[22:25], v3 offset:61440
    s_waitcnt lgkmcnt(7)
    v_mfma_f32_16x16x32_bf16 v[42:45], v[26:29], a[40:43], v[42:45]
    buffer_load_dwordx4 a[36:39], v2, s[12:15], s35 offen sc1
    v_mfma_f32_16x16x32_bf16 v[58:61], v[26:29], a[44:47], v[58:61]
    ds_read_b128 v[26:29], v3 offset:62464
    s_waitcnt lgkmcnt(7)
    v_mfma_f32_16x16x32_bf16 v[46:49], v[30:33], a[40:43], v[46:49]
    v_mfma_f32_16x16x32_bf16 v[62:65], v[30:33], a[44:47], v[62:65]
    ds_read_b128 v[30:33], v3 offset:63488
    s_waitcnt lgkmcnt(7)
    v_mfma_f32_16x16x32_bf16 v[50:53], v[34:37], a[40:43], v[50:53]
    v_mfma_f32_16x16x32_bf16 v[66:69], v[34:37], a[44:47], v[66:69]
    ds_read_b128 v[34:37], v3 offset:64512
    s_barrier
    s_waitcnt vmcnt(19) lgkmcnt(7)
    v_mfma_f32_16x16x32_bf16 v[38:41], v[6:9], a[48:51], v[38:41]
    buffer_load_dwordx4 a[40:43], v1, s[12:15], s35 offen offset:1024 sc1
    s_waitcnt vmcnt(19)
    v_mfma_f32_16x16x32_bf16 v[54:57], v[6:9], a[52:55], v[54:57]
    ds_read_b128 v[6:9], v4 offset:0
    s_waitcnt lgkmcnt(7)
    v_mfma_f32_16x16x32_bf16 v[42:45], v[10:13], a[48:51], v[42:45]
    buffer_load_dwordx4 a[44:47], v2, s[12:15], s35 offen offset:1024 sc1
    v_mfma_f32_16x16x32_bf16 v[58:61], v[10:13], a[52:55], v[58:61]
    ds_read_b128 v[10:13], v4 offset:1024
    s_waitcnt lgkmcnt(7)
    v_mfma_f32_16x16x32_bf16 v[46:49], v[14:17], a[48:51], v[46:49]
    v_mfma_f32_16x16x32_bf16 v[62:65], v[14:17], a[52:55], v[62:65]
    ds_read_b128 v[14:17], v4 offset:2048
    s_waitcnt lgkmcnt(7)
    v_mfma_f32_16x16x32_bf16 v[50:53], v[18:21], a[48:51], v[50:53]
    v_mfma_f32_16x16x32_bf16 v[66:69], v[18:21], a[52:55], v[66:69]
    ds_read_b128 v[18:21], v4 offset:3072
    s_waitcnt vmcnt(19) lgkmcnt(7)
    v_mfma_f32_16x16x32_bf16 v[38:41], v[22:25], a[56:59], v[38:41]
    buffer_load_dwordx4 a[48:51], v1, s[12:15], s35 offen offset:2048 sc1
    s_waitcnt vmcnt(19)
    v_mfma_f32_16x16x32_bf16 v[54:57], v[22:25], a[60:63], v[54:57]
    ds_read_b128 v[22:25], v4 offset:4096
    s_waitcnt lgkmcnt(7)
    v_mfma_f32_16x16x32_bf16 v[42:45], v[26:29], a[56:59], v[42:45]
    buffer_load_dwordx4 a[52:55], v2, s[12:15], s35 offen offset:2048 sc1
    v_mfma_f32_16x16x32_bf16 v[58:61], v[26:29], a[60:63], v[58:61]
    ds_read_b128 v[26:29], v4 offset:5120
    s_waitcnt lgkmcnt(7)
    v_mfma_f32_16x16x32_bf16 v[46:49], v[30:33], a[56:59], v[46:49]
    v_mfma_f32_16x16x32_bf16 v[62:65], v[30:33], a[60:63], v[62:65]
    ds_read_b128 v[30:33], v4 offset:6144
    s_waitcnt lgkmcnt(7)
    v_mfma_f32_16x16x32_bf16 v[50:53], v[34:37], a[56:59], v[50:53]
    v_mfma_f32_16x16x32_bf16 v[66:69], v[34:37], a[60:63], v[66:69]
    ds_read_b128 v[34:37], v4 offset:7168
    s_barrier
    s_waitcnt vmcnt(17) lgkmcnt(7)
    v_mfma_f32_16x16x32_bf16 v[38:41], v[6:9], a[0:3], v[38:41]
    buffer_load_dwordx4 a[56:59], v1, s[12:15], s35 offen offset:3072 sc1
    s_waitcnt vmcnt(17)
    v_mfma_f32_16x16x32_bf16 v[54:57], v[6:9], a[4:7], v[54:57]
    ds_read_b128 v[6:9], v4 offset:8192
    s_waitcnt lgkmcnt(7)
    v_mfma_f32_16x16x32_bf16 v[42:45], v[10:13], a[0:3], v[42:45]
    buffer_load_dwordx4 a[60:63], v2, s[12:15], s35 offen offset:3072 sc1
    s_add_u32 s35, s35, 4096
    v_mfma_f32_16x16x32_bf16 v[58:61], v[10:13], a[4:7], v[58:61]
    ds_read_b128 v[10:13], v4 offset:9216
    s_waitcnt lgkmcnt(7)
    v_mfma_f32_16x16x32_bf16 v[46:49], v[14:17], a[0:3], v[46:49]
    v_mfma_f32_16x16x32_bf16 v[62:65], v[14:17], a[4:7], v[62:65]
    ds_read_b128 v[14:17], v4 offset:10240
    s_waitcnt lgkmcnt(7)
    v_mfma_f32_16x16x32_bf16 v[50:53], v[18:21], a[0:3], v[50:53]
    v_mfma_f32_16x16x32_bf16 v[66:69], v[18:21], a[4:7], v[66:69]
    ds_read_b128 v[18:21], v4 offset:11264
    s_waitcnt vmcnt(15) lgkmcnt(7)
    v_mfma_f32_16x16x32_bf16 v[38:41], v[22:25], a[8:11], v[38:41]
    buffer_load_dwordx4 a[0:3], v1, s[12:15], s35 offen sc1
    s_waitcnt vmcnt(15)
    v_mfma_f32_16x16x32_bf16 v[54:57], v[22:25], a[12:15], v[54:57]
    ds_read_b128 v[22:25], v4 offset:12288
    s_waitcnt lgkmcnt(7)
    v_mfma_f32_16x16x32_bf16 v[42:45], v[26:29], a[8:11], v[42:45]
    buffer_load_dwordx4 a[4:7], v2, s[12:15], s35 offen sc1
    v_mfma_f32_16x16x32_bf16 v[58:61], v[26:29], a[12:15], v[58:61]
    ds_read_b128 v[26:29], v4 offset:13312
    s_waitcnt lgkmcnt(7)
    v_mfma_f32_16x16x32_bf16 v[46:49], v[30:33], a[8:11], v[46:49]
    v_mfma_f32_16x16x32_bf16 v[62:65], v[30:33], a[12:15], v[62:65]
    ds_read_b128 v[30:33], v4 offset:14336
    s_waitcnt lgkmcnt(7)
    v_mfma_f32_16x16x32_bf16 v[50:53], v[34:37], a[8:11], v[50:53]
    v_mfma_f32_16x16x32_bf16 v[66:69], v[34:37], a[12:15], v[66:69]
    ds_read_b128 v[34:37], v4 offset:15360
    s_barrier
    s_waitcnt vmcnt(13) lgkmcnt(7)
    v_mfma_f32_16x16x32_bf16 v[38:41], v[6:9], a[16:19], v[38:41]
    buffer_load_dwordx4 a[8:11], v1, s[12:15], s35 offen offset:1024 sc1
    s_waitcnt vmcnt(13)
    v_mfma_f32_16x16x32_bf16 v[54:57], v[6:9], a[20:23], v[54:57]
    ds_read_b128 v[6:9], v4 offset:16384
    s_waitcnt lgkmcnt(7)
    v_mfma_f32_16x16x32_bf16 v[42:45], v[10:13], a[16:19], v[42:45]
    buffer_load_dwordx4 a[12:15], v2, s[12:15], s35 offen offset:1024 sc1
    v_mfma_f32_16x16x32_bf16 v[58:61], v[10:13], a[20:23], v[58:61]
    ds_read_b128 v[10:13], v4 offset:17408
    s_waitcnt lgkmcnt(7)
    v_mfma_f32_16x16x32_bf16 v[46:49], v[14:17], a[16:19], v[46:49]
    v_mfma_f32_16x16x32_bf16 v[62:65], v[14:17], a[20:23], v[62:65]
    ds_read_b128 v[14:17], v4 offset:18432
    s_waitcnt lgkmcnt(7)
    v_mfma_f32_16x16x32_bf16 v[50:53], v[18:21], a[16:19], v[50:53]
    v_mfma_f32_16x16x32_bf16 v[66:69], v[18:21], a[20:23], v[66:69]
    ds_read_b128 v[18:21], v4 offset:19456
    s_waitcnt vmcnt(13) lgkmcnt(7)
    v_mfma_f32_16x16x32_bf16 v[38:41], v[22:25], a[24:27], v[38:41]
    buffer_load_dwordx4 a[16:19], v1, s[12:15], s35 offen offset:2048 sc1
    s_waitcnt vmcnt(13)
    v_mfma_f32_16x16x32_bf16 v[54:57], v[22:25], a[28:31], v[54:57]
    ds_read_b128 v[22:25], v4 offset:20480
    s_waitcnt lgkmcnt(7)
    v_mfma_f32_16x16x32_bf16 v[42:45], v[26:29], a[24:27], v[42:45]
    buffer_load_dwordx4 a[20:23], v2, s[12:15], s35 offen offset:2048 sc1
    v_mfma_f32_16x16x32_bf16 v[58:61], v[26:29], a[28:31], v[58:61]
    ds_read_b128 v[26:29], v4 offset:21504
    s_waitcnt lgkmcnt(7)
    v_mfma_f32_16x16x32_bf16 v[46:49], v[30:33], a[24:27], v[46:49]
    v_mfma_f32_16x16x32_bf16 v[62:65], v[30:33], a[28:31], v[62:65]
    ds_read_b128 v[30:33], v4 offset:22528
    s_waitcnt lgkmcnt(7)
    v_mfma_f32_16x16x32_bf16 v[50:53], v[34:37], a[24:27], v[50:53]
    v_mfma_f32_16x16x32_bf16 v[66:69], v[34:37], a[28:31], v[66:69]
    ds_read_b128 v[34:37], v4 offset:23552
    s_barrier
    s_waitcnt vmcnt(13) lgkmcnt(7)
    v_mfma_f32_16x16x32_bf16 v[38:41], v[6:9], a[32:35], v[38:41]
    buffer_load_dwordx4 a[24:27], v1, s[12:15], s35 offen offset:3072 sc1
    s_waitcnt vmcnt(13)
    v_mfma_f32_16x16x32_bf16 v[54:57], v[6:9], a[36:39], v[54:57]
    ds_read_b128 v[6:9], v4 offset:24576
    s_waitcnt lgkmcnt(7)
    v_mfma_f32_16x16x32_bf16 v[42:45], v[10:13], a[32:35], v[42:45]
    buffer_load_dwordx4 a[28:31], v2, s[12:15], s35 offen offset:3072 sc1
    s_add_u32 s35, s35, 4096
    v_mfma_f32_16x16x32_bf16 v[58:61], v[10:13], a[36:39], v[58:61]
    ds_read_b128 v[10:13], v4 offset:25600
    s_waitcnt lgkmcnt(7)
    v_mfma_f32_16x16x32_bf16 v[46:49], v[14:17], a[32:35], v[46:49]
    v_mfma_f32_16x16x32_bf16 v[62:65], v[14:17], a[36:39], v[62:65]
    ds_read_b128 v[14:17], v4 offset:26624
    s_waitcnt lgkmcnt(7)
    v_mfma_f32_16x16x32_bf16 v[50:53], v[18:21], a[32:35], v[50:53]
    v_mfma_f32_16x16x32_bf16 v[66:69], v[18:21], a[36:39], v[66:69]
    ds_read_b128 v[18:21], v4 offset:27648
    s_waitcnt vmcnt(13) lgkmcnt(7)
    v_mfma_f32_16x16x32_bf16 v[38:41], v[22:25], a[40:43], v[38:41]
    buffer_load_dwordx4 a[32:35], v1, s[12:15], s35 offen sc1
    s_waitcnt vmcnt(13)
    v_mfma_f32_16x16x32_bf16 v[54:57], v[22:25], a[44:47], v[54:57]
    ds_read_b128 v[22:25], v4 offset:28672
    s_waitcnt lgkmcnt(7)
    v_mfma_f32_16x16x32_bf16 v[42:45], v[26:29], a[40:43], v[42:45]
    buffer_load_dwordx4 a[36:39], v2, s[12:15], s35 offen sc1
    v_mfma_f32_16x16x32_bf16 v[58:61], v[26:29], a[44:47], v[58:61]
    ds_read_b128 v[26:29], v4 offset:29696
    s_waitcnt lgkmcnt(7)
    v_mfma_f32_16x16x32_bf16 v[46:49], v[30:33], a[40:43], v[46:49]
    v_mfma_f32_16x16x32_bf16 v[62:65], v[30:33], a[44:47], v[62:65]
    ds_read_b128 v[30:33], v4 offset:30720
    s_waitcnt lgkmcnt(7)
    v_mfma_f32_16x16x32_bf16 v[50:53], v[34:37], a[40:43], v[50:53]
    v_mfma_f32_16x16x32_bf16 v[66:69], v[34:37], a[44:47], v[66:69]
    ds_read_b128 v[34:37], v4 offset:31744
    s_barrier
    s_waitcnt vmcnt(13) lgkmcnt(7)
    v_mfma_f32_16x16x32_bf16 v[38:41], v[6:9], a[48:51], v[38:41]
    buffer_load_dwordx4 a[40:43], v1, s[12:15], s35 offen offset:1024 sc1
    s_waitcnt vmcnt(13)
    v_mfma_f32_16x16x32_bf16 v[54:57], v[6:9], a[52:55], v[54:57]
    ds_read_b128 v[6:9], v4 offset:32768
    s_waitcnt lgkmcnt(7)
    v_mfma_f32_16x16x32_bf16 v[42:45], v[10:13], a[48:51], v[42:45]
    buffer_load_dwordx4 a[44:47], v2, s[12:15], s35 offen offset:1024 sc1
    v_mfma_f32_16x16x32_bf16 v[58:61], v[10:13], a[52:55], v[58:61]
    ds_read_b128 v[10:13], v4 offset:33792
    s_waitcnt lgkmcnt(7)
    v_mfma_f32_16x16x32_bf16 v[46:49], v[14:17], a[48:51], v[46:49]
    v_mfma_f32_16x16x32_bf16 v[62:65], v[14:17], a[52:55], v[62:65]
    ds_read_b128 v[14:17], v4 offset:34816
    s_waitcnt lgkmcnt(7)
    v_mfma_f32_16x16x32_bf16 v[50:53], v[18:21], a[48:51], v[50:53]
    v_mfma_f32_16x16x32_bf16 v[66:69], v[18:21], a[52:55], v[66:69]
    ds_read_b128 v[18:21], v4 offset:35840
    s_waitcnt vmcnt(13) lgkmcnt(7)
    v_mfma_f32_16x16x32_bf16 v[38:41], v[22:25], a[56:59], v[38:41]
    buffer_load_dwordx4 a[48:51], v1, s[12:15], s35 offen offset:2048 sc1
    s_waitcnt vmcnt(13)
    v_mfma_f32_16x16x32_bf16 v[54:57], v[22:25], a[60:63], v[54:57]
    ds_read_b128 v[22:25], v4 offset:36864
    s_waitcnt lgkmcnt(7)
    v_mfma_f32_16x16x32_bf16 v[42:45], v[26:29], a[56:59], v[42:45]
    buffer_load_dwordx4 a[52:55], v2, s[12:15], s35 offen offset:2048 sc1
    v_mfma_f32_16x16x32_bf16 v[58:61], v[26:29], a[60:63], v[58:61]
    ds_read_b128 v[26:29], v4 offset:37888
    s_waitcnt lgkmcnt(7)
    v_mfma_f32_16x16x32_bf16 v[46:49], v[30:33], a[56:59], v[46:49]
    v_mfma_f32_16x16x32_bf16 v[62:65], v[30:33], a[60:63], v[62:65]
    ds_read_b128 v[30:33], v4 offset:38912
    s_waitcnt lgkmcnt(7)
    v_mfma_f32_16x16x32_bf16 v[50:53], v[34:37], a[56:59], v[50:53]
    v_mfma_f32_16x16x32_bf16 v[66:69], v[34:37], a[60:63], v[66:69]
    ds_read_b128 v[34:37], v4 offset:39936
    s_barrier
    s_waitcnt vmcnt(13) lgkmcnt(7)
    v_mfma_f32_16x16x32_bf16 v[38:41], v[6:9], a[0:3], v[38:41]
    buffer_load_dwordx4 a[56:59], v1, s[12:15], s35 offen offset:3072 sc1
    s_waitcnt vmcnt(13)
    v_mfma_f32_16x16x32_bf16 v[54:57], v[6:9], a[4:7], v[54:57]
    ds_read_b128 v[6:9], v4 offset:40960
    s_waitcnt lgkmcnt(7)
    v_mfma_f32_16x16x32_bf16 v[42:45], v[10:13], a[0:3], v[42:45]
    buffer_load_dwordx4 a[60:63], v2, s[12:15], s35 offen offset:3072 sc1
    s_add_u32 s35, s35, 4096
    v_mfma_f32_16x16x32_bf16 v[58:61], v[10:13], a[4:7], v[58:61]
    ds_read_b128 v[10:13], v4 offset:41984
    s_waitcnt lgkmcnt(7)
    v_mfma_f32_16x16x32_bf16 v[46:49], v[14:17], a[0:3], v[46:49]
    v_mfma_f32_16x16x32_bf16 v[62:65], v[14:17], a[4:7], v[62:65]
    ds_read_b128 v[14:17], v4 offset:43008
    s_waitcnt lgkmcnt(7)
    v_mfma_f32_16x16x32_bf16 v[50:53], v[18:21], a[0:3], v[50:53]
    v_mfma_f32_16x16x32_bf16 v[66:69], v[18:21], a[4:7], v[66:69]
    ds_read_b128 v[18:21], v4 offset:44032
    s_waitcnt vmcnt(13) lgkmcnt(7)
    v_mfma_f32_16x16x32_bf16 v[38:41], v[22:25], a[8:11], v[38:41]
    s_waitcnt vmcnt(12)
    v_mfma_f32_16x16x32_bf16 v[54:57], v[22:25], a[12:15], v[54:57]
    ds_read_b128 v[22:25], v4 offset:45056
    s_waitcnt lgkmcnt(7)
    v_mfma_f32_16x16x32_bf16 v[42:45], v[26:29], a[8:11], v[42:45]
    v_mfma_f32_16x16x32_bf16 v[58:61], v[26:29], a[12:15], v[58:61]
    ds_read_b128 v[26:29], v4 offset:46080
    s_waitcnt lgkmcnt(7)
    v_mfma_f32_16x16x32_bf16 v[46:49], v[30:33], a[8:11], v[46:49]
    v_mfma_f32_16x16x32_bf16 v[62:65], v[30:33], a[12:15], v[62:65]
    ds_read_b128 v[30:33], v4 offset:47104
    s_waitcnt lgkmcnt(7)
    v_mfma_f32_16x16x32_bf16 v[50:53], v[34:37], a[8:11], v[50:53]
    v_mfma_f32_16x16x32_bf16 v[66:69], v[34:37], a[12:15], v[66:69]
    ds_read_b128 v[34:37], v4 offset:48128
    s_barrier
    buffer_load_dwordx4 v[80:83], v77, s[24:27], 0 offen offset:0 sc1
    buffer_load_dwordx4 v[84:87], v77, s[24:27], 0 offen offset:1024 sc1
    buffer_load_dwordx4 v[88:91], v78, s[24:27], 0 offen offset:0 sc1
    buffer_load_dwordx4 v[92:95], v78, s[24:27], 0 offen offset:1024 sc1
    s_getpc_b64 s[60:61]
L_pc6:
    s_add_u32 s60, s60, L_g3_kernel_entry-L_pc6
    s_addc_u32 s61, s61, 0
    s_lshr_b32 s62, s2, 3
    s_and_b32 s62, s62, 7
    s_lshl_b32 s62, s62, 2
    s_add_u32 s62, s62, s32
    s_mul_i32 s62, s62, 1024
    v_and_b32 v98, 63, v0
    v_lshlrev_b32 v98, 7, v98
    v_add_u32 v98, s62, v98
    v_min_u32 v98, L_g4_kernel_entry-L_g3_kernel_entry-4, v98
    s_mov_b64 exec, 255
    global_load_dword v96, v98, s[60:61]
    s_mov_b64 exec, -1
    s_waitcnt vmcnt(16) lgkmcnt(7)
    v_mfma_f32_16x16x32_bf16 v[38:41], v[6:9], a[16:19], v[38:41]
    s_waitcnt vmcnt(15)
    v_mfma_f32_16x16x32_bf16 v[54:57], v[6:9], a[20:23], v[54:57]
    ds_read_b128 v[6:9], v4 offset:49152
    s_waitcnt lgkmcnt(7)
    v_mfma_f32_16x16x32_bf16 v[42:45], v[10:13], a[16:19], v[42:45]
    v_mfma_f32_16x16x32_bf16 v[58:61], v[10:13], a[20:23], v[58:61]
    ds_read_b128 v[10:13], v4 offset:50176
    s_waitcnt lgkmcnt(7)
    v_mfma_f32_16x16x32_bf16 v[46:49], v[14:17], a[16:19], v[46:49]
    v_mfma_f32_16x16x32_bf16 v[62:65], v[14:17], a[20:23], v[62:65]
    ds_read_b128 v[14:17], v4 offset:51200
    s_waitcnt lgkmcnt(7)
    v_mfma_f32_16x16x32_bf16 v[50:53], v[18:21], a[16:19], v[50:53]
    v_mfma_f32_16x16x32_bf16 v[66:69], v[18:21], a[20:23], v[66:69]
    ds_read_b128 v[18:21], v4 offset:52224
    s_waitcnt vmcnt(14) lgkmcnt(7)
    v_mfma_f32_16x16x32_bf16 v[38:41], v[22:25], a[24:27], v[38:41]
    s_waitcnt vmcnt(13)
    v_mfma_f32_16x16x32_bf16 v[54:57], v[22:25], a[28:31], v[54:57]
    ds_read_b128 v[22:25], v4 offset:53248
    s_waitcnt lgkmcnt(7)
    v_mfma_f32_16x16x32_bf16 v[42:45], v[26:29], a[24:27], v[42:45]
    v_mfma_f32_16x16x32_bf16 v[58:61], v[26:29], a[28:31], v[58:61]
    ds_read_b128 v[26:29], v4 offset:54272
    s_waitcnt lgkmcnt(7)
    v_mfma_f32_16x16x32_bf16 v[46:49], v[30:33], a[24:27], v[46:49]
    v_mfma_f32_16x16x32_bf16 v[62:65], v[30:33], a[28:31], v[62:65]
    ds_read_b128 v[30:33], v4 offset:55296
    s_waitcnt lgkmcnt(7)
    v_mfma_f32_16x16x32_bf16 v[50:53], v[34:37], a[24:27], v[50:53]
    v_mfma_f32_16x16x32_bf16 v[66:69], v[34:37], a[28:31], v[66:69]
    ds_read_b128 v[34:37], v4 offset:56320
    s_barrier
    s_waitcnt vmcnt(12) lgkmcnt(7)
    v_mfma_f32_16x16x32_bf16 v[38:41], v[6:9], a[32:35], v[38:41]
    s_waitcnt vmcnt(11)
    v_mfma_f32_16x16x32_bf16 v[54:57], v[6:9], a[36:39], v[54:57]
    ds_read_b128 v[6:9], v4 offset:57344
    s_waitcnt lgkmcnt(7)
    v_mfma_f32_16x16x32_bf16 v[42:45], v[10:13], a[32:35], v[42:45]
    v_mfma_f32_16x16x32_bf16 v[58:61], v[10:13], a[36:39], v[58:61]
    ds_read_b128 v[10:13], v4 offset:58368
    s_waitcnt lgkmcnt(7)
    v_mfma_f32_16x16x32_bf16 v[46:49], v[14:17], a[32:35], v[46:49]
    v_mfma_f32_16x16x32_bf16 v[62:65], v[14:17], a[36:39], v[62:65]
    ds_read_b128 v[14:17], v4 offset:59392
    s_waitcnt lgkmcnt(7)
    v_mfma_f32_16x16x32_bf16 v[50:53], v[18:21], a[32:35], v[50:53]
    v_mfma_f32_16x16x32_bf16 v[66:69], v[18:21], a[36:39], v[66:69]
    ds_read_b128 v[18:21], v4 offset:60416
    s_waitcnt vmcnt(10) lgkmcnt(7)
    v_mfma_f32_16x16x32_bf16 v[38:41], v[22:25], a[40:43], v[38:41]
    s_waitcnt vmcnt(9)
    v_mfma_f32_16x16x32_bf16 v[54:57], v[22:25], a[44:47], v[54:57]
    ds_read_b128 v[22:25], v4 offset:61440
    s_waitcnt lgkmcnt(7)
    v_mfma_f32_16x16x32_bf16 v[42:45], v[26:29], a[40:43], v[42:45]
    v_mfma_f32_16x16x32_bf16 v[58:61], v[26:29], a[44:47], v[58:61]
    ds_read_b128 v[26:29], v4 offset:62464
    s_waitcnt lgkmcnt(7)
    v_mfma_f32_16x16x32_bf16 v[46:49], v[30:33], a[40:43], v[46:49]
    v_mfma_f32_16x16x32_bf16 v[62:65], v[30:33], a[44:47], v[62:65]
    ds_read_b128 v[30:33], v4 offset:63488
    s_waitcnt lgkmcnt(7)
    v_mfma_f32_16x16x32_bf16 v[50:53], v[34:37], a[40:43], v[50:53]
    v_mfma_f32_16x16x32_bf16 v[66:69], v[34:37], a[44:47], v[66:69]
    ds_read_b128 v[34:37], v4 offset:64512
    s_waitcnt vmcnt(8) lgkmcnt(7)
    v_mfma_f32_16x16x32_bf16 v[38:41], v[6:9], a[48:51], v[38:41]
    s_waitcnt vmcnt(7)
    v_mfma_f32_16x16x32_bf16 v[54:57], v[6:9], a[52:55], v[54:57]
    s_waitcnt lgkmcnt(6)
    v_mfma_f32_16x16x32_bf16 v[42:45], v[10:13], a[48:51], v[42:45]
    v_mfma_f32_16x16x32_bf16 v[58:61], v[10:13], a[52:55], v[58:61]
    s_waitcnt lgkmcnt(5)
    v_mfma_f32_16x16x32_bf16 v[46:49], v[14:17], a[48:51], v[46:49]
    v_mfma_f32_16x16x32_bf16 v[62:65], v[14:17], a[52:55], v[62:65]
    s_waitcnt lgkmcnt(4)
    v_mfma_f32_16x16x32_bf16 v[50:53], v[18:21], a[48:51], v[50:53]
    v_mfma_f32_16x16x32_bf16 v[66:69], v[18:21], a[52:55], v[66:69]
    s_waitcnt vmcnt(6) lgkmcnt(3)
    v_mfma_f32_16x16x32_bf16 v[38:41], v[22:25], a[56:59], v[38:41]
    s_waitcnt vmcnt(5)
    v_mfma_f32_16x16x32_bf16 v[54:57], v[22:25], a[60:63], v[54:57]
    s_waitcnt lgkmcnt(2)
    v_mfma_f32_16x16x32_bf16 v[42:45], v[26:29], a[56:59], v[42:45]
    v_mfma_f32_16x16x32_bf16 v[58:61], v[26:29], a[60:63], v[58:61]
    s_waitcnt lgkmcnt(1)
    v_mfma_f32_16x16x32_bf16 v[46:49], v[30:33], a[56:59], v[46:49]
    v_mfma_f32_16x16x32_bf16 v[62:65], v[30:33], a[60:63], v[62:65]
    s_waitcnt lgkmcnt(0)
    v_mfma_f32_16x16x32_bf16 v[50:53], v[34:37], a[56:59], v[50:53]
    v_mfma_f32_16x16x32_bf16 v[66:69], v[34:37], a[60:63], v[66:69]
    s_waitcnt vmcnt(4)
    v_lshlrev_b32 v98, 16, v80
    v_and_b32 v99, 0xffff0000, v80
    v_lshlrev_b32 v100, 16, v81
    v_and_b32 v101, 0xffff0000, v81
    v_lshlrev_b32 v102, 16, v82
    v_and_b32 v103, 0xffff0000, v82
    v_lshlrev_b32 v104, 16, v83
    v_and_b32 v105, 0xffff0000, v83
    v_pk_add_f32 v[38:39], v[38:39], v[98:99]
    v_pk_add_f32 v[40:41], v[40:41], v[100:101]
    v_pk_add_f32 v[42:43], v[42:43], v[102:103]
    v_pk_add_f32 v[44:45], v[44:45], v[104:105]
    s_waitcnt vmcnt(3)
    v_lshlrev_b32 v98, 16, v84
    v_and_b32 v99, 0xffff0000, v84
    v_lshlrev_b32 v100, 16, v85
    v_and_b32 v101, 0xffff0000, v85
    v_lshlrev_b32 v102, 16, v86
    v_and_b32 v103, 0xffff0000, v86
    v_lshlrev_b32 v104, 16, v87
    v_and_b32 v105, 0xffff0000, v87
    v_pk_add_f32 v[46:47], v[46:47], v[98:99]
    v_pk_add_f32 v[48:49], v[48:49], v[100:101]
    v_pk_add_f32 v[50:51], v[50:51], v[102:103]
    v_pk_add_f32 v[52:53], v[52:53], v[104:105]
    s_waitcnt vmcnt(2)
    v_lshlrev_b32 v98, 16, v88
    v_and_b32 v99, 0xffff0000, v88
    v_lshlrev_b32 v100, 16, v89
    v_and_b32 v101, 0xffff0000, v89
    v_lshlrev_b32 v102, 16, v90
    v_and_b32 v103, 0xffff0000, v90
    v_lshlrev_b32 v104, 16, v91
    v_and_b32 v105, 0xffff0000, v91
    v_pk_add_f32 v[54:55], v[54:55], v[98:99]
    v_pk_add_f32 v[56:57], v[56:57], v[100:101]
    v_pk_add_f32 v[58:59], v[58:59], v[102:103]
    v_pk_add_f32 v[60:61], v[60:61], v[104:105]
    s_waitcnt vmcnt(1)
    v_lshlrev_b32 v98, 16, v92
    v_and_b32 v99, 0xffff0000, v92
    v_lshlrev_b32 v100, 16, v93
    v_and_b32 v101, 0xffff0000, v93
    v_lshlrev_b32 v102, 16, v94
    v_and_b32 v103, 0xffff0000, v94
    v_lshlrev_b32 v104, 16, v95
    v_and_b32 v105, 0xffff0000, v95
    v_pk_add_f32 v[62:63], v[62:63], v[98:99]
    v_pk_add_f32 v[64:65], v[64:65], v[100:101]
    v_pk_add_f32 v[66:67], v[66:67], v[102:103]
    v_pk_add_f32 v[68:69], v[68:69], v[104:105]
    v_cvt_pk_bf16_f32 v106, v38, v39
    v_cvt_pk_bf16_f32 v107, v40, v41
    v_cvt_pk_bf16_f32 v108, v42, v43
    v_cvt_pk_bf16_f32 v109, v44, v45
    buffer_store_dwordx4 v[106:109], v77, s[20:23], 0 offen offset:0 sc1
    v_cvt_pk_bf16_f32 v110, v46, v47
    v_cvt_pk_bf16_f32 v111, v48, v49
    v_cvt_pk_bf16_f32 v112, v50, v51
    v_cvt_pk_bf16_f32 v113, v52, v53
    buffer_store_dwordx4 v[110:113], v77, s[20:23], 0 offen offset:1024 sc1
    v_cvt_pk_bf16_f32 v114, v54, v55
    v_cvt_pk_bf16_f32 v115, v56, v57
    v_cvt_pk_bf16_f32 v116, v58, v59
    v_cvt_pk_bf16_f32 v117, v60, v61
    buffer_store_dwordx4 v[114:117], v78, s[20:23], 0 offen offset:0 sc1
    v_cvt_pk_bf16_f32 v118, v62, v63
    v_cvt_pk_bf16_f32 v119, v64, v65
    v_cvt_pk_bf16_f32 v120, v66, v67
    v_cvt_pk_bf16_f32 v121, v68, v69
    buffer_store_dwordx4 v[118:121], v78, s[20:23], 0 offen offset:1024 sc1
    v_pk_add_f32 v[80:81], v[38:39], v[40:41]
    v_pk_mul_f32 v[82:83], v[38:39], v[38:39]
    v_pk_fma_f32 v[82:83], v[40:41], v[40:41], v[82:83]
    v_pk_add_f32 v[80:81], v[80:81], v[42:43]
    v_pk_fma_f32 v[82:83], v[42:43], v[42:43], v[82:83]
    v_pk_add_f32 v[80:81], v[80:81], v[44:45]
    v_pk_fma_f32 v[82:83], v[44:45], v[44:45], v[82:83]
    v_pk_add_f32 v[80:81], v[80:81], v[46:47]
    v_pk_fma_f32 v[82:83], v[46:47], v[46:47], v[82:83]
    v_pk_add_f32 v[80:81], v[80:81], v[48:49]
    v_pk_fma_f32 v[82:83], v[48:49], v[48:49], v[82:83]
    v_pk_add_f32 v[80:81], v[80:81], v[50:51]
    v_pk_fma_f32 v[82:83], v[50:51], v[50:51], v[82:83]
    v_pk_add_f32 v[80:81], v[80:81], v[52:53]
    v_pk_fma_f32 v[82:83], v[52:53], v[52:53], v[82:83]
    v_pk_add_f32 v[84:85], v[54:55], v[56:57]
    v_pk_mul_f32 v[86:87], v[54:55], v[54:55]
    v_pk_fma_f32 v[86:87], v[56:57], v[56:57], v[86:87]
    v_pk_add_f32 v[84:85], v[84:85], v[58:59]
    v_pk_fma_f32 v[86:87], v[58:59], v[58:59], v[86:87]
    v_pk_add_f32 v[84:85], v[84:85], v[60:61]
    v_pk_fma_f32 v[86:87], v[60:61], v[60:61], v[86:87]
    v_pk_add_f32 v[84:85], v[84:85], v[62:63]
    v_pk_fma_f32 v[86:87], v[62:63], v[62:63], v[86:87]
    v_pk_add_f32 v[84:85], v[84:85], v[64:65]
    v_pk_fma_f32 v[86:87], v[64:65], v[64:65], v[86:87]
    v_pk_add_f32 v[84:85], v[84:85], v[66:67]
    v_pk_fma_f32 v[86:87], v[66:67], v[66:67], v[86:87]
    v_pk_add_f32 v[84:85], v[84:85], v[68:69]
    v_pk_fma_f32 v[86:87], v[68:69], v[68:69], v[86:87]
    v_add_f32 v80, v80, v81
    v_add_f32 v81, v82, v83
    v_add_f32 v84, v84, v85
    v_add_f32 v85, v86, v87
    v_mov_b32 v98, v80
    v_mov_b32 v99, v81
    v_mov_b32 v100, v84
    v_mov_b32 v101, v85
    v_permlane16_swap_b32 v80, v98
    v_permlane16_swap_b32 v81, v99
    v_permlane16_swap_b32 v84, v100
    v_permlane16_swap_b32 v85, v101
    v_add_f32 v80, v80, v98
    v_add_f32 v81, v81, v99
    v_add_f32 v84, v84, v100
    v_add_f32 v85, v85, v101
    v_mov_b32 v98, v80
    v_mov_b32 v99, v81
    v_mov_b32 v100, v84
    v_mov_b32 v101, v85
    v_permlane32_swap_b32 v80, v98
    v_permlane32_swap_b32 v81, v99
    v_permlane32_swap_b32 v84, v100
    v_permlane32_swap_b32 v85, v101
    v_add_f32 v80, v80, v98
    v_add_f32 v81, v81, v99
    v_add_f32 v84, v84, v100
    v_add_f32 v85, v85, v101
    s_mov_b64 exec, 0xffff
    buffer_store_dwordx2 v[80:81], v70, s[28:31], 0 offen offset:0 sc1
    buffer_store_dwordx2 v[84:85], v70, s[28:31], 0 offen offset:2048 sc1
    s_mov_b64 exec, -1
    s_waitcnt vmcnt(0)
    s_barrier
    s_and_b32 s90, s2, 7
    s_add_u32 s90, s90, 64
    s_lshl_b32 s90, s90, 8
    s_add_u32 s96, s84, 47513600
    s_addc_u32 s97, s85, 0
    s_mov_b32 s98, 32768
    s_mov_b32 s99, 0x20000
    s_cmp_eq_u32 s32, 0
    s_cselect_b32 s98, s98, 0
    v_mov_b32 v38, s90
    v_mov_b32 v39, 1
    s_mov_b64 exec, 1
    buffer_atomic_add v39, v38, s[96:99], 0 offen sc1
    s_mov_b64 exec, -1
L_g3_kernel_entry:
    v_mbcnt_lo_u32_b32 v0, -1, 0
    v_mbcnt_hi_u32_b32 v0, -1, v0
    v_lshl_add_u32 v0, s32, 6, v0
    s_mov_b64 s[4:5], s[76:77]
    s_mov_b64 s[6:7], s[84:85]
    s_mov_b64 s[8:9], s[78:79]
    v_and_b32 v0, 63, v0
    s_and_b32 s38, s2, 7
    s_lshr_b32 s39, s2, 3
    s_cmp_ge_u32 s39, 28
    s_cbranch_scc1 L_g3_kernel_helper
    s_and_b32 s33, s39, 3
    s_and_b32 s34, s38, 4
    s_add_u32 s33, s33, s34
    s_and_b32 s34, s38, 1
    s_lshl_b32 s34, s34, 1
    s_bfe_u32 s38, s38, 0x10001
    s_add_u32 s34, s34, s38
    s_mul_i32 s34, s34, 7
    s_lshr_b32 s39, s39, 2
    s_add_u32 s34, s34, s39
    s_mul_i32 s38, s32, 57344
    s_lshl_b32 s39, s34, 8
    s_add_u32 s38, s38, s39
    v_lshrrev_b32 v7, 4, v0
    v_lshlrev_b32 v8, 2, v7
    v_xor_b32 v8, v8, v0
    v_and_b32 v8, 15, v8
    v_mul_u32_u24 v7, 7168, v7
    v_lshl_add_u32 v7, v8, 4, v7
    v_add_u32 v2, s38, v7
    v_add_u32 v3, 27648, v2
    v_lshlrev_b32 v7, 4, v0
    s_lshl_b32 s38, s33, 19
    s_lshl_b32 s39, s32, 15
    s_add_u32 s39, s39, s38
    v_add_u32 v4, s39, v7
    v_add_u32 v5, 131072, v4
    s_and_b32 s39, s32, 1
    s_lshl_b32 s39, s39, 15
    s_add_u32 s38, s38, s39
    s_lshr_b32 s39, s32, 1
    s_lshl_b32 s39, s39, 12
    s_add_u32 s38, s38, s39
    s_add_u32 s38, s38, 262144
    v_add_u32 v6, s38, v7
    s_lshl_b32 s37, s32, 10
    s_mov_b32 s35, 0
    s_mov_b32 s36, 0
    s_mov_b32 s41, 0
    s_waitcnt vmcnt(0)
    s_mov_b32 s16, s4
    s_mov_b32 s17, s5
    s_mov_b32 s18, 7340032
    s_mov_b32 s19, 0x20000
    s_add_u32 s12, s6, 25165824
    s_addc_u32 s13, s7, 0
    s_mov_b32 s14, 4194304
    s_mov_b32 s15, 0x20000
    s_and_b32 s38, s32, 1
    s_lshl_b32 s38, s38, 13
    s_lshr_b32 s42, s32, 1
    s_lshl_b32 s42, s42, 12
    s_add_u32 s42, s42, s38
    s_lshl_b32 s38, s37, 1
    s_add_u32 m0, s38, 0
    s_nop 0
    buffer_load_dwordx4 v2, s[16:19], s36 offen lds
    buffer_load_dwordx4 v3, s[16:19], s36 offen offset:1024 lds
    s_add_u32 s36, s36, 229376
    s_lshl_b32 s38, s37, 1
    s_add_u32 m0, s38, 16384
    s_nop 0
    buffer_load_dwordx4 v2, s[16:19], s36 offen lds
    buffer_load_dwordx4 v3, s[16:19], s36 offen offset:1024 lds
    s_add_u32 s36, s36, 229376
    v_and_b32 v10, 31, v0
    v_lshrrev_b32 v11, 5, v0
    v_bfe_u32 v7, v0, 2, 2
    v_xor_b32 v8, s32, v7
    v_lshlrev_b32 v8, 6, v8
    v_lshl_add_u32 v7, v11, 2, v7
    v_lshl_add_u32 v8, v7, 8, v8
    v_bfe_u32 v7, v0, 4, 1
    v_lshl_add_u32 v8, v7, 5, v8
    v_and_b32 v7, 3, v0
    v_lshl_add_u32 v12, v7, 3, v8
    v_add_u32 v13, 65536, v12
    v_add_u32 v14, 131072, v12
    v_and_b32 v7, 15, v0
    v_lshlrev_b32 v7, 4, v7
    v_lshl_add_u32 v7, v11, 8, v7
    v_bfe_u32 v8, v0, 4, 1
    v_lshl_add_u32 v18, v8, 10, v7
    v_add_u32 v19, 65536, v18
    v_add_u32 v20, 131072, v18
    v_lshl_add_u32 v22, v8, 13, v7
    v_add_u32 v23, 65536, v22
    v_add_u32 v24, 131072, v22
    v_mul_u32_u24 v8, 114688, v8
    v_add_u32 v7, v7, v8
    s_mul_i32 s38, s33, 1835008
    s_lshl_b32 s39, s34, 12
    s_add_u32 s38, s38, s39
    s_add_u32 s38, s38, s37
    v_add_u32 v26, s38, v7
    v_add_u32 v27, 114688, v26
    s_mov_b32 s40, 0
    s_add_u32 s20, s6, 29360128
    s_addc_u32 s21, s7, 0
    s_mov_b32 s22, 14680064
    s_mov_b32 s23, 0x20000
    s_add_u32 s24, s6, 46202880
    s_addc_u32 s25, s7, 0
    s_mov_b32 s26, 262144
    s_mov_b32 s27, 0x20000
    v_lshrrev_b32 v7, 4, v0
    v_lshlrev_b32 v7, 11, v7
    v_and_b32 v8, 15, v0
    v_lshl_add_u32 v7, v8, 3, v7
    s_lshl_b32 s38, s33, 15
    s_lshl_b32 s39, s32, 13
    s_add_u32 s38, s38, s39
    v_add_u32 v28, s38, v7
    v_lshlrev_b32 v29, 4, v0
    s_add_u32 s38, s37, 147456
    v_add_u32 v29, s38, v29
    v_lshlrev_b32 v30, 4, v10
    v_add_u32 v30, 147456, v30
    v_mov_b32 v32, 0x3f803f80
    v_mov_b32 v33, 0x3f803f80
    v_mov_b32 v34, 0x3f803f80
    v_mov_b32 v35, 0x3f803f80
    s_mov_b32 s44, 0xc0135761
    s_mov_b32 s45, 0xbdd2d3e8
    s_add_u32 s38, s33, 64
    s_lshl_b32 s38, s38, 8
    v_mov_b32 v7, s38
    v_mov_b32 v9, 32
    s_add_u32 s96, s84, 47513600
    s_addc_u32 s97, s85, 0
    s_mov_b32 s98, 32768
    s_mov_b32 s99, 0x20000
    s_cmp_eq_u32 s32, 0
    s_cselect_b32 s98, s98, 0
    buffer_load_dword v8, v7, s[96:99], 0 offen sc1
    s_lshl_b32 s38, s37, 1
    s_add_u32 m0, s38, 32768
    s_nop 0
    buffer_load_dwordx4 v2, s[16:19], s36 offen lds
    buffer_load_dwordx4 v3, s[16:19], s36 offen offset:1024 lds
    s_add_u32 s36, s36, 229376
    s_lshl_b32 s38, s37, 1
    s_add_u32 m0, s38, 49152
    s_nop 0
    buffer_load_dwordx4 v2, s[16:19], s36 offen lds
    buffer_load_dwordx4 v3, s[16:19], s36 offen offset:1024 lds
    s_add_u32 s36, s36, 229376
    s_lshl_b32 s38, s37, 1
    s_add_u32 m0, s38, 65536
    s_nop 0
    buffer_load_dwordx4 v2, s[16:19], s36 offen lds
    buffer_load_dwordx4 v3, s[16:19], s36 offen offset:1024 lds
    s_add_u32 s36, s36, 229376
    s_waitcnt vmcnt(6)
    v_cmp_le_u32 vcc, v9, v8
    s_mov_b32 s91, 0x80000
    s_nop 4
    s_cmp_lg_u32 s32, 0
    s_cbranch_scc1 L_g3_kernel_go
    s_cmp_eq_u64 vcc, -1
    s_cbranch_scc1 L_g3_kernel_go
L_g3_kernel_poll:
    buffer_load_dword v8, v7, s[96:99], 0 offen sc1
    s_sub_u32 s91, s91, 1
    s_waitcnt vmcnt(0)
    v_cmp_le_u32 vcc, v9, v8
    s_nop 4
    s_cmp_eq_u64 vcc, -1
    s_cbranch_scc1 L_g3_kernel_go
    s_cmp_lg_u32 s91, 0
    s_cbranch_scc1 L_g3_kernel_poll
L_g3_kernel_go:
    s_nop 4
    s_barrier
    s_add_u32 m0, s37, 8192
    s_nop 0
    buffer_load_dwordx4 v4, s[12:15], s35 offen sc1 lds
    s_add_u32 m0, s37, 12288
    s_nop 0
    buffer_load_dwordx4 v5, s[12:15], s35 offen sc1 lds
    s_add_u32 s35, s35, 1024
    s_add_u32 m0, s37, 24576
    s_nop 0
    buffer_load_dwordx4 v4, s[12:15], s35 offen sc1 lds
    s_add_u32 m0, s37, 28672
    s_nop 0
    buffer_load_dwordx4 v5, s[12:15], s35 offen sc1 lds
    s_add_u32 s35, s35, 1024
    s_add_u32 m0, s37, 40960
    s_nop 0
    buffer_load_dwordx4 v4, s[12:15], s35 offen sc1 lds
    s_add_u32 m0, s37, 45056
    s_nop 0
    buffer_load_dwordx4 v5, s[12:15], s35 offen sc1 lds
    s_add_u32 s35, s35, 1024
    s_add_u32 m0, s37, 57344
    s_nop 0
    buffer_load_dwordx4 v4, s[12:15], s35 offen sc1 lds
    s_add_u32 m0, s37, 61440
    s_nop 0
    buffer_load_dwordx4 v5, s[12:15], s35 offen sc1 lds
    s_add_u32 s35, s35, 1024
    s_add_u32 m0, s37, 73728
    s_nop 0
    buffer_load_dwordx4 v4, s[12:15], s35 offen sc1 lds
    s_add_u32 m0, s37, 77824
    s_nop 0
    buffer_load_dwordx4 v5, s[12:15], s35 offen sc1 lds
    s_add_u32 s35, s35, 1024
    s_waitcnt vmcnt(8)
    s_barrier
    ds_read_b64_tr_b16 a[0:1], v12 offset:0
    ds_read_b64_tr_b16 a[2:3], v12 offset:4096
    ds_read_b64_tr_b16 a[4:5], v12 offset:2048
    ds_read_b64_tr_b16 a[6:7], v12 offset:6144
    ds_read_b128 v[132:135], v18 offset:8192
    ds_read_b128 v[136:139], v18 offset:10240
    ds_read_b128 v[140:143], v18 offset:12288
    ds_read_b128 v[144:147], v18 offset:14336
    ds_read_b128 v[148:151], v18 offset:8704
    ds_read_b128 v[152:155], v18 offset:10752
    ds_read_b128 v[156:159], v18 offset:12800
    ds_read_b128 v[160:163], v18 offset:14848
    s_waitcnt vmcnt(6)
    s_barrier
    s_waitcnt lgkmcnt(7)
    v_mfma_f32_32x32x16_bf16 v[36:51], a[0:3], v[132:135], 0
    ds_read_b128 v[164:167], v18 offset:24576
    s_waitcnt lgkmcnt(7)
    v_mfma_f32_32x32x16_bf16 v[52:67], a[0:3], v[136:139], 0
    ds_read_b128 v[168:171], v18 offset:26624
    s_waitcnt lgkmcnt(7)
    v_mfma_f32_32x32x16_bf16 v[68:83], a[0:3], v[140:143], 0
    ds_read_b128 v[132:135], v18 offset:28672
    s_waitcnt lgkmcnt(7)
    v_mfma_f32_32x32x16_bf16 v[84:99], a[0:3], v[144:147], 0
    ds_read_b128 v[136:139], v18 offset:30720
    v_mfma_f32_32x32x16_bf16 v[116:131], a[0:3], v[32:35], 0
    ds_read_b64_tr_b16 a[8:9], v12 offset:16384
    ds_read_b64_tr_b16 a[10:11], v12 offset:20480
    s_waitcnt lgkmcnt(9)
    v_mfma_f32_32x32x16_bf16 v[36:51], a[4:7], v[148:151], v[36:51]
    ds_read_b128 v[140:143], v18 offset:25088
    s_waitcnt lgkmcnt(9)
    v_mfma_f32_32x32x16_bf16 v[52:67], a[4:7], v[152:155], v[52:67]
    ds_read_b128 v[144:147], v18 offset:27136
    s_waitcnt lgkmcnt(9)
    v_mfma_f32_32x32x16_bf16 v[68:83], a[4:7], v[156:159], v[68:83]
    ds_read_b128 v[148:151], v18 offset:29184
    s_waitcnt lgkmcnt(9)
    v_mfma_f32_32x32x16_bf16 v[84:99], a[4:7], v[160:163], v[84:99]
    ds_read_b128 v[152:155], v18 offset:31232
    v_mfma_f32_32x32x16_bf16 v[116:131], a[4:7], v[32:35], v[116:131]
    ds_read_b64_tr_b16 a[12:13], v12 offset:18432
    ds_read_b64_tr_b16 a[14:15], v12 offset:22528
    s_waitcnt vmcnt(4)
    s_barrier
    s_waitcnt lgkmcnt(6)
    v_mfma_f32_32x32x16_bf16 v[36:51], a[8:11], v[164:167], v[36:51]
    ds_read_b128 v[156:159], v18 offset:40960
    s_lshl_b32 s38, s37, 1
    s_add_u32 m0, s38, 81920
    s_nop 0
    buffer_load_dwordx4 v2, s[16:19], s36 offen lds
    v_mfma_f32_32x32x16_bf16 v[52:67], a[8:11], v[168:171], v[52:67]
    ds_read_b128 v[160:163], v18 offset:43008
    buffer_load_dwordx4 v3, s[16:19], s36 offen offset:1024 lds
    s_add_u32 s36, s36, 229376
    v_mfma_f32_32x32x16_bf16 v[68:83], a[8:11], v[132:135], v[68:83]
    ds_read_b128 v[164:167], v18 offset:45056
    s_add_u32 m0, s37, 90112
    s_nop 0
    buffer_load_dwordx4 v4, s[12:15], s35 offen sc1 lds
    v_mfma_f32_32x32x16_bf16 v[84:99], a[8:11], v[136:139], v[84:99]
    ds_read_b128 v[168:171], v18 offset:47104
    s_add_u32 m0, s37, 94208
    s_nop 0
    buffer_load_dwordx4 v5, s[12:15], s35 offen sc1 lds
    s_add_u32 s35, s35, 1024
    v_mfma_f32_32x32x16_bf16 v[116:131], a[8:11], v[32:35], v[116:131]
    ds_read_b64_tr_b16 a[16:17], v12 offset:32768
    ds_read_b64_tr_b16 a[18:19], v12 offset:36864
    s_waitcnt lgkmcnt(6)
    v_mfma_f32_32x32x16_bf16 v[36:51], a[12:15], v[140:143], v[36:51]
    ds_read_b128 v[132:135], v18 offset:41472
    v_mfma_f32_32x32x16_bf16 v[52:67], a[12:15], v[144:147], v[52:67]
    ds_read_b128 v[136:139], v18 offset:43520
    v_mfma_f32_32x32x16_bf16 v[68:83], a[12:15], v[148:151], v[68:83]
    ds_read_b128 v[140:143], v18 offset:45568
    v_mfma_f32_32x32x16_bf16 v[84:99], a[12:15], v[152:155], v[84:99]
    ds_read_b128 v[144:147], v18 offset:47616
    v_mfma_f32_32x32x16_bf16 v[116:131], a[12:15], v[32:35], v[116:131]
    ds_read_b64_tr_b16 a[20:21], v12 offset:34816
    ds_read_b64_tr_b16 a[22:23], v12 offset:38912
    s_waitcnt vmcnt(6)
    s_barrier
    s_waitcnt lgkmcnt(6)
    v_mfma_f32_32x32x16_bf16 v[36:51], a[16:19], v[156:159], v[36:51]
    ds_read_b128 v[148:151], v18 offset:57344
    s_lshl_b32 s38, s37, 1
    s_add_u32 m0, s38, 0
    s_nop 0
    buffer_load_dwordx4 v2, s[16:19], s36 offen lds
    v_mfma_f32_32x32x16_bf16 v[52:67], a[16:19], v[160:163], v[52:67]
    ds_read_b128 v[152:155], v18 offset:59392
    buffer_load_dwordx4 v3, s[16:19], s36 offen offset:1024 lds
    s_add_u32 s36, s36, 229376
    v_mfma_f32_32x32x16_bf16 v[68:83], a[16:19], v[164:167], v[68:83]
    ds_read_b128 v[156:159], v18 offset:61440
    s_add_u32 m0, s37, 8192
    s_nop 0
    buffer_load_dwordx4 v4, s[12:15], s35 offen sc1 lds
    v_mfma_f32_32x32x16_bf16 v[84:99], a[16:19], v[168:171], v[84:99]
    ds_read_b128 v[160:163], v18 offset:63488
    s_add_u32 m0, s37, 12288
    s_nop 0
    buffer_load_dwordx4 v5, s[12:15], s35 offen sc1 lds
    s_add_u32 s35, s35, 1024
    v_mfma_f32_32x32x16_bf16 v[116:131], a[16:19], v[32:35], v[116:131]
    ds_read_b64_tr_b16 a[24:25], v12 offset:49152
    ds_read_b64_tr_b16 a[26:27], v12 offset:53248
    s_waitcnt lgkmcnt(6)
    v_mfma_f32_32x32x16_bf16 v[36:51], a[20:23], v[132:135], v[36:51]
    ds_read_b128 v[164:167], v18 offset:57856
    v_mfma_f32_32x32x16_bf16 v[52:67], a[20:23], v[136:139], v[52:67]
    ds_read_b128 v[168:171], v18 offset:59904
    v_mfma_f32_32x32x16_bf16 v[68:83], a[20:23], v[140:143], v[68:83]
    ds_read_b128 v[132:135], v18 offset:61952
    v_mfma_f32_32x32x16_bf16 v[84:99], a[20:23], v[144:147], v[84:99]
    ds_read_b128 v[136:139], v18 offset:64000
    v_mfma_f32_32x32x16_bf16 v[116:131], a[20:23], v[32:35], v[116:131]
    ds_read_b64_tr_b16 a[28:29], v12 offset:51200
    ds_read_b64_tr_b16 a[30:31], v12 offset:55296
    s_waitcnt vmcnt(8)
    s_barrier
    s_waitcnt lgkmcnt(6)
    v_mfma_f32_32x32x16_bf16 v[36:51], a[24:27], v[148:151], v[36:51]
    ds_read_b128 v[140:143], v19 offset:8192
    s_lshl_b32 s38, s37, 1
    s_add_u32 m0, s38, 16384
    s_nop 0
    buffer_load_dwordx4 v2, s[16:19], s36 offen lds
    v_mfma_f32_32x32x16_bf16 v[52:67], a[24:27], v[152:155], v[52:67]
    ds_read_b128 v[144:147], v19 offset:10240
    buffer_load_dwordx4 v3, s[16:19], s36 offen offset:1024 lds
    s_add_u32 s36, s36, 229376
    v_mfma_f32_32x32x16_bf16 v[68:83], a[24:27], v[156:159], v[68:83]
    ds_read_b128 v[148:151], v19 offset:12288
    s_add_u32 m0, s37, 24576
    s_nop 0
    buffer_load_dwordx4 v4, s[12:15], s35 offen sc1 lds
    v_mfma_f32_32x32x16_bf16 v[84:99], a[24:27], v[160:163], v[84:99]
    ds_read_b128 v[152:155], v19 offset:14336
    s_add_u32 m0, s37, 28672
    s_nop 0
    buffer_load_dwordx4 v5, s[12:15], s35 offen sc1 lds
    s_add_u32 s35, s35, 1024
    v_mfma_f32_32x32x16_bf16 v[116:131], a[24:27], v[32:35], v[116:131]
    ds_read_b64_tr_b16 a[32:33], v13 offset:0
    ds_read_b64_tr_b16 a[34:35], v13 offset:4096
    s_waitcnt lgkmcnt(6)
    v_mfma_f32_32x32x16_bf16 v[36:51], a[28:31], v[164:167], v[36:51]
    ds_read_b128 v[156:159], v19 offset:8704
    v_mfma_f32_32x32x16_bf16 v[52:67], a[28:31], v[168:171], v[52:67]
    ds_read_b128 v[160:163], v19 offset:10752
    v_mfma_f32_32x32x16_bf16 v[68:83], a[28:31], v[132:135], v[68:83]
    ds_read_b128 v[164:167], v19 offset:12800
    v_mfma_f32_32x32x16_bf16 v[84:99], a[28:31], v[136:139], v[84:99]
    ds_read_b128 v[168:171], v19 offset:14848
    v_mfma_f32_32x32x16_bf16 v[116:131], a[28:31], v[32:35], v[116:131]
    ds_read_b64_tr_b16 a[36:37], v13 offset:2048
    ds_read_b64_tr_b16 a[38:39], v13 offset:6144
    s_waitcnt vmcnt(8)
    s_barrier
    s_waitcnt lgkmcnt(6)
    v_mfma_f32_32x32x16_bf16 v[36:51], a[32:35], v[140:143], v[36:51]
    ds_read_b128 v[132:135], v19 offset:24576
    s_lshl_b32 s38, s37, 1
    s_add_u32 m0, s38, 32768
    s_nop 0
    buffer_load_dwordx4 v2, s[16:19], s36 offen lds
    v_mfma_f32_32x32x16_bf16 v[52:67], a[32:35], v[144:147], v[52:67]
    ds_read_b128 v[136:139], v19 offset:26624
    buffer_load_dwordx4 v3, s[16:19], s36 offen offset:1024 lds
    s_add_u32 s36, s36, 229376
    v_mfma_f32_32x32x16_bf16 v[68:83], a[32:35], v[148:151], v[68:83]
    ds_read_b128 v[140:143], v19 offset:28672
    s_add_u32 m0, s37, 40960
    s_nop 0
    buffer_load_dwordx4 v4, s[12:15], s35 offen sc1 lds
    v_mfma_f32_32x32x16_bf16 v[84:99], a[32:35], v[152:155], v[84:99]
    ds_read_b128 v[144:147], v19 offset:30720
    s_add_u32 m0, s37, 45056
    s_nop 0
    buffer_load_dwordx4 v5, s[12:15], s35 offen sc1 lds
    s_add_u32 s35, s35, 1024
    v_mfma_f32_32x32x16_bf16 v[116:131], a[32:35], v[32:35], v[116:131]
    ds_read_b64_tr_b16 a[40:41], v13 offset:16384
    ds_read_b64_tr_b16 a[42:43], v13 offset:20480
    s_waitcnt lgkmcnt(6)
    v_mfma_f32_32x32x16_bf16 v[36:51], a[36:39], v[156:159], v[36:51]
    ds_read_b128 v[148:151], v19 offset:25088
    v_mfma_f32_32x32x16_bf16 v[52:67], a[36:39], v[160:163], v[52:67]
    ds_read_b128 v[152:155], v19 offset:27136
    v_mfma_f32_32x32x16_bf16 v[68:83], a[36:39], v[164:167], v[68:83]
    ds_read_b128 v[156:159], v19 offset:29184
    v_mfma_f32_32x32x16_bf16 v[84:99], a[36:39], v[168:171], v[84:99]
    ds_read_b128 v[160:163], v19 offset:31232
    v_mfma_f32_32x32x16_bf16 v[116:131], a[36:39], v[32:35], v[116:131]
    ds_read_b64_tr_b16 a[44:45], v13 offset:18432
    ds_read_b64_tr_b16 a[46:47], v13 offset:22528
    s_waitcnt vmcnt(8)
    s_barrier
    s_waitcnt lgkmcnt(6)
    v_mfma_f32_32x32x16_bf16 v[36:51], a[40:43], v[132:135], v[36:51]
    ds_read_b128 v[164:167], v18 offset:8192
    s_lshl_b32 s38, s37, 1
    s_add_u32 m0, s38, 49152
    s_nop 0
    buffer_load_dwordx4 v2, s[16:19], s36 offen lds
    v_mfma_f32_32x32x16_bf16 v[52:67], a[40:43], v[136:139], v[52:67]
    ds_read_b128 v[168:171], v18 offset:10240
    buffer_load_dwordx4 v3, s[16:19], s36 offen offset:1024 lds
    s_add_u32 s36, s36, 229376
    v_mfma_f32_32x32x16_bf16 v[68:83], a[40:43], v[140:143], v[68:83]
    ds_read_b128 v[132:135], v18 offset:12288
    s_add_u32 m0, s37, 57344
    s_nop 0
    buffer_load_dwordx4 v4, s[12:15], s35 offen sc1 lds
    v_mfma_f32_32x32x16_bf16 v[84:99], a[40:43], v[144:147], v[84:99]
    ds_read_b128 v[136:139], v18 offset:14336
    s_add_u32 m0, s37, 61440
    s_nop 0
    buffer_load_dwordx4 v5, s[12:15], s35 offen sc1 lds
    s_add_u32 s35, s35, 1024
    v_mfma_f32_32x32x16_bf16 v[116:131], a[40:43], v[32:35], v[116:131]
    ds_read_b64_tr_b16 a[48:49], v12 offset:0
    ds_read_b64_tr_b16 a[50:51], v12 offset:4096
    s_waitcnt lgkmcnt(6)
    v_mfma_f32_32x32x16_bf16 v[36:51], a[44:47], v[148:151], v[36:51]
    ds_read_b128 v[140:143], v18 offset:8704
    v_mfma_f32_32x32x16_bf16 v[52:67], a[44:47], v[152:155], v[52:67]
    ds_read_b128 v[144:147], v18 offset:10752
    v_mfma_f32_32x32x16_bf16 v[68:83], a[44:47], v[156:159], v[68:83]
    ds_read_b128 v[148:151], v18 offset:12800
    v_mfma_f32_32x32x16_bf16 v[84:99], a[44:47], v[160:163], v[84:99]
    ds_read_b128 v[152:155], v18 offset:14848
    v_mfma_f32_32x32x16_bf16 v[116:131], a[44:47], v[32:35], v[116:131]
    ds_read_b64_tr_b16 a[52:53], v12 offset:2048
    ds_read_b64_tr_b16 a[54:55], v12 offset:6144
    s_waitcnt vmcnt(8)
    s_barrier
    s_waitcnt lgkmcnt(6)
    v_mfma_f32_32x32x16_bf16 v[36:51], a[48:51], v[164:167], v[36:51]
    ds_read_b128 v[156:159], v18 offset:24576
    s_lshl_b32 s38, s37, 1
    s_add_u32 m0, s38, 65536
    s_nop 0
    buffer_load_dwordx4 v2, s[16:19], s36 offen lds
    v_mfma_f32_32x32x16_bf16 v[52:67], a[48:51], v[168:171], v[52:67]
    ds_read_b128 v[160:163], v18 offset:26624
    buffer_load_dwordx4 v3, s[16:19], s36 offen offset:1024 lds
    s_add_u32 s36, s36, 229376
    v_mfma_f32_32x32x16_bf16 v[68:83], a[48:51], v[132:135], v[68:83]
    ds_read_b128 v[164:167], v18 offset:28672
    s_add_u32 m0, s37, 73728
    s_nop 0
    buffer_load_dwordx4 v4, s[12:15], s35 offen sc1 lds
    v_mfma_f32_32x32x16_bf16 v[84:99], a[48:51], v[136:139], v[84:99]
    ds_read_b128 v[168:171], v18 offset:30720
    s_add_u32 m0, s37, 77824
    s_nop 0
    buffer_load_dwordx4 v5, s[12:15], s35 offen sc1 lds
    s_add_u32 s35, s35, 1024
    v_mfma_f32_32x32x16_bf16 v[116:131], a[48:51], v[32:35], v[116:131]
    ds_read_b64_tr_b16 a[56:57], v12 offset:16384
    ds_read_b64_tr_b16 a[58:59], v12 offset:20480
    s_waitcnt lgkmcnt(6)
    v_mfma_f32_32x32x16_bf16 v[36:51], a[52:55], v[140:143], v[36:51]
    ds_read_b128 v[132:135], v18 offset:25088
    v_mfma_f32_32x32x16_bf16 v[52:67], a[52:55], v[144:147], v[52:67]
    ds_read_b128 v[136:139], v18 offset:27136
    v_mfma_f32_32x32x16_bf16 v[68:83], a[52:55], v[148:151], v[68:83]
    ds_read_b128 v[140:143], v18 offset:29184
    v_mfma_f32_32x32x16_bf16 v[84:99], a[52:55], v[152:155], v[84:99]
    ds_read_b128 v[144:147], v18 offset:31232
    v_mfma_f32_32x32x16_bf16 v[116:131], a[52:55], v[32:35], v[116:131]
    ds_read_b64_tr_b16 a[60:61], v12 offset:18432
    ds_read_b64_tr_b16 a[62:63], v12 offset:22528
    s_waitcnt vmcnt(8)
    s_barrier
    s_waitcnt lgkmcnt(6)
    v_mfma_f32_32x32x16_bf16 v[36:51], a[56:59], v[156:159], v[36:51]
    ds_read_b128 v[148:151], v18 offset:40960
    s_lshl_b32 s38, s37, 1
    s_add_u32 m0, s38, 81920
    s_nop 0
    buffer_load_dwordx4 v2, s[16:19], s36 offen lds
    v_mfma_f32_32x32x16_bf16 v[52:67], a[56:59], v[160:163], v[52:67]
    ds_read_b128 v[152:155], v18 offset:43008
    buffer_load_dwordx4 v3, s[16:19], s36 offen offset:1024 lds
    s_add_u32 s36, s36, 229376
    v_mfma_f32_32x32x16_bf16 v[68:83], a[56:59], v[164:167], v[68:83]
    ds_read_b128 v[156:159], v18 offset:45056
    s_add_u32 m0, s37, 90112
    s_nop 0
    buffer_load_dwordx4 v4, s[12:15], s35 offen sc1 lds
    v_mfma_f32_32x32x16_bf16 v[84:99], a[56:59], v[168:171], v[84:99]
    ds_read_b128 v[160:163], v18 offset:47104
    s_add_u32 m0, s37, 94208
    s_nop 0
    buffer_load_dwordx4 v5, s[12:15], s35 offen sc1 lds
    s_add_u32 s35, s35, 1024
    v_mfma_f32_32x32x16_bf16 v[116:131], a[56:59], v[32:35], v[116:131]
    ds_read_b64_tr_b16 a[64:65], v12 offset:32768
    ds_read_b64_tr_b16 a[66:67], v12 offset:36864
    s_waitcnt lgkmcnt(6)
    v_mfma_f32_32x32x16_bf16 v[36:51], a[60:63], v[132:135], v[36:51]
    ds_read_b128 v[164:167], v18 offset:41472
    v_mfma_f32_32x32x16_bf16 v[52:67], a[60:63], v[136:139], v[52:67]
    ds_read_b128 v[168:171], v18 offset:43520
    v_mfma_f32_32x32x16_bf16 v[68:83], a[60:63], v[140:143], v[68:83]
    ds_read_b128 v[132:135], v18 offset:45568
    v_mfma_f32_32x32x16_bf16 v[84:99], a[60:63], v[144:147], v[84:99]
    ds_read_b128 v[136:139], v18 offset:47616
    v_mfma_f32_32x32x16_bf16 v[116:131], a[60:63], v[32:35], v[116:131]
    ds_read_b64_tr_b16 a[68:69], v12 offset:34816
    ds_read_b64_tr_b16 a[70:71], v12 offset:38912
    s_waitcnt vmcnt(8)
    s_barrier
    s_waitcnt lgkmcnt(6)
    v_mfma_f32_32x32x16_bf16 v[36:51], a[64:67], v[148:151], v[36:51]
    ds_read_b128 v[140:143], v18 offset:57344
    s_lshl_b32 s38, s37, 1
    s_add_u32 m0, s38, 0
    s_nop 0
    buffer_load_dwordx4 v2, s[16:19], s36 offen lds
    v_mfma_f32_32x32x16_bf16 v[52:67], a[64:67], v[152:155], v[52:67]
    ds_read_b128 v[144:147], v18 offset:59392
    buffer_load_dwordx4 v3, s[16:19], s36 offen offset:1024 lds
    s_add_u32 s36, s36, 229376
    v_mfma_f32_32x32x16_bf16 v[68:83], a[64:67], v[156:159], v[68:83]
    ds_read_b128 v[148:151], v18 offset:61440
    s_add_u32 m0, s37, 8192
    s_nop 0
    buffer_load_dwordx4 v4, s[12:15], s35 offen sc1 lds
    v_mfma_f32_32x32x16_bf16 v[84:99], a[64:67], v[160:163], v[84:99]
    ds_read_b128 v[152:155], v18 offset:63488
    s_add_u32 m0, s37, 12288
    s_nop 0
    buffer_load_dwordx4 v5, s[12:15], s35 offen sc1 lds
    s_add_u32 s35, s35, 1024
    v_mfma_f32_32x32x16_bf16 v[116:131], a[64:67], v[32:35], v[116:131]
    ds_read_b64_tr_b16 a[72:73], v12 offset:49152
    ds_read_b64_tr_b16 a[74:75], v12 offset:53248
    s_waitcnt lgkmcnt(6)
    v_mfma_f32_32x32x16_bf16 v[36:51], a[68:71], v[164:167], v[36:51]
    ds_read_b128 v[156:159], v18 offset:57856
    buffer_load_dwordx2 v[204:205], v28, s[24:27], 0 offen offset:0 sc1
    v_mfma_f32_32x32x16_bf16 v[52:67], a[68:71], v[168:171], v[52:67]
    ds_read_b128 v[160:163], v18 offset:59904
    buffer_load_dwordx2 v[206:207], v28, s[24:27], 0 offen offset:128 sc1
    v_mfma_f32_32x32x16_bf16 v[68:83], a[68:71], v[132:135], v[68:83]
    ds_read_b128 v[164:167], v18 offset:61952
    buffer_load_dwordx2 v[208:209], v28, s[24:27], 0 offen offset:256 sc1
    v_mfma_f32_32x32x16_bf16 v[84:99], a[68:71], v[136:139], v[84:99]
    ds_read_b128 v[168:171], v18 offset:64000
    buffer_load_dwordx2 v[210:211], v28, s[24:27], 0 offen offset:384 sc1
    v_mfma_f32_32x32x16_bf16 v[116:131], a[68:71], v[32:35], v[116:131]
    ds_read_b64_tr_b16 a[76:77], v12 offset:51200
    ds_read_b64_tr_b16 a[78:79], v12 offset:55296
    buffer_load_dwordx2 v[212:213], v28, s[24:27], 0 offen offset:512 sc1
    buffer_load_dwordx2 v[214:215], v28, s[24:27], 0 offen offset:640 sc1
    buffer_load_dwordx2 v[216:217], v28, s[24:27], 0 offen offset:768 sc1
    buffer_load_dwordx2 v[218:219], v28, s[24:27], 0 offen offset:896 sc1
    buffer_load_dwordx2 v[220:221], v28, s[24:27], 0 offen offset:1024 sc1
    buffer_load_dwordx2 v[222:223], v28, s[24:27], 0 offen offset:1152 sc1
    buffer_load_dwordx2 v[224:225], v28, s[24:27], 0 offen offset:1280 sc1
    buffer_load_dwordx2 v[226:227], v28, s[24:27], 0 offen offset:1408 sc1
    buffer_load_dwordx2 v[228:229], v28, s[24:27], 0 offen offset:1536 sc1
    buffer_load_dwordx2 v[230:231], v28, s[24:27], 0 offen offset:1664 sc1
    buffer_load_dwordx2 v[232:233], v28, s[24:27], 0 offen offset:1792 sc1
    buffer_load_dwordx2 v[234:235], v28, s[24:27], 0 offen offset:1920 sc1
    s_waitcnt vmcnt(24)
    s_barrier
    s_waitcnt lgkmcnt(6)
    v_mfma_f32_32x32x16_bf16 v[36:51], a[72:75], v[140:143], v[36:51]
    ds_read_b128 v[132:135], v19 offset:8192
    s_lshl_b32 s38, s37, 1
    s_add_u32 m0, s38, 16384
    s_nop 0
    buffer_load_dwordx4 v2, s[16:19], s36 offen lds
    v_mfma_f32_32x32x16_bf16 v[52:67], a[72:75], v[144:147], v[52:67]
    ds_read_b128 v[136:139], v19 offset:10240
    buffer_load_dwordx4 v3, s[16:19], s36 offen offset:1024 lds
    s_add_u32 s36, s36, 229376
    v_mfma_f32_32x32x16_bf16 v[68:83], a[72:75], v[148:151], v[68:83]
    ds_read_b128 v[140:143], v19 offset:12288
    s_add_u32 m0, s37, 24576
    s_nop 0
    buffer_load_dwordx4 v4, s[12:15], s35 offen sc1 lds
    v_mfma_f32_32x32x16_bf16 v[84:99], a[72:75], v[152:155], v[84:99]
    ds_read_b128 v[144:147], v19 offset:14336
    s_add_u32 m0, s37, 28672
    s_nop 0
    buffer_load_dwordx4 v5, s[12:15], s35 offen sc1 lds
    s_add_u32 s35, s35, 1024
    v_mfma_f32_32x32x16_bf16 v[116:131], a[72:75], v[32:35], v[116:131]
    ds_read_b64_tr_b16 a[80:81], v13 offset:0
    ds_read_b64_tr_b16 a[82:83], v13 offset:4096
    s_waitcnt lgkmcnt(6)
    v_mfma_f32_32x32x16_bf16 v[36:51], a[76:79], v[156:159], v[36:51]
    ds_read_b128 v[148:151], v19 offset:8704
    v_mfma_f32_32x32x16_bf16 v[52:67], a[76:79], v[160:163], v[52:67]
    ds_read_b128 v[152:155], v19 offset:10752
    v_mfma_f32_32x32x16_bf16 v[68:83], a[76:79], v[164:167], v[68:83]
    ds_read_b128 v[156:159], v19 offset:12800
    v_mfma_f32_32x32x16_bf16 v[84:99], a[76:79], v[168:171], v[84:99]
    ds_read_b128 v[160:163], v19 offset:14848
    v_mfma_f32_32x32x16_bf16 v[116:131], a[76:79], v[32:35], v[116:131]
    ds_read_b64_tr_b16 a[84:85], v13 offset:2048
    ds_read_b64_tr_b16 a[86:87], v13 offset:6144
    s_waitcnt vmcnt(24)
    s_barrier
    s_waitcnt lgkmcnt(6)
    v_mfma_f32_32x32x16_bf16 v[36:51], a[80:83], v[132:135], v[36:51]
    ds_read_b128 v[164:167], v19 offset:24576
    s_lshl_b32 s38, s37, 1
    s_add_u32 m0, s38, 32768
    s_nop 0
    buffer_load_dwordx4 v2, s[16:19], s36 offen lds
    v_mfma_f32_32x32x16_bf16 v[52:67], a[80:83], v[136:139], v[52:67]
    ds_read_b128 v[168:171], v19 offset:26624
    buffer_load_dwordx4 v3, s[16:19], s36 offen offset:1024 lds
    s_add_u32 s36, s36, 229376
    v_mfma_f32_32x32x16_bf16 v[68:83], a[80:83], v[140:143], v[68:83]
    ds_read_b128 v[132:135], v19 offset:28672
    s_add_u32 m0, s37, 40960
    s_nop 0
    buffer_load_dwordx4 v4, s[12:15], s35 offen sc1 lds
    v_mfma_f32_32x32x16_bf16 v[84:99], a[80:83], v[144:147], v[84:99]
    ds_read_b128 v[136:139], v19 offset:30720
    s_add_u32 m0, s37, 45056
    s_nop 0
    buffer_load_dwordx4 v5, s[12:15], s35 offen sc1 lds
    s_add_u32 s35, s35, 1024
    v_mfma_f32_32x32x16_bf16 v[116:131], a[80:83], v[32:35], v[116:131]
    ds_read_b64_tr_b16 a[88:89], v13 offset:16384
    ds_read_b64_tr_b16 a[90:91], v13 offset:20480
    s_waitcnt lgkmcnt(6)
    v_mfma_f32_32x32x16_bf16 v[36:51], a[84:87], v[148:151], v[36:51]
    ds_read_b128 v[140:143], v19 offset:25088
    v_mfma_f32_32x32x16_bf16 v[52:67], a[84:87], v[152:155], v[52:67]
    ds_read_b128 v[144:147], v19 offset:27136
    v_mfma_f32_32x32x16_bf16 v[68:83], a[84:87], v[156:159], v[68:83]
    ds_read_b128 v[148:151], v19 offset:29184
    v_mfma_f32_32x32x16_bf16 v[84:99], a[84:87], v[160:163], v[84:99]
    ds_read_b128 v[152:155], v19 offset:31232
    v_mfma_f32_32x32x16_bf16 v[116:131], a[84:87], v[32:35], v[116:131]
    ds_read_b64_tr_b16 a[92:93], v13 offset:18432
    ds_read_b64_tr_b16 a[94:95], v13 offset:22528
    s_waitcnt vmcnt(24)
    s_barrier
    s_waitcnt lgkmcnt(6)
    v_mfma_f32_32x32x16_bf16 v[36:51], a[88:91], v[164:167], v[36:51]
    ds_read_b128 v[156:159], v18 offset:8192
    s_lshl_b32 s38, s37, 1
    s_add_u32 m0, s38, 49152
    s_nop 0
    buffer_load_dwordx4 v2, s[16:19], s36 offen lds
    v_mfma_f32_32x32x16_bf16 v[52:67], a[88:91], v[168:171], v[52:67]
    ds_read_b128 v[160:163], v18 offset:10240
    buffer_load_dwordx4 v3, s[16:19], s36 offen offset:1024 lds
    s_add_u32 s36, s36, 229376
    v_mfma_f32_32x32x16_bf16 v[68:83], a[88:91], v[132:135], v[68:83]
    ds_read_b128 v[164:167], v18 offset:12288
    s_add_u32 m0, s37, 57344
    s_nop 0
    buffer_load_dwordx4 v4, s[12:15], s35 offen sc1 lds
    v_mfma_f32_32x32x16_bf16 v[84:99], a[88:91], v[136:139], v[84:99]
    ds_read_b128 v[168:171], v18 offset:14336
    s_add_u32 m0, s37, 61440
    s_nop 0
    buffer_load_dwordx4 v5, s[12:15], s35 offen sc1 lds
    s_add_u32 s35, s35, 1024
    v_mfma_f32_32x32x16_bf16 v[116:131], a[88:91], v[32:35], v[116:131]
    ds_read_b64_tr_b16 a[96:97], v12 offset:0
    ds_read_b64_tr_b16 a[98:99], v12 offset:4096
    s_waitcnt lgkmcnt(6)
    v_mfma_f32_32x32x16_bf16 v[36:51], a[92:95], v[140:143], v[36:51]
    ds_read_b128 v[132:135], v18 offset:8704
    v_mfma_f32_32x32x16_bf16 v[52:67], a[92:95], v[144:147], v[52:67]
    ds_read_b128 v[136:139], v18 offset:10752
    v_mfma_f32_32x32x16_bf16 v[68:83], a[92:95], v[148:151], v[68:83]
    ds_read_b128 v[140:143], v18 offset:12800
    v_mfma_f32_32x32x16_bf16 v[84:99], a[92:95], v[152:155], v[84:99]
    ds_read_b128 v[144:147], v18 offset:14848
    v_mfma_f32_32x32x16_bf16 v[116:131], a[92:95], v[32:35], v[116:131]
    ds_read_b64_tr_b16 a[100:101], v12 offset:2048
    ds_read_b64_tr_b16 a[102:103], v12 offset:6144
    s_waitcnt vmcnt(8)
    s_barrier
    s_waitcnt lgkmcnt(6)
    v_mfma_f32_32x32x16_bf16 v[36:51], a[96:99], v[156:159], v[36:51]
    ds_read_b128 v[148:151], v18 offset:24576
    s_lshl_b32 s38, s37, 1
    s_add_u32 m0, s38, 65536
    s_nop 0
    buffer_load_dwordx4 v2, s[16:19], s36 offen lds
    v_mfma_f32_32x32x16_bf16 v[52:67], a[96:99], v[160:163], v[52:67]
    ds_read_b128 v[152:155], v18 offset:26624
    buffer_load_dwordx4 v3, s[16:19], s36 offen offset:1024 lds
    s_add_u32 s36, s36, 229376
    v_mfma_f32_32x32x16_bf16 v[68:83], a[96:99], v[164:167], v[68:83]
    ds_read_b128 v[156:159], v18 offset:28672
    s_add_u32 m0, s37, 73728
    s_nop 0
    buffer_load_dwordx4 v4, s[12:15], s35 offen sc1 lds
    v_mfma_f32_32x32x16_bf16 v[84:99], a[96:99], v[168:171], v[84:99]
    ds_read_b128 v[160:163], v18 offset:30720
    s_add_u32 m0, s37, 77824
    s_nop 0
    buffer_load_dwordx4 v5, s[12:15], s35 offen sc1 lds
    s_add_u32 s35, s35, 1024
    v_mfma_f32_32x32x16_bf16 v[116:131], a[96:99], v[32:35], v[116:131]
    ds_read_b64_tr_b16 a[104:105], v12 offset:16384
    ds_read_b64_tr_b16 a[106:107], v12 offset:20480
    s_waitcnt lgkmcnt(6)
    v_mfma_f32_32x32x16_bf16 v[36:51], a[100:103], v[132:135], v[36:51]
    ds_read_b128 v[164:167], v18 offset:25088
    v_mfma_f32_32x32x16_bf16 v[52:67], a[100:103], v[136:139], v[52:67]
    ds_read_b128 v[168:171], v18 offset:27136
    v_mfma_f32_32x32x16_bf16 v[68:83], a[100:103], v[140:143], v[68:83]
    ds_read_b128 v[132:135], v18 offset:29184
    v_mfma_f32_32x32x16_bf16 v[84:99], a[100:103], v[144:147], v[84:99]
    ds_read_b128 v[136:139], v18 offset:31232
    v_mfma_f32_32x32x16_bf16 v[116:131], a[100:103], v[32:35], v[116:131]
    ds_read_b64_tr_b16 a[108:109], v12 offset:18432
    ds_read_b64_tr_b16 a[110:111], v12 offset:22528
    s_waitcnt vmcnt(8)
    s_barrier
    s_waitcnt lgkmcnt(6)
    v_mfma_f32_32x32x16_bf16 v[36:51], a[104:107], v[148:151], v[36:51]
    ds_read_b128 v[140:143], v18 offset:40960
    s_lshl_b32 s38, s37, 1
    s_add_u32 m0, s38, 81920
    s_nop 0
    buffer_load_dwordx4 v2, s[16:19], s36 offen lds
    v_mfma_f32_32x32x16_bf16 v[52:67], a[104:107], v[152:155], v[52:67]
    ds_read_b128 v[144:147], v18 offset:43008
    buffer_load_dwordx4 v3, s[16:19], s36 offen offset:1024 lds
    s_add_u32 s36, s36, 229376
    v_mfma_f32_32x32x16_bf16 v[68:83], a[104:107], v[156:159], v[68:83]
    ds_read_b128 v[148:151], v18 offset:45056
    s_add_u32 m0, s37, 90112
    s_nop 0
    buffer_load_dwordx4 v4, s[12:15], s35 offen sc1 lds
    v_mfma_f32_32x32x16_bf16 v[84:99], a[104:107], v[160:163], v[84:99]
    ds_read_b128 v[152:155], v18 offset:47104
    s_add_u32 m0, s37, 94208
    s_nop 0
    buffer_load_dwordx4 v5, s[12:15], s35 offen sc1 lds
    s_add_u32 s35, s35, 1024
    v_mfma_f32_32x32x16_bf16 v[116:131], a[104:107], v[32:35], v[116:131]
    ds_read_b64_tr_b16 a[112:113], v12 offset:32768
    ds_read_b64_tr_b16 a[114:115], v12 offset:36864
    s_waitcnt lgkmcnt(6)
    v_mfma_f32_32x32x16_bf16 v[36:51], a[108:111], v[164:167], v[36:51]
    ds_read_b128 v[156:159], v18 offset:41472
    v_mfma_f32_32x32x16_bf16 v[52:67], a[108:111], v[168:171], v[52:67]
    ds_read_b128 v[160:163], v18 offset:43520
    v_mfma_f32_32x32x16_bf16 v[68:83], a[108:111], v[132:135], v[68:83]
    ds_read_b128 v[164:167], v18 offset:45568
    v_mfma_f32_32x32x16_bf16 v[84:99], a[108:111], v[136:139], v[84:99]
    ds_read_b128 v[168:171], v18 offset:47616
    v_mfma_f32_32x32x16_bf16 v[116:131], a[108:111], v[32:35], v[116:131]
    ds_read_b64_tr_b16 a[116:117], v12 offset:34816
    ds_read_b64_tr_b16 a[118:119], v12 offset:38912
    s_waitcnt vmcnt(8)
    s_barrier
    s_waitcnt lgkmcnt(6)
    v_mfma_f32_32x32x16_bf16 v[36:51], a[112:115], v[140:143], v[36:51]
    ds_read_b128 v[132:135], v18 offset:57344
    s_lshl_b32 s38, s37, 1
    s_add_u32 m0, s38, 0
    s_nop 0
    buffer_load_dwordx4 v2, s[16:19], s36 offen lds
    v_add_f32 v204, v204, v220
    v_mfma_f32_32x32x16_bf16 v[52:67], a[112:115], v[144:147], v[52:67]
    ds_read_b128 v[136:139], v18 offset:59392
    buffer_load_dwordx4 v3, s[16:19], s36 offen offset:1024 lds
    s_add_u32 s36, s36, 229376
    v_add_f32 v205, v205, v221
    v_mfma_f32_32x32x16_bf16 v[68:83], a[112:115], v[148:151], v[68:83]
    ds_read_b128 v[140:143], v18 offset:61440
    s_add_u32 m0, s37, 8192
    s_nop 0
    buffer_load_dwordx4 v4, s[12:15], s35 offen sc1 lds
    v_add_f32 v206, v206, v222
    v_mfma_f32_32x32x16_bf16 v[84:99], a[112:115], v[152:155], v[84:99]
    ds_read_b128 v[144:147], v18 offset:63488
    s_add_u32 m0, s37, 12288
    s_nop 0
    buffer_load_dwordx4 v5, s[12:15], s35 offen sc1 lds
    s_add_u32 s35, s35, 1024
    v_add_f32 v207, v207, v223
    v_mfma_f32_32x32x16_bf16 v[116:131], a[112:115], v[32:35], v[116:131]
    ds_read_b64_tr_b16 a[120:121], v12 offset:49152
    ds_read_b64_tr_b16 a[122:123], v12 offset:53248
    v_add_f32 v208, v208, v224
    s_waitcnt lgkmcnt(6)
    v_mfma_f32_32x32x16_bf16 v[36:51], a[116:119], v[156:159], v[36:51]
    ds_read_b128 v[148:151], v18 offset:57856
    v_add_f32 v209, v209, v225
    v_add_f32 v210, v210, v226
    v_add_f32 v211, v211, v227
    v_mfma_f32_32x32x16_bf16 v[52:67], a[116:119], v[160:163], v[52:67]
    ds_read_b128 v[152:155], v18 offset:59904
    v_add_f32 v212, v212, v228
    v_add_f32 v213, v213, v229
    v_add_f32 v214, v214, v230
    v_mfma_f32_32x32x16_bf16 v[68:83], a[116:119], v[164:167], v[68:83]
    ds_read_b128 v[156:159], v18 offset:61952
    v_add_f32 v215, v215, v231
    v_add_f32 v216, v216, v232
    v_add_f32 v217, v217, v233
    v_mfma_f32_32x32x16_bf16 v[84:99], a[116:119], v[168:171], v[84:99]
    ds_read_b128 v[160:163], v18 offset:64000
    v_add_f32 v218, v218, v234
    v_add_f32 v219, v219, v235
    v_add_f32 v204, v204, v212
    v_mfma_f32_32x32x16_bf16 v[116:131], a[116:119], v[32:35], v[116:131]
    ds_read_b64_tr_b16 a[124:125], v12 offset:51200
    ds_read_b64_tr_b16 a[126:127], v12 offset:55296
    v_add_f32 v205, v205, v213
    s_waitcnt vmcnt(8)
    s_barrier
    s_waitcnt lgkmcnt(6)
    v_mfma_f32_32x32x16_bf16 v[36:51], a[120:123], v[132:135], v[36:51]
    ds_read_b128 v[164:167], v19 offset:8192
    s_lshl_b32 s38, s37, 1
    s_add_u32 m0, s38, 16384
    s_nop 0
    buffer_load_dwordx4 v2, s[16:19], s36 offen lds
    v_add_f32 v206, v206, v214
    v_mfma_f32_32x32x16_bf16 v[52:67], a[120:123], v[136:139], v[52:67]
    ds_read_b128 v[168:171], v19 offset:10240
    buffer_load_dwordx4 v3, s[16:19], s36 offen offset:1024 lds
    s_add_u32 s36, s36, 229376
    v_add_f32 v207, v207, v215
    v_mfma_f32_32x32x16_bf16 v[68:83], a[120:123], v[140:143], v[68:83]
    ds_read_b128 v[132:135], v19 offset:12288
    s_add_u32 m0, s37, 24576
    s_nop 0
    buffer_load_dwordx4 v4, s[12:15], s35 offen sc1 lds
    v_add_f32 v208, v208, v216
    v_mfma_f32_32x32x16_bf16 v[84:99], a[120:123], v[144:147], v[84:99]
    ds_read_b128 v[136:139], v19 offset:14336
    s_add_u32 m0, s37, 28672
    s_nop 0
    buffer_load_dwordx4 v5, s[12:15], s35 offen sc1 lds
    s_add_u32 s35, s35, 1024
    v_add_f32 v209, v209, v217
    v_mfma_f32_32x32x16_bf16 v[116:131], a[120:123], v[32:35], v[116:131]
    ds_read_b64_tr_b16 a[128:129], v13 offset:0
    ds_read_b64_tr_b16 a[130:131], v13 offset:4096
    v_add_f32 v210, v210, v218
    s_waitcnt lgkmcnt(6)
    v_mfma_f32_32x32x16_bf16 v[36:51], a[124:127], v[148:151], v[36:51]
    ds_read_b128 v[140:143], v19 offset:8704
    v_add_f32 v211, v211, v219
    v_add_f32 v204, v204, v208
    v_add_f32 v205, v205, v209
    v_mfma_f32_32x32x16_bf16 v[52:67], a[124:127], v[152:155], v[52:67]
    ds_read_b128 v[144:147], v19 offset:10752
    v_add_f32 v206, v206, v210
    v_add_f32 v207, v207, v211
    v_add_f32 v204, v204, v206
    v_mfma_f32_32x32x16_bf16 v[68:83], a[124:127], v[156:159], v[68:83]
    ds_read_b128 v[148:151], v19 offset:12800
    v_add_f32 v205, v205, v207
    v_mul_f32 v208, 0x3a800000, v204
    v_mul_f32 v209, 0x3a800000, v205
    v_mfma_f32_32x32x16_bf16 v[84:99], a[124:127], v[160:163], v[84:99]
    ds_read_b128 v[152:155], v19 offset:14848
    v_fma_f32 v209, -v208, v208, v209
    v_max_f32 v209, 0, v209
    v_add_f32 v209, 0x3727c5ac, v209
    v_mfma_f32_32x32x16_bf16 v[116:131], a[124:127], v[32:35], v[116:131]
    ds_read_b64_tr_b16 a[132:133], v13 offset:2048
    ds_read_b64_tr_b16 a[134:135], v13 offset:6144
    v_rsq_f32 v210, v209
    s_waitcnt vmcnt(8)
    s_barrier
    s_waitcnt lgkmcnt(6)
    v_mfma_f32_32x32x16_bf16 v[36:51], a[128:131], v[164:167], v[36:51]
    ds_read_b128 v[156:159], v19 offset:24576
    s_lshl_b32 s38, s37, 1
    s_add_u32 m0, s38, 32768
    s_nop 0
    buffer_load_dwordx4 v2, s[16:19], s36 offen lds
    v_sqrt_f32 v209, v209
    v_mfma_f32_32x32x16_bf16 v[52:67], a[128:131], v[168:171], v[52:67]
    ds_read_b128 v[160:163], v19 offset:26624
    buffer_load_dwordx4 v3, s[16:19], s36 offen offset:1024 lds
    s_add_u32 s36, s36, 229376
    v_mul_f32 v211, v210, v210
    v_mfma_f32_32x32x16_bf16 v[68:83], a[128:131], v[132:135], v[68:83]
    ds_read_b128 v[164:167], v19 offset:28672
    s_add_u32 m0, s37, 40960
    s_nop 0
    buffer_load_dwordx4 v4, s[12:15], s35 offen sc1 lds
    v_mul_f32 v211, v211, v210
    v_mfma_f32_32x32x16_bf16 v[84:99], a[128:131], v[136:139], v[84:99]
    ds_read_b128 v[168:171], v19 offset:30720
    s_add_u32 m0, s37, 45056
    s_nop 0
    buffer_load_dwordx4 v5, s[12:15], s35 offen sc1 lds
    s_add_u32 s35, s35, 1024
    v_mul_f32 v210, s44, v210
    v_mfma_f32_32x32x16_bf16 v[116:131], a[128:131], v[32:35], v[116:131]
    ds_read_b64_tr_b16 a[136:137], v13 offset:16384
    ds_read_b64_tr_b16 a[138:139], v13 offset:20480
    v_mul_f32 v211, s45, v211
    s_waitcnt lgkmcnt(6)
    v_mfma_f32_32x32x16_bf16 v[36:51], a[132:135], v[140:143], v[36:51]
    ds_read_b128 v[132:135], v19 offset:25088
    ds_write_b128 v29, v[208:211]
    v_mfma_f32_32x32x16_bf16 v[52:67], a[132:135], v[144:147], v[52:67]
    ds_read_b128 v[136:139], v19 offset:27136
    v_mfma_f32_32x32x16_bf16 v[68:83], a[132:135], v[148:151], v[68:83]
    ds_read_b128 v[140:143], v19 offset:29184
    v_mfma_f32_32x32x16_bf16 v[84:99], a[132:135], v[152:155], v[84:99]
    ds_read_b128 v[144:147], v19 offset:31232
    v_mfma_f32_32x32x16_bf16 v[116:131], a[132:135], v[32:35], v[116:131]
    ds_read_b64_tr_b16 a[140:141], v13 offset:18432
    ds_read_b64_tr_b16 a[142:143], v13 offset:22528
    s_waitcnt vmcnt(8)
    s_barrier
    s_waitcnt lgkmcnt(7)
    v_mfma_f32_32x32x16_bf16 v[36:51], a[136:139], v[156:159], v[36:51]
    ds_read_b128 v[148:151], v18 offset:8192
    s_lshl_b32 s38, s37, 1
    s_add_u32 m0, s38, 49152
    s_nop 0
    buffer_load_dwordx4 v2, s[16:19], s36 offen lds
    v_mfma_f32_32x32x16_bf16 v[52:67], a[136:139], v[160:163], v[52:67]
    ds_read_b128 v[152:155], v18 offset:10240
    buffer_load_dwordx4 v3, s[16:19], s36 offen offset:1024 lds
    s_add_u32 s36, s36, 229376
    v_mfma_f32_32x32x16_bf16 v[68:83], a[136:139], v[164:167], v[68:83]
    ds_read_b128 v[156:159], v18 offset:12288
    s_add_u32 m0, s37, 57344
    s_nop 0
    buffer_load_dwordx4 v4, s[12:15], s35 offen sc1 lds
    v_mfma_f32_32x32x16_bf16 v[84:99], a[136:139], v[168:171], v[84:99]
    ds_read_b128 v[160:163], v18 offset:14336
    s_add_u32 m0, s37, 61440
    s_nop 0
    buffer_load_dwordx4 v5, s[12:15], s35 offen sc1 lds
    s_add_u32 s35, s35, 1024
    v_mfma_f32_32x32x16_bf16 v[116:131], a[136:139], v[32:35], v[116:131]
    ds_read_b64_tr_b16 a[144:145], v12 offset:0
    ds_read_b64_tr_b16 a[146:147], v12 offset:4096
    s_waitcnt lgkmcnt(6)
    v_mfma_f32_32x32x16_bf16 v[36:51], a[140:143], v[132:135], v[36:51]
    ds_read_b128 v[164:167], v18 offset:8704
    v_mfma_f32_32x32x16_bf16 v[52:67], a[140:143], v[136:139], v[52:67]
    ds_read_b128 v[168:171], v18 offset:10752
    v_mfma_f32_32x32x16_bf16 v[68:83], a[140:143], v[140:143], v[68:83]
    ds_read_b128 v[132:135], v18 offset:12800
    v_mfma_f32_32x32x16_bf16 v[84:99], a[140:143], v[144:147], v[84:99]
    ds_read_b128 v[136:139], v18 offset:14848
    v_mfma_f32_32x32x16_bf16 v[116:131], a[140:143], v[32:35], v[116:131]
    ds_read_b64_tr_b16 a[148:149], v12 offset:2048
    ds_read_b64_tr_b16 a[150:151], v12 offset:6144
    s_waitcnt vmcnt(8)
    s_barrier
    s_waitcnt lgkmcnt(6)
    v_mfma_f32_32x32x16_bf16 v[36:51], a[144:147], v[148:151], v[36:51]
    ds_read_b128 v[140:143], v18 offset:24576
    s_lshl_b32 s38, s37, 1
    s_add_u32 m0, s38, 65536
    s_nop 0
    buffer_load_dwordx4 v2, s[16:19], s36 offen lds
    v_mfma_f32_32x32x16_bf16 v[52:67], a[144:147], v[152:155], v[52:67]
    ds_read_b128 v[144:147], v18 offset:26624
    buffer_load_dwordx4 v3, s[16:19], s36 offen offset:1024 lds
    s_add_u32 s36, s36, 229376
    v_mfma_f32_32x32x16_bf16 v[68:83], a[144:147], v[156:159], v[68:83]
    ds_read_b128 v[148:151], v18 offset:28672
    s_add_u32 m0, s37, 73728
    s_nop 0
    buffer_load_dwordx4 v4, s[12:15], s35 offen sc1 lds
    v_mfma_f32_32x32x16_bf16 v[84:99], a[144:147], v[160:163], v[84:99]
    ds_read_b128 v[152:155], v18 offset:30720
    s_add_u32 m0, s37, 77824
    s_nop 0
    buffer_load_dwordx4 v5, s[12:15], s35 offen sc1 lds
    s_add_u32 s35, s35, 1024
    v_mfma_f32_32x32x16_bf16 v[116:131], a[144:147], v[32:35], v[116:131]
    ds_read_b64_tr_b16 a[152:153], v12 offset:16384
    ds_read_b64_tr_b16 a[154:155], v12 offset:20480
    s_waitcnt lgkmcnt(6)
    v_mfma_f32_32x32x16_bf16 v[36:51], a[148:151], v[164:167], v[36:51]
    ds_read_b128 v[156:159], v18 offset:25088
    v_mfma_f32_32x32x16_bf16 v[52:67], a[148:151], v[168:171], v[52:67]
    ds_read_b128 v[160:163], v18 offset:27136
    v_mfma_f32_32x32x16_bf16 v[68:83], a[148:151], v[132:135], v[68:83]
    ds_read_b128 v[164:167], v18 offset:29184
    v_mfma_f32_32x32x16_bf16 v[84:99], a[148:151], v[136:139], v[84:99]
    ds_read_b128 v[168:171], v18 offset:31232
    v_mfma_f32_32x32x16_bf16 v[116:131], a[148:151], v[32:35], v[116:131]
    ds_read_b64_tr_b16 a[156:157], v12 offset:18432
    ds_read_b64_tr_b16 a[158:159], v12 offset:22528
    s_waitcnt vmcnt(8)
    s_barrier
    s_waitcnt lgkmcnt(6)
    v_mfma_f32_32x32x16_bf16 v[36:51], a[152:155], v[140:143], v[36:51]
    ds_read_b128 v[132:135], v18 offset:40960
    s_lshl_b32 s38, s37, 1
    s_add_u32 m0, s38, 81920
    s_nop 0
    buffer_load_dwordx4 v2, s[16:19], s36 offen lds
    v_mfma_f32_32x32x16_bf16 v[52:67], a[152:155], v[144:147], v[52:67]
    ds_read_b128 v[136:139], v18 offset:43008
    buffer_load_dwordx4 v3, s[16:19], s36 offen offset:1024 lds
    s_add_u32 s36, s36, 229376
    v_mfma_f32_32x32x16_bf16 v[68:83], a[152:155], v[148:151], v[68:83]
    ds_read_b128 v[140:143], v18 offset:45056
    s_add_u32 m0, s37, 90112
    s_nop 0
    buffer_load_dwordx4 v4, s[12:15], s35 offen sc1 lds
    v_mfma_f32_32x32x16_bf16 v[84:99], a[152:155], v[152:155], v[84:99]
    ds_read_b128 v[144:147], v18 offset:47104
    s_add_u32 m0, s37, 94208
    s_nop 0
    buffer_load_dwordx4 v5, s[12:15], s35 offen sc1 lds
    s_add_u32 s35, s35, 1024
    v_mfma_f32_32x32x16_bf16 v[116:131], a[152:155], v[32:35], v[116:131]
    ds_read_b64_tr_b16 a[160:161], v12 offset:32768
    ds_read_b64_tr_b16 a[162:163], v12 offset:36864
    s_waitcnt lgkmcnt(6)
    v_mfma_f32_32x32x16_bf16 v[36:51], a[156:159], v[156:159], v[36:51]
    ds_read_b128 v[148:151], v18 offset:41472
    v_mfma_f32_32x32x16_bf16 v[52:67], a[156:159], v[160:163], v[52:67]
    ds_read_b128 v[152:155], v18 offset:43520
    v_mfma_f32_32x32x16_bf16 v[68:83], a[156:159], v[164:167], v[68:83]
    ds_read_b128 v[156:159], v18 offset:45568
    v_mfma_f32_32x32x16_bf16 v[84:99], a[156:159], v[168:171], v[84:99]
    ds_read_b128 v[160:163], v18 offset:47616
    v_mfma_f32_32x32x16_bf16 v[116:131], a[156:159], v[32:35], v[116:131]
    ds_read_b64_tr_b16 a[164:165], v12 offset:34816
    ds_read_b64_tr_b16 a[166:167], v12 offset:38912
    s_waitcnt vmcnt(8)
    s_barrier
    s_waitcnt lgkmcnt(6)
    v_mfma_f32_32x32x16_bf16 v[36:51], a[160:163], v[132:135], v[36:51]
    ds_read_b128 v[164:167], v18 offset:57344
    s_lshl_b32 s38, s37, 1
    s_add_u32 m0, s38, 0
    s_nop 0
    buffer_load_dwordx4 v2, s[16:19], s36 offen lds
    v_mfma_f32_32x32x16_bf16 v[52:67], a[160:163], v[136:139], v[52:67]
    ds_read_b128 v[168:171], v18 offset:59392
    buffer_load_dwordx4 v3, s[16:19], s36 offen offset:1024 lds
    s_add_u32 s36, s36, 229376
    v_mfma_f32_32x32x16_bf16 v[68:83], a[160:163], v[140:143], v[68:83]
    ds_read_b128 v[132:135], v18 offset:61440
    s_add_u32 m0, s37, 8192
    s_nop 0
    buffer_load_dwordx4 v4, s[12:15], s35 offen sc1 lds
    v_mfma_f32_32x32x16_bf16 v[84:99], a[160:163], v[144:147], v[84:99]
    ds_read_b128 v[136:139], v18 offset:63488
    s_add_u32 m0, s37, 12288
    s_nop 0
    buffer_load_dwordx4 v5, s[12:15], s35 offen sc1 lds
    s_add_u32 s35, s35, 1024
    v_mfma_f32_32x32x16_bf16 v[116:131], a[160:163], v[32:35], v[116:131]
    ds_read_b64_tr_b16 a[168:169], v12 offset:49152
    ds_read_b64_tr_b16 a[170:171], v12 offset:53248
    s_waitcnt lgkmcnt(6)
    v_mfma_f32_32x32x16_bf16 v[36:51], a[164:167], v[148:151], v[36:51]
    ds_read_b128 v[140:143], v18 offset:57856
    v_mfma_f32_32x32x16_bf16 v[52:67], a[164:167], v[152:155], v[52:67]
    ds_read_b128 v[144:147], v18 offset:59904
    v_mfma_f32_32x32x16_bf16 v[68:83], a[164:167], v[156:159], v[68:83]
    ds_read_b128 v[148:151], v18 offset:61952
    v_mfma_f32_32x32x16_bf16 v[84:99], a[164:167], v[160:163], v[84:99]
    ds_read_b128 v[152:155], v18 offset:64000
    v_mfma_f32_32x32x16_bf16 v[116:131], a[164:167], v[32:35], v[116:131]
    ds_read_b64_tr_b16 a[172:173], v12 offset:51200
    ds_read_b64_tr_b16 a[174:175], v12 offset:55296
    s_waitcnt vmcnt(8)
    s_barrier
    s_waitcnt lgkmcnt(6)
    v_mfma_f32_32x32x16_bf16 v[36:51], a[168:171], v[164:167], v[36:51]
    ds_read_b128 v[156:159], v19 offset:8192
    s_lshl_b32 s38, s37, 1
    s_add_u32 m0, s38, 16384
    s_nop 0
    buffer_load_dwordx4 v2, s[16:19], s36 offen lds
    v_mfma_f32_32x32x16_bf16 v[52:67], a[168:171], v[168:171], v[52:67]
    ds_read_b128 v[160:163], v19 offset:10240
    buffer_load_dwordx4 v3, s[16:19], s36 offen offset:1024 lds
    s_add_u32 s36, s36, 229376
    v_mfma_f32_32x32x16_bf16 v[68:83], a[168:171], v[132:135], v[68:83]
    ds_read_b128 v[164:167], v19 offset:12288
    s_add_u32 m0, s37, 24576
    s_nop 0
    buffer_load_dwordx4 v4, s[12:15], s35 offen sc1 lds
    v_mfma_f32_32x32x16_bf16 v[84:99], a[168:171], v[136:139], v[84:99]
    ds_read_b128 v[168:171], v19 offset:14336
    s_add_u32 m0, s37, 28672
    s_nop 0
    buffer_load_dwordx4 v5, s[12:15], s35 offen sc1 lds
    s_add_u32 s35, s35, 1024
    v_mfma_f32_32x32x16_bf16 v[116:131], a[168:171], v[32:35], v[116:131]
    ds_read_b64_tr_b16 a[176:177], v13 offset:0
    ds_read_b64_tr_b16 a[178:179], v13 offset:4096
    s_waitcnt lgkmcnt(6)
    v_mfma_f32_32x32x16_bf16 v[36:51], a[172:175], v[140:143], v[36:51]
    ds_read_b128 v[132:135], v19 offset:8704
    v_mfma_f32_32x32x16_bf16 v[52:67], a[172:175], v[144:147], v[52:67]
    ds_read_b128 v[136:139], v19 offset:10752
    v_mfma_f32_32x32x16_bf16 v[68:83], a[172:175], v[148:151], v[68:83]
    ds_read_b128 v[140:143], v19 offset:12800
    v_mfma_f32_32x32x16_bf16 v[84:99], a[172:175], v[152:155], v[84:99]
    ds_read_b128 v[144:147], v19 offset:14848
    v_mfma_f32_32x32x16_bf16 v[116:131], a[172:175], v[32:35], v[116:131]
    ds_read_b64_tr_b16 a[180:181], v13 offset:2048
    ds_read_b64_tr_b16 a[182:183], v13 offset:6144
    s_waitcnt vmcnt(8)
    s_barrier
    s_waitcnt lgkmcnt(6)
    v_mfma_f32_32x32x16_bf16 v[36:51], a[176:179], v[156:159], v[36:51]
    ds_read_b128 v[148:151], v19 offset:24576
    s_lshl_b32 s38, s37, 1
    s_add_u32 m0, s38, 32768
    s_nop 0
    buffer_load_dwordx4 v2, s[16:19], s36 offen lds
    v_mfma_f32_32x32x16_bf16 v[52:67], a[176:179], v[160:163], v[52:67]
    ds_read_b128 v[152:155], v19 offset:26624
    buffer_load_dwordx4 v3, s[16:19], s36 offen offset:1024 lds
    s_add_u32 s36, s36, 229376
    v_mfma_f32_32x32x16_bf16 v[68:83], a[176:179], v[164:167], v[68:83]
    ds_read_b128 v[156:159], v19 offset:28672
    s_add_u32 m0, s37, 40960
    s_nop 0
    buffer_load_dwordx4 v4, s[12:15], s35 offen sc1 lds
    v_mfma_f32_32x32x16_bf16 v[84:99], a[176:179], v[168:171], v[84:99]
    ds_read_b128 v[160:163], v19 offset:30720
    s_add_u32 m0, s37, 45056
    s_nop 0
    buffer_load_dwordx4 v5, s[12:15], s35 offen sc1 lds
    s_add_u32 s35, s35, 1024
    v_mfma_f32_32x32x16_bf16 v[116:131], a[176:179], v[32:35], v[116:131]
    ds_read_b64_tr_b16 a[184:185], v13 offset:16384
    ds_read_b64_tr_b16 a[186:187], v13 offset:20480
    s_waitcnt lgkmcnt(6)
    v_mfma_f32_32x32x16_bf16 v[36:51], a[180:183], v[132:135], v[36:51]
    ds_read_b128 v[164:167], v19 offset:25088
    v_mfma_f32_32x32x16_bf16 v[52:67], a[180:183], v[136:139], v[52:67]
    ds_read_b128 v[168:171], v19 offset:27136
    v_mfma_f32_32x32x16_bf16 v[68:83], a[180:183], v[140:143], v[68:83]
    ds_read_b128 v[132:135], v19 offset:29184
    v_mfma_f32_32x32x16_bf16 v[84:99], a[180:183], v[144:147], v[84:99]
    ds_read_b128 v[136:139], v19 offset:31232
    v_mfma_f32_32x32x16_bf16 v[116:131], a[180:183], v[32:35], v[116:131]
    ds_read_b64_tr_b16 a[188:189], v13 offset:18432
    ds_read_b64_tr_b16 a[190:191], v13 offset:22528
    s_waitcnt vmcnt(8)
    s_barrier
    s_waitcnt lgkmcnt(6)
    v_mfma_f32_32x32x16_bf16 v[36:51], a[184:187], v[148:151], v[36:51]
    ds_read_b128 v[140:143], v18 offset:8192
    s_lshl_b32 s38, s37, 1
    s_add_u32 m0, s38, 49152
    s_nop 0
    buffer_load_dwordx4 v2, s[16:19], s36 offen lds
    v_mfma_f32_32x32x16_bf16 v[52:67], a[184:187], v[152:155], v[52:67]
    ds_read_b128 v[144:147], v18 offset:10240
    buffer_load_dwordx4 v3, s[16:19], s36 offen offset:1024 lds
    s_add_u32 s36, s36, 229376
    v_mfma_f32_32x32x16_bf16 v[68:83], a[184:187], v[156:159], v[68:83]
    ds_read_b128 v[148:151], v18 offset:12288
    s_add_u32 m0, s37, 57344
    s_nop 0
    buffer_load_dwordx4 v4, s[12:15], s35 offen sc1 lds
    v_mfma_f32_32x32x16_bf16 v[84:99], a[184:187], v[160:163], v[84:99]
    ds_read_b128 v[152:155], v18 offset:14336
    s_add_u32 m0, s37, 61440
    s_nop 0
    buffer_load_dwordx4 v5, s[12:15], s35 offen sc1 lds
    s_add_u32 s35, s35, 1024
    v_mfma_f32_32x32x16_bf16 v[116:131], a[184:187], v[32:35], v[116:131]
    ds_read_b64_tr_b16 a[192:193], v12 offset:0
    ds_read_b64_tr_b16 a[194:195], v12 offset:4096
    s_waitcnt lgkmcnt(6)
    v_mfma_f32_32x32x16_bf16 v[36:51], a[188:191], v[164:167], v[36:51]
    ds_read_b128 v[156:159], v18 offset:8704
    v_mfma_f32_32x32x16_bf16 v[52:67], a[188:191], v[168:171], v[52:67]
    ds_read_b128 v[160:163], v18 offset:10752
    v_mfma_f32_32x32x16_bf16 v[68:83], a[188:191], v[132:135], v[68:83]
    ds_read_b128 v[164:167], v18 offset:12800
    v_mfma_f32_32x32x16_bf16 v[84:99], a[188:191], v[136:139], v[84:99]
    ds_read_b128 v[168:171], v18 offset:14848
    v_mfma_f32_32x32x16_bf16 v[116:131], a[188:191], v[32:35], v[116:131]
    ds_read_b64_tr_b16 a[196:197], v12 offset:2048
    ds_read_b64_tr_b16 a[198:199], v12 offset:6144
    s_waitcnt vmcnt(8)
    s_barrier
    s_waitcnt lgkmcnt(6)
    v_mfma_f32_32x32x16_bf16 v[36:51], a[192:195], v[140:143], v[36:51]
    ds_read_b128 v[132:135], v18 offset:24576
    s_lshl_b32 s38, s37, 1
    s_add_u32 m0, s38, 65536
    s_nop 0
    buffer_load_dwordx4 v2, s[16:19], s36 offen lds
    v_mfma_f32_32x32x16_bf16 v[52:67], a[192:195], v[144:147], v[52:67]
    ds_read_b128 v[136:139], v18 offset:26624
    buffer_load_dwordx4 v3, s[16:19], s36 offen offset:1024 lds
    s_add_u32 s36, s36, 229376
    v_mfma_f32_32x32x16_bf16 v[68:83], a[192:195], v[148:151], v[68:83]
    ds_read_b128 v[140:143], v18 offset:28672
    s_add_u32 m0, s37, 73728
    s_nop 0
    buffer_load_dwordx4 v4, s[12:15], s35 offen sc1 lds
    v_mfma_f32_32x32x16_bf16 v[84:99], a[192:195], v[152:155], v[84:99]
    ds_read_b128 v[144:147], v18 offset:30720
    s_add_u32 m0, s37, 77824
    s_nop 0
    buffer_load_dwordx4 v5, s[12:15], s35 offen sc1 lds
    s_add_u32 s35, s35, 1024
    v_mfma_f32_32x32x16_bf16 v[116:131], a[192:195], v[32:35], v[116:131]
    ds_read_b64_tr_b16 a[200:201], v12 offset:16384
    ds_read_b64_tr_b16 a[202:203], v12 offset:20480
    s_waitcnt lgkmcnt(6)
    v_mfma_f32_32x32x16_bf16 v[36:51], a[196:199], v[156:159], v[36:51]
    ds_read_b128 v[148:151], v18 offset:25088
    v_mfma_f32_32x32x16_bf16 v[52:67], a[196:199], v[160:163], v[52:67]
    ds_read_b128 v[152:155], v18 offset:27136
    v_mfma_f32_32x32x16_bf16 v[68:83], a[196:199], v[164:167], v[68:83]
    ds_read_b128 v[156:159], v18 offset:29184
    v_mfma_f32_32x32x16_bf16 v[84:99], a[196:199], v[168:171], v[84:99]
    ds_read_b128 v[160:163], v18 offset:31232
    v_mfma_f32_32x32x16_bf16 v[116:131], a[196:199], v[32:35], v[116:131]
    ds_read_b64_tr_b16 a[204:205], v12 offset:18432
    ds_read_b64_tr_b16 a[206:207], v12 offset:22528
    s_waitcnt vmcnt(8)
    s_barrier
    s_waitcnt lgkmcnt(6)
    v_mfma_f32_32x32x16_bf16 v[36:51], a[200:203], v[132:135], v[36:51]
    ds_read_b128 v[164:167], v18 offset:40960
    s_lshl_b32 s38, s37, 1
    s_add_u32 m0, s38, 81920
    s_nop 0
    buffer_load_dwordx4 v2, s[16:19], s36 offen lds
    v_mfma_f32_32x32x16_bf16 v[52:67], a[200:203], v[136:139], v[52:67]
    ds_read_b128 v[168:171], v18 offset:43008
    buffer_load_dwordx4 v3, s[16:19], s36 offen offset:1024 lds
    s_add_u32 s36, s36, 229376
    v_mfma_f32_32x32x16_bf16 v[68:83], a[200:203], v[140:143], v[68:83]
    ds_read_b128 v[132:135], v18 offset:45056
    s_add_u32 m0, s37, 90112
    s_nop 0
    buffer_load_dwordx4 v4, s[12:15], s35 offen sc1 lds
    v_mfma_f32_32x32x16_bf16 v[84:99], a[200:203], v[144:147], v[84:99]
    ds_read_b128 v[136:139], v18 offset:47104
    s_add_u32 m0, s37, 94208
    s_nop 0
    buffer_load_dwordx4 v5, s[12:15], s35 offen sc1 lds
    s_add_u32 s35, s35, 1024
    v_mfma_f32_32x32x16_bf16 v[116:131], a[200:203], v[32:35], v[116:131]
    ds_read_b64_tr_b16 a[208:209], v12 offset:32768
    ds_read_b64_tr_b16 a[210:211], v12 offset:36864
    s_waitcnt lgkmcnt(6)
    v_mfma_f32_32x32x16_bf16 v[36:51], a[204:207], v[148:151], v[36:51]
    ds_read_b128 v[140:143], v18 offset:41472
    v_mfma_f32_32x32x16_bf16 v[52:67], a[204:207], v[152:155], v[52:67]
    ds_read_b128 v[144:147], v18 offset:43520
    v_mfma_f32_32x32x16_bf16 v[68:83], a[204:207], v[156:159], v[68:83]
    ds_read_b128 v[148:151], v18 offset:45568
    v_mfma_f32_32x32x16_bf16 v[84:99], a[204:207], v[160:163], v[84:99]
    ds_read_b128 v[152:155], v18 offset:47616
    v_mfma_f32_32x32x16_bf16 v[116:131], a[204:207], v[32:35], v[116:131]
    ds_read_b64_tr_b16 a[212:213], v12 offset:34816
    ds_read_b64_tr_b16 a[214:215], v12 offset:38912
    s_waitcnt vmcnt(8)
    s_barrier
    s_waitcnt lgkmcnt(6)
    v_mfma_f32_32x32x16_bf16 v[36:51], a[208:211], v[164:167], v[36:51]
    ds_read_b128 v[156:159], v18 offset:57344
    s_lshl_b32 s38, s37, 1
    s_add_u32 m0, s38, 0
    s_nop 0
    buffer_load_dwordx4 v2, s[16:19], s36 offen lds
    v_mfma_f32_32x32x16_bf16 v[52:67], a[208:211], v[168:171], v[52:67]
    ds_read_b128 v[160:163], v18 offset:59392
    buffer_load_dwordx4 v3, s[16:19], s36 offen offset:1024 lds
    s_add_u32 s36, s36, 229376
    v_mfma_f32_32x32x16_bf16 v[68:83], a[208:211], v[132:135], v[68:83]
    ds_read_b128 v[164:167], v18 offset:61440
    s_add_u32 m0, s37, 8192
    s_nop 0
    buffer_load_dwordx4 v4, s[12:15], s35 offen sc1 lds
    v_mfma_f32_32x32x16_bf16 v[84:99], a[208:211], v[136:139], v[84:99]
    ds_read_b128 v[168:171], v18 offset:63488
    s_add_u32 m0, s37, 12288
    s_nop 0
    buffer_load_dwordx4 v5, s[12:15], s35 offen sc1 lds
    s_add_u32 s35, s35, 1024
    v_mfma_f32_32x32x16_bf16 v[116:131], a[208:211], v[32:35], v[116:131]
    ds_read_b64_tr_b16 a[216:217], v12 offset:49152
    ds_read_b64_tr_b16 a[218:219], v12 offset:53248
    s_waitcnt lgkmcnt(6)
    v_mfma_f32_32x32x16_bf16 v[36:51], a[212:215], v[140:143], v[36:51]
    ds_read_b128 v[132:135], v18 offset:57856
    s_add_u32 m0, s42, 98304
    s_nop 0
    buffer_load_dwordx4 v6, s[12:15], s41 offen offset:0 sc1 lds
    v_mfma_f32_32x32x16_bf16 v[52:67], a[212:215], v[144:147], v[52:67]
    ds_read_b128 v[136:139], v18 offset:59904
    buffer_load_dwordx4 v6, s[12:15], s41 offen offset:1024 sc1 lds
    v_mfma_f32_32x32x16_bf16 v[68:83], a[212:215], v[148:151], v[68:83]
    ds_read_b128 v[140:143], v18 offset:61952
    buffer_load_dwordx4 v6, s[12:15], s41 offen offset:2048 sc1 lds
    v_mfma_f32_32x32x16_bf16 v[84:99], a[212:215], v[152:155], v[84:99]
    ds_read_b128 v[144:147], v18 offset:64000
    buffer_load_dwordx4 v6, s[12:15], s41 offen offset:3072 sc1 lds
    s_add_u32 s41, s41, 8192
    v_mfma_f32_32x32x16_bf16 v[116:131], a[212:215], v[32:35], v[116:131]
    ds_read_b64_tr_b16 a[220:221], v12 offset:51200
    ds_read_b64_tr_b16 a[222:223], v12 offset:55296
    s_waitcnt vmcnt(12)
    s_barrier
    s_waitcnt lgkmcnt(6)
    v_mfma_f32_32x32x16_bf16 v[36:51], a[216:219], v[156:159], v[36:51]
    ds_read_b128 v[148:151], v19 offset:8192
    s_lshl_b32 s38, s37, 1
    s_add_u32 m0, s38, 16384
    s_nop 0
    buffer_load_dwordx4 v2, s[16:19], s36 offen lds
    v_mfma_f32_32x32x16_bf16 v[52:67], a[216:219], v[160:163], v[52:67]
    ds_read_b128 v[152:155], v19 offset:10240
    buffer_load_dwordx4 v3, s[16:19], s36 offen offset:1024 lds
    s_add_u32 s36, s36, 229376
    v_mfma_f32_32x32x16_bf16 v[68:83], a[216:219], v[164:167], v[68:83]
    ds_read_b128 v[156:159], v19 offset:12288
    s_add_u32 m0, s37, 24576
    s_nop 0
    buffer_load_dwordx4 v4, s[12:15], s35 offen sc1 lds
    v_mfma_f32_32x32x16_bf16 v[84:99], a[216:219], v[168:171], v[84:99]
    ds_read_b128 v[160:163], v19 offset:14336
    s_add_u32 m0, s37, 28672
    s_nop 0
    buffer_load_dwordx4 v5, s[12:15], s35 offen sc1 lds
    s_add_u32 s35, s35, 1024
    v_mfma_f32_32x32x16_bf16 v[116:131], a[216:219], v[32:35], v[116:131]
    ds_read_b64_tr_b16 a[224:225], v13 offset:0
    ds_read_b64_tr_b16 a[226:227], v13 offset:4096
    s_waitcnt lgkmcnt(6)
    v_mfma_f32_32x32x16_bf16 v[36:51], a[220:223], v[132:135], v[36:51]
    ds_read_b128 v[164:167], v19 offset:8704
    v_mfma_f32_32x32x16_bf16 v[52:67], a[220:223], v[136:139], v[52:67]
    ds_read_b128 v[168:171], v19 offset:10752
    v_mfma_f32_32x32x16_bf16 v[68:83], a[220:223], v[140:143], v[68:83]
    ds_read_b128 v[132:135], v19 offset:12800
    v_mfma_f32_32x32x16_bf16 v[84:99], a[220:223], v[144:147], v[84:99]
    ds_read_b128 v[136:139], v19 offset:14848
    v_mfma_f32_32x32x16_bf16 v[116:131], a[220:223], v[32:35], v[116:131]
    ds_read_b64_tr_b16 a[228:229], v13 offset:2048
    ds_read_b64_tr_b16 a[230:231], v13 offset:6144
    s_waitcnt vmcnt(12)
    s_barrier
    s_waitcnt lgkmcnt(6)
    v_mfma_f32_32x32x16_bf16 v[36:51], a[224:227], v[148:151], v[36:51]
    ds_read_b128 v[140:143], v19 offset:24576
    s_add_u32 m0, s42, 114688
    s_nop 0
    buffer_load_dwordx4 v6, s[12:15], s41 offen offset:0 sc1 lds
    v_mfma_f32_32x32x16_bf16 v[52:67], a[224:227], v[152:155], v[52:67]
    ds_read_b128 v[144:147], v19 offset:26624
    buffer_load_dwordx4 v6, s[12:15], s41 offen offset:1024 sc1 lds
    v_mfma_f32_32x32x16_bf16 v[68:83], a[224:227], v[156:159], v[68:83]
    ds_read_b128 v[148:151], v19 offset:28672
    buffer_load_dwordx4 v6, s[12:15], s41 offen offset:2048 sc1 lds
    v_mfma_f32_32x32x16_bf16 v[84:99], a[224:227], v[160:163], v[84:99]
    ds_read_b128 v[152:155], v19 offset:30720
    buffer_load_dwordx4 v6, s[12:15], s41 offen offset:3072 sc1 lds
    s_add_u32 s41, s41, 8192
    v_mfma_f32_32x32x16_bf16 v[116:131], a[224:227], v[32:35], v[116:131]
    ds_read_b64_tr_b16 a[232:233], v13 offset:16384
    ds_read_b64_tr_b16 a[234:235], v13 offset:20480
    s_waitcnt lgkmcnt(6)
    v_mfma_f32_32x32x16_bf16 v[36:51], a[228:231], v[164:167], v[36:51]
    ds_read_b128 v[156:159], v19 offset:25088
    v_mfma_f32_32x32x16_bf16 v[52:67], a[228:231], v[168:171], v[52:67]
    ds_read_b128 v[160:163], v19 offset:27136
    v_mfma_f32_32x32x16_bf16 v[68:83], a[228:231], v[132:135], v[68:83]
    ds_read_b128 v[164:167], v19 offset:29184
    v_mfma_f32_32x32x16_bf16 v[84:99], a[228:231], v[136:139], v[84:99]
    ds_read_b128 v[168:171], v19 offset:31232
    v_mfma_f32_32x32x16_bf16 v[116:131], a[228:231], v[32:35], v[116:131]
    ds_read_b64_tr_b16 a[236:237], v13 offset:18432
    ds_read_b64_tr_b16 a[238:239], v13 offset:22528
    s_waitcnt vmcnt(12)
    s_barrier
    s_waitcnt lgkmcnt(6)
    v_mfma_f32_32x32x16_bf16 v[36:51], a[232:235], v[140:143], v[36:51]
    ds_read_b128 v[132:135], v18 offset:8192
    v_mfma_f32_32x32x16_bf16 v[52:67], a[232:235], v[144:147], v[52:67]
    ds_read_b128 v[136:139], v18 offset:10240
    v_mfma_f32_32x32x16_bf16 v[68:83], a[232:235], v[148:151], v[68:83]
    ds_read_b128 v[140:143], v18 offset:12288
    v_mfma_f32_32x32x16_bf16 v[84:99], a[232:235], v[152:155], v[84:99]
    ds_read_b128 v[144:147], v18 offset:14336
    v_mfma_f32_32x32x16_bf16 v[116:131], a[232:235], v[32:35], v[116:131]
    ds_read_b64_tr_b16 a[240:241], v12 offset:0
    ds_read_b64_tr_b16 a[242:243], v12 offset:4096
    s_waitcnt lgkmcnt(6)
    v_mfma_f32_32x32x16_bf16 v[36:51], a[236:239], v[156:159], v[36:51]
    ds_read_b128 v[148:151], v18 offset:8704
    v_mfma_f32_32x32x16_bf16 v[52:67], a[236:239], v[160:163], v[52:67]
    ds_read_b128 v[152:155], v18 offset:10752
    v_mfma_f32_32x32x16_bf16 v[68:83], a[236:239], v[164:167], v[68:83]
    ds_read_b128 v[156:159], v18 offset:12800
    v_mfma_f32_32x32x16_bf16 v[84:99], a[236:239], v[168:171], v[84:99]
    ds_read_b128 v[160:163], v18 offset:14848
    v_mfma_f32_32x32x16_bf16 v[116:131], a[236:239], v[32:35], v[116:131]
    ds_read_b64_tr_b16 a[244:245], v12 offset:2048
    ds_read_b64_tr_b16 a[246:247], v12 offset:6144
    s_waitcnt vmcnt(4)
    s_barrier
    s_waitcnt lgkmcnt(6)
    v_mfma_f32_32x32x16_bf16 v[36:51], a[240:243], v[132:135], v[36:51]
    ds_read_b128 v[164:167], v18 offset:24576
    s_add_u32 m0, s42, 131072
    s_nop 0
    buffer_load_dwordx4 v6, s[12:15], s41 offen offset:0 sc1 lds
    v_mfma_f32_32x32x16_bf16 v[52:67], a[240:243], v[136:139], v[52:67]
    ds_read_b128 v[168:171], v18 offset:26624
    buffer_load_dwordx4 v6, s[12:15], s41 offen offset:1024 sc1 lds
    v_mfma_f32_32x32x16_bf16 v[68:83], a[240:243], v[140:143], v[68:83]
    ds_read_b128 v[132:135], v18 offset:28672
    buffer_load_dwordx4 v6, s[12:15], s41 offen offset:2048 sc1 lds
    v_mfma_f32_32x32x16_bf16 v[84:99], a[240:243], v[144:147], v[84:99]
    ds_read_b128 v[136:139], v18 offset:30720
    buffer_load_dwordx4 v6, s[12:15], s41 offen offset:3072 sc1 lds
    s_add_u32 s41, s41, 8192
    v_mfma_f32_32x32x16_bf16 v[116:131], a[240:243], v[32:35], v[116:131]
    ds_read_b64_tr_b16 a[248:249], v12 offset:16384
    ds_read_b64_tr_b16 a[250:251], v12 offset:20480
    s_waitcnt lgkmcnt(6)
    v_mfma_f32_32x32x16_bf16 v[36:51], a[244:247], v[148:151], v[36:51]
    ds_read_b128 v[140:143], v18 offset:25088
    v_mfma_f32_32x32x16_bf16 v[52:67], a[244:247], v[152:155], v[52:67]
    ds_read_b128 v[144:147], v18 offset:27136
    v_mfma_f32_32x32x16_bf16 v[68:83], a[244:247], v[156:159], v[68:83]
    ds_read_b128 v[148:151], v18 offset:29184
    v_mfma_f32_32x32x16_bf16 v[84:99], a[244:247], v[160:163], v[84:99]
    ds_read_b128 v[152:155], v18 offset:31232
    v_mfma_f32_32x32x16_bf16 v[116:131], a[244:247], v[32:35], v[116:131]
    ds_read_b64_tr_b16 a[252:253], v12 offset:18432
    ds_read_b64_tr_b16 a[254:255], v12 offset:22528
    s_barrier
    s_waitcnt lgkmcnt(6)
    v_mfma_f32_32x32x16_bf16 v[36:51], a[248:251], v[164:167], v[36:51]
    v_mfma_f32_32x32x16_bf16 v[52:67], a[248:251], v[168:171], v[52:67]
    v_mfma_f32_32x32x16_bf16 v[68:83], a[248:251], v[132:135], v[68:83]
    ds_read_b128 v[156:159], v23 offset:32768
    v_mfma_f32_32x32x16_bf16 v[84:99], a[248:251], v[136:139], v[84:99]
    ds_read_b128 v[160:163], v23 offset:33280
    v_mfma_f32_32x32x16_bf16 v[116:131], a[248:251], v[32:35], v[116:131]
    s_waitcnt lgkmcnt(2)
    v_mfma_f32_32x32x16_bf16 v[36:51], a[252:255], v[140:143], v[36:51]
    ds_read_b128 v[164:167], v23 offset:33792
    v_mfma_f32_32x32x16_bf16 v[52:67], a[252:255], v[144:147], v[52:67]
    ds_read_b128 v[168:171], v23 offset:34304
    v_mfma_f32_32x32x16_bf16 v[68:83], a[252:255], v[148:151], v[68:83]
    ds_read_b128 v[132:135], v23 offset:34816
    v_mfma_f32_32x32x16_bf16 v[84:99], a[252:255], v[152:155], v[84:99]
    ds_read_b128 v[136:139], v23 offset:35328
    v_mfma_f32_32x32x16_bf16 v[116:131], a[252:255], v[32:35], v[116:131]
    ds_read_b128 v[172:175], v30 offset:0
    ds_read_b128 v[180:183], v30 offset:512
    ds_read_b128 v[188:191], v30 offset:1024
    ds_read_b128 v[196:199], v30 offset:1536
    s_waitcnt lgkmcnt(9)
    v_mfma_f32_32x32x16_bf16 v[100:115], a[0:3], v[156:159], 0
    ds_read_b128 v[140:143], v23 offset:35840
    s_waitcnt lgkmcnt(9)
    v_mfma_f32_32x32x16_bf16 v[100:115], a[4:7], v[160:163], v[100:115]
    ds_read_b128 v[144:147], v23 offset:36352
    s_waitcnt lgkmcnt(5)
    s_nop 0
    v_fma_f32 v36, -v172, v116, v36
    v_fma_f32 v37, -v172, v117, v37
    v_fma_f32 v38, -v172, v118, v38
    v_fma_f32 v39, -v172, v119, v39
    v_mul_f32 v204, v36, v36
    v_mfma_f32_32x32x16_bf16 v[100:115], a[8:11], v[164:167], v[100:115]
    ds_read_b128 v[148:151], v23 offset:36864
    v_mul_f32 v205, v37, v37
    v_mul_f32 v206, v38, v38
    v_mul_f32 v207, v39, v39
    v_fma_f32 v204, v204, v175, v174
    v_fma_f32 v205, v205, v175, v174
    v_mfma_f32_32x32x16_bf16 v[100:115], a[12:15], v[168:171], v[100:115]
    ds_read_b128 v[152:155], v23 offset:37376
    v_fma_f32 v206, v206, v175, v174
    v_fma_f32 v207, v207, v175, v174
    v_mul_f32 v204, v204, v36
    v_mul_f32 v205, v205, v37
    v_mul_f32 v206, v206, v38
    v_mfma_f32_32x32x16_bf16 v[100:115], a[16:19], v[132:135], v[100:115]
    ds_read_b128 v[156:159], v23 offset:37888
    v_mul_f32 v207, v207, v39
    v_exp_f32 v204, v204
    v_exp_f32 v205, v205
    s_waitcnt lgkmcnt(3)
    v_mfma_f32_32x32x16_bf16 v[100:115], a[20:23], v[136:139], v[100:115]
    ds_read_b128 v[160:163], v23 offset:38400
    v_exp_f32 v206, v206
    v_exp_f32 v207, v207
    v_fma_f32 v204, v204, v173, v173
    v_mfma_f32_32x32x16_bf16 v[100:115], a[24:27], v[140:143], v[100:115]
    ds_read_b128 v[164:167], v23 offset:38912
    v_fma_f32 v205, v205, v173, v173
    v_fma_f32 v206, v206, v173, v173
    v_fma_f32 v207, v207, v173, v173
    v_rcp_f32 v204, v204
    v_mfma_f32_32x32x16_bf16 v[100:115], a[28:31], v[144:147], v[100:115]
    ds_read_b128 v[168:171], v23 offset:39424
    v_rcp_f32 v205, v205
    v_rcp_f32 v206, v206
    s_waitcnt lgkmcnt(3)
    v_mfma_f32_32x32x16_bf16 v[100:115], a[32:35], v[148:151], v[100:115]
    ds_read_b128 v[132:135], v23 offset:39936
    v_rcp_f32 v207, v207
    v_mul_f32 v36, v204, v36
    v_mul_f32 v37, v205, v37
    v_mul_f32 v38, v206, v38
    s_waitcnt vmcnt(4)
    s_barrier
    v_mfma_f32_32x32x16_bf16 v[100:115], a[36:39], v[152:155], v[100:115]
    ds_read_b128 v[136:139], v23 offset:40448
    s_add_u32 m0, s42, 0
    s_nop 0
    buffer_load_dwordx4 v6, s[12:15], s41 offen offset:0 sc1 lds
    v_mul_f32 v39, v207, v39
    v_fma_f32 v40, -v172, v120, v40
    v_fma_f32 v41, -v172, v121, v41
    v_mfma_f32_32x32x16_bf16 v[100:115], a[40:43], v[156:159], v[100:115]
    ds_read_b128 v[140:143], v23 offset:49152
    v_fma_f32 v42, -v172, v122, v42
    v_fma_f32 v43, -v172, v123, v43
    v_mul_f32 v208, v40, v40
    v_mul_f32 v209, v41, v41
    v_mul_f32 v210, v42, v42
    s_waitcnt lgkmcnt(3)
    v_mfma_f32_32x32x16_bf16 v[100:115], a[44:47], v[160:163], v[100:115]
    ds_read_b128 v[144:147], v23 offset:49664
    buffer_load_dwordx4 v6, s[12:15], s41 offen offset:1024 sc1 lds
    v_mul_f32 v211, v43, v43
    v_fma_f32 v208, v208, v175, v174
    v_fma_f32 v209, v209, v175, v174
    v_mfma_f32_32x32x16_bf16 v[100:115], a[48:51], v[164:167], v[100:115]
    ds_read_b128 v[148:151], v23 offset:50176
    v_fma_f32 v210, v210, v175, v174
    v_fma_f32 v211, v211, v175, v174
    v_mul_f32 v208, v208, v40
    v_mul_f32 v209, v209, v41
    v_mul_f32 v210, v210, v42
    v_mfma_f32_32x32x16_bf16 v[100:115], a[52:55], v[168:171], v[100:115]
    ds_read_b128 v[152:155], v23 offset:50688
    buffer_load_dwordx4 v6, s[12:15], s41 offen offset:2048 sc1 lds
    v_mul_f32 v211, v211, v43
    v_exp_f32 v208, v208
    s_waitcnt lgkmcnt(3)
    v_mfma_f32_32x32x16_bf16 v[100:115], a[56:59], v[132:135], v[100:115]
    ds_read_b128 v[156:159], v23 offset:51200
    v_exp_f32 v209, v209
    v_exp_f32 v210, v210
    v_mfma_f32_32x32x16_bf16 v[100:115], a[60:63], v[136:139], v[100:115]
    ds_read_b128 v[160:163], v23 offset:51712
    buffer_load_dwordx4 v6, s[12:15], s41 offen offset:3072 sc1 lds
    s_add_u32 s41, s41, 40960
    v_exp_f32 v211, v211
    v_fma_f32 v208, v208, v173, v173
    v_mfma_f32_32x32x16_bf16 v[100:115], a[64:67], v[140:143], v[100:115]
    ds_read_b128 v[164:167], v23 offset:52224
    v_fma_f32 v209, v209, v173, v173
    v_fma_f32 v210, v210, v173, v173
    v_fma_f32 v211, v211, v173, v173
    v_rcp_f32 v208, v208
    s_waitcnt lgkmcnt(3)
    v_mfma_f32_32x32x16_bf16 v[100:115], a[68:71], v[144:147], v[100:115]
    ds_read_b128 v[168:171], v23 offset:52736
    s_add_u32 m0, s42, 16384
    s_nop 0
    buffer_load_dwordx4 v6, s[12:15], s41 offen offset:0 sc1 lds
    v_rcp_f32 v209, v209
    v_mfma_f32_32x32x16_bf16 v[100:115], a[72:75], v[148:151], v[100:115]
    ds_read_b128 v[132:135], v23 offset:53248
    v_rcp_f32 v210, v210
    v_rcp_f32 v211, v211
    v_mul_f32 v40, v208, v40
    v_mfma_f32_32x32x16_bf16 v[100:115], a[76:79], v[152:155], v[100:115]
    ds_read_b128 v[136:139], v23 offset:53760
    buffer_load_dwordx4 v6, s[12:15], s41 offen offset:1024 sc1 lds
    v_mul_f32 v41, v209, v41
    v_mul_f32 v42, v210, v42
    v_mul_f32 v43, v211, v43
    s_waitcnt lgkmcnt(3)
    v_mfma_f32_32x32x16_bf16 v[100:115], a[80:83], v[156:159], v[100:115]
    ds_read_b128 v[140:143], v23 offset:54272
    v_fma_f32 v44, -v172, v124, v44
    v_fma_f32 v45, -v172, v125, v45
    v_fma_f32 v46, -v172, v126, v46
    v_fma_f32 v47, -v172, v127, v47
    v_mul_f32 v204, v44, v44
    v_mfma_f32_32x32x16_bf16 v[100:115], a[84:87], v[160:163], v[100:115]
    ds_read_b128 v[144:147], v23 offset:54784
    buffer_load_dwordx4 v6, s[12:15], s41 offen offset:2048 sc1 lds
    v_mul_f32 v205, v45, v45
    v_mul_f32 v206, v46, v46
    v_mul_f32 v207, v47, v47
    v_mfma_f32_32x32x16_bf16 v[100:115], a[88:91], v[164:167], v[100:115]
    ds_read_b128 v[148:151], v23 offset:55296
    v_fma_f32 v204, v204, v175, v174
    v_fma_f32 v205, v205, v175, v174
    v_fma_f32 v206, v206, v175, v174
    v_fma_f32 v207, v207, v175, v174
    v_mul_f32 v204, v204, v44
    s_waitcnt lgkmcnt(3)
    v_mfma_f32_32x32x16_bf16 v[100:115], a[92:95], v[168:171], v[100:115]
    ds_read_b128 v[152:155], v23 offset:55808
    buffer_load_dwordx4 v6, s[12:15], s41 offen offset:3072 sc1 lds
    s_add_u32 s41, s41, 8192
    v_mul_f32 v205, v205, v45
    v_mul_f32 v206, v206, v46
    v_mul_f32 v207, v207, v47
    v_mfma_f32_32x32x16_bf16 v[100:115], a[96:99], v[132:135], v[100:115]
    ds_read_b128 v[156:159], v23 offset:56320
    v_exp_f32 v204, v204
    v_exp_f32 v205, v205
    s_waitcnt vmcnt(8)
    s_barrier
    v_mfma_f32_32x32x16_bf16 v[100:115], a[100:103], v[136:139], v[100:115]
    ds_read_b128 v[160:163], v23 offset:56832
    v_exp_f32 v206, v206
    v_exp_f32 v207, v207
    v_fma_f32 v204, v204, v173, v173
    s_waitcnt lgkmcnt(3)
    v_mfma_f32_32x32x16_bf16 v[100:115], a[104:107], v[140:143], v[100:115]
    ds_read_b128 v[164:167], v24 offset:0
    v_fma_f32 v205, v205, v173, v173
    v_fma_f32 v206, v206, v173, v173
    v_fma_f32 v207, v207, v173, v173
    v_rcp_f32 v204, v204
    v_mfma_f32_32x32x16_bf16 v[100:115], a[108:111], v[144:147], v[100:115]
    ds_read_b128 v[168:171], v24 offset:512
    v_rcp_f32 v205, v205
    v_rcp_f32 v206, v206
    v_mfma_f32_32x32x16_bf16 v[100:115], a[112:115], v[148:151], v[100:115]
    ds_read_b128 v[132:135], v24 offset:1024
    v_rcp_f32 v207, v207
    v_mul_f32 v44, v204, v44
    v_mul_f32 v45, v205, v45
    v_mul_f32 v46, v206, v46
    s_waitcnt lgkmcnt(3)
    v_mfma_f32_32x32x16_bf16 v[100:115], a[116:119], v[152:155], v[100:115]
    ds_read_b128 v[136:139], v24 offset:1536
    v_mul_f32 v47, v207, v47
    v_fma_f32 v48, -v172, v128, v48
    v_fma_f32 v49, -v172, v129, v49
    v_fma_f32 v50, -v172, v130, v50
    v_fma_f32 v51, -v172, v131, v51
    v_mfma_f32_32x32x16_bf16 v[100:115], a[120:123], v[156:159], v[100:115]
    ds_read_b128 v[140:143], v24 offset:2048
    v_mul_f32 v208, v48, v48
    v_mul_f32 v209, v49, v49
    v_mul_f32 v210, v50, v50
    v_mul_f32 v211, v51, v51
    v_fma_f32 v208, v208, v175, v174
    v_mfma_f32_32x32x16_bf16 v[100:115], a[124:127], v[160:163], v[100:115]
    ds_read_b128 v[144:147], v24 offset:2560
    v_fma_f32 v209, v209, v175, v174
    v_fma_f32 v210, v210, v175, v174
    v_fma_f32 v211, v211, v175, v174
    v_mul_f32 v208, v208, v48
    v_mul_f32 v209, v209, v49
    s_waitcnt lgkmcnt(3)
    v_mfma_f32_32x32x16_bf16 v[100:115], a[128:131], v[164:167], v[100:115]
    ds_read_b128 v[148:151], v24 offset:3072
    v_mul_f32 v210, v210, v50
    v_mul_f32 v211, v211, v51
    v_exp_f32 v208, v208
    v_mfma_f32_32x32x16_bf16 v[100:115], a[132:135], v[168:171], v[100:115]
    ds_read_b128 v[152:155], v24 offset:3584
    s_add_u32 m0, s42, 32768
    s_nop 0
    buffer_load_dwordx4 v6, s[12:15], s41 offen offset:0 sc1 lds
    v_exp_f32 v209, v209
    v_mfma_f32_32x32x16_bf16 v[100:115], a[136:139], v[132:135], v[100:115]
    ds_read_b128 v[156:159], v24 offset:4096
    v_exp_f32 v210, v210
    v_exp_f32 v211, v211
    v_fma_f32 v208, v208, v173, v173
    s_waitcnt lgkmcnt(3)
    v_mfma_f32_32x32x16_bf16 v[100:115], a[140:143], v[136:139], v[100:115]
    ds_read_b128 v[160:163], v24 offset:4608
    buffer_load_dwordx4 v6, s[12:15], s41 offen offset:1024 sc1 lds
    v_fma_f32 v209, v209, v173, v173
    v_fma_f32 v210, v210, v173, v173
    v_fma_f32 v211, v211, v173, v173
    v_mfma_f32_32x32x16_bf16 v[100:115], a[144:147], v[140:143], v[100:115]
    ds_read_b128 v[164:167], v24 offset:5120
    v_rcp_f32 v208, v208
    v_rcp_f32 v209, v209
    v_mfma_f32_32x32x16_bf16 v[100:115], a[148:151], v[144:147], v[100:115]
    ds_read_b128 v[168:171], v24 offset:5632
    buffer_load_dwordx4 v6, s[12:15], s41 offen offset:2048 sc1 lds
    v_rcp_f32 v210, v210
    s_waitcnt lgkmcnt(3)
    v_mfma_f32_32x32x16_bf16 v[100:115], a[152:155], v[148:151], v[100:115]
    ds_read_b128 v[132:135], v24 offset:6144
    v_rcp_f32 v211, v211
    v_mul_f32 v48, v208, v48
    v_mul_f32 v49, v209, v49
    v_mul_f32 v50, v210, v50
    v_mfma_f32_32x32x16_bf16 v[100:115], a[156:159], v[152:155], v[100:115]
    ds_read_b128 v[136:139], v24 offset:6656
    buffer_load_dwordx4 v6, s[12:15], s41 offen offset:3072 sc1 lds
    s_add_u32 s41, s41, 8192
    v_mul_f32 v51, v211, v51
    v_cvt_pk_bf16_f32 v236, v36, v37
    v_mfma_f32_32x32x16_bf16 v[100:115], a[160:163], v[156:159], v[100:115]
    ds_read_b128 v[140:143], v24 offset:7168
    v_cvt_pk_bf16_f32 v237, v38, v39
    v_cvt_pk_bf16_f32 v238, v44, v45
    v_cvt_pk_bf16_f32 v239, v46, v47
    s_waitcnt vmcnt(8)
    s_barrier
    s_waitcnt lgkmcnt(3)
    v_mfma_f32_32x32x16_bf16 v[100:115], a[164:167], v[160:163], v[100:115]
    ds_read_b128 v[144:147], v24 offset:7680
    buffer_store_dwordx4 v[236:239], v26, s[20:23], s40 offen offset:0 sc1
    v_cvt_pk_bf16_f32 v240, v40, v41
    v_cvt_pk_bf16_f32 v241, v42, v43
    v_mfma_f32_32x32x16_bf16 v[100:115], a[168:171], v[164:167], v[100:115]
    ds_read_b128 v[148:151], v22 offset:0
    v_cvt_pk_bf16_f32 v242, v48, v49
    v_cvt_pk_bf16_f32 v243, v50, v51
    buffer_store_dwordx4 v[240:243], v26, s[20:23], s40 offen offset:512 sc1
    v_mfma_f32_32x32x16_bf16 v[100:115], a[172:175], v[168:171], v[100:115]
    ds_read_b128 v[152:155], v22 offset:512
    s_add_u32 s40, s40, 229376
    ds_read_b128 v[172:175], v30 offset:2048
    v_fma_f32 v52, -v180, v116, v52
    v_fma_f32 v53, -v180, v117, v53
    v_fma_f32 v54, -v180, v118, v54
    s_waitcnt lgkmcnt(4)
    v_mfma_f32_32x32x16_bf16 v[100:115], a[176:179], v[132:135], v[100:115]
    ds_read_b128 v[156:159], v22 offset:1024
    v_fma_f32 v55, -v180, v119, v55
    v_mul_f32 v204, v52, v52
    v_mul_f32 v205, v53, v53
    v_mul_f32 v206, v54, v54
    v_mul_f32 v207, v55, v55
    v_mfma_f32_32x32x16_bf16 v[100:115], a[180:183], v[136:139], v[100:115]
    ds_read_b128 v[160:163], v22 offset:1536
    v_fma_f32 v204, v204, v183, v182
    v_fma_f32 v205, v205, v183, v182
    v_fma_f32 v206, v206, v183, v182
    v_fma_f32 v207, v207, v183, v182
    v_mul_f32 v204, v204, v52
    v_mfma_f32_32x32x16_bf16 v[100:115], a[184:187], v[140:143], v[100:115]
    ds_read_b128 v[164:167], v22 offset:2048
    v_mul_f32 v205, v205, v53
    v_mul_f32 v206, v206, v54
    v_mul_f32 v207, v207, v55
    v_exp_f32 v204, v204
    s_waitcnt lgkmcnt(4)
    v_mfma_f32_32x32x16_bf16 v[100:115], a[188:191], v[144:147], v[100:115]
    ds_read_b128 v[168:171], v22 offset:2560
    v_exp_f32 v205, v205
    v_exp_f32 v206, v206
    v_mfma_f32_32x32x16_bf16 v[100:115], a[192:195], v[148:151], v[100:115]
    ds_read_b128 v[132:135], v22 offset:3072
    v_exp_f32 v207, v207
    v_fma_f32 v204, v204, v181, v181
    v_fma_f32 v205, v205, v181, v181
    v_fma_f32 v206, v206, v181, v181
    v_mfma_f32_32x32x16_bf16 v[100:115], a[196:199], v[152:155], v[100:115]
    ds_read_b128 v[136:139], v22 offset:3584
    s_add_u32 m0, s42, 49152
    s_nop 0
    buffer_load_dwordx4 v6, s[12:15], s41 offen offset:0 sc1 lds
    v_fma_f32 v207, v207, v181, v181
    v_rcp_f32 v204, v204
    s_waitcnt lgkmcnt(3)
    v_mfma_f32_32x32x16_bf16 v[100:115], a[200:203], v[156:159], v[100:115]
    ds_read_b128 v[140:143], v22 offset:4096
    v_rcp_f32 v205, v205
    v_rcp_f32 v206, v206
    v_mfma_f32_32x32x16_bf16 v[100:115], a[204:207], v[160:163], v[100:115]
    ds_read_b128 v[144:147], v22 offset:4608
    buffer_load_dwordx4 v6, s[12:15], s41 offen offset:1024 sc1 lds
    v_rcp_f32 v207, v207
    v_mul_f32 v52, v204, v52
    v_mfma_f32_32x32x16_bf16 v[100:115], a[208:211], v[164:167], v[100:115]
    ds_read_b128 v[148:151], v22 offset:5120
    v_mul_f32 v53, v205, v53
    v_mul_f32 v54, v206, v54
    v_mul_f32 v55, v207, v55
    v_fma_f32 v56, -v180, v120, v56
    v_fma_f32 v57, -v180, v121, v57
    s_waitcnt lgkmcnt(3)
    v_mfma_f32_32x32x16_bf16 v[100:115], a[212:215], v[168:171], v[100:115]
    ds_read_b128 v[152:155], v22 offset:5632
    buffer_load_dwordx4 v6, s[12:15], s41 offen offset:2048 sc1 lds
    v_fma_f32 v58, -v180, v122, v58
    v_fma_f32 v59, -v180, v123, v59
    v_mul_f32 v208, v56, v56
    v_mfma_f32_32x32x16_bf16 v[100:115], a[216:219], v[132:135], v[100:115]
    ds_read_b128 v[156:159], v22 offset:6144
    v_mul_f32 v209, v57, v57
    v_mul_f32 v210, v58, v58
    v_mul_f32 v211, v59, v59
    v_fma_f32 v208, v208, v183, v182
    v_fma_f32 v209, v209, v183, v182
    v_mfma_f32_32x32x16_bf16 v[100:115], a[220:223], v[136:139], v[100:115]
    ds_read_b128 v[160:163], v22 offset:6656
    buffer_load_dwordx4 v6, s[12:15], s41 offen offset:3072 sc1 lds
    s_add_u32 s41, s41, 8192
    v_fma_f32 v210, v210, v183, v182
    v_fma_f32 v211, v211, v183, v182
    v_mul_f32 v208, v208, v56
    s_waitcnt lgkmcnt(3)
    v_mfma_f32_32x32x16_bf16 v[100:115], a[224:227], v[140:143], v[100:115]
    ds_read_b128 v[164:167], v22 offset:7168
    v_mul_f32 v209, v209, v57
    v_mul_f32 v210, v210, v58
    v_mul_f32 v211, v211, v59
    v_exp_f32 v208, v208
    s_waitcnt vmcnt(10)
    s_barrier
    v_mfma_f32_32x32x16_bf16 v[100:115], a[228:231], v[144:147], v[100:115]
    ds_read_b128 v[168:171], v22 offset:7680
    v_exp_f32 v209, v209
    v_exp_f32 v210, v210
    v_mfma_f32_32x32x16_bf16 v[100:115], a[232:235], v[148:151], v[100:115]
    ds_read_b128 v[132:135], v22 offset:16384
    v_exp_f32 v211, v211
    v_fma_f32 v208, v208, v181, v181
    v_fma_f32 v209, v209, v181, v181
    v_fma_f32 v210, v210, v181, v181
    s_waitcnt lgkmcnt(3)
    v_mfma_f32_32x32x16_bf16 v[100:115], a[236:239], v[152:155], v[100:115]
    ds_read_b128 v[136:139], v22 offset:16896
    v_fma_f32 v211, v211, v181, v181
    v_rcp_f32 v208, v208
    v_rcp_f32 v209, v209
    v_mfma_f32_32x32x16_bf16 v[100:115], a[240:243], v[156:159], v[100:115]
    ds_read_b128 v[140:143], v22 offset:17408
    v_rcp_f32 v210, v210
    v_rcp_f32 v211, v211
    v_mul_f32 v56, v208, v56
    v_mfma_f32_32x32x16_bf16 v[100:115], a[244:247], v[160:163], v[100:115]
    ds_read_b128 v[144:147], v22 offset:17920
    v_mul_f32 v57, v209, v57
    v_mul_f32 v58, v210, v58
    v_mul_f32 v59, v211, v59
    v_fma_f32 v60, -v180, v124, v60
    v_fma_f32 v61, -v180, v125, v61
    s_waitcnt lgkmcnt(3)
    v_mfma_f32_32x32x16_bf16 v[100:115], a[248:251], v[164:167], v[100:115]
    ds_read_b128 v[148:151], v22 offset:18432
    v_fma_f32 v62, -v180, v126, v62
    v_fma_f32 v63, -v180, v127, v63
    v_mul_f32 v204, v60, v60
    v_mul_f32 v205, v61, v61
    v_mul_f32 v206, v62, v62
    v_mfma_f32_32x32x16_bf16 v[100:115], a[252:255], v[168:171], v[100:115]
    ds_read_b128 v[152:155], v22 offset:18944
    v_mul_f32 v207, v63, v63
    v_fma_f32 v204, v204, v183, v182
    v_fma_f32 v205, v205, v183, v182
    v_fma_f32 v206, v206, v183, v182
    v_fma_f32 v207, v207, v183, v182
    v_mfma_f32_32x32x16_bf16 v[36:51], a[0:3], v[132:135], 0
    ds_read_b128 v[156:159], v22 offset:19456
    s_waitcnt lgkmcnt(3)
    v_mfma_f32_32x32x16_bf16 v[36:51], a[4:7], v[136:139], v[36:51]
    ds_read_b128 v[160:163], v22 offset:19968
    s_add_u32 m0, s42, 65536
    s_nop 0
    buffer_load_dwordx4 v6, s[12:15], s41 offen offset:0 sc1 lds
    v_mul_f32 v204, v204, v60
    v_mul_f32 v205, v205, v61
    v_mul_f32 v206, v206, v62
    v_mfma_f32_32x32x16_bf16 v[36:51], a[8:11], v[140:143], v[36:51]
    ds_read_b128 v[164:167], v22 offset:20480
    v_mul_f32 v207, v207, v63
    v_exp_f32 v204, v204
    v_exp_f32 v205, v205
    v_mfma_f32_32x32x16_bf16 v[36:51], a[12:15], v[144:147], v[36:51]
    ds_read_b128 v[168:171], v22 offset:20992
    v_exp_f32 v206, v206
    v_exp_f32 v207, v207
    v_fma_f32 v204, v204, v181, v181
    s_waitcnt lgkmcnt(3)
    v_mfma_f32_32x32x16_bf16 v[36:51], a[16:19], v[148:151], v[36:51]
    ds_read_b128 v[132:135], v22 offset:21504
    v_fma_f32 v205, v205, v181, v181
    v_fma_f32 v206, v206, v181, v181
    v_fma_f32 v207, v207, v181, v181
    v_rcp_f32 v204, v204
    v_mfma_f32_32x32x16_bf16 v[36:51], a[20:23], v[152:155], v[36:51]
    ds_read_b128 v[136:139], v22 offset:22016
    buffer_load_dwordx4 v6, s[12:15], s41 offen offset:1024 sc1 lds
    v_rcp_f32 v205, v205
    v_mfma_f32_32x32x16_bf16 v[36:51], a[24:27], v[156:159], v[36:51]
    ds_read_b128 v[140:143], v22 offset:22528
    v_rcp_f32 v206, v206
    v_rcp_f32 v207, v207
    v_mul_f32 v60, v204, v60
    s_waitcnt lgkmcnt(3)
    v_mfma_f32_32x32x16_bf16 v[36:51], a[28:31], v[160:163], v[36:51]
    ds_read_b128 v[144:147], v22 offset:23040
    v_mul_f32 v61, v205, v61
    v_mul_f32 v62, v206, v62
    v_mul_f32 v63, v207, v63
    v_fma_f32 v64, -v180, v128, v64
    v_fma_f32 v65, -v180, v129, v65
    v_mfma_f32_32x32x16_bf16 v[36:51], a[32:35], v[164:167], v[36:51]
    ds_read_b128 v[148:151], v22 offset:23552
    v_fma_f32 v66, -v180, v130, v66
    v_fma_f32 v67, -v180, v131, v67
    v_mul_f32 v208, v64, v64
    v_mul_f32 v209, v65, v65
    v_mul_f32 v210, v66, v66
    s_waitcnt vmcnt(8)
    s_barrier
    v_mfma_f32_32x32x16_bf16 v[36:51], a[36:39], v[168:171], v[36:51]
    ds_read_b128 v[152:155], v22 offset:24064
    buffer_load_dwordx4 v6, s[12:15], s41 offen offset:2048 sc1 lds
    v_mul_f32 v211, v67, v67
    v_fma_f32 v208, v208, v183, v182
    v_fma_f32 v209, v209, v183, v182
    s_waitcnt lgkmcnt(3)
    v_mfma_f32_32x32x16_bf16 v[36:51], a[40:43], v[132:135], v[36:51]
    ds_read_b128 v[156:159], v22 offset:32768
    v_fma_f32 v210, v210, v183, v182
    v_fma_f32 v211, v211, v183, v182
    v_mul_f32 v208, v208, v64
    v_mul_f32 v209, v209, v65
    v_mul_f32 v210, v210, v66
    v_mfma_f32_32x32x16_bf16 v[36:51], a[44:47], v[136:139], v[36:51]
    ds_read_b128 v[160:163], v22 offset:33280
    v_mul_f32 v211, v211, v67
    v_exp_f32 v208, v208
    v_exp_f32 v209, v209
    v_mfma_f32_32x32x16_bf16 v[36:51], a[48:51], v[140:143], v[36:51]
    ds_read_b128 v[164:167], v22 offset:33792
    v_exp_f32 v210, v210
    v_exp_f32 v211, v211
    v_fma_f32 v208, v208, v181, v181
    s_waitcnt lgkmcnt(3)
    v_mfma_f32_32x32x16_bf16 v[36:51], a[52:55], v[144:147], v[36:51]
    ds_read_b128 v[168:171], v22 offset:34304
    buffer_load_dwordx4 v6, s[12:15], s41 offen offset:3072 sc1 lds
    s_add_u32 s41, s41, 40960
    v_fma_f32 v209, v209, v181, v181
    v_fma_f32 v210, v210, v181, v181
    v_fma_f32 v211, v211, v181, v181
    v_mfma_f32_32x32x16_bf16 v[36:51], a[56:59], v[148:151], v[36:51]
    ds_read_b128 v[132:135], v22 offset:34816
    v_rcp_f32 v208, v208
    v_rcp_f32 v209, v209
    v_mfma_f32_32x32x16_bf16 v[36:51], a[60:63], v[152:155], v[36:51]
    ds_read_b128 v[136:139], v22 offset:35328
    v_rcp_f32 v210, v210
    v_rcp_f32 v211, v211
    v_mul_f32 v64, v208, v64
    s_waitcnt lgkmcnt(3)
    v_mfma_f32_32x32x16_bf16 v[36:51], a[64:67], v[156:159], v[36:51]
    ds_read_b128 v[140:143], v22 offset:35840
    v_mul_f32 v65, v209, v65
    v_mul_f32 v66, v210, v66
    v_mul_f32 v67, v211, v67
    v_cvt_pk_bf16_f32 v236, v52, v53
    v_mfma_f32_32x32x16_bf16 v[36:51], a[68:71], v[160:163], v[36:51]
    ds_read_b128 v[144:147], v22 offset:36352
    s_add_u32 m0, s42, 81920
    s_nop 0
    buffer_load_dwordx4 v6, s[12:15], s41 offen offset:0 sc1 lds
    v_cvt_pk_bf16_f32 v237, v54, v55
    v_cvt_pk_bf16_f32 v238, v60, v61
    v_mfma_f32_32x32x16_bf16 v[36:51], a[72:75], v[164:167], v[36:51]
    ds_read_b128 v[148:151], v22 offset:36864
    v_cvt_pk_bf16_f32 v239, v62, v63
    buffer_store_dwordx4 v[236:239], v26, s[20:23], s40 offen offset:0 sc1
    v_cvt_pk_bf16_f32 v240, v56, v57
    s_waitcnt lgkmcnt(3)
    v_mfma_f32_32x32x16_bf16 v[36:51], a[76:79], v[168:171], v[36:51]
    ds_read_b128 v[152:155], v22 offset:37376
    v_cvt_pk_bf16_f32 v241, v58, v59
    v_cvt_pk_bf16_f32 v242, v64, v65
    v_cvt_pk_bf16_f32 v243, v66, v67
    v_mfma_f32_32x32x16_bf16 v[36:51], a[80:83], v[132:135], v[36:51]
    ds_read_b128 v[156:159], v22 offset:37888
    buffer_store_dwordx4 v[240:243], v26, s[20:23], s40 offen offset:512 sc1
    s_add_u32 s40, s40, 229376
    ds_read_b128 v[180:183], v30 offset:2560
    v_fma_f32 v68, -v188, v116, v68
    v_mfma_f32_32x32x16_bf16 v[36:51], a[84:87], v[136:139], v[36:51]
    ds_read_b128 v[160:163], v22 offset:38400
    buffer_load_dwordx4 v6, s[12:15], s41 offen offset:1024 sc1 lds
    v_fma_f32 v69, -v188, v117, v69
    v_fma_f32 v70, -v188, v118, v70
    v_fma_f32 v71, -v188, v119, v71
    s_waitcnt lgkmcnt(4)
    v_mfma_f32_32x32x16_bf16 v[36:51], a[88:91], v[140:143], v[36:51]
    ds_read_b128 v[164:167], v22 offset:38912
    v_mul_f32 v204, v68, v68
    v_mul_f32 v205, v69, v69
    v_mul_f32 v206, v70, v70
    v_mul_f32 v207, v71, v71
    v_fma_f32 v204, v204, v191, v190
    v_mfma_f32_32x32x16_bf16 v[36:51], a[92:95], v[144:147], v[36:51]
    ds_read_b128 v[168:171], v22 offset:39424
    v_fma_f32 v205, v205, v191, v190
    v_fma_f32 v206, v206, v191, v190
    v_fma_f32 v207, v207, v191, v190
    v_mul_f32 v204, v204, v68
    v_mul_f32 v205, v205, v69
    v_mfma_f32_32x32x16_bf16 v[36:51], a[96:99], v[148:151], v[36:51]
    ds_read_b128 v[132:135], v22 offset:39936
    v_mul_f32 v206, v206, v70
    v_mul_f32 v207, v207, v71
    v_exp_f32 v204, v204
    s_waitcnt vmcnt(8)
    s_barrier
    s_waitcnt lgkmcnt(3)
    v_mfma_f32_32x32x16_bf16 v[36:51], a[100:103], v[152:155], v[36:51]
    ds_read_b128 v[136:139], v22 offset:40448
    buffer_load_dwordx4 v6, s[12:15], s41 offen offset:2048 sc1 lds
    v_exp_f32 v205, v205
    v_mfma_f32_32x32x16_bf16 v[36:51], a[104:107], v[156:159], v[36:51]
    ds_read_b128 v[140:143], v22 offset:49152
    v_exp_f32 v206, v206
    v_exp_f32 v207, v207
    v_fma_f32 v204, v204, v189, v189
    v_mfma_f32_32x32x16_bf16 v[36:51], a[108:111], v[160:163], v[36:51]
    ds_read_b128 v[144:147], v22 offset:49664
    v_fma_f32 v205, v205, v189, v189
    v_fma_f32 v206, v206, v189, v189
    v_fma_f32 v207, v207, v189, v189
    v_rcp_f32 v204, v204
    s_waitcnt lgkmcnt(3)
    v_mfma_f32_32x32x16_bf16 v[36:51], a[112:115], v[164:167], v[36:51]
    ds_read_b128 v[148:151], v22 offset:50176
    v_rcp_f32 v205, v205
    v_rcp_f32 v206, v206
    v_mfma_f32_32x32x16_bf16 v[36:51], a[116:119], v[168:171], v[36:51]
    ds_read_b128 v[152:155], v22 offset:50688
    buffer_load_dwordx4 v6, s[12:15], s41 offen offset:3072 sc1 lds
    s_add_u32 s41, s41, 8192
    v_rcp_f32 v207, v207
    v_mul_f32 v68, v204, v68
    v_mfma_f32_32x32x16_bf16 v[36:51], a[120:123], v[132:135], v[36:51]
    ds_read_b128 v[156:159], v22 offset:51200
    v_mul_f32 v69, v205, v69
    v_mul_f32 v70, v206, v70
    v_mul_f32 v71, v207, v71
    v_fma_f32 v72, -v188, v120, v72
    v_fma_f32 v73, -v188, v121, v73
    s_waitcnt lgkmcnt(3)
    v_mfma_f32_32x32x16_bf16 v[36:51], a[124:127], v[136:139], v[36:51]
    ds_read_b128 v[160:163], v22 offset:51712
    v_fma_f32 v74, -v188, v122, v74
    v_fma_f32 v75, -v188, v123, v75
    v_mul_f32 v208, v72, v72
    v_mul_f32 v209, v73, v73
    v_mul_f32 v210, v74, v74
    v_mfma_f32_32x32x16_bf16 v[36:51], a[128:131], v[140:143], v[36:51]
    ds_read_b128 v[164:167], v22 offset:52224
    v_mul_f32 v211, v75, v75
    v_fma_f32 v208, v208, v191, v190
    v_fma_f32 v209, v209, v191, v190
    v_fma_f32 v210, v210, v191, v190
    v_fma_f32 v211, v211, v191, v190
    v_mfma_f32_32x32x16_bf16 v[36:51], a[132:135], v[144:147], v[36:51]
    ds_read_b128 v[168:171], v22 offset:52736
    s_add_u32 m0, s42, 98304
    s_nop 0
    buffer_load_dwordx4 v6, s[12:15], s41 offen offset:0 sc1 lds
    v_mul_f32 v208, v208, v72
    v_mul_f32 v209, v209, v73
    v_mul_f32 v210, v210, v74
    s_waitcnt lgkmcnt(3)
    v_mfma_f32_32x32x16_bf16 v[36:51], a[136:139], v[148:151], v[36:51]
    ds_read_b128 v[132:135], v22 offset:53248
    v_mul_f32 v211, v211, v75
    v_exp_f32 v208, v208
    v_exp_f32 v209, v209
    v_mfma_f32_32x32x16_bf16 v[36:51], a[140:143], v[152:155], v[36:51]
    ds_read_b128 v[136:139], v22 offset:53760
    v_exp_f32 v210, v210
    v_exp_f32 v211, v211
    v_fma_f32 v208, v208, v189, v189
    v_mfma_f32_32x32x16_bf16 v[36:51], a[144:147], v[156:159], v[36:51]
    ds_read_b128 v[140:143], v22 offset:54272
    v_fma_f32 v209, v209, v189, v189
    v_fma_f32 v210, v210, v189, v189
    v_fma_f32 v211, v211, v189, v189
    v_rcp_f32 v208, v208
    s_waitcnt lgkmcnt(3)
    v_mfma_f32_32x32x16_bf16 v[36:51], a[148:151], v[160:163], v[36:51]
    ds_read_b128 v[144:147], v22 offset:54784
    buffer_load_dwordx4 v6, s[12:15], s41 offen offset:1024 sc1 lds
    v_rcp_f32 v209, v209
    v_mfma_f32_32x32x16_bf16 v[36:51], a[152:155], v[164:167], v[36:51]
    ds_read_b128 v[148:151], v22 offset:55296
    v_rcp_f32 v210, v210
    v_rcp_f32 v211, v211
    v_mul_f32 v72, v208, v72
    v_mfma_f32_32x32x16_bf16 v[36:51], a[156:159], v[168:171], v[36:51]
    ds_read_b128 v[152:155], v22 offset:55808
    v_mul_f32 v73, v209, v73
    v_mul_f32 v74, v210, v74
    v_mul_f32 v75, v211, v75
    v_fma_f32 v76, -v188, v124, v76
    v_fma_f32 v77, -v188, v125, v77
    s_waitcnt lgkmcnt(3)
    v_mfma_f32_32x32x16_bf16 v[36:51], a[160:163], v[132:135], v[36:51]
    ds_read_b128 v[156:159], v22 offset:56320
    v_fma_f32 v78, -v188, v126, v78
    v_fma_f32 v79, -v188, v127, v79
    v_mul_f32 v204, v76, v76
    v_mul_f32 v205, v77, v77
    v_mul_f32 v206, v78, v78
    s_waitcnt vmcnt(8)
    s_barrier
    v_mfma_f32_32x32x16_bf16 v[36:51], a[164:167], v[136:139], v[36:51]
    ds_read_b128 v[160:163], v22 offset:56832
    buffer_load_dwordx4 v6, s[12:15], s41 offen offset:2048 sc1 lds
    v_mul_f32 v207, v79, v79
    v_fma_f32 v204, v204, v191, v190
    v_fma_f32 v205, v205, v191, v190
    v_mfma_f32_32x32x16_bf16 v[36:51], a[168:171], v[140:143], v[36:51]
    ds_read_b128 v[164:167], v23 offset:0
    v_fma_f32 v206, v206, v191, v190
    v_fma_f32 v207, v207, v191, v190
    v_mul_f32 v204, v204, v76
    v_mul_f32 v205, v205, v77
    v_mul_f32 v206, v206, v78
    s_waitcnt lgkmcnt(3)
    v_mfma_f32_32x32x16_bf16 v[36:51], a[172:175], v[144:147], v[36:51]
    ds_read_b128 v[168:171], v23 offset:512
    v_mul_f32 v207, v207, v79
    v_exp_f32 v204, v204
    v_exp_f32 v205, v205
    v_mfma_f32_32x32x16_bf16 v[36:51], a[176:179], v[148:151], v[36:51]
    ds_read_b128 v[132:135], v23 offset:1024
    v_exp_f32 v206, v206
    v_exp_f32 v207, v207
    v_fma_f32 v204, v204, v189, v189
    v_mfma_f32_32x32x16_bf16 v[36:51], a[180:183], v[152:155], v[36:51]
    ds_read_b128 v[136:139], v23 offset:1536
    buffer_load_dwordx4 v6, s[12:15], s41 offen offset:3072 sc1 lds
    s_add_u32 s41, s41, 8192
    v_fma_f32 v205, v205, v189, v189
    v_fma_f32 v206, v206, v189, v189
    v_fma_f32 v207, v207, v189, v189
    s_waitcnt lgkmcnt(3)
    v_mfma_f32_32x32x16_bf16 v[36:51], a[184:187], v[156:159], v[36:51]
    ds_read_b128 v[140:143], v23 offset:2048
    v_rcp_f32 v204, v204
    v_rcp_f32 v205, v205
    v_mfma_f32_32x32x16_bf16 v[36:51], a[188:191], v[160:163], v[36:51]
    ds_read_b128 v[144:147], v23 offset:2560
    v_rcp_f32 v206, v206
    v_rcp_f32 v207, v207
    v_mul_f32 v76, v204, v76
    v_mfma_f32_32x32x16_bf16 v[36:51], a[192:195], v[164:167], v[36:51]
    ds_read_b128 v[148:151], v23 offset:3072
    v_mul_f32 v77, v205, v77
    v_mul_f32 v78, v206, v78
    v_mul_f32 v79, v207, v79
    v_fma_f32 v80, -v188, v128, v80
    v_fma_f32 v81, -v188, v129, v81
    s_waitcnt lgkmcnt(3)
    v_mfma_f32_32x32x16_bf16 v[36:51], a[196:199], v[168:171], v[36:51]
    ds_read_b128 v[152:155], v23 offset:3584
    s_add_u32 m0, s42, 114688
    s_nop 0
    buffer_load_dwordx4 v6, s[12:15], s41 offen offset:0 sc1 lds
    v_fma_f32 v82, -v188, v130, v82
    v_fma_f32 v83, -v188, v131, v83
    v_mul_f32 v208, v80, v80
    v_mfma_f32_32x32x16_bf16 v[36:51], a[200:203], v[132:135], v[36:51]
    ds_read_b128 v[156:159], v23 offset:4096
    v_mul_f32 v209, v81, v81
    v_mul_f32 v210, v82, v82
    v_mul_f32 v211, v83, v83
    v_fma_f32 v208, v208, v191, v190
    v_fma_f32 v209, v209, v191, v190
    v_mfma_f32_32x32x16_bf16 v[36:51], a[204:207], v[136:139], v[36:51]
    ds_read_b128 v[160:163], v23 offset:4608
    v_fma_f32 v210, v210, v191, v190
    v_fma_f32 v211, v211, v191, v190
    v_mul_f32 v208, v208, v80
    v_mul_f32 v209, v209, v81
    v_mul_f32 v210, v210, v82
    s_waitcnt lgkmcnt(3)
    v_mfma_f32_32x32x16_bf16 v[36:51], a[208:211], v[140:143], v[36:51]
    ds_read_b128 v[164:167], v23 offset:5120
    v_mul_f32 v211, v211, v83
    v_exp_f32 v208, v208
    v_exp_f32 v209, v209
    v_mfma_f32_32x32x16_bf16 v[36:51], a[212:215], v[144:147], v[36:51]
    ds_read_b128 v[168:171], v23 offset:5632
    buffer_load_dwordx4 v6, s[12:15], s41 offen offset:1024 sc1 lds
    v_exp_f32 v210, v210
    v_mfma_f32_32x32x16_bf16 v[36:51], a[216:219], v[148:151], v[36:51]
    ds_read_b128 v[132:135], v23 offset:6144
    v_exp_f32 v211, v211
    v_fma_f32 v208, v208, v189, v189
    v_fma_f32 v209, v209, v189, v189
    v_fma_f32 v210, v210, v189, v189
    s_waitcnt lgkmcnt(3)
    v_mfma_f32_32x32x16_bf16 v[36:51], a[220:223], v[152:155], v[36:51]
    ds_read_b128 v[136:139], v23 offset:6656
    v_fma_f32 v211, v211, v189, v189
    v_rcp_f32 v208, v208
    v_rcp_f32 v209, v209
    v_mfma_f32_32x32x16_bf16 v[36:51], a[224:227], v[156:159], v[36:51]
    ds_read_b128 v[140:143], v23 offset:7168
    v_rcp_f32 v210, v210
    v_rcp_f32 v211, v211
    v_mul_f32 v80, v208, v80
    s_waitcnt vmcnt(6)
    s_barrier
    v_mfma_f32_32x32x16_bf16 v[36:51], a[228:231], v[160:163], v[36:51]
    ds_read_b128 v[144:147], v23 offset:7680
    buffer_load_dwordx4 v6, s[12:15], s41 offen offset:2048 sc1 lds
    v_mul_f32 v81, v209, v81
    v_mul_f32 v82, v210, v82
    v_mul_f32 v83, v211, v83
    s_waitcnt lgkmcnt(3)
    v_mfma_f32_32x32x16_bf16 v[36:51], a[232:235], v[164:167], v[36:51]
    ds_read_b128 v[148:151], v23 offset:16384
    v_cvt_pk_bf16_f32 v236, v68, v69
    v_cvt_pk_bf16_f32 v237, v70, v71
    v_cvt_pk_bf16_f32 v238, v76, v77
    v_mfma_f32_32x32x16_bf16 v[36:51], a[236:239], v[168:171], v[36:51]
    ds_read_b128 v[152:155], v23 offset:16896
    v_cvt_pk_bf16_f32 v239, v78, v79
    buffer_store_dwordx4 v[236:239], v26, s[20:23], s40 offen offset:0 sc1
    v_cvt_pk_bf16_f32 v240, v72, v73
    v_mfma_f32_32x32x16_bf16 v[36:51], a[240:243], v[132:135], v[36:51]
    ds_read_b128 v[156:159], v23 offset:17408
    v_cvt_pk_bf16_f32 v241, v74, v75
    v_cvt_pk_bf16_f32 v242, v80, v81
    v_cvt_pk_bf16_f32 v243, v82, v83
    s_waitcnt lgkmcnt(3)
    v_mfma_f32_32x32x16_bf16 v[36:51], a[244:247], v[136:139], v[36:51]
    ds_read_b128 v[160:163], v23 offset:17920
    buffer_load_dwordx4 v6, s[12:15], s41 offen offset:3072 sc1 lds
    s_add_u32 s41, s41, 8192
    buffer_store_dwordx4 v[240:243], v26, s[20:23], s40 offen offset:512 sc1
    s_add_u32 s40, s40, 229376
    v_mfma_f32_32x32x16_bf16 v[36:51], a[248:251], v[140:143], v[36:51]
    ds_read_b128 v[164:167], v23 offset:18432
    ds_read_b128 v[188:191], v30 offset:3072
    v_fma_f32 v84, -v196, v116, v84
    v_fma_f32 v85, -v196, v117, v85
    v_fma_f32 v86, -v196, v118, v86
    v_mfma_f32_32x32x16_bf16 v[36:51], a[252:255], v[144:147], v[36:51]
    ds_read_b128 v[168:171], v23 offset:18944
    v_fma_f32 v87, -v196, v119, v87
    v_mul_f32 v204, v84, v84
    v_mul_f32 v205, v85, v85
    v_mul_f32 v206, v86, v86
    v_mul_f32 v207, v87, v87
    s_waitcnt lgkmcnt(4)
    v_mfma_f32_32x32x16_bf16 v[52:67], a[0:3], v[148:151], 0
    ds_read_b128 v[132:135], v23 offset:19456
    v_mfma_f32_32x32x16_bf16 v[52:67], a[4:7], v[152:155], v[52:67]
    ds_read_b128 v[136:139], v23 offset:19968
    s_add_u32 m0, s42, 131072
    s_nop 0
    buffer_load_dwordx4 v6, s[12:15], s41 offen offset:0 sc1 lds
    v_fma_f32 v204, v204, v199, v198
    v_fma_f32 v205, v205, v199, v198
    v_fma_f32 v206, v206, v199, v198
    v_mfma_f32_32x32x16_bf16 v[52:67], a[8:11], v[156:159], v[52:67]
    ds_read_b128 v[140:143], v23 offset:20480
    v_fma_f32 v207, v207, v199, v198
    v_mul_f32 v204, v204, v84
    v_mul_f32 v205, v205, v85
    v_mul_f32 v206, v206, v86
    v_mul_f32 v207, v207, v87
    s_waitcnt lgkmcnt(3)
    v_mfma_f32_32x32x16_bf16 v[52:67], a[12:15], v[160:163], v[52:67]
    ds_read_b128 v[144:147], v23 offset:20992
    v_exp_f32 v204, v204
    v_exp_f32 v205, v205
    v_mfma_f32_32x32x16_bf16 v[52:67], a[16:19], v[164:167], v[52:67]
    ds_read_b128 v[148:151], v23 offset:21504
    v_exp_f32 v206, v206
    v_exp_f32 v207, v207
    v_fma_f32 v204, v204, v197, v197
    v_mfma_f32_32x32x16_bf16 v[52:67], a[20:23], v[168:171], v[52:67]
    ds_read_b128 v[152:155], v23 offset:22016
    buffer_load_dwordx4 v6, s[12:15], s41 offen offset:1024 sc1 lds
    v_fma_f32 v205, v205, v197, v197
    v_fma_f32 v206, v206, v197, v197
    v_fma_f32 v207, v207, v197, v197
    s_waitcnt lgkmcnt(3)
    v_mfma_f32_32x32x16_bf16 v[52:67], a[24:27], v[132:135], v[52:67]
    ds_read_b128 v[156:159], v23 offset:22528
    v_rcp_f32 v204, v204
    v_rcp_f32 v205, v205
    v_mfma_f32_32x32x16_bf16 v[52:67], a[28:31], v[136:139], v[52:67]
    ds_read_b128 v[160:163], v23 offset:23040
    v_rcp_f32 v206, v206
    v_rcp_f32 v207, v207
    v_mul_f32 v84, v204, v84
    v_mfma_f32_32x32x16_bf16 v[52:67], a[32:35], v[140:143], v[52:67]
    ds_read_b128 v[164:167], v23 offset:23552
    v_mul_f32 v85, v205, v85
    v_mul_f32 v86, v206, v86
    v_mul_f32 v87, v207, v87
    v_fma_f32 v88, -v196, v120, v88
    v_fma_f32 v89, -v196, v121, v89
    s_waitcnt vmcnt(8)
    s_barrier
    s_waitcnt lgkmcnt(3)
    v_mfma_f32_32x32x16_bf16 v[52:67], a[36:39], v[144:147], v[52:67]
    ds_read_b128 v[168:171], v23 offset:24064
    buffer_load_dwordx4 v6, s[12:15], s41 offen offset:2048 sc1 lds
    v_fma_f32 v90, -v196, v122, v90
    v_fma_f32 v91, -v196, v123, v91
    v_mul_f32 v208, v88, v88
    v_mfma_f32_32x32x16_bf16 v[52:67], a[40:43], v[148:151], v[52:67]
    ds_read_b128 v[132:135], v23 offset:32768
    v_mul_f32 v209, v89, v89
    v_mul_f32 v210, v90, v90
    v_mul_f32 v211, v91, v91
    v_fma_f32 v208, v208, v199, v198
    v_fma_f32 v209, v209, v199, v198
    v_mfma_f32_32x32x16_bf16 v[52:67], a[44:47], v[152:155], v[52:67]
    ds_read_b128 v[136:139], v23 offset:33280
    v_fma_f32 v210, v210, v199, v198
    v_fma_f32 v211, v211, v199, v198
    v_mul_f32 v208, v208, v88
    v_mul_f32 v209, v209, v89
    v_mul_f32 v210, v210, v90
    s_waitcnt lgkmcnt(3)
    v_mfma_f32_32x32x16_bf16 v[52:67], a[48:51], v[156:159], v[52:67]
    ds_read_b128 v[140:143], v23 offset:33792
    v_mul_f32 v211, v211, v91
    v_exp_f32 v208, v208
    v_exp_f32 v209, v209
    v_mfma_f32_32x32x16_bf16 v[52:67], a[52:55], v[160:163], v[52:67]
    ds_read_b128 v[144:147], v23 offset:34304
    buffer_load_dwordx4 v6, s[12:15], s41 offen offset:3072 sc1 lds
    s_add_u32 s41, s41, 40960
    v_exp_f32 v210, v210
    v_mfma_f32_32x32x16_bf16 v[52:67], a[56:59], v[164:167], v[52:67]
    ds_read_b128 v[148:151], v23 offset:34816
    v_exp_f32 v211, v211
    v_fma_f32 v208, v208, v197, v197
    v_fma_f32 v209, v209, v197, v197
    v_fma_f32 v210, v210, v197, v197
    s_waitcnt lgkmcnt(3)
    v_mfma_f32_32x32x16_bf16 v[52:67], a[60:63], v[168:171], v[52:67]
    ds_read_b128 v[152:155], v23 offset:35328
    v_fma_f32 v211, v211, v197, v197
    v_rcp_f32 v208, v208
    v_rcp_f32 v209, v209
    v_mfma_f32_32x32x16_bf16 v[52:67], a[64:67], v[132:135], v[52:67]
    ds_read_b128 v[156:159], v23 offset:35840
    v_rcp_f32 v210, v210
    v_rcp_f32 v211, v211
    v_mul_f32 v88, v208, v88
    v_mfma_f32_32x32x16_bf16 v[52:67], a[68:71], v[136:139], v[52:67]
    ds_read_b128 v[160:163], v23 offset:36352
    s_add_u32 m0, s42, 0
    s_nop 0
    buffer_load_dwordx4 v6, s[12:15], s41 offen offset:0 sc1 lds
    v_mul_f32 v89, v209, v89
    v_mul_f32 v90, v210, v90
    v_mul_f32 v91, v211, v91
    s_waitcnt lgkmcnt(3)
    v_mfma_f32_32x32x16_bf16 v[52:67], a[72:75], v[140:143], v[52:67]
    ds_read_b128 v[164:167], v23 offset:36864
    v_fma_f32 v92, -v196, v124, v92
    v_fma_f32 v93, -v196, v125, v93
    v_fma_f32 v94, -v196, v126, v94
    v_fma_f32 v95, -v196, v127, v95
    v_mul_f32 v204, v92, v92
    v_mfma_f32_32x32x16_bf16 v[52:67], a[76:79], v[144:147], v[52:67]
    ds_read_b128 v[168:171], v23 offset:37376
    v_mul_f32 v205, v93, v93
    v_mul_f32 v206, v94, v94
    v_mul_f32 v207, v95, v95
    v_fma_f32 v204, v204, v199, v198
    v_fma_f32 v205, v205, v199, v198
    v_mfma_f32_32x32x16_bf16 v[52:67], a[80:83], v[148:151], v[52:67]
    ds_read_b128 v[132:135], v23 offset:37888
    v_fma_f32 v206, v206, v199, v198
    v_fma_f32 v207, v207, v199, v198
    v_mul_f32 v204, v204, v92
    v_mul_f32 v205, v205, v93
    v_mul_f32 v206, v206, v94
    s_waitcnt lgkmcnt(3)
    v_mfma_f32_32x32x16_bf16 v[52:67], a[84:87], v[152:155], v[52:67]
    ds_read_b128 v[136:139], v23 offset:38400
    buffer_load_dwordx4 v6, s[12:15], s41 offen offset:1024 sc1 lds
    v_mul_f32 v207, v207, v95
    v_exp_f32 v204, v204
    v_mfma_f32_32x32x16_bf16 v[52:67], a[88:91], v[156:159], v[52:67]
    ds_read_b128 v[140:143], v23 offset:38912
    v_exp_f32 v205, v205
    v_exp_f32 v206, v206
    v_mfma_f32_32x32x16_bf16 v[52:67], a[92:95], v[160:163], v[52:67]
    ds_read_b128 v[144:147], v23 offset:39424
    v_exp_f32 v207, v207
    v_fma_f32 v204, v204, v197, v197
    v_fma_f32 v205, v205, v197, v197
    v_fma_f32 v206, v206, v197, v197
    s_waitcnt lgkmcnt(3)
    v_mfma_f32_32x32x16_bf16 v[52:67], a[96:99], v[164:167], v[52:67]
    ds_read_b128 v[148:151], v23 offset:39936
    v_fma_f32 v207, v207, v197, v197
    v_rcp_f32 v204, v204
    v_rcp_f32 v205, v205
    s_waitcnt vmcnt(7)
    s_barrier
    v_mfma_f32_32x32x16_bf16 v[52:67], a[100:103], v[168:171], v[52:67]
    ds_read_b128 v[152:155], v23 offset:40448
    buffer_load_dwordx4 v6, s[12:15], s41 offen offset:2048 sc1 lds
    v_rcp_f32 v206, v206
    v_mfma_f32_32x32x16_bf16 v[52:67], a[104:107], v[132:135], v[52:67]
    ds_read_b128 v[156:159], v23 offset:49152
    v_rcp_f32 v207, v207
    v_mul_f32 v92, v204, v92
    v_mul_f32 v93, v205, v93
    v_mul_f32 v94, v206, v94
    s_waitcnt lgkmcnt(3)
    v_mfma_f32_32x32x16_bf16 v[52:67], a[108:111], v[136:139], v[52:67]
    ds_read_b128 v[160:163], v23 offset:49664
    v_mul_f32 v95, v207, v95
    v_fma_f32 v96, -v196, v128, v96
    v_fma_f32 v97, -v196, v129, v97
    v_fma_f32 v98, -v196, v130, v98
    v_fma_f32 v99, -v196, v131, v99
    v_mfma_f32_32x32x16_bf16 v[52:67], a[112:115], v[140:143], v[52:67]
    ds_read_b128 v[164:167], v23 offset:50176
    v_mul_f32 v208, v96, v96
    v_mul_f32 v209, v97, v97
    v_mul_f32 v210, v98, v98
    v_mul_f32 v211, v99, v99
    v_fma_f32 v208, v208, v199, v198
    v_mfma_f32_32x32x16_bf16 v[52:67], a[116:119], v[144:147], v[52:67]
    ds_read_b128 v[168:171], v23 offset:50688
    buffer_load_dwordx4 v6, s[12:15], s41 offen offset:3072 sc1 lds
    s_add_u32 s41, s41, 8192
    v_fma_f32 v209, v209, v199, v198
    v_fma_f32 v210, v210, v199, v198
    v_fma_f32 v211, v211, v199, v198
    s_waitcnt lgkmcnt(3)
    v_mfma_f32_32x32x16_bf16 v[52:67], a[120:123], v[148:151], v[52:67]
    ds_read_b128 v[132:135], v23 offset:51200
    v_mul_f32 v208, v208, v96
    v_mul_f32 v209, v209, v97
    v_mul_f32 v210, v210, v98
    v_mul_f32 v211, v211, v99
    v_mfma_f32_32x32x16_bf16 v[52:67], a[124:127], v[152:155], v[52:67]
    ds_read_b128 v[136:139], v23 offset:51712
    v_exp_f32 v208, v208
    v_exp_f32 v209, v209
    v_mfma_f32_32x32x16_bf16 v[52:67], a[128:131], v[156:159], v[52:67]
    ds_read_b128 v[140:143], v23 offset:52224
    v_exp_f32 v210, v210
    v_exp_f32 v211, v211
    v_fma_f32 v208, v208, v197, v197
    s_waitcnt lgkmcnt(3)
    v_mfma_f32_32x32x16_bf16 v[52:67], a[132:135], v[160:163], v[52:67]
    ds_read_b128 v[144:147], v23 offset:52736
    s_add_u32 m0, s42, 16384
    s_nop 0
    buffer_load_dwordx4 v6, s[12:15], s41 offen offset:0 sc1 lds
    v_fma_f32 v209, v209, v197, v197
    v_fma_f32 v210, v210, v197, v197
    v_fma_f32 v211, v211, v197, v197
    v_mfma_f32_32x32x16_bf16 v[52:67], a[136:139], v[164:167], v[52:67]
    ds_read_b128 v[148:151], v23 offset:53248
    v_rcp_f32 v208, v208
    v_rcp_f32 v209, v209
    v_mfma_f32_32x32x16_bf16 v[52:67], a[140:143], v[168:171], v[52:67]
    ds_read_b128 v[152:155], v23 offset:53760
    v_rcp_f32 v210, v210
    v_rcp_f32 v211, v211
    v_mul_f32 v96, v208, v96
    s_waitcnt lgkmcnt(3)
    v_mfma_f32_32x32x16_bf16 v[52:67], a[144:147], v[132:135], v[52:67]
    ds_read_b128 v[156:159], v23 offset:54272
    v_mul_f32 v97, v209, v97
    v_mul_f32 v98, v210, v98
    v_mul_f32 v99, v211, v99
    v_cvt_pk_bf16_f32 v236, v84, v85
    v_mfma_f32_32x32x16_bf16 v[52:67], a[148:151], v[136:139], v[52:67]
    ds_read_b128 v[160:163], v23 offset:54784
    buffer_load_dwordx4 v6, s[12:15], s41 offen offset:1024 sc1 lds
    v_cvt_pk_bf16_f32 v237, v86, v87
    v_cvt_pk_bf16_f32 v238, v92, v93
    v_mfma_f32_32x32x16_bf16 v[52:67], a[152:155], v[140:143], v[52:67]
    ds_read_b128 v[164:167], v23 offset:55296
    v_cvt_pk_bf16_f32 v239, v94, v95
    buffer_store_dwordx4 v[236:239], v26, s[20:23], s40 offen offset:0 sc1
    v_cvt_pk_bf16_f32 v240, v88, v89
    s_waitcnt lgkmcnt(3)
    v_mfma_f32_32x32x16_bf16 v[52:67], a[156:159], v[144:147], v[52:67]
    ds_read_b128 v[168:171], v23 offset:55808
    v_cvt_pk_bf16_f32 v241, v90, v91
    v_cvt_pk_bf16_f32 v242, v96, v97
    v_cvt_pk_bf16_f32 v243, v98, v99
    v_mfma_f32_32x32x16_bf16 v[52:67], a[160:163], v[148:151], v[52:67]
    ds_read_b128 v[132:135], v23 offset:56320
    buffer_store_dwordx4 v[240:243], v26, s[20:23], s40 offen offset:512 sc1
    s_add_u32 s40, s40, 229376
    ds_read_b128 v[196:199], v30 offset:3584
    v_fma_f32 v100, -v172, v116, v100
    s_waitcnt vmcnt(8)
    s_barrier
    v_mfma_f32_32x32x16_bf16 v[52:67], a[164:167], v[152:155], v[52:67]
    ds_read_b128 v[136:139], v23 offset:56832
    buffer_load_dwordx4 v6, s[12:15], s41 offen offset:2048 sc1 lds
    v_fma_f32 v101, -v172, v117, v101
    v_fma_f32 v102, -v172, v118, v102
    v_fma_f32 v103, -v172, v119, v103
    s_waitcnt lgkmcnt(4)
    v_mfma_f32_32x32x16_bf16 v[52:67], a[168:171], v[156:159], v[52:67]
    ds_read_b128 v[140:143], v24 offset:0
    v_mul_f32 v204, v100, v100
    v_mul_f32 v205, v101, v101
    v_mul_f32 v206, v102, v102
    v_mul_f32 v207, v103, v103
    v_fma_f32 v204, v204, v175, v174
    v_mfma_f32_32x32x16_bf16 v[52:67], a[172:175], v[160:163], v[52:67]
    ds_read_b128 v[144:147], v24 offset:512
    v_fma_f32 v205, v205, v175, v174
    v_fma_f32 v206, v206, v175, v174
    v_fma_f32 v207, v207, v175, v174
    v_mul_f32 v204, v204, v100
    v_mul_f32 v205, v205, v101
    v_mfma_f32_32x32x16_bf16 v[52:67], a[176:179], v[164:167], v[52:67]
    ds_read_b128 v[148:151], v24 offset:1024
    v_mul_f32 v206, v206, v102
    v_mul_f32 v207, v207, v103
    v_exp_f32 v204, v204
    s_waitcnt lgkmcnt(3)
    v_mfma_f32_32x32x16_bf16 v[52:67], a[180:183], v[168:171], v[52:67]
    ds_read_b128 v[152:155], v24 offset:1536
    buffer_load_dwordx4 v6, s[12:15], s41 offen offset:3072 sc1 lds
    s_add_u32 s41, s41, 8192
    v_exp_f32 v205, v205
    v_mfma_f32_32x32x16_bf16 v[52:67], a[184:187], v[132:135], v[52:67]
    ds_read_b128 v[156:159], v24 offset:2048
    v_exp_f32 v206, v206
    v_exp_f32 v207, v207
    v_fma_f32 v204, v204, v173, v173
    v_mfma_f32_32x32x16_bf16 v[52:67], a[188:191], v[136:139], v[52:67]
    ds_read_b128 v[160:163], v24 offset:2560
    v_fma_f32 v205, v205, v173, v173
    v_fma_f32 v206, v206, v173, v173
    v_fma_f32 v207, v207, v173, v173
    v_rcp_f32 v204, v204
    s_waitcnt lgkmcnt(3)
    v_mfma_f32_32x32x16_bf16 v[52:67], a[192:195], v[140:143], v[52:67]
    ds_read_b128 v[164:167], v24 offset:3072
    v_rcp_f32 v205, v205
    v_rcp_f32 v206, v206
    v_mfma_f32_32x32x16_bf16 v[52:67], a[196:199], v[144:147], v[52:67]
    ds_read_b128 v[168:171], v24 offset:3584
    s_add_u32 m0, s42, 32768
    s_nop 0
    buffer_load_dwordx4 v6, s[12:15], s41 offen offset:0 sc1 lds
    v_rcp_f32 v207, v207
    v_mul_f32 v100, v204, v100
    v_mfma_f32_32x32x16_bf16 v[52:67], a[200:203], v[148:151], v[52:67]
    ds_read_b128 v[132:135], v24 offset:4096
    v_mul_f32 v101, v205, v101
    v_mul_f32 v102, v206, v102
    v_mul_f32 v103, v207, v103
    v_fma_f32 v104, -v172, v120, v104
    v_fma_f32 v105, -v172, v121, v105
    s_waitcnt lgkmcnt(3)
    v_mfma_f32_32x32x16_bf16 v[52:67], a[204:207], v[152:155], v[52:67]
    ds_read_b128 v[136:139], v24 offset:4608
    v_fma_f32 v106, -v172, v122, v106
    v_fma_f32 v107, -v172, v123, v107
    v_mul_f32 v208, v104, v104
    v_mul_f32 v209, v105, v105
    v_mul_f32 v210, v106, v106
    v_mfma_f32_32x32x16_bf16 v[52:67], a[208:211], v[156:159], v[52:67]
    ds_read_b128 v[140:143], v24 offset:5120
    v_mul_f32 v211, v107, v107
    v_fma_f32 v208, v208, v175, v174
    v_fma_f32 v209, v209, v175, v174
    v_fma_f32 v210, v210, v175, v174
    v_fma_f32 v211, v211, v175, v174
    v_mfma_f32_32x32x16_bf16 v[52:67], a[212:215], v[160:163], v[52:67]
    ds_read_b128 v[144:147], v24 offset:5632
    buffer_load_dwordx4 v6, s[12:15], s41 offen offset:1024 sc1 lds
    v_mul_f32 v208, v208, v104
    v_mul_f32 v209, v209, v105
    v_mul_f32 v210, v210, v106
    s_waitcnt lgkmcnt(3)
    v_mfma_f32_32x32x16_bf16 v[52:67], a[216:219], v[164:167], v[52:67]
    ds_read_b128 v[148:151], v24 offset:6144
    v_mul_f32 v211, v211, v107
    v_exp_f32 v208, v208
    v_exp_f32 v209, v209
    v_mfma_f32_32x32x16_bf16 v[52:67], a[220:223], v[168:171], v[52:67]
    ds_read_b128 v[152:155], v24 offset:6656
    v_exp_f32 v210, v210
    v_exp_f32 v211, v211
    v_fma_f32 v208, v208, v173, v173
    v_mfma_f32_32x32x16_bf16 v[52:67], a[224:227], v[132:135], v[52:67]
    ds_read_b128 v[156:159], v24 offset:7168
    v_fma_f32 v209, v209, v173, v173
    v_fma_f32 v210, v210, v173, v173
    v_fma_f32 v211, v211, v173, v173
    v_rcp_f32 v208, v208
    s_waitcnt vmcnt(8)
    s_barrier
    s_waitcnt lgkmcnt(3)
    v_mfma_f32_32x32x16_bf16 v[52:67], a[228:231], v[136:139], v[52:67]
    ds_read_b128 v[160:163], v24 offset:7680
    buffer_load_dwordx4 v6, s[12:15], s41 offen offset:2048 sc1 lds
    v_rcp_f32 v209, v209
    v_mfma_f32_32x32x16_bf16 v[52:67], a[232:235], v[140:143], v[52:67]
    ds_read_b128 v[164:167], v22 offset:0
    v_rcp_f32 v210, v210
    v_rcp_f32 v211, v211
    v_mul_f32 v104, v208, v104
    v_mfma_f32_32x32x16_bf16 v[52:67], a[236:239], v[144:147], v[52:67]
    ds_read_b128 v[168:171], v22 offset:512
    v_mul_f32 v105, v209, v105
    v_mul_f32 v106, v210, v106
    v_mul_f32 v107, v211, v107
    v_fma_f32 v108, -v172, v124, v108
    v_fma_f32 v109, -v172, v125, v109
    s_waitcnt lgkmcnt(3)
    v_mfma_f32_32x32x16_bf16 v[52:67], a[240:243], v[148:151], v[52:67]
    ds_read_b128 v[132:135], v22 offset:1024
    v_fma_f32 v110, -v172, v126, v110
    v_fma_f32 v111, -v172, v127, v111
    v_mul_f32 v204, v108, v108
    v_mul_f32 v205, v109, v109
    v_mul_f32 v206, v110, v110
    v_mfma_f32_32x32x16_bf16 v[52:67], a[244:247], v[152:155], v[52:67]
    ds_read_b128 v[136:139], v22 offset:1536
    buffer_load_dwordx4 v6, s[12:15], s41 offen offset:3072 sc1 lds
    s_add_u32 s41, s41, 8192
    v_mul_f32 v207, v111, v111
    v_fma_f32 v204, v204, v175, v174
    v_fma_f32 v205, v205, v175, v174
    v_mfma_f32_32x32x16_bf16 v[52:67], a[248:251], v[156:159], v[52:67]
    ds_read_b128 v[140:143], v22 offset:2048
    v_fma_f32 v206, v206, v175, v174
    v_fma_f32 v207, v207, v175, v174
    v_mul_f32 v204, v204, v108
    v_mul_f32 v205, v205, v109
    v_mul_f32 v206, v206, v110
    s_waitcnt lgkmcnt(3)
    v_mfma_f32_32x32x16_bf16 v[52:67], a[252:255], v[160:163], v[52:67]
    ds_read_b128 v[144:147], v22 offset:2560
    v_mul_f32 v207, v207, v111
    v_exp_f32 v204, v204
    v_exp_f32 v205, v205
    s_getpc_b64 s[60:61]
L_pc7:
    s_add_u32 s60, s60, L_g4_kernel_entry-L_pc7
    s_addc_u32 s61, s61, 0
    s_lshr_b32 s62, s2, 3
    s_and_b32 s62, s62, 7
    s_lshl_b32 s62, s62, 2
    s_add_u32 s62, s62, s32
    s_mul_i32 s62, s62, 1024
    v_and_b32 v7, 63, v0
    v_lshlrev_b32 v7, 7, v7
    v_add_u32 v7, s62, v7
    v_min_u32 v7, L_text_end-L_g4_kernel_entry-4, v7
    s_mov_b64 exec, 255
    global_load_dword v9, v7, s[60:61]
    s_mov_b64 exec, -1
    v_mfma_f32_32x32x16_bf16 v[68:83], a[0:3], v[164:167], 0
    ds_read_b128 v[148:151], v22 offset:3072
    v_mfma_f32_32x32x16_bf16 v[68:83], a[4:7], v[168:171], v[68:83]
    ds_read_b128 v[152:155], v22 offset:3584
    s_add_u32 m0, s42, 49152
    s_nop 0
    buffer_load_dwordx4 v6, s[12:15], s41 offen offset:0 sc1 lds
    v_exp_f32 v206, v206
    s_waitcnt lgkmcnt(3)
    v_mfma_f32_32x32x16_bf16 v[68:83], a[8:11], v[132:135], v[68:83]
    ds_read_b128 v[156:159], v22 offset:4096
    v_exp_f32 v207, v207
    v_fma_f32 v204, v204, v173, v173
    v_fma_f32 v205, v205, v173, v173
    v_fma_f32 v206, v206, v173, v173
    v_mfma_f32_32x32x16_bf16 v[68:83], a[12:15], v[136:139], v[68:83]
    ds_read_b128 v[160:163], v22 offset:4608
    v_fma_f32 v207, v207, v173, v173
    v_rcp_f32 v204, v204
    v_rcp_f32 v205, v205
    v_mfma_f32_32x32x16_bf16 v[68:83], a[16:19], v[140:143], v[68:83]
    ds_read_b128 v[164:167], v22 offset:5120
    v_rcp_f32 v206, v206
    v_rcp_f32 v207, v207
    v_mul_f32 v108, v204, v108
    s_waitcnt lgkmcnt(3)
    v_mfma_f32_32x32x16_bf16 v[68:83], a[20:23], v[144:147], v[68:83]
    ds_read_b128 v[168:171], v22 offset:5632
    buffer_load_dwordx4 v6, s[12:15], s41 offen offset:1024 sc1 lds
    v_mul_f32 v109, v205, v109
    v_mul_f32 v110, v206, v110
    v_mul_f32 v111, v207, v111
    v_mfma_f32_32x32x16_bf16 v[68:83], a[24:27], v[148:151], v[68:83]
    ds_read_b128 v[132:135], v22 offset:6144
    v_fma_f32 v112, -v172, v128, v112
    v_fma_f32 v113, -v172, v129, v113
    v_fma_f32 v114, -v172, v130, v114
    v_fma_f32 v115, -v172, v131, v115
    v_mul_f32 v208, v112, v112
    v_mfma_f32_32x32x16_bf16 v[68:83], a[28:31], v[152:155], v[68:83]
    ds_read_b128 v[136:139], v22 offset:6656
    v_mul_f32 v209, v113, v113
    v_mul_f32 v210, v114, v114
    v_mul_f32 v211, v115, v115
    v_fma_f32 v208, v208, v175, v174
    v_fma_f32 v209, v209, v175, v174
    s_waitcnt lgkmcnt(3)
    v_mfma_f32_32x32x16_bf16 v[68:83], a[32:35], v[156:159], v[68:83]
    ds_read_b128 v[140:143], v22 offset:7168
    v_fma_f32 v210, v210, v175, v174
    v_fma_f32 v211, v211, v175, v174
    v_mul_f32 v208, v208, v112
    v_mul_f32 v209, v209, v113
    v_mul_f32 v210, v210, v114
    s_waitcnt vmcnt(7)
    s_barrier
    v_mfma_f32_32x32x16_bf16 v[68:83], a[36:39], v[160:163], v[68:83]
    ds_read_b128 v[144:147], v22 offset:7680
    buffer_load_dwordx4 v6, s[12:15], s41 offen offset:2048 sc1 lds
    v_mul_f32 v211, v211, v115
    v_exp_f32 v208, v208
    v_mfma_f32_32x32x16_bf16 v[68:83], a[40:43], v[164:167], v[68:83]
    ds_read_b128 v[148:151], v22 offset:16384
    v_exp_f32 v209, v209
    v_exp_f32 v210, v210
    s_waitcnt lgkmcnt(3)
    v_mfma_f32_32x32x16_bf16 v[68:83], a[44:47], v[168:171], v[68:83]
    ds_read_b128 v[152:155], v22 offset:16896
    v_exp_f32 v211, v211
    v_fma_f32 v208, v208, v173, v173
    v_fma_f32 v209, v209, v173, v173
    v_fma_f32 v210, v210, v173, v173
    v_mfma_f32_32x32x16_bf16 v[68:83], a[48:51], v[132:135], v[68:83]
    ds_read_b128 v[156:159], v22 offset:17408
    v_fma_f32 v211, v211, v173, v173
    v_rcp_f32 v208, v208
    v_rcp_f32 v209, v209
    v_mfma_f32_32x32x16_bf16 v[68:83], a[52:55], v[136:139], v[68:83]
    ds_read_b128 v[160:163], v22 offset:17920
    buffer_load_dwordx4 v6, s[12:15], s41 offen offset:3072 sc1 lds
    s_add_u32 s41, s41, 40960
    v_rcp_f32 v210, v210
    s_waitcnt lgkmcnt(3)
    v_mfma_f32_32x32x16_bf16 v[68:83], a[56:59], v[140:143], v[68:83]
    ds_read_b128 v[164:167], v22 offset:18432
    v_rcp_f32 v211, v211
    v_mul_f32 v112, v208, v112
    v_mul_f32 v113, v209, v113
    v_mul_f32 v114, v210, v114
    v_mfma_f32_32x32x16_bf16 v[68:83], a[60:63], v[144:147], v[68:83]
    ds_read_b128 v[168:171], v22 offset:18944
    v_mul_f32 v115, v211, v115
    v_cvt_pk_bf16_f32 v236, v100, v101
    v_cvt_pk_bf16_f32 v237, v102, v103
    v_mfma_f32_32x32x16_bf16 v[68:83], a[64:67], v[148:151], v[68:83]
    ds_read_b128 v[132:135], v22 offset:19456
    v_cvt_pk_bf16_f32 v238, v108, v109
    v_cvt_pk_bf16_f32 v239, v110, v111
    buffer_store_dwordx4 v[236:239], v26, s[20:23], s40 offen offset:0 sc1
    s_waitcnt lgkmcnt(3)
    v_mfma_f32_32x32x16_bf16 v[68:83], a[68:71], v[152:155], v[68:83]
    ds_read_b128 v[136:139], v22 offset:19968
    v_cvt_pk_bf16_f32 v240, v104, v105
    v_cvt_pk_bf16_f32 v241, v106, v107
    v_cvt_pk_bf16_f32 v242, v112, v113
    v_mfma_f32_32x32x16_bf16 v[68:83], a[72:75], v[156:159], v[68:83]
    ds_read_b128 v[140:143], v22 offset:20480
    v_cvt_pk_bf16_f32 v243, v114, v115
    buffer_store_dwordx4 v[240:243], v26, s[20:23], s40 offen offset:512 sc1
    s_add_u32 s40, s40, 229376
    v_fma_f32 v36, -v180, v116, v36
    v_mfma_f32_32x32x16_bf16 v[68:83], a[76:79], v[160:163], v[68:83]
    ds_read_b128 v[144:147], v22 offset:20992
    v_fma_f32 v37, -v180, v117, v37
    v_fma_f32 v38, -v180, v118, v38
    v_fma_f32 v39, -v180, v119, v39
    v_mul_f32 v204, v36, v36
    v_mul_f32 v205, v37, v37
    s_waitcnt lgkmcnt(3)
    v_mfma_f32_32x32x16_bf16 v[68:83], a[80:83], v[164:167], v[68:83]
    ds_read_b128 v[148:151], v22 offset:21504
    v_mul_f32 v206, v38, v38
    v_mul_f32 v207, v39, v39
    v_fma_f32 v204, v204, v183, v182
    v_fma_f32 v205, v205, v183, v182
    v_fma_f32 v206, v206, v183, v182
    v_mfma_f32_32x32x16_bf16 v[68:83], a[84:87], v[168:171], v[68:83]
    ds_read_b128 v[152:155], v22 offset:22016
    v_fma_f32 v207, v207, v183, v182
    v_mul_f32 v204, v204, v36
    v_mul_f32 v205, v205, v37
    v_mul_f32 v206, v206, v38
    v_mul_f32 v207, v207, v39
    v_mfma_f32_32x32x16_bf16 v[68:83], a[88:91], v[132:135], v[68:83]
    ds_read_b128 v[156:159], v22 offset:22528
    v_exp_f32 v204, v204
    v_exp_f32 v205, v205
    s_waitcnt lgkmcnt(3)
    v_mfma_f32_32x32x16_bf16 v[68:83], a[92:95], v[136:139], v[68:83]
    ds_read_b128 v[160:163], v22 offset:23040
    v_exp_f32 v206, v206
    v_exp_f32 v207, v207
    v_fma_f32 v204, v204, v181, v181
    v_mfma_f32_32x32x16_bf16 v[68:83], a[96:99], v[140:143], v[68:83]
    ds_read_b128 v[164:167], v22 offset:23552
    v_fma_f32 v205, v205, v181, v181
    v_fma_f32 v206, v206, v181, v181
    v_fma_f32 v207, v207, v181, v181
    v_rcp_f32 v204, v204
    s_waitcnt vmcnt(7)
    s_barrier
    v_mfma_f32_32x32x16_bf16 v[68:83], a[100:103], v[144:147], v[68:83]
    ds_read_b128 v[168:171], v22 offset:24064
    v_rcp_f32 v205, v205
    v_rcp_f32 v206, v206
    s_waitcnt lgkmcnt(3)
    v_mfma_f32_32x32x16_bf16 v[68:83], a[104:107], v[148:151], v[68:83]
    ds_read_b128 v[132:135], v22 offset:32768
    v_rcp_f32 v207, v207
    v_mul_f32 v36, v204, v36
    v_mul_f32 v37, v205, v37
    v_mul_f32 v38, v206, v38
    v_mfma_f32_32x32x16_bf16 v[68:83], a[108:111], v[152:155], v[68:83]
    ds_read_b128 v[136:139], v22 offset:33280
    v_mul_f32 v39, v207, v39
    v_fma_f32 v40, -v180, v120, v40
    v_fma_f32 v41, -v180, v121, v41
    v_fma_f32 v42, -v180, v122, v42
    v_fma_f32 v43, -v180, v123, v43
    v_mfma_f32_32x32x16_bf16 v[68:83], a[112:115], v[156:159], v[68:83]
    ds_read_b128 v[140:143], v22 offset:33792
    v_mul_f32 v208, v40, v40
    v_mul_f32 v209, v41, v41
    v_mul_f32 v210, v42, v42
    v_mul_f32 v211, v43, v43
    v_fma_f32 v208, v208, v183, v182
    s_waitcnt lgkmcnt(3)
    v_mfma_f32_32x32x16_bf16 v[68:83], a[116:119], v[160:163], v[68:83]
    ds_read_b128 v[144:147], v22 offset:34304
    v_fma_f32 v209, v209, v183, v182
    v_fma_f32 v210, v210, v183, v182
    v_fma_f32 v211, v211, v183, v182
    v_mul_f32 v208, v208, v40
    v_mul_f32 v209, v209, v41
    v_mfma_f32_32x32x16_bf16 v[68:83], a[120:123], v[164:167], v[68:83]
    ds_read_b128 v[148:151], v22 offset:34816
    v_mul_f32 v210, v210, v42
    v_mul_f32 v211, v211, v43
    v_exp_f32 v208, v208
    v_mfma_f32_32x32x16_bf16 v[68:83], a[124:127], v[168:171], v[68:83]
    ds_read_b128 v[152:155], v22 offset:35328
    v_exp_f32 v209, v209
    v_exp_f32 v210, v210
    s_waitcnt lgkmcnt(3)
    v_mfma_f32_32x32x16_bf16 v[68:83], a[128:131], v[132:135], v[68:83]
    ds_read_b128 v[156:159], v22 offset:35840
    v_exp_f32 v211, v211
    v_fma_f32 v208, v208, v181, v181
    v_fma_f32 v209, v209, v181, v181
    v_fma_f32 v210, v210, v181, v181
    v_mfma_f32_32x32x16_bf16 v[68:83], a[132:135], v[136:139], v[68:83]
    ds_read_b128 v[160:163], v22 offset:36352
    v_fma_f32 v211, v211, v181, v181
    v_rcp_f32 v208, v208
    v_rcp_f32 v209, v209
    v_mfma_f32_32x32x16_bf16 v[68:83], a[136:139], v[140:143], v[68:83]
    ds_read_b128 v[164:167], v22 offset:36864
    v_rcp_f32 v210, v210
    v_rcp_f32 v211, v211
    v_mul_f32 v40, v208, v40
    s_waitcnt lgkmcnt(3)
    v_mfma_f32_32x32x16_bf16 v[68:83], a[140:143], v[144:147], v[68:83]
    ds_read_b128 v[168:171], v22 offset:37376
    v_mul_f32 v41, v209, v41
    v_mul_f32 v42, v210, v42
    v_mul_f32 v43, v211, v43
    v_fma_f32 v44, -v180, v124, v44
    v_fma_f32 v45, -v180, v125, v45
    v_mfma_f32_32x32x16_bf16 v[68:83], a[144:147], v[148:151], v[68:83]
    ds_read_b128 v[132:135], v22 offset:37888
    v_fma_f32 v46, -v180, v126, v46
    v_fma_f32 v47, -v180, v127, v47
    v_mul_f32 v204, v44, v44
    v_mul_f32 v205, v45, v45
    v_mul_f32 v206, v46, v46
    v_mfma_f32_32x32x16_bf16 v[68:83], a[148:151], v[152:155], v[68:83]
    ds_read_b128 v[136:139], v22 offset:38400
    v_mul_f32 v207, v47, v47
    v_fma_f32 v204, v204, v183, v182
    v_fma_f32 v205, v205, v183, v182
    v_fma_f32 v206, v206, v183, v182
    v_fma_f32 v207, v207, v183, v182
    s_waitcnt lgkmcnt(3)
    v_mfma_f32_32x32x16_bf16 v[68:83], a[152:155], v[156:159], v[68:83]
    ds_read_b128 v[140:143], v22 offset:38912
    v_mul_f32 v204, v204, v44
    v_mul_f32 v205, v205, v45
    v_mul_f32 v206, v206, v46
    v_mul_f32 v207, v207, v47
    v_mfma_f32_32x32x16_bf16 v[68:83], a[156:159], v[160:163], v[68:83]
    ds_read_b128 v[144:147], v22 offset:39424
    v_exp_f32 v204, v204
    v_exp_f32 v205, v205
    v_mfma_f32_32x32x16_bf16 v[68:83], a[160:163], v[164:167], v[68:83]
    ds_read_b128 v[148:151], v22 offset:39936
    v_exp_f32 v206, v206
    v_exp_f32 v207, v207
    v_fma_f32 v204, v204, v181, v181
    s_waitcnt vmcnt(2)
    s_barrier
    s_waitcnt lgkmcnt(3)
    v_mfma_f32_32x32x16_bf16 v[68:83], a[164:167], v[168:171], v[68:83]
    ds_read_b128 v[152:155], v22 offset:40448
    v_fma_f32 v205, v205, v181, v181
    v_fma_f32 v206, v206, v181, v181
    v_fma_f32 v207, v207, v181, v181
    v_rcp_f32 v204, v204
    v_mfma_f32_32x32x16_bf16 v[68:83], a[168:171], v[132:135], v[68:83]
    ds_read_b128 v[156:159], v22 offset:49152
    v_rcp_f32 v205, v205
    v_rcp_f32 v206, v206
    v_mfma_f32_32x32x16_bf16 v[68:83], a[172:175], v[136:139], v[68:83]
    ds_read_b128 v[160:163], v22 offset:49664
    v_rcp_f32 v207, v207
    v_mul_f32 v44, v204, v44
    v_mul_f32 v45, v205, v45
    v_mul_f32 v46, v206, v46
    s_waitcnt lgkmcnt(3)
    v_mfma_f32_32x32x16_bf16 v[68:83], a[176:179], v[140:143], v[68:83]
    ds_read_b128 v[164:167], v22 offset:50176
    v_mul_f32 v47, v207, v47
    v_fma_f32 v48, -v180, v128, v48
    v_fma_f32 v49, -v180, v129, v49
    v_fma_f32 v50, -v180, v130, v50
    v_fma_f32 v51, -v180, v131, v51
    v_mfma_f32_32x32x16_bf16 v[68:83], a[180:183], v[144:147], v[68:83]
    ds_read_b128 v[168:171], v22 offset:50688
    v_mul_f32 v208, v48, v48
    v_mul_f32 v209, v49, v49
    v_mul_f32 v210, v50, v50
    v_mul_f32 v211, v51, v51
    v_fma_f32 v208, v208, v183, v182
    v_mfma_f32_32x32x16_bf16 v[68:83], a[184:187], v[148:151], v[68:83]
    ds_read_b128 v[132:135], v22 offset:51200
    v_fma_f32 v209, v209, v183, v182
    v_fma_f32 v210, v210, v183, v182
    v_fma_f32 v211, v211, v183, v182
    v_mul_f32 v208, v208, v48
    v_mul_f32 v209, v209, v49
    s_waitcnt lgkmcnt(3)
    v_mfma_f32_32x32x16_bf16 v[68:83], a[188:191], v[152:155], v[68:83]
    ds_read_b128 v[136:139], v22 offset:51712
    v_mul_f32 v210, v210, v50
    v_mul_f32 v211, v211, v51
    v_exp_f32 v208, v208
    v_mfma_f32_32x32x16_bf16 v[68:83], a[192:195], v[156:159], v[68:83]
    ds_read_b128 v[140:143], v22 offset:52224
    v_exp_f32 v209, v209
    v_exp_f32 v210, v210
    v_mfma_f32_32x32x16_bf16 v[68:83], a[196:199], v[160:163], v[68:83]
    ds_read_b128 v[144:147], v22 offset:52736
    v_exp_f32 v211, v211
    v_fma_f32 v208, v208, v181, v181
    v_fma_f32 v209, v209, v181, v181
    v_fma_f32 v210, v210, v181, v181
    s_waitcnt lgkmcnt(3)
    v_mfma_f32_32x32x16_bf16 v[68:83], a[200:203], v[164:167], v[68:83]
    ds_read_b128 v[148:151], v22 offset:53248
    v_fma_f32 v211, v211, v181, v181
    v_rcp_f32 v208, v208
    v_rcp_f32 v209, v209
    v_mfma_f32_32x32x16_bf16 v[68:83], a[204:207], v[168:171], v[68:83]
    ds_read_b128 v[152:155], v22 offset:53760
    v_rcp_f32 v210, v210
    v_rcp_f32 v211, v211
    v_mul_f32 v48, v208, v48
    v_mfma_f32_32x32x16_bf16 v[68:83], a[208:211], v[132:135], v[68:83]
    ds_read_b128 v[156:159], v22 offset:54272
    v_mul_f32 v49, v209, v49
    v_mul_f32 v50, v210, v50
    v_mul_f32 v51, v211, v51
    v_cvt_pk_bf16_f32 v236, v36, v37
    s_waitcnt lgkmcnt(3)
    v_mfma_f32_32x32x16_bf16 v[68:83], a[212:215], v[136:139], v[68:83]
    ds_read_b128 v[160:163], v22 offset:54784
    v_cvt_pk_bf16_f32 v237, v38, v39
    v_cvt_pk_bf16_f32 v238, v44, v45
    v_cvt_pk_bf16_f32 v239, v46, v47
    v_mfma_f32_32x32x16_bf16 v[68:83], a[216:219], v[140:143], v[68:83]
    ds_read_b128 v[164:167], v22 offset:55296
    buffer_store_dwordx4 v[236:239], v26, s[20:23], s40 offen offset:0 sc1
    v_cvt_pk_bf16_f32 v240, v40, v41
    v_cvt_pk_bf16_f32 v241, v42, v43
    v_mfma_f32_32x32x16_bf16 v[68:83], a[220:223], v[144:147], v[68:83]
    ds_read_b128 v[168:171], v22 offset:55808
    v_cvt_pk_bf16_f32 v242, v48, v49
    v_cvt_pk_bf16_f32 v243, v50, v51
    buffer_store_dwordx4 v[240:243], v26, s[20:23], s40 offen offset:512 sc1
    s_waitcnt lgkmcnt(3)
    v_mfma_f32_32x32x16_bf16 v[68:83], a[224:227], v[148:151], v[68:83]
    ds_read_b128 v[132:135], v22 offset:56320
    s_add_u32 s40, s40, 229376
    v_fma_f32 v52, -v188, v116, v52
    v_fma_f32 v53, -v188, v117, v53
    v_fma_f32 v54, -v188, v118, v54
    v_fma_f32 v55, -v188, v119, v55
    v_mul_f32 v204, v52, v52
    v_mfma_f32_32x32x16_bf16 v[68:83], a[228:231], v[152:155], v[68:83]
    ds_read_b128 v[136:139], v22 offset:56832
    v_mul_f32 v205, v53, v53
    v_mul_f32 v206, v54, v54
    v_mul_f32 v207, v55, v55
    v_fma_f32 v204, v204, v191, v190
    v_fma_f32 v205, v205, v191, v190
    v_mfma_f32_32x32x16_bf16 v[68:83], a[232:235], v[156:159], v[68:83]
    v_fma_f32 v206, v206, v191, v190
    v_fma_f32 v207, v207, v191, v190
    v_mul_f32 v204, v204, v52
    v_mul_f32 v205, v205, v53
    v_mul_f32 v206, v206, v54
    v_mul_f32 v207, v207, v55
    s_waitcnt lgkmcnt(2)
    v_mfma_f32_32x32x16_bf16 v[68:83], a[236:239], v[160:163], v[68:83]
    v_exp_f32 v204, v204
    v_exp_f32 v205, v205
    v_exp_f32 v206, v206
    v_mfma_f32_32x32x16_bf16 v[68:83], a[240:243], v[164:167], v[68:83]
    v_exp_f32 v207, v207
    v_fma_f32 v204, v204, v189, v189
    v_fma_f32 v205, v205, v189, v189
    v_fma_f32 v206, v206, v189, v189
    v_fma_f32 v207, v207, v189, v189
    v_mfma_f32_32x32x16_bf16 v[68:83], a[244:247], v[168:171], v[68:83]
    v_rcp_f32 v204, v204
    v_rcp_f32 v205, v205
    v_rcp_f32 v206, v206
    s_waitcnt lgkmcnt(0)
    v_mfma_f32_32x32x16_bf16 v[68:83], a[248:251], v[132:135], v[68:83]
    v_rcp_f32 v207, v207
    v_mul_f32 v52, v204, v52
    v_mul_f32 v53, v205, v53
    v_mul_f32 v54, v206, v54
    v_mul_f32 v55, v207, v55
    v_fma_f32 v56, -v188, v120, v56
    v_mfma_f32_32x32x16_bf16 v[68:83], a[252:255], v[136:139], v[68:83]
    v_fma_f32 v57, -v188, v121, v57
    v_fma_f32 v58, -v188, v122, v58
    v_fma_f32 v59, -v188, v123, v59
    v_mul_f32 v208, v56, v56
    v_mul_f32 v209, v57, v57
    v_mul_f32 v210, v58, v58
    v_mul_f32 v211, v59, v59
    v_fma_f32 v208, v208, v191, v190
    v_fma_f32 v209, v209, v191, v190
    v_fma_f32 v210, v210, v191, v190
    v_fma_f32 v211, v211, v191, v190
    v_mul_f32 v208, v208, v56
    v_mul_f32 v209, v209, v57
    v_mul_f32 v210, v210, v58
    v_mul_f32 v211, v211, v59
    v_exp_f32 v208, v208
    v_exp_f32 v209, v209
    v_exp_f32 v210, v210
    v_exp_f32 v211, v211
    v_fma_f32 v208, v208, v189, v189
    v_fma_f32 v209, v209, v189, v189
    v_fma_f32 v210, v210, v189, v189
    v_fma_f32 v211, v211, v189, v189
    v_rcp_f32 v208, v208
    v_rcp_f32 v209, v209
    v_rcp_f32 v210, v210
    v_rcp_f32 v211, v211
    v_mul_f32 v56, v208, v56
    v_mul_f32 v57, v209, v57
    v_mul_f32 v58, v210, v58
    v_mul_f32 v59, v211, v59
    v_fma_f32 v60, -v188, v124, v60
    v_fma_f32 v61, -v188, v125, v61
    v_fma_f32 v62, -v188, v126, v62
    v_fma_f32 v63, -v188, v127, v63
    v_mul_f32 v204, v60, v60
    v_mul_f32 v205, v61, v61
    v_mul_f32 v206, v62, v62
    v_mul_f32 v207, v63, v63
    v_fma_f32 v204, v204, v191, v190
    v_fma_f32 v205, v205, v191, v190
    v_fma_f32 v206, v206, v191, v190
    v_fma_f32 v207, v207, v191, v190
    v_mul_f32 v204, v204, v60
    v_mul_f32 v205, v205, v61
    v_mul_f32 v206, v206, v62
    v_mul_f32 v207, v207, v63
    v_exp_f32 v204, v204
    v_exp_f32 v205, v205
    v_exp_f32 v206, v206
    v_exp_f32 v207, v207
    v_fma_f32 v204, v204, v189, v189
    v_fma_f32 v205, v205, v189, v189
    v_fma_f32 v206, v206, v189, v189
    v_fma_f32 v207, v207, v189, v189
    v_rcp_f32 v204, v204
    v_rcp_f32 v205, v205
    v_rcp_f32 v206, v206
    v_rcp_f32 v207, v207
    v_mul_f32 v60, v204, v60
    v_mul_f32 v61, v205, v61
    v_mul_f32 v62, v206, v62
    v_mul_f32 v63, v207, v63
    v_fma_f32 v64, -v188, v128, v64
    v_fma_f32 v65, -v188, v129, v65
    v_fma_f32 v66, -v188, v130, v66
    v_fma_f32 v67, -v188, v131, v67
    v_mul_f32 v208, v64, v64
    v_mul_f32 v209, v65, v65
    v_mul_f32 v210, v66, v66
    v_mul_f32 v211, v67, v67
    v_fma_f32 v208, v208, v191, v190
    v_fma_f32 v209, v209, v191, v190
    v_fma_f32 v210, v210, v191, v190
    v_fma_f32 v211, v211, v191, v190
    v_mul_f32 v208, v208, v64
    v_mul_f32 v209, v209, v65
    v_mul_f32 v210, v210, v66
    v_mul_f32 v211, v211, v67
    v_exp_f32 v208, v208
    v_exp_f32 v209, v209
    v_exp_f32 v210, v210
    v_exp_f32 v211, v211
    v_fma_f32 v208, v208, v189, v189
    v_fma_f32 v209, v209, v189, v189
    v_fma_f32 v210, v210, v189, v189
    v_fma_f32 v211, v211, v189, v189
    v_rcp_f32 v208, v208
    v_rcp_f32 v209, v209
    v_rcp_f32 v210, v210
    v_rcp_f32 v211, v211
    v_mul_f32 v64, v208, v64
    v_mul_f32 v65, v209, v65
    v_mul_f32 v66, v210, v66
    v_mul_f32 v67, v211, v67
    v_cvt_pk_bf16_f32 v236, v52, v53
    v_cvt_pk_bf16_f32 v237, v54, v55
    v_cvt_pk_bf16_f32 v238, v60, v61
    v_cvt_pk_bf16_f32 v239, v62, v63
    buffer_store_dwordx4 v[236:239], v26, s[20:23], s40 offen offset:0 sc1
    v_cvt_pk_bf16_f32 v240, v56, v57
    v_cvt_pk_bf16_f32 v241, v58, v59
    v_cvt_pk_bf16_f32 v242, v64, v65
    v_cvt_pk_bf16_f32 v243, v66, v67
    buffer_store_dwordx4 v[240:243], v26, s[20:23], s40 offen offset:512 sc1
    s_add_u32 s40, s40, 229376
    v_pk_fma_f32 v[68:69], v[116:117], v[196:197], v[68:69] op_sel_hi:[1,0,1] neg_lo:[0,1,0] neg_hi:[0,1,0]
    v_pk_fma_f32 v[70:71], v[118:119], v[196:197], v[70:71] op_sel_hi:[1,0,1] neg_lo:[0,1,0] neg_hi:[0,1,0]
    v_pk_fma_f32 v[72:73], v[120:121], v[196:197], v[72:73] op_sel_hi:[1,0,1] neg_lo:[0,1,0] neg_hi:[0,1,0]
    v_pk_fma_f32 v[74:75], v[122:123], v[196:197], v[74:75] op_sel_hi:[1,0,1] neg_lo:[0,1,0] neg_hi:[0,1,0]
    v_pk_fma_f32 v[76:77], v[124:125], v[196:197], v[76:77] op_sel_hi:[1,0,1] neg_lo:[0,1,0] neg_hi:[0,1,0]
    v_pk_fma_f32 v[78:79], v[126:127], v[196:197], v[78:79] op_sel_hi:[1,0,1] neg_lo:[0,1,0] neg_hi:[0,1,0]
    v_pk_fma_f32 v[80:81], v[128:129], v[196:197], v[80:81] op_sel_hi:[1,0,1] neg_lo:[0,1,0] neg_hi:[0,1,0]
    v_pk_fma_f32 v[82:83], v[130:131], v[196:197], v[82:83] op_sel_hi:[1,0,1] neg_lo:[0,1,0] neg_hi:[0,1,0]
    v_pk_mul_f32 v[204:205], v[68:69], v[68:69]
    v_pk_mul_f32 v[206:207], v[70:71], v[70:71]
    v_pk_mul_f32 v[208:209], v[72:73], v[72:73]
    v_pk_mul_f32 v[210:211], v[74:75], v[74:75]
    v_pk_mul_f32 v[212:213], v[76:77], v[76:77]
    v_pk_mul_f32 v[214:215], v[78:79], v[78:79]
    v_pk_mul_f32 v[216:217], v[80:81], v[80:81]
    v_pk_mul_f32 v[218:219], v[82:83], v[82:83]
    v_pk_fma_f32 v[204:205], v[204:205], v[198:199], v[198:199] op_sel:[0,1,0] op_sel_hi:[1,1,0]
    v_pk_fma_f32 v[206:207], v[206:207], v[198:199], v[198:199] op_sel:[0,1,0] op_sel_hi:[1,1,0]
    v_pk_fma_f32 v[208:209], v[208:209], v[198:199], v[198:199] op_sel:[0,1,0] op_sel_hi:[1,1,0]
    v_pk_fma_f32 v[210:211], v[210:211], v[198:199], v[198:199] op_sel:[0,1,0] op_sel_hi:[1,1,0]
    v_pk_fma_f32 v[212:213], v[212:213], v[198:199], v[198:199] op_sel:[0,1,0] op_sel_hi:[1,1,0]
    v_pk_fma_f32 v[214:215], v[214:215], v[198:199], v[198:199] op_sel:[0,1,0] op_sel_hi:[1,1,0]
    v_pk_fma_f32 v[216:217], v[216:217], v[198:199], v[198:199] op_sel:[0,1,0] op_sel_hi:[1,1,0]
    v_pk_fma_f32 v[218:219], v[218:219], v[198:199], v[198:199] op_sel:[0,1,0] op_sel_hi:[1,1,0]
    v_pk_mul_f32 v[204:205], v[204:205], v[68:69]
    v_pk_mul_f32 v[206:207], v[206:207], v[70:71]
    v_pk_mul_f32 v[208:209], v[208:209], v[72:73]
    v_pk_mul_f32 v[210:211], v[210:211], v[74:75]
    v_pk_mul_f32 v[212:213], v[212:213], v[76:77]
    v_pk_mul_f32 v[214:215], v[214:215], v[78:79]
    v_pk_mul_f32 v[216:217], v[216:217], v[80:81]
    v_pk_mul_f32 v[218:219], v[218:219], v[82:83]
    v_exp_f32 v204, v204
    v_exp_f32 v205, v205
    v_exp_f32 v206, v206
    v_exp_f32 v207, v207
    v_exp_f32 v208, v208
    v_exp_f32 v209, v209
    v_exp_f32 v210, v210
    v_exp_f32 v211, v211
    v_exp_f32 v212, v212
    v_exp_f32 v213, v213
    v_exp_f32 v214, v214
    v_exp_f32 v215, v215
    v_exp_f32 v216, v216
    v_exp_f32 v217, v217
    v_exp_f32 v218, v218
    v_exp_f32 v219, v219
    v_pk_fma_f32 v[204:205], v[204:205], v[196:197], v[196:197] op_sel:[0,1,1] op_sel_hi:[1,1,1]
    v_pk_fma_f32 v[206:207], v[206:207], v[196:197], v[196:197] op_sel:[0,1,1] op_sel_hi:[1,1,1]
    v_pk_fma_f32 v[208:209], v[208:209], v[196:197], v[196:197] op_sel:[0,1,1] op_sel_hi:[1,1,1]
    v_pk_fma_f32 v[210:211], v[210:211], v[196:197], v[196:197] op_sel:[0,1,1] op_sel_hi:[1,1,1]
    v_pk_fma_f32 v[212:213], v[212:213], v[196:197], v[196:197] op_sel:[0,1,1] op_sel_hi:[1,1,1]
    v_pk_fma_f32 v[214:215], v[214:215], v[196:197], v[196:197] op_sel:[0,1,1] op_sel_hi:[1,1,1]
    v_pk_fma_f32 v[216:217], v[216:217], v[196:197], v[196:197] op_sel:[0,1,1] op_sel_hi:[1,1,1]
    v_pk_fma_f32 v[218:219], v[218:219], v[196:197], v[196:197] op_sel:[0,1,1] op_sel_hi:[1,1,1]
    v_rcp_f32 v204, v204
    v_rcp_f32 v205, v205
    v_rcp_f32 v206, v206
    v_rcp_f32 v207, v207
    v_rcp_f32 v208, v208
    v_rcp_f32 v209, v209
    v_rcp_f32 v210, v210
    v_rcp_f32 v211, v211
    v_rcp_f32 v212, v212
    v_rcp_f32 v213, v213
    v_rcp_f32 v214, v214
    v_rcp_f32 v215, v215
    v_rcp_f32 v216, v216
    v_rcp_f32 v217, v217
    v_rcp_f32 v218, v218
    v_rcp_f32 v219, v219
    v_pk_mul_f32 v[68:69], v[204:205], v[68:69]
    v_pk_mul_f32 v[70:71], v[206:207], v[70:71]
    v_pk_mul_f32 v[72:73], v[208:209], v[72:73]
    v_pk_mul_f32 v[74:75], v[210:211], v[74:75]
    v_pk_mul_f32 v[76:77], v[212:213], v[76:77]
    v_pk_mul_f32 v[78:79], v[214:215], v[78:79]
    v_pk_mul_f32 v[80:81], v[216:217], v[80:81]
    v_pk_mul_f32 v[82:83], v[218:219], v[82:83]
    v_cvt_pk_bf16_f32 v236, v68, v69
    v_cvt_pk_bf16_f32 v237, v70, v71
    v_cvt_pk_bf16_f32 v238, v76, v77
    v_cvt_pk_bf16_f32 v239, v78, v79
    buffer_store_dwordx4 v[236:239], v26, s[20:23], s40 offen offset:0 sc1
    v_cvt_pk_bf16_f32 v240, v72, v73
    v_cvt_pk_bf16_f32 v241, v74, v75
    v_cvt_pk_bf16_f32 v242, v80, v81
    v_cvt_pk_bf16_f32 v243, v82, v83
    buffer_store_dwordx4 v[240:243], v26, s[20:23], s40 offen offset:512 sc1
    s_add_u32 s40, s40, 229376
    s_waitcnt vmcnt(0)
    s_barrier
    s_cmp_ge_u32 s34, 14
    s_cselect_b32 s90, 1, 0
    s_lshl_b32 s38, s33, 1
    s_add_u32 s90, s90, s38
    s_add_u32 s90, s90, 72
    s_lshl_b32 s90, s90, 8
    s_add_u32 s96, s84, 47513600
    s_addc_u32 s97, s85, 0
    s_mov_b32 s98, 32768
    s_mov_b32 s99, 0x20000
    s_cmp_eq_u32 s32, 0
    s_cselect_b32 s98, s98, 0
    v_mov_b32 v7, s90
    v_mov_b32 v8, 1
    s_mov_b64 exec, 1
    buffer_atomic_add v8, v7, s[96:99], 0 offen sc1
    s_mov_b64 exec, -1
L_g4_kernel_entry:
    v_mbcnt_lo_u32_b32 v0, -1, 0
    v_mbcnt_hi_u32_b32 v0, -1, v0
    v_lshl_add_u32 v0, s32, 6, v0
    s_mov_b64 s[4:5], s[78:79]
    s_mov_b64 s[6:7], s[84:85]
    s_mov_b64 s[8:9], s[80:81]
    v_and_b32 v0, 63, v0
    s_and_b32 s38, s2, 7
    s_lshr_b32 s39, s2, 3
    s_and_b32 s40, s38, 1
    s_and_b32 s33, s39, 7
    s_and_b32 s34, s38, 4
    s_lshl_b32 s34, s34, 1
    s_add_u32 s33, s33, s34
    s_and_b32 s34, s38, 2
    s_lshl_b32 s34, s34, 1
    s_lshr_b32 s39, s39, 3
    s_add_u32 s34, s34, s39
    s_mul_i32 s33, s33, 8
    s_mul_i32 s38, s32, 2
    s_add_u32 s33, s33, s38
    s_mul_i32 s38, s33, 114688
    s_mul_i32 s39, s40, 57344
    s_add_u32 s38, s38, s39
    v_lshlrev_b32 v1, 4, v0
    v_add_u32 v1, s38, v1
    v_add_u32 v2, 114688, v1
    s_mul_i32 s37, s32, 4096
    s_mul_i32 s38, s34, 917504
    s_add_u32 s38, s38, s37
    s_mul_i32 s39, s40, 458752
    s_add_u32 s38, s38, s39
    v_lshlrev_b32 v250, 4, v0
    v_add_u32 v250, s38, v250
    s_mov_b32 s35, 0
    s_mov_b32 s36, 0
    s_add_u32 s16, s6, 52428800
    s_addc_u32 s17, s7, 0
    s_mov_b32 s18, 7340032
    s_mov_b32 s19, 0x20000
    s_add_u32 s12, s6, 29360128
    s_addc_u32 s13, s7, 0
    s_mov_b32 s14, 14680064
    s_mov_b32 s15, 0x20000
    s_lshl_b32 s38, s34, 1
    s_add_u32 s38, s38, s40
    s_add_u32 s38, s38, 88
    s_lshl_b32 s38, s38, 8
    v_mov_b32 v38, s38
    v_mov_b32 v40, 2
    s_add_u32 s96, s84, 47513600
    s_addc_u32 s97, s85, 0
    s_mov_b32 s98, 32768
    s_mov_b32 s99, 0x20000
    s_mov_b32 s91, 0x80000
    s_nop 4
    s_cmp_lg_u32 s32, 0
    s_cbranch_scc1 L_g4_kernel_w_go
L_g4_kernel_w_poll:
    buffer_load_dword v39, v38, s[96:99], 0 offen sc1
    s_sub_u32 s91, s91, 1
    s_waitcnt vmcnt(0)
    v_cmp_le_u32 vcc, v40, v39
    s_nop 4
    s_cmp_eq_u64 vcc, -1
    s_cbranch_scc1 L_g4_kernel_w_go
    s_cmp_lg_u32 s91, 0
    s_cbranch_scc1 L_g4_kernel_w_poll
L_g4_kernel_w_go:
    s_nop 4
    s_barrier
    s_add_u32 m0, s37, 0
    s_nop 0
    buffer_load_dwordx4 v250, s[16:19], s36 offen sc1 lds
    buffer_load_dwordx4 v250, s[16:19], s36 offen offset:1024 sc1 lds
    buffer_load_dwordx4 v250, s[16:19], s36 offen offset:2048 sc1 lds
    buffer_load_dwordx4 v250, s[16:19], s36 offen offset:3072 sc1 lds
    s_add_u32 s36, s36, 16384
    s_add_u32 m0, s37, 16384
    s_nop 0
    buffer_load_dwordx4 v250, s[16:19], s36 offen sc1 lds
    buffer_load_dwordx4 v250, s[16:19], s36 offen offset:1024 sc1 lds
    buffer_load_dwordx4 v250, s[16:19], s36 offen offset:2048 sc1 lds
    buffer_load_dwordx4 v250, s[16:19], s36 offen offset:3072 sc1 lds
    s_add_u32 s36, s36, 16384
    s_add_u32 m0, s37, 32768
    s_nop 0
    buffer_load_dwordx4 v250, s[16:19], s36 offen sc1 lds
    buffer_load_dwordx4 v250, s[16:19], s36 offen offset:1024 sc1 lds
    buffer_load_dwordx4 v250, s[16:19], s36 offen offset:2048 sc1 lds
    buffer_load_dwordx4 v250, s[16:19], s36 offen offset:3072 sc1 lds
    s_add_u32 s36, s36, 16384
    s_add_u32 m0, s37, 49152
    s_nop 0
    buffer_load_dwordx4 v250, s[16:19], s36 offen sc1 lds
    buffer_load_dwordx4 v250, s[16:19], s36 offen offset:1024 sc1 lds
    buffer_load_dwordx4 v250, s[16:19], s36 offen offset:2048 sc1 lds
    buffer_load_dwordx4 v250, s[16:19], s36 offen offset:3072 sc1 lds
    s_add_u32 s36, s36, 16384
    s_add_u32 m0, s37, 65536
    s_nop 0
    buffer_load_dwordx4 v250, s[16:19], s36 offen sc1 lds
    buffer_load_dwordx4 v250, s[16:19], s36 offen offset:1024 sc1 lds
    buffer_load_dwordx4 v250, s[16:19], s36 offen offset:2048 sc1 lds
    buffer_load_dwordx4 v250, s[16:19], s36 offen offset:3072 sc1 lds
    s_add_u32 s36, s36, 16384
    v_lshlrev_b32 v3, 4, v0
    v_add_u32 v4, 65536, v3
    s_mov_b32 s44, 0xc0135761
    s_mov_b32 s46, 0xbdd2d3e8
    s_mov_b32 s48, 1.0
    v_mov_b32 v104, s44
    s_lshl_b32 s34, s34, 1
    s_add_u32 s34, s34, s40
    s_lshl_b32 s38, s33, 15
    s_lshl_b32 s39, s34, 11
    s_add_u32 s38, s38, s39
    v_lshlrev_b32 v109, 4, v0
    v_add_u32 v109, s38, v109
    v_add_u32 v110, 32768, v109
    s_mov_b32 s20, s8
    s_mov_b32 s21, s9
    s_mov_b32 s22, 4194304
    s_mov_b32 s23, 0x20000
    s_add_u32 s24, s6, 12582912
    s_addc_u32 s25, s7, 0
    s_mov_b32 s26, 4194304
    s_mov_b32 s27, 0x20000
    s_add_u32 s28, s6, 25165824
    s_addc_u32 s29, s7, 0
    s_mov_b32 s30, 4194304
    s_mov_b32 s31, 0x20000
    s_lshl_b32 s38, s2, 2
    s_add_u32 s38, s38, s32
    s_lshl_b32 s39, s38, 13
    v_lshlrev_b32 v106, 4, v0
    v_add_u32 v182, s39, v106
    v_xor_b32 v183, 0x8000, v182
    s_lshl_b32 s38, s2, 2
    s_add_u32 s38, s38, s32
    s_lshl_b32 s38, s38, 5
    v_mov_b32 v184, s38
    v_xor_b32 v185, 0x80, v184
    s_add_u32 s52, s6, 60817408
    s_addc_u32 s53, s7, 0
    s_mov_b32 s54, 8388608
    s_mov_b32 s55, 0x20000
    s_add_u32 s56, s6, 47448064
    s_addc_u32 s57, s7, 0
    s_mov_b32 s58, 32768
    s_mov_b32 s59, 0x20000
    s_lshl_b32 s38, s32, 12
    s_add_u32 s38, s38, 114688
    v_and_b32 v106, 15, v0
    v_lshlrev_b32 v107, 7, v106
    v_bfe_u32 v108, v0, 4, 1
    v_lshl_add_u32 v107, v108, 3, v107
    v_add_u32 v107, s38, v107
    v_and_b32 v106, 7, v106
    v_lshrrev_b32 v108, 5, v0
    v_xor_b32 v106, v106, v108
    v_xor_b32 v108, 0, v106
    v_lshl_add_u32 v177, v108, 4, v107
    v_xor_b32 v108, 2, v106
    v_lshl_add_u32 v178, v108, 4, v107
    v_xor_b32 v108, 4, v106
    v_lshl_add_u32 v179, v108, 4, v107
    v_xor_b32 v108, 6, v106
    v_lshl_add_u32 v180, v108, 4, v107
    v_lshrrev_b32 v106, 3, v0
    v_and_b32 v107, 7, v0
    v_xor_b32 v108, v106, v107
    v_lshlrev_b32 v108, 4, v108
    v_lshl_add_u32 v108, v106, 7, v108
    v_add_u32 v181, s38, v108
    s_lshl_b32 s38, s33, 15
    s_lshl_b32 s39, s34, 7
    s_add_u32 s38, s38, s39
    v_lshlrev_b32 v106, 11, v106
    v_lshl_add_u32 v106, v107, 4, v106
    v_add_u32 v176, s38, v106
    s_lshr_b32 s38, s33, 3
    s_lshr_b32 s38, s33, 4
    s_lshl_b32 s38, s38, 1
    s_add_u32 s38, s38, s40
    s_add_u32 s38, s38, 72
    s_lshl_b32 s38, s38, 8
    v_mov_b32 v38, s38
    v_mov_b32 v40, 14
    s_add_u32 s96, s84, 47513600
    s_addc_u32 s97, s85, 0
    s_mov_b32 s98, 32768
    s_mov_b32 s99, 0x20000
    s_cmp_eq_u32 s32, 0
    s_cselect_b32 s98, s98, 0
    buffer_load_dword v39, v38, s[96:99], 0 offen sc1
    s_add_u32 m0, s37, 81920
    s_nop 0
    buffer_load_dwordx4 v250, s[16:19], s36 offen sc1 lds
    buffer_load_dwordx4 v250, s[16:19], s36 offen offset:1024 sc1 lds
    buffer_load_dwordx4 v250, s[16:19], s36 offen offset:2048 sc1 lds
    buffer_load_dwordx4 v250, s[16:19], s36 offen offset:3072 sc1 lds
    s_add_u32 s36, s36, 16384
    s_add_u32 m0, s37, 98304
    s_nop 0
    buffer_load_dwordx4 v250, s[16:19], s36 offen sc1 lds
    buffer_load_dwordx4 v250, s[16:19], s36 offen offset:1024 sc1 lds
    buffer_load_dwordx4 v250, s[16:19], s36 offen offset:2048 sc1 lds
    buffer_load_dwordx4 v250, s[16:19], s36 offen offset:3072 sc1 lds
    s_add_u32 s36, s36, 16384
    s_waitcnt vmcnt(8)
    v_cmp_le_u32 vcc, v40, v39
    s_mov_b32 s91, 0x80000
    s_nop 4
    s_cmp_lg_u32 s32, 0
    s_cbranch_scc1 L_g4_kernel_go
    s_cmp_eq_u64 vcc, -1
    s_cbranch_scc1 L_g4_kernel_go
L_g4_kernel_poll:
    buffer_load_dword v39, v38, s[96:99], 0 offen sc1
    s_sub_u32 s91, s91, 1
    s_waitcnt vmcnt(0)
    v_cmp_le_u32 vcc, v40, v39
    s_nop 4
    s_cmp_eq_u64 vcc, -1
    s_cbranch_scc1 L_g4_kernel_go
    s_cmp_lg_u32 s91, 0
    s_cbranch_scc1 L_g4_kernel_poll
L_g4_kernel_go:
    s_nop 4
    s_barrier
    buffer_load_dwordx4 a[0:3], v1, s[12:15], s35 offen sc1
    buffer_load_dwordx4 a[4:7], v2, s[12:15], s35 offen sc1
    buffer_load_dwordx4 a[8:11], v1, s[12:15], s35 offen offset:1024 sc1
    buffer_load_dwordx4 a[12:15], v2, s[12:15], s35 offen offset:1024 sc1
    s_add_u32 s35, s35, 2048
    buffer_load_dwordx4 a[16:19], v1, s[12:15], s35 offen sc1
    buffer_load_dwordx4 a[20:23], v2, s[12:15], s35 offen sc1
    buffer_load_dwordx4 a[24:27], v1, s[12:15], s35 offen offset:1024 sc1
    buffer_load_dwordx4 a[28:31], v2, s[12:15], s35 offen offset:1024 sc1
    s_add_u32 s35, s35, 2048
    buffer_load_dwordx4 a[32:35], v1, s[12:15], s35 offen sc1
    buffer_load_dwordx4 a[36:39], v2, s[12:15], s35 offen sc1
    buffer_load_dwordx4 a[40:43], v1, s[12:15], s35 offen offset:1024 sc1
    buffer_load_dwordx4 a[44:47], v2, s[12:15], s35 offen offset:1024 sc1
    s_add_u32 s35, s35, 2048
    s_barrier
    ds_read_b128 v[6:9], v3 offset:0
    ds_read_b128 v[10:13], v3 offset:1024
    ds_read_b128 v[14:17], v3 offset:2048
    ds_read_b128 v[18:21], v3 offset:3072
    ds_read_b128 v[22:25], v3 offset:4096
    ds_read_b128 v[26:29], v3 offset:5120
    ds_read_b128 v[30:33], v3 offset:6144
    ds_read_b128 v[34:37], v3 offset:7168
    s_waitcnt vmcnt(11) lgkmcnt(7)
    v_mfma_f32_16x16x32_bf16 v[38:41], v[6:9], a[0:3], 0
    buffer_load_dwordx4 a[48:51], v1, s[12:15], s35 offen sc1
    s_waitcnt vmcnt(11)
    v_mfma_f32_16x16x32_bf16 v[70:73], v[6:9], a[4:7], 0
    ds_read_b128 v[6:9], v3 offset:8192
    s_waitcnt lgkmcnt(7)
    v_mfma_f32_16x16x32_bf16 v[42:45], v[10:13], a[0:3], 0
    buffer_load_dwordx4 a[52:55], v2, s[12:15], s35 offen sc1
    v_mfma_f32_16x16x32_bf16 v[74:77], v[10:13], a[4:7], 0
    ds_read_b128 v[10:13], v3 offset:9216
    s_waitcnt lgkmcnt(7)
    v_mfma_f32_16x16x32_bf16 v[46:49], v[14:17], a[0:3], 0
    buffer_load_dwordx4 a[56:59], v1, s[12:15], s35 offen offset:1024 sc1
    v_mfma_f32_16x16x32_bf16 v[78:81], v[14:17], a[4:7], 0
    ds_read_b128 v[14:17], v3 offset:10240
    s_waitcnt lgkmcnt(7)
    v_mfma_f32_16x16x32_bf16 v[50:53], v[18:21], a[0:3], 0
    buffer_load_dwordx4 a[60:63], v2, s[12:15], s35 offen offset:1024 sc1
    s_add_u32 s35, s35, 2048
    v_mfma_f32_16x16x32_bf16 v[82:85], v[18:21], a[4:7], 0
    ds_read_b128 v[18:21], v3 offset:11264
    s_waitcnt lgkmcnt(7)
    v_mfma_f32_16x16x32_bf16 v[54:57], v[22:25], a[0:3], 0
    v_mfma_f32_16x16x32_bf16 v[86:89], v[22:25], a[4:7], 0
    ds_read_b128 v[22:25], v3 offset:12288
    s_waitcnt lgkmcnt(7)
    v_mfma_f32_16x16x32_bf16 v[58:61], v[26:29], a[0:3], 0
    v_mfma_f32_16x16x32_bf16 v[90:93], v[26:29], a[4:7], 0
    ds_read_b128 v[26:29], v3 offset:13312
    s_waitcnt lgkmcnt(7)
    v_mfma_f32_16x16x32_bf16 v[62:65], v[30:33], a[0:3], 0
    v_mfma_f32_16x16x32_bf16 v[94:97], v[30:33], a[4:7], 0
    ds_read_b128 v[30:33], v3 offset:14336
    s_waitcnt lgkmcnt(7)
    v_mfma_f32_16x16x32_bf16 v[66:69], v[34:37], a[0:3], 0
    v_mfma_f32_16x16x32_bf16 v[98:101], v[34:37], a[4:7], 0
    ds_read_b128 v[34:37], v3 offset:15360
    s_barrier
    s_waitcnt vmcnt(13) lgkmcnt(7)
    v_mfma_f32_16x16x32_bf16 v[38:41], v[6:9], a[8:11], v[38:41]
    buffer_load_dwordx4 a[64:67], v1, s[12:15], s35 offen sc1
    s_waitcnt vmcnt(13)
    v_mfma_f32_16x16x32_bf16 v[70:73], v[6:9], a[12:15], v[70:73]
    ds_read_b128 v[6:9], v3 offset:16384
    s_waitcnt lgkmcnt(7)
    v_mfma_f32_16x16x32_bf16 v[42:45], v[10:13], a[8:11], v[42:45]
    buffer_load_dwordx4 a[68:71], v2, s[12:15], s35 offen sc1
    v_mfma_f32_16x16x32_bf16 v[74:77], v[10:13], a[12:15], v[74:77]
    ds_read_b128 v[10:13], v3 offset:17408
    s_waitcnt lgkmcnt(7)
    v_mfma_f32_16x16x32_bf16 v[46:49], v[14:17], a[8:11], v[46:49]
    buffer_load_dwordx4 a[72:75], v1, s[12:15], s35 offen offset:1024 sc1
    v_mfma_f32_16x16x32_bf16 v[78:81], v[14:17], a[12:15], v[78:81]
    ds_read_b128 v[14:17], v3 offset:18432
    s_waitcnt lgkmcnt(7)
    v_mfma_f32_16x16x32_bf16 v[50:53], v[18:21], a[8:11], v[50:53]
    buffer_load_dwordx4 a[76:79], v2, s[12:15], s35 offen offset:1024 sc1
    s_add_u32 s35, s35, 2048
    v_mfma_f32_16x16x32_bf16 v[82:85], v[18:21], a[12:15], v[82:85]
    ds_read_b128 v[18:21], v3 offset:19456
    s_waitcnt lgkmcnt(7)
    v_mfma_f32_16x16x32_bf16 v[54:57], v[22:25], a[8:11], v[54:57]
    v_mfma_f32_16x16x32_bf16 v[86:89], v[22:25], a[12:15], v[86:89]
    ds_read_b128 v[22:25], v3 offset:20480
    s_waitcnt lgkmcnt(7)
    v_mfma_f32_16x16x32_bf16 v[58:61], v[26:29], a[8:11], v[58:61]
    v_mfma_f32_16x16x32_bf16 v[90:93], v[26:29], a[12:15], v[90:93]
    ds_read_b128 v[26:29], v3 offset:21504
    s_waitcnt lgkmcnt(7)
    v_mfma_f32_16x16x32_bf16 v[62:65], v[30:33], a[8:11], v[62:65]
    v_mfma_f32_16x16x32_bf16 v[94:97], v[30:33], a[12:15], v[94:97]
    ds_read_b128 v[30:33], v3 offset:22528
    s_waitcnt lgkmcnt(7)
    v_mfma_f32_16x16x32_bf16 v[66:69], v[34:37], a[8:11], v[66:69]
    v_mfma_f32_16x16x32_bf16 v[98:101], v[34:37], a[12:15], v[98:101]
    ds_read_b128 v[34:37], v3 offset:23552
    s_waitcnt vmcnt(15) lgkmcnt(7)
    v_mfma_f32_16x16x32_bf16 v[38:41], v[6:9], a[16:19], v[38:41]
    buffer_load_dwordx4 a[80:83], v1, s[12:15], s35 offen sc1
    s_waitcnt vmcnt(15)
    v_mfma_f32_16x16x32_bf16 v[70:73], v[6:9], a[20:23], v[70:73]
    ds_read_b128 v[6:9], v3 offset:24576
    s_waitcnt lgkmcnt(7)
    v_mfma_f32_16x16x32_bf16 v[42:45], v[10:13], a[16:19], v[42:45]
    buffer_load_dwordx4 a[84:87], v2, s[12:15], s35 offen sc1
    v_mfma_f32_16x16x32_bf16 v[74:77], v[10:13], a[20:23], v[74:77]
    ds_read_b128 v[10:13], v3 offset:25600
    s_waitcnt lgkmcnt(7)
    v_mfma_f32_16x16x32_bf16 v[46:49], v[14:17], a[16:19], v[46:49]
    buffer_load_dwordx4 a[88:91], v1, s[12:15], s35 offen offset:1024 sc1
    v_mfma_f32_16x16x32_bf16 v[78:81], v[14:17], a[20:23], v[78:81]
    ds_read_b128 v[14:17], v3 offset:26624
    s_waitcnt lgkmcnt(7)
    v_mfma_f32_16x16x32_bf16 v[50:53], v[18:21], a[16:19], v[50:53]
    buffer_load_dwordx4 a[92:95], v2, s[12:15], s35 offen offset:1024 sc1
    s_add_u32 s35, s35, 2048
    v_mfma_f32_16x16x32_bf16 v[82:85], v[18:21], a[20:23], v[82:85]
    ds_read_b128 v[18:21], v3 offset:27648
    s_waitcnt lgkmcnt(7)
    v_mfma_f32_16x16x32_bf16 v[54:57], v[22:25], a[16:19], v[54:57]
    v_mfma_f32_16x16x32_bf16 v[86:89], v[22:25], a[20:23], v[86:89]
    ds_read_b128 v[22:25], v3 offset:28672
    s_waitcnt lgkmcnt(7)
    v_mfma_f32_16x16x32_bf16 v[58:61], v[26:29], a[16:19], v[58:61]
    v_mfma_f32_16x16x32_bf16 v[90:93], v[26:29], a[20:23], v[90:93]
    ds_read_b128 v[26:29], v3 offset:29696
    s_waitcnt lgkmcnt(7)
    v_mfma_f32_16x16x32_bf16 v[62:65], v[30:33], a[16:19], v[62:65]
    v_mfma_f32_16x16x32_bf16 v[94:97], v[30:33], a[20:23], v[94:97]
    ds_read_b128 v[30:33], v3 offset:30720
    s_waitcnt lgkmcnt(7)
    v_mfma_f32_16x16x32_bf16 v[66:69], v[34:37], a[16:19], v[66:69]
    v_mfma_f32_16x16x32_bf16 v[98:101], v[34:37], a[20:23], v[98:101]
    ds_read_b128 v[34:37], v3 offset:31744
    s_barrier
    s_waitcnt vmcnt(17) lgkmcnt(7)
    v_mfma_f32_16x16x32_bf16 v[38:41], v[6:9], a[24:27], v[38:41]
    s_add_u32 m0, s37, 0
    s_nop 0
    buffer_load_dwordx4 v250, s[16:19], s36 offen sc1 lds
    s_waitcnt vmcnt(17)
    v_mfma_f32_16x16x32_bf16 v[70:73], v[6:9], a[28:31], v[70:73]
    ds_read_b128 v[6:9], v3 offset:32768
    s_waitcnt lgkmcnt(7)
    v_mfma_f32_16x16x32_bf16 v[42:45], v[10:13], a[24:27], v[42:45]
    buffer_load_dwordx4 v250, s[16:19], s36 offen offset:1024 sc1 lds
    v_mfma_f32_16x16x32_bf16 v[74:77], v[10:13], a[28:31], v[74:77]
    ds_read_b128 v[10:13], v3 offset:33792
    s_waitcnt lgkmcnt(7)
    v_mfma_f32_16x16x32_bf16 v[46:49], v[14:17], a[24:27], v[46:49]
    buffer_load_dwordx4 v250, s[16:19], s36 offen offset:2048 sc1 lds
    v_mfma_f32_16x16x32_bf16 v[78:81], v[14:17], a[28:31], v[78:81]
    ds_read_b128 v[14:17], v3 offset:34816
    s_waitcnt lgkmcnt(7)
    v_mfma_f32_16x16x32_bf16 v[50:53], v[18:21], a[24:27], v[50:53]
    buffer_load_dwordx4 v250, s[16:19], s36 offen offset:3072 sc1 lds
    s_add_u32 s36, s36, 16384
    v_mfma_f32_16x16x32_bf16 v[82:85], v[18:21], a[28:31], v[82:85]
    ds_read_b128 v[18:21], v3 offset:35840
    s_waitcnt lgkmcnt(7)
    v_mfma_f32_16x16x32_bf16 v[54:57], v[22:25], a[24:27], v[54:57]
    buffer_load_dwordx4 a[96:99], v1, s[12:15], s35 offen sc1
    v_mfma_f32_16x16x32_bf16 v[86:89], v[22:25], a[28:31], v[86:89]
    ds_read_b128 v[22:25], v3 offset:36864
    s_waitcnt lgkmcnt(7)
    v_mfma_f32_16x16x32_bf16 v[58:61], v[26:29], a[24:27], v[58:61]
    buffer_load_dwordx4 a[100:103], v2, s[12:15], s35 offen sc1
    v_mfma_f32_16x16x32_bf16 v[90:93], v[26:29], a[28:31], v[90:93]
    ds_read_b128 v[26:29], v3 offset:37888
    s_waitcnt lgkmcnt(7)
    v_mfma_f32_16x16x32_bf16 v[62:65], v[30:33], a[24:27], v[62:65]
    buffer_load_dwordx4 a[104:107], v1, s[12:15], s35 offen offset:1024 sc1
    v_mfma_f32_16x16x32_bf16 v[94:97], v[30:33], a[28:31], v[94:97]
    ds_read_b128 v[30:33], v3 offset:38912
    s_waitcnt lgkmcnt(7)
    v_mfma_f32_16x16x32_bf16 v[66:69], v[34:37], a[24:27], v[66:69]
    buffer_load_dwordx4 a[108:111], v2, s[12:15], s35 offen offset:1024 sc1
    s_add_u32 s35, s35, 2048
    v_mfma_f32_16x16x32_bf16 v[98:101], v[34:37], a[28:31], v[98:101]
    ds_read_b128 v[34:37], v3 offset:39936
    s_waitcnt vmcnt(23) lgkmcnt(7)
    v_mfma_f32_16x16x32_bf16 v[38:41], v[6:9], a[32:35], v[38:41]
    buffer_load_dwordx4 a[0:3], v1, s[12:15], s35 offen sc1
    s_waitcnt vmcnt(23)
    v_mfma_f32_16x16x32_bf16 v[70:73], v[6:9], a[36:39], v[70:73]
    ds_read_b128 v[6:9], v3 offset:40960
    s_waitcnt lgkmcnt(7)
    v_mfma_f32_16x16x32_bf16 v[42:45], v[10:13], a[32:35], v[42:45]
    buffer_load_dwordx4 a[4:7], v2, s[12:15], s35 offen sc1
    v_mfma_f32_16x16x32_bf16 v[74:77], v[10:13], a[36:39], v[74:77]
    ds_read_b128 v[10:13], v3 offset:41984
    s_waitcnt lgkmcnt(7)
    v_mfma_f32_16x16x32_bf16 v[46:49], v[14:17], a[32:35], v[46:49]
    buffer_load_dwordx4 a[8:11], v1, s[12:15], s35 offen offset:1024 sc1
    v_mfma_f32_16x16x32_bf16 v[78:81], v[14:17], a[36:39], v[78:81]
    ds_read_b128 v[14:17], v3 offset:43008
    s_waitcnt lgkmcnt(7)
    v_mfma_f32_16x16x32_bf16 v[50:53], v[18:21], a[32:35], v[50:53]
    buffer_load_dwordx4 a[12:15], v2, s[12:15], s35 offen offset:1024 sc1
    s_add_u32 s35, s35, 2048
    v_mfma_f32_16x16x32_bf16 v[82:85], v[18:21], a[36:39], v[82:85]
    ds_read_b128 v[18:21], v3 offset:44032
    s_waitcnt lgkmcnt(7)
    v_mfma_f32_16x16x32_bf16 v[54:57], v[22:25], a[32:35], v[54:57]
    v_mfma_f32_16x16x32_bf16 v[86:89], v[22:25], a[36:39], v[86:89]
    ds_read_b128 v[22:25], v3 offset:45056
    s_waitcnt lgkmcnt(7)
    v_mfma_f32_16x16x32_bf16 v[58:61], v[26:29], a[32:35], v[58:61]
    v_mfma_f32_16x16x32_bf16 v[90:93], v[26:29], a[36:39], v[90:93]
    ds_read_b128 v[26:29], v3 offset:46080
    s_waitcnt lgkmcnt(7)
    v_mfma_f32_16x16x32_bf16 v[62:65], v[30:33], a[32:35], v[62:65]
    v_mfma_f32_16x16x32_bf16 v[94:97], v[30:33], a[36:39], v[94:97]
    ds_read_b128 v[30:33], v3 offset:47104
    s_waitcnt lgkmcnt(7)
    v_mfma_f32_16x16x32_bf16 v[66:69], v[34:37], a[32:35], v[66:69]
    v_mfma_f32_16x16x32_bf16 v[98:101], v[34:37], a[36:39], v[98:101]
    ds_read_b128 v[34:37], v3 offset:48128
    s_barrier
    s_waitcnt vmcnt(25) lgkmcnt(7)
    v_mfma_f32_16x16x32_bf16 v[38:41], v[6:9], a[40:43], v[38:41]
    s_add_u32 m0, s37, 16384
    s_nop 0
    buffer_load_dwordx4 v250, s[16:19], s36 offen sc1 lds
    s_waitcnt vmcnt(25)
    v_mfma_f32_16x16x32_bf16 v[70:73], v[6:9], a[44:47], v[70:73]
    ds_read_b128 v[6:9], v3 offset:49152
    s_waitcnt lgkmcnt(7)
    v_mfma_f32_16x16x32_bf16 v[42:45], v[10:13], a[40:43], v[42:45]
    buffer_load_dwordx4 v250, s[16:19], s36 offen offset:1024 sc1 lds
    v_mfma_f32_16x16x32_bf16 v[74:77], v[10:13], a[44:47], v[74:77]
    ds_read_b128 v[10:13], v3 offset:50176
    s_waitcnt lgkmcnt(7)
    v_mfma_f32_16x16x32_bf16 v[46:49], v[14:17], a[40:43], v[46:49]
    buffer_load_dwordx4 v250, s[16:19], s36 offen offset:2048 sc1 lds
    v_mfma_f32_16x16x32_bf16 v[78:81], v[14:17], a[44:47], v[78:81]
    ds_read_b128 v[14:17], v3 offset:51200
    s_waitcnt lgkmcnt(7)
    v_mfma_f32_16x16x32_bf16 v[50:53], v[18:21], a[40:43], v[50:53]
    buffer_load_dwordx4 v250, s[16:19], s36 offen offset:3072 sc1 lds
    s_add_u32 s36, s36, 16384
    v_mfma_f32_16x16x32_bf16 v[82:85], v[18:21], a[44:47], v[82:85]
    ds_read_b128 v[18:21], v3 offset:52224
    s_waitcnt lgkmcnt(7)
    v_mfma_f32_16x16x32_bf16 v[54:57], v[22:25], a[40:43], v[54:57]
    buffer_load_dwordx4 a[16:19], v1, s[12:15], s35 offen sc1
    v_mfma_f32_16x16x32_bf16 v[86:89], v[22:25], a[44:47], v[86:89]
    ds_read_b128 v[22:25], v3 offset:53248
    s_waitcnt lgkmcnt(7)
    v_mfma_f32_16x16x32_bf16 v[58:61], v[26:29], a[40:43], v[58:61]
    buffer_load_dwordx4 a[20:23], v2, s[12:15], s35 offen sc1
    v_mfma_f32_16x16x32_bf16 v[90:93], v[26:29], a[44:47], v[90:93]
    ds_read_b128 v[26:29], v3 offset:54272
    s_waitcnt lgkmcnt(7)
    v_mfma_f32_16x16x32_bf16 v[62:65], v[30:33], a[40:43], v[62:65]
    buffer_load_dwordx4 a[24:27], v1, s[12:15], s35 offen offset:1024 sc1
    v_mfma_f32_16x16x32_bf16 v[94:97], v[30:33], a[44:47], v[94:97]
    ds_read_b128 v[30:33], v3 offset:55296
    s_waitcnt lgkmcnt(7)
    v_mfma_f32_16x16x32_bf16 v[66:69], v[34:37], a[40:43], v[66:69]
    buffer_load_dwordx4 a[28:31], v2, s[12:15], s35 offen offset:1024 sc1
    s_add_u32 s35, s35, 2048
    v_mfma_f32_16x16x32_bf16 v[98:101], v[34:37], a[44:47], v[98:101]
    ds_read_b128 v[34:37], v3 offset:56320
    s_waitcnt vmcnt(31) lgkmcnt(7)
    v_mfma_f32_16x16x32_bf16 v[38:41], v[6:9], a[48:51], v[38:41]
    buffer_load_dwordx4 a[32:35], v1, s[12:15], s35 offen sc1
    s_waitcnt vmcnt(31)
    v_mfma_f32_16x16x32_bf16 v[70:73], v[6:9], a[52:55], v[70:73]
    ds_read_b128 v[6:9], v3 offset:57344
    s_waitcnt lgkmcnt(7)
    v_mfma_f32_16x16x32_bf16 v[42:45], v[10:13], a[48:51], v[42:45]
    buffer_load_dwordx4 a[36:39], v2, s[12:15], s35 offen sc1
    v_mfma_f32_16x16x32_bf16 v[74:77], v[10:13], a[52:55], v[74:77]
    ds_read_b128 v[10:13], v3 offset:58368
    s_waitcnt lgkmcnt(7)
    v_mfma_f32_16x16x32_bf16 v[46:49], v[14:17], a[48:51], v[46:49]
    buffer_load_dwordx4 a[40:43], v1, s[12:15], s35 offen offset:1024 sc1
    v_mfma_f32_16x16x32_bf16 v[78:81], v[14:17], a[52:55], v[78:81]
    ds_read_b128 v[14:17], v3 offset:59392
    s_waitcnt lgkmcnt(7)
    v_mfma_f32_16x16x32_bf16 v[50:53], v[18:21], a[48:51], v[50:53]
    buffer_load_dwordx4 a[44:47], v2, s[12:15], s35 offen offset:1024 sc1
    s_add_u32 s35, s35, 2048
    v_mfma_f32_16x16x32_bf16 v[82:85], v[18:21], a[52:55], v[82:85]
    ds_read_b128 v[18:21], v3 offset:60416
    s_waitcnt lgkmcnt(7)
    v_mfma_f32_16x16x32_bf16 v[54:57], v[22:25], a[48:51], v[54:57]
    v_mfma_f32_16x16x32_bf16 v[86:89], v[22:25], a[52:55], v[86:89]
    ds_read_b128 v[22:25], v3 offset:61440
    s_waitcnt lgkmcnt(7)
    v_mfma_f32_16x16x32_bf16 v[58:61], v[26:29], a[48:51], v[58:61]
    v_mfma_f32_16x16x32_bf16 v[90:93], v[26:29], a[52:55], v[90:93]
    ds_read_b128 v[26:29], v3 offset:62464
    s_waitcnt lgkmcnt(7)
    v_mfma_f32_16x16x32_bf16 v[62:65], v[30:33], a[48:51], v[62:65]
    v_mfma_f32_16x16x32_bf16 v[94:97], v[30:33], a[52:55], v[94:97]
    ds_read_b128 v[30:33], v3 offset:63488
    s_waitcnt lgkmcnt(7)
    v_mfma_f32_16x16x32_bf16 v[66:69], v[34:37], a[48:51], v[66:69]
    v_mfma_f32_16x16x32_bf16 v[98:101], v[34:37], a[52:55], v[98:101]
    ds_read_b128 v[34:37], v3 offset:64512
    s_barrier
    s_waitcnt vmcnt(33) lgkmcnt(7)
    v_mfma_f32_16x16x32_bf16 v[38:41], v[6:9], a[56:59], v[38:41]
    s_add_u32 m0, s37, 32768
    s_nop 0
    buffer_load_dwordx4 v250, s[16:19], s36 offen sc1 lds
    s_waitcnt vmcnt(33)
    v_mfma_f32_16x16x32_bf16 v[70:73], v[6:9], a[60:63], v[70:73]
    ds_read_b128 v[6:9], v4 offset:0
    s_waitcnt lgkmcnt(7)
    v_mfma_f32_16x16x32_bf16 v[42:45], v[10:13], a[56:59], v[42:45]
    buffer_load_dwordx4 v250, s[16:19], s36 offen offset:1024 sc1 lds
    v_mfma_f32_16x16x32_bf16 v[74:77], v[10:13], a[60:63], v[74:77]
    ds_read_b128 v[10:13], v4 offset:1024
    s_waitcnt lgkmcnt(7)
    v_mfma_f32_16x16x32_bf16 v[46:49], v[14:17], a[56:59], v[46:49]
    buffer_load_dwordx4 v250, s[16:19], s36 offen offset:2048 sc1 lds
    v_mfma_f32_16x16x32_bf16 v[78:81], v[14:17], a[60:63], v[78:81]
    ds_read_b128 v[14:17], v4 offset:2048
    s_waitcnt lgkmcnt(7)
    v_mfma_f32_16x16x32_bf16 v[50:53], v[18:21], a[56:59], v[50:53]
    buffer_load_dwordx4 v250, s[16:19], s36 offen offset:3072 sc1 lds
    s_add_u32 s36, s36, 16384
    v_mfma_f32_16x16x32_bf16 v[82:85], v[18:21], a[60:63], v[82:85]
    ds_read_b128 v[18:21], v4 offset:3072
    s_waitcnt lgkmcnt(7)
    v_mfma_f32_16x16x32_bf16 v[54:57], v[22:25], a[56:59], v[54:57]
    buffer_load_dwordx4 a[48:51], v1, s[12:15], s35 offen sc1
    v_mfma_f32_16x16x32_bf16 v[86:89], v[22:25], a[60:63], v[86:89]
    ds_read_b128 v[22:25], v4 offset:4096
    s_waitcnt lgkmcnt(7)
    v_mfma_f32_16x16x32_bf16 v[58:61], v[26:29], a[56:59], v[58:61]
    buffer_load_dwordx4 a[52:55], v2, s[12:15], s35 offen sc1
    v_mfma_f32_16x16x32_bf16 v[90:93], v[26:29], a[60:63], v[90:93]
    ds_read_b128 v[26:29], v4 offset:5120
    s_waitcnt lgkmcnt(7)
    v_mfma_f32_16x16x32_bf16 v[62:65], v[30:33], a[56:59], v[62:65]
    v_mfma_f32_16x16x32_bf16 v[94:97], v[30:33], a[60:63], v[94:97]
    ds_read_b128 v[30:33], v4 offset:6144
    s_waitcnt lgkmcnt(7)
    v_mfma_f32_16x16x32_bf16 v[66:69], v[34:37], a[56:59], v[66:69]
    v_mfma_f32_16x16x32_bf16 v[98:101], v[34:37], a[60:63], v[98:101]
    ds_read_b128 v[34:37], v4 offset:7168
    s_waitcnt vmcnt(37) lgkmcnt(7)
    v_mfma_f32_16x16x32_bf16 v[38:41], v[6:9], a[64:67], v[38:41]
    buffer_load_dwordx4 a[56:59], v1, s[12:15], s35 offen offset:1024 sc1
    s_waitcnt vmcnt(37)
    v_mfma_f32_16x16x32_bf16 v[70:73], v[6:9], a[68:71], v[70:73]
    ds_read_b128 v[6:9], v4 offset:8192
    s_waitcnt lgkmcnt(7)
    v_mfma_f32_16x16x32_bf16 v[42:45], v[10:13], a[64:67], v[42:45]
    buffer_load_dwordx4 a[60:63], v2, s[12:15], s35 offen offset:1024 sc1
    s_add_u32 s35, s35, 2048
    v_mfma_f32_16x16x32_bf16 v[74:77], v[10:13], a[68:71], v[74:77]
    ds_read_b128 v[10:13], v4 offset:9216
    s_waitcnt lgkmcnt(7)
    v_mfma_f32_16x16x32_bf16 v[46:49], v[14:17], a[64:67], v[46:49]
    v_mfma_f32_16x16x32_bf16 v[78:81], v[14:17], a[68:71], v[78:81]
    ds_read_b128 v[14:17], v4 offset:10240
    s_waitcnt lgkmcnt(7)
    v_mfma_f32_16x16x32_bf16 v[50:53], v[18:21], a[64:67], v[50:53]
    v_mfma_f32_16x16x32_bf16 v[82:85], v[18:21], a[68:71], v[82:85]
    ds_read_b128 v[18:21], v4 offset:11264
    s_waitcnt lgkmcnt(7)
    v_mfma_f32_16x16x32_bf16 v[54:57], v[22:25], a[64:67], v[54:57]
    v_mfma_f32_16x16x32_bf16 v[86:89], v[22:25], a[68:71], v[86:89]
    ds_read_b128 v[22:25], v4 offset:12288
    s_waitcnt lgkmcnt(7)
    v_mfma_f32_16x16x32_bf16 v[58:61], v[26:29], a[64:67], v[58:61]
    v_mfma_f32_16x16x32_bf16 v[90:93], v[26:29], a[68:71], v[90:93]
    ds_read_b128 v[26:29], v4 offset:13312
    s_waitcnt lgkmcnt(7)
    v_mfma_f32_16x16x32_bf16 v[62:65], v[30:33], a[64:67], v[62:65]
    v_mfma_f32_16x16x32_bf16 v[94:97], v[30:33], a[68:71], v[94:97]
    ds_read_b128 v[30:33], v4 offset:14336
    s_waitcnt lgkmcnt(7)
    v_mfma_f32_16x16x32_bf16 v[66:69], v[34:37], a[64:67], v[66:69]
    v_mfma_f32_16x16x32_bf16 v[98:101], v[34:37], a[68:71], v[98:101]
    ds_read_b128 v[34:37], v4 offset:15360
    s_barrier
    s_waitcnt vmcnt(37) lgkmcnt(7)
    v_mfma_f32_16x16x32_bf16 v[38:41], v[6:9], a[72:75], v[38:41]
    s_add_u32 m0, s37, 49152
    s_nop 0
    buffer_load_dwordx4 v250, s[16:19], s36 offen sc1 lds
    s_waitcnt vmcnt(37)
    v_mfma_f32_16x16x32_bf16 v[70:73], v[6:9], a[76:79], v[70:73]
    ds_read_b128 v[6:9], v4 offset:16384
    s_waitcnt lgkmcnt(7)
    v_mfma_f32_16x16x32_bf16 v[42:45], v[10:13], a[72:75], v[42:45]
    buffer_load_dwordx4 v250, s[16:19], s36 offen offset:1024 sc1 lds
    v_mfma_f32_16x16x32_bf16 v[74:77], v[10:13], a[76:79], v[74:77]
    ds_read_b128 v[10:13], v4 offset:17408
    s_waitcnt lgkmcnt(7)
    v_mfma_f32_16x16x32_bf16 v[46:49], v[14:17], a[72:75], v[46:49]
    buffer_load_dwordx4 v250, s[16:19], s36 offen offset:2048 sc1 lds
    v_mfma_f32_16x16x32_bf16 v[78:81], v[14:17], a[76:79], v[78:81]
    ds_read_b128 v[14:17], v4 offset:18432
    s_waitcnt lgkmcnt(7)
    v_mfma_f32_16x16x32_bf16 v[50:53], v[18:21], a[72:75], v[50:53]
    buffer_load_dwordx4 v250, s[16:19], s36 offen offset:3072 sc1 lds
    s_add_u32 s36, s36, 16384
    v_mfma_f32_16x16x32_bf16 v[82:85], v[18:21], a[76:79], v[82:85]
    ds_read_b128 v[18:21], v4 offset:19456
    s_waitcnt lgkmcnt(7)
    v_mfma_f32_16x16x32_bf16 v[54:57], v[22:25], a[72:75], v[54:57]
    buffer_load_dwordx4 a[64:67], v1, s[12:15], s35 offen sc1
    v_mfma_f32_16x16x32_bf16 v[86:89], v[22:25], a[76:79], v[86:89]
    ds_read_b128 v[22:25], v4 offset:20480
    s_waitcnt lgkmcnt(7)
    v_mfma_f32_16x16x32_bf16 v[58:61], v[26:29], a[72:75], v[58:61]
    buffer_load_dwordx4 a[68:71], v2, s[12:15], s35 offen sc1
    v_mfma_f32_16x16x32_bf16 v[90:93], v[26:29], a[76:79], v[90:93]
    ds_read_b128 v[26:29], v4 offset:21504
    s_waitcnt lgkmcnt(7)
    v_mfma_f32_16x16x32_bf16 v[62:65], v[30:33], a[72:75], v[62:65]
    v_mfma_f32_16x16x32_bf16 v[94:97], v[30:33], a[76:79], v[94:97]
    ds_read_b128 v[30:33], v4 offset:22528
    s_waitcnt lgkmcnt(7)
    v_mfma_f32_16x16x32_bf16 v[66:69], v[34:37], a[72:75], v[66:69]
    v_mfma_f32_16x16x32_bf16 v[98:101], v[34:37], a[76:79], v[98:101]
    ds_read_b128 v[34:37], v4 offset:23552
    s_waitcnt vmcnt(41) lgkmcnt(7)
    v_mfma_f32_16x16x32_bf16 v[38:41], v[6:9], a[80:83], v[38:41]
    buffer_load_dwordx4 a[72:75], v1, s[12:15], s35 offen offset:1024 sc1
    s_waitcnt vmcnt(41)
    v_mfma_f32_16x16x32_bf16 v[70:73], v[6:9], a[84:87], v[70:73]
    ds_read_b128 v[6:9], v4 offset:24576
    s_waitcnt lgkmcnt(7)
    v_mfma_f32_16x16x32_bf16 v[42:45], v[10:13], a[80:83], v[42:45]
    buffer_load_dwordx4 a[76:79], v2, s[12:15], s35 offen offset:1024 sc1
    s_add_u32 s35, s35, 2048
    v_mfma_f32_16x16x32_bf16 v[74:77], v[10:13], a[84:87], v[74:77]
    ds_read_b128 v[10:13], v4 offset:25600
    s_waitcnt lgkmcnt(7)
    v_mfma_f32_16x16x32_bf16 v[46:49], v[14:17], a[80:83], v[46:49]
    v_mfma_f32_16x16x32_bf16 v[78:81], v[14:17], a[84:87], v[78:81]
    ds_read_b128 v[14:17], v4 offset:26624
    s_waitcnt lgkmcnt(7)
    v_mfma_f32_16x16x32_bf16 v[50:53], v[18:21], a[80:83], v[50:53]
    v_mfma_f32_16x16x32_bf16 v[82:85], v[18:21], a[84:87], v[82:85]
    ds_read_b128 v[18:21], v4 offset:27648
    s_waitcnt lgkmcnt(7)
    v_mfma_f32_16x16x32_bf16 v[54:57], v[22:25], a[80:83], v[54:57]
    v_mfma_f32_16x16x32_bf16 v[86:89], v[22:25], a[84:87], v[86:89]
    ds_read_b128 v[22:25], v4 offset:28672
    s_waitcnt lgkmcnt(7)
    v_mfma_f32_16x16x32_bf16 v[58:61], v[26:29], a[80:83], v[58:61]
    v_mfma_f32_16x16x32_bf16 v[90:93], v[26:29], a[84:87], v[90:93]
    ds_read_b128 v[26:29], v4 offset:29696
    s_waitcnt lgkmcnt(7)
    v_mfma_f32_16x16x32_bf16 v[62:65], v[30:33], a[80:83], v[62:65]
    v_mfma_f32_16x16x32_bf16 v[94:97], v[30:33], a[84:87], v[94:97]
    ds_read_b128 v[30:33], v4 offset:30720
    s_waitcnt lgkmcnt(7)
    v_mfma_f32_16x16x32_bf16 v[66:69], v[34:37], a[80:83], v[66:69]
    v_mfma_f32_16x16x32_bf16 v[98:101], v[34:37], a[84:87], v[98:101]
    ds_read_b128 v[34:37], v4 offset:31744
    s_barrier
    s_waitcnt vmcnt(41) lgkmcnt(7)
    v_mfma_f32_16x16x32_bf16 v[38:41], v[6:9], a[88:91], v[38:41]
    s_add_u32 m0, s37, 65536
    s_nop 0
    buffer_load_dwordx4 v250, s[16:19], s36 offen sc1 lds
    s_waitcnt vmcnt(41)
    v_mfma_f32_16x16x32_bf16 v[70:73], v[6:9], a[92:95], v[70:73]
    ds_read_b128 v[6:9], v4 offset:32768
    s_waitcnt lgkmcnt(7)
    v_mfma_f32_16x16x32_bf16 v[42:45], v[10:13], a[88:91], v[42:45]
    buffer_load_dwordx4 v250, s[16:19], s36 offen offset:1024 sc1 lds
    v_mfma_f32_16x16x32_bf16 v[74:77], v[10:13], a[92:95], v[74:77]
    ds_read_b128 v[10:13], v4 offset:33792
    s_waitcnt lgkmcnt(7)
    v_mfma_f32_16x16x32_bf16 v[46:49], v[14:17], a[88:91], v[46:49]
    buffer_load_dwordx4 v250, s[16:19], s36 offen offset:2048 sc1 lds
    v_mfma_f32_16x16x32_bf16 v[78:81], v[14:17], a[92:95], v[78:81]
    ds_read_b128 v[14:17], v4 offset:34816
    s_waitcnt lgkmcnt(7)
    v_mfma_f32_16x16x32_bf16 v[50:53], v[18:21], a[88:91], v[50:53]
    buffer_load_dwordx4 v250, s[16:19], s36 offen offset:3072 sc1 lds
    s_add_u32 s36, s36, 16384
    v_mfma_f32_16x16x32_bf16 v[82:85], v[18:21], a[92:95], v[82:85]
    ds_read_b128 v[18:21], v4 offset:35840
    s_waitcnt lgkmcnt(7)
    v_mfma_f32_16x16x32_bf16 v[54:57], v[22:25], a[88:91], v[54:57]
    buffer_load_dwordx4 a[80:83], v1, s[12:15], s35 offen sc1
    v_mfma_f32_16x16x32_bf16 v[86:89], v[22:25], a[92:95], v[86:89]
    ds_read_b128 v[22:25], v4 offset:36864
    s_waitcnt lgkmcnt(7)
    v_mfma_f32_16x16x32_bf16 v[58:61], v[26:29], a[88:91], v[58:61]
    buffer_load_dwordx4 a[84:87], v2, s[12:15], s35 offen sc1
    v_mfma_f32_16x16x32_bf16 v[90:93], v[26:29], a[92:95], v[90:93]
    ds_read_b128 v[26:29], v4 offset:37888
    s_waitcnt lgkmcnt(7)
    v_mfma_f32_16x16x32_bf16 v[62:65], v[30:33], a[88:91], v[62:65]
    v_mfma_f32_16x16x32_bf16 v[94:97], v[30:33], a[92:95], v[94:97]
    ds_read_b128 v[30:33], v4 offset:38912
    s_waitcnt lgkmcnt(7)
    v_mfma_f32_16x16x32_bf16 v[66:69], v[34:37], a[88:91], v[66:69]
    v_mfma_f32_16x16x32_bf16 v[98:101], v[34:37], a[92:95], v[98:101]
    ds_read_b128 v[34:37], v4 offset:39936
    s_waitcnt vmcnt(41) lgkmcnt(7)
    v_mfma_f32_16x16x32_bf16 v[38:41], v[6:9], a[96:99], v[38:41]
    buffer_load_dwordx4 a[88:91], v1, s[12:15], s35 offen offset:1024 sc1
    s_waitcnt vmcnt(41)
    v_mfma_f32_16x16x32_bf16 v[70:73], v[6:9], a[100:103], v[70:73]
    ds_read_b128 v[6:9], v4 offset:40960
    s_waitcnt lgkmcnt(7)
    v_mfma_f32_16x16x32_bf16 v[42:45], v[10:13], a[96:99], v[42:45]
    buffer_load_dwordx4 a[92:95], v2, s[12:15], s35 offen offset:1024 sc1
    s_add_u32 s35, s35, 2048
    v_mfma_f32_16x16x32_bf16 v[74:77], v[10:13], a[100:103], v[74:77]
    ds_read_b128 v[10:13], v4 offset:41984
    s_waitcnt lgkmcnt(7)
    v_mfma_f32_16x16x32_bf16 v[46:49], v[14:17], a[96:99], v[46:49]
    v_mfma_f32_16x16x32_bf16 v[78:81], v[14:17], a[100:103], v[78:81]
    ds_read_b128 v[14:17], v4 offset:43008
    s_waitcnt lgkmcnt(7)
    v_mfma_f32_16x16x32_bf16 v[50:53], v[18:21], a[96:99], v[50:53]
    v_mfma_f32_16x16x32_bf16 v[82:85], v[18:21], a[100:103], v[82:85]
    ds_read_b128 v[18:21], v4 offset:44032
    s_waitcnt lgkmcnt(7)
    v_mfma_f32_16x16x32_bf16 v[54:57], v[22:25], a[96:99], v[54:57]
    v_mfma_f32_16x16x32_bf16 v[86:89], v[22:25], a[100:103], v[86:89]
    ds_read_b128 v[22:25], v4 offset:45056
    s_waitcnt lgkmcnt(7)
    v_mfma_f32_16x16x32_bf16 v[58:61], v[26:29], a[96:99], v[58:61]
    v_mfma_f32_16x16x32_bf16 v[90:93], v[26:29], a[100:103], v[90:93]
    ds_read_b128 v[26:29], v4 offset:46080
    s_waitcnt lgkmcnt(7)
    v_mfma_f32_16x16x32_bf16 v[62:65], v[30:33], a[96:99], v[62:65]
    v_mfma_f32_16x16x32_bf16 v[94:97], v[30:33], a[100:103], v[94:97]
    ds_read_b128 v[30:33], v4 offset:47104
    s_waitcnt lgkmcnt(7)
    v_mfma_f32_16x16x32_bf16 v[66:69], v[34:37], a[96:99], v[66:69]
    v_mfma_f32_16x16x32_bf16 v[98:101], v[34:37], a[100:103], v[98:101]
    ds_read_b128 v[34:37], v4 offset:48128
    s_barrier
    s_waitcnt vmcnt(41) lgkmcnt(7)
    v_mfma_f32_16x16x32_bf16 v[38:41], v[6:9], a[104:107], v[38:41]
    s_add_u32 m0, s37, 81920
    s_nop 0
    buffer_load_dwordx4 v250, s[16:19], s36 offen sc1 lds
    s_waitcnt vmcnt(41)
    v_mfma_f32_16x16x32_bf16 v[70:73], v[6:9], a[108:111], v[70:73]
    ds_read_b128 v[6:9], v3 offset:0
    s_waitcnt lgkmcnt(7)
    v_mfma_f32_16x16x32_bf16 v[42:45], v[10:13], a[104:107], v[42:45]
    buffer_load_dwordx4 v250, s[16:19], s36 offen offset:1024 sc1 lds
    v_mfma_f32_16x16x32_bf16 v[74:77], v[10:13], a[108:111], v[74:77]
    ds_read_b128 v[10:13], v3 offset:1024
    s_waitcnt lgkmcnt(7)
    v_mfma_f32_16x16x32_bf16 v[46:49], v[14:17], a[104:107], v[46:49]
    buffer_load_dwordx4 v250, s[16:19], s36 offen offset:2048 sc1 lds
    v_mfma_f32_16x16x32_bf16 v[78:81], v[14:17], a[108:111], v[78:81]
    ds_read_b128 v[14:17], v3 offset:2048
    s_waitcnt lgkmcnt(7)
    v_mfma_f32_16x16x32_bf16 v[50:53], v[18:21], a[104:107], v[50:53]
    buffer_load_dwordx4 v250, s[16:19], s36 offen offset:3072 sc1 lds
    s_add_u32 s36, s36, 16384
    v_mfma_f32_16x16x32_bf16 v[82:85], v[18:21], a[108:111], v[82:85]
    ds_read_b128 v[18:21], v3 offset:3072
    s_waitcnt lgkmcnt(7)
    v_mfma_f32_16x16x32_bf16 v[54:57], v[22:25], a[104:107], v[54:57]
    buffer_load_dwordx4 a[96:99], v1, s[12:15], s35 offen sc1
    v_mfma_f32_16x16x32_bf16 v[86:89], v[22:25], a[108:111], v[86:89]
    ds_read_b128 v[22:25], v3 offset:4096
    s_waitcnt lgkmcnt(7)
    v_mfma_f32_16x16x32_bf16 v[58:61], v[26:29], a[104:107], v[58:61]
    buffer_load_dwordx4 a[100:103], v2, s[12:15], s35 offen sc1
    v_mfma_f32_16x16x32_bf16 v[90:93], v[26:29], a[108:111], v[90:93]
    ds_read_b128 v[26:29], v3 offset:5120
    s_waitcnt lgkmcnt(7)
    v_mfma_f32_16x16x32_bf16 v[62:65], v[30:33], a[104:107], v[62:65]
    v_mfma_f32_16x16x32_bf16 v[94:97], v[30:33], a[108:111], v[94:97]
    ds_read_b128 v[30:33], v3 offset:6144
    s_waitcnt lgkmcnt(7)
    v_mfma_f32_16x16x32_bf16 v[66:69], v[34:37], a[104:107], v[66:69]
    v_mfma_f32_16x16x32_bf16 v[98:101], v[34:37], a[108:111], v[98:101]
    ds_read_b128 v[34:37], v3 offset:7168
    s_mov_b32 s41, 2
L_g4_kernel_loop:
    s_waitcnt vmcnt(45) lgkmcnt(7)
    v_mfma_f32_16x16x32_bf16 v[38:41], v[6:9], a[0:3], v[38:41]
    buffer_load_dwordx4 a[104:107], v1, s[12:15], s35 offen offset:1024 sc1
    s_waitcnt vmcnt(45)
    v_mfma_f32_16x16x32_bf16 v[70:73], v[6:9], a[4:7], v[70:73]
    ds_read_b128 v[6:9], v3 offset:8192
    s_waitcnt lgkmcnt(7)
    v_mfma_f32_16x16x32_bf16 v[42:45], v[10:13], a[0:3], v[42:45]
    buffer_load_dwordx4 a[108:111], v2, s[12:15], s35 offen offset:1024 sc1
    s_add_u32 s35, s35, 2048
    v_mfma_f32_16x16x32_bf16 v[74:77], v[10:13], a[4:7], v[74:77]
    ds_read_b128 v[10:13], v3 offset:9216
    s_waitcnt lgkmcnt(7)
    v_mfma_f32_16x16x32_bf16 v[46:49], v[14:17], a[0:3], v[46:49]
    v_mfma_f32_16x16x32_bf16 v[78:81], v[14:17], a[4:7], v[78:81]
    ds_read_b128 v[14:17], v3 offset:10240
    s_waitcnt lgkmcnt(7)
    v_mfma_f32_16x16x32_bf16 v[50:53], v[18:21], a[0:3], v[50:53]
    v_mfma_f32_16x16x32_bf16 v[82:85], v[18:21], a[4:7], v[82:85]
    ds_read_b128 v[18:21], v3 offset:11264
    s_waitcnt lgkmcnt(7)
    v_mfma_f32_16x16x32_bf16 v[54:57], v[22:25], a[0:3], v[54:57]
    v_mfma_f32_16x16x32_bf16 v[86:89], v[22:25], a[4:7], v[86:89]
    ds_read_b128 v[22:25], v3 offset:12288
    s_waitcnt lgkmcnt(7)
    v_mfma_f32_16x16x32_bf16 v[58:61], v[26:29], a[0:3], v[58:61]
    v_mfma_f32_16x16x32_bf16 v[90:93], v[26:29], a[4:7], v[90:93]
    ds_read_b128 v[26:29], v3 offset:13312
    s_waitcnt lgkmcnt(7)
    v_mfma_f32_16x16x32_bf16 v[62:65], v[30:33], a[0:3], v[62:65]
    v_mfma_f32_16x16x32_bf16 v[94:97], v[30:33], a[4:7], v[94:97]
    ds_read_b128 v[30:33], v3 offset:14336
    s_waitcnt lgkmcnt(7)
    v_mfma_f32_16x16x32_bf16 v[66:69], v[34:37], a[0:3], v[66:69]
    v_mfma_f32_16x16x32_bf16 v[98:101], v[34:37], a[4:7], v[98:101]
    ds_read_b128 v[34:37], v3 offset:15360
    s_waitcnt vmcnt(36)
    s_barrier
    s_waitcnt lgkmcnt(7)
    v_mfma_f32_16x16x32_bf16 v[38:41], v[6:9], a[8:11], v[38:41]
    s_add_u32 m0, s37, 98304
    s_nop 0
    buffer_load_dwordx4 v250, s[16:19], s36 offen sc1 lds
    v_mfma_f32_16x16x32_bf16 v[70:73], v[6:9], a[12:15], v[70:73]
    ds_read_b128 v[6:9], v3 offset:16384
    s_waitcnt lgkmcnt(7)
    v_mfma_f32_16x16x32_bf16 v[42:45], v[10:13], a[8:11], v[42:45]
    buffer_load_dwordx4 v250, s[16:19], s36 offen offset:1024 sc1 lds
    v_mfma_f32_16x16x32_bf16 v[74:77], v[10:13], a[12:15], v[74:77]
    ds_read_b128 v[10:13], v3 offset:17408
    s_waitcnt lgkmcnt(7)
    v_mfma_f32_16x16x32_bf16 v[46:49], v[14:17], a[8:11], v[46:49]
    buffer_load_dwordx4 v250, s[16:19], s36 offen offset:2048 sc1 lds
    v_mfma_f32_16x16x32_bf16 v[78:81], v[14:17], a[12:15], v[78:81]
    ds_read_b128 v[14:17], v3 offset:18432
    s_waitcnt lgkmcnt(7)
    v_mfma_f32_16x16x32_bf16 v[50:53], v[18:21], a[8:11], v[50:53]
    buffer_load_dwordx4 v250, s[16:19], s36 offen offset:3072 sc1 lds
    s_add_u32 s36, s36, 16384
    v_mfma_f32_16x16x32_bf16 v[82:85], v[18:21], a[12:15], v[82:85]
    ds_read_b128 v[18:21], v3 offset:19456
    s_waitcnt lgkmcnt(7)
    v_mfma_f32_16x16x32_bf16 v[54:57], v[22:25], a[8:11], v[54:57]
    buffer_load_dwordx4 a[0:3], v1, s[12:15], s35 offen sc1
    v_mfma_f32_16x16x32_bf16 v[86:89], v[22:25], a[12:15], v[86:89]
    ds_read_b128 v[22:25], v3 offset:20480
    s_waitcnt lgkmcnt(7)
    v_mfma_f32_16x16x32_bf16 v[58:61], v[26:29], a[8:11], v[58:61]
    buffer_load_dwordx4 a[4:7], v2, s[12:15], s35 offen sc1
    v_mfma_f32_16x16x32_bf16 v[90:93], v[26:29], a[12:15], v[90:93]
    ds_read_b128 v[26:29], v3 offset:21504
    s_waitcnt lgkmcnt(7)
    v_mfma_f32_16x16x32_bf16 v[62:65], v[30:33], a[8:11], v[62:65]
    v_mfma_f32_16x16x32_bf16 v[94:97], v[30:33], a[12:15], v[94:97]
    ds_read_b128 v[30:33], v3 offset:22528
    s_waitcnt lgkmcnt(7)
    v_mfma_f32_16x16x32_bf16 v[66:69], v[34:37], a[8:11], v[66:69]
    v_mfma_f32_16x16x32_bf16 v[98:101], v[34:37], a[12:15], v[98:101]
    ds_read_b128 v[34:37], v3 offset:23552
    s_waitcnt vmcnt(45) lgkmcnt(7)
    v_mfma_f32_16x16x32_bf16 v[38:41], v[6:9], a[16:19], v[38:41]
    buffer_load_dwordx4 a[8:11], v1, s[12:15], s35 offen offset:1024 sc1
    s_waitcnt vmcnt(45)
    v_mfma_f32_16x16x32_bf16 v[70:73], v[6:9], a[20:23], v[70:73]
    ds_read_b128 v[6:9], v3 offset:24576
    s_waitcnt lgkmcnt(7)
    v_mfma_f32_16x16x32_bf16 v[42:45], v[10:13], a[16:19], v[42:45]
    buffer_load_dwordx4 a[12:15], v2, s[12:15], s35 offen offset:1024 sc1
    s_add_u32 s35, s35, 2048
    v_mfma_f32_16x16x32_bf16 v[74:77], v[10:13], a[20:23], v[74:77]
    ds_read_b128 v[10:13], v3 offset:25600
    s_waitcnt lgkmcnt(7)
    v_mfma_f32_16x16x32_bf16 v[46:49], v[14:17], a[16:19], v[46:49]
    v_mfma_f32_16x16x32_bf16 v[78:81], v[14:17], a[20:23], v[78:81]
    ds_read_b128 v[14:17], v3 offset:26624
    s_waitcnt lgkmcnt(7)
    v_mfma_f32_16x16x32_bf16 v[50:53], v[18:21], a[16:19], v[50:53]
    v_mfma_f32_16x16x32_bf16 v[82:85], v[18:21], a[20:23], v[82:85]
    ds_read_b128 v[18:21], v3 offset:27648
    s_waitcnt lgkmcnt(7)
    v_mfma_f32_16x16x32_bf16 v[54:57], v[22:25], a[16:19], v[54:57]
    v_mfma_f32_16x16x32_bf16 v[86:89], v[22:25], a[20:23], v[86:89]
    ds_read_b128 v[22:25], v3 offset:28672
    s_waitcnt lgkmcnt(7)
    v_mfma_f32_16x16x32_bf16 v[58:61], v[26:29], a[16:19], v[58:61]
    v_mfma_f32_16x16x32_bf16 v[90:93], v[26:29], a[20:23], v[90:93]
    ds_read_b128 v[26:29], v3 offset:29696
    s_waitcnt lgkmcnt(7)
    v_mfma_f32_16x16x32_bf16 v[62:65], v[30:33], a[16:19], v[62:65]
    v_mfma_f32_16x16x32_bf16 v[94:97], v[30:33], a[20:23], v[94:97]
    ds_read_b128 v[30:33], v3 offset:30720
    s_waitcnt lgkmcnt(7)
    v_mfma_f32_16x16x32_bf16 v[66:69], v[34:37], a[16:19], v[66:69]
    v_mfma_f32_16x16x32_bf16 v[98:101], v[34:37], a[20:23], v[98:101]
    ds_read_b128 v[34:37], v3 offset:31744
    s_waitcnt vmcnt(36)
    s_barrier
    s_waitcnt lgkmcnt(7)
    v_mfma_f32_16x16x32_bf16 v[38:41], v[6:9], a[24:27], v[38:41]
    s_add_u32 m0, s37, 0
    s_nop 0
    buffer_load_dwordx4 v250, s[16:19], s36 offen sc1 lds
    v_mfma_f32_16x16x32_bf16 v[70:73], v[6:9], a[28:31], v[70:73]
    ds_read_b128 v[6:9], v3 offset:32768
    s_waitcnt lgkmcnt(7)
    v_mfma_f32_16x16x32_bf16 v[42:45], v[10:13], a[24:27], v[42:45]
    buffer_load_dwordx4 v250, s[16:19], s36 offen offset:1024 sc1 lds
    v_mfma_f32_16x16x32_bf16 v[74:77], v[10:13], a[28:31], v[74:77]
    ds_read_b128 v[10:13], v3 offset:33792
    s_waitcnt lgkmcnt(7)
    v_mfma_f32_16x16x32_bf16 v[46:49], v[14:17], a[24:27], v[46:49]
    buffer_load_dwordx4 v250, s[16:19], s36 offen offset:2048 sc1 lds
    v_mfma_f32_16x16x32_bf16 v[78:81], v[14:17], a[28:31], v[78:81]
    ds_read_b128 v[14:17], v3 offset:34816
    s_waitcnt lgkmcnt(7)
    v_mfma_f32_16x16x32_bf16 v[50:53], v[18:21], a[24:27], v[50:53]
    buffer_load_dwordx4 v250, s[16:19], s36 offen offset:3072 sc1 lds
    s_add_u32 s36, s36, 16384
    v_mfma_f32_16x16x32_bf16 v[82:85], v[18:21], a[28:31], v[82:85]
    ds_read_b128 v[18:21], v3 offset:35840
    s_waitcnt lgkmcnt(7)
    v_mfma_f32_16x16x32_bf16 v[54:57], v[22:25], a[24:27], v[54:57]
    buffer_load_dwordx4 a[16:19], v1, s[12:15], s35 offen sc1
    v_mfma_f32_16x16x32_bf16 v[86:89], v[22:25], a[28:31], v[86:89]
    ds_read_b128 v[22:25], v3 offset:36864
    s_waitcnt lgkmcnt(7)
    v_mfma_f32_16x16x32_bf16 v[58:61], v[26:29], a[24:27], v[58:61]
    buffer_load_dwordx4 a[20:23], v2, s[12:15], s35 offen sc1
    v_mfma_f32_16x16x32_bf16 v[90:93], v[26:29], a[28:31], v[90:93]
    ds_read_b128 v[26:29], v3 offset:37888
    s_waitcnt lgkmcnt(7)
    v_mfma_f32_16x16x32_bf16 v[62:65], v[30:33], a[24:27], v[62:65]
    v_mfma_f32_16x16x32_bf16 v[94:97], v[30:33], a[28:31], v[94:97]
    ds_read_b128 v[30:33], v3 offset:38912
    s_waitcnt lgkmcnt(7)
    v_mfma_f32_16x16x32_bf16 v[66:69], v[34:37], a[24:27], v[66:69]
    v_mfma_f32_16x16x32_bf16 v[98:101], v[34:37], a[28:31], v[98:101]
    ds_read_b128 v[34:37], v3 offset:39936
    s_waitcnt lgkmcnt(7)
    v_mfma_f32_16x16x32_bf16 v[38:41], v[6:9], a[32:35], v[38:41]
    buffer_load_dwordx4 a[24:27], v1, s[12:15], s35 offen offset:1024 sc1
    v_mfma_f32_16x16x32_bf16 v[70:73], v[6:9], a[36:39], v[70:73]
    ds_read_b128 v[6:9], v3 offset:40960
    s_waitcnt lgkmcnt(7)
    v_mfma_f32_16x16x32_bf16 v[42:45], v[10:13], a[32:35], v[42:45]
    buffer_load_dwordx4 a[28:31], v2, s[12:15], s35 offen offset:1024 sc1
    s_add_u32 s35, s35, 2048
    v_mfma_f32_16x16x32_bf16 v[74:77], v[10:13], a[36:39], v[74:77]
    ds_read_b128 v[10:13], v3 offset:41984
    s_waitcnt lgkmcnt(7)
    v_mfma_f32_16x16x32_bf16 v[46:49], v[14:17], a[32:35], v[46:49]
    v_mfma_f32_16x16x32_bf16 v[78:81], v[14:17], a[36:39], v[78:81]
    ds_read_b128 v[14:17], v3 offset:43008
    s_waitcnt lgkmcnt(7)
    v_mfma_f32_16x16x32_bf16 v[50:53], v[18:21], a[32:35], v[50:53]
    v_mfma_f32_16x16x32_bf16 v[82:85], v[18:21], a[36:39], v[82:85]
    ds_read_b128 v[18:21], v3 offset:44032
    s_waitcnt lgkmcnt(7)
    v_mfma_f32_16x16x32_bf16 v[54:57], v[22:25], a[32:35], v[54:57]
    v_mfma_f32_16x16x32_bf16 v[86:89], v[22:25], a[36:39], v[86:89]
    ds_read_b128 v[22:25], v3 offset:45056
    s_waitcnt lgkmcnt(7)
    v_mfma_f32_16x16x32_bf16 v[58:61], v[26:29], a[32:35], v[58:61]
    v_mfma_f32_16x16x32_bf16 v[90:93], v[26:29], a[36:39], v[90:93]
    ds_read_b128 v[26:29], v3 offset:46080
    s_waitcnt lgkmcnt(7)
    v_mfma_f32_16x16x32_bf16 v[62:65], v[30:33], a[32:35], v[62:65]
    v_mfma_f32_16x16x32_bf16 v[94:97], v[30:33], a[36:39], v[94:97]
    ds_read_b128 v[30:33], v3 offset:47104
    s_waitcnt lgkmcnt(7)
    v_mfma_f32_16x16x32_bf16 v[66:69], v[34:37], a[32:35], v[66:69]
    v_mfma_f32_16x16x32_bf16 v[98:101], v[34:37], a[36:39], v[98:101]
    ds_read_b128 v[34:37], v3 offset:48128
    s_waitcnt vmcnt(36)
    s_barrier
    s_waitcnt lgkmcnt(7)
    v_mfma_f32_16x16x32_bf16 v[38:41], v[6:9], a[40:43], v[38:41]
    s_add_u32 m0, s37, 16384
    s_nop 0
    buffer_load_dwordx4 v250, s[16:19], s36 offen sc1 lds
    v_mfma_f32_16x16x32_bf16 v[70:73], v[6:9], a[44:47], v[70:73]
    ds_read_b128 v[6:9], v3 offset:49152
    s_waitcnt lgkmcnt(7)
    v_mfma_f32_16x16x32_bf16 v[42:45], v[10:13], a[40:43], v[42:45]
    buffer_load_dwordx4 v250, s[16:19], s36 offen offset:1024 sc1 lds
    v_mfma_f32_16x16x32_bf16 v[74:77], v[10:13], a[44:47], v[74:77]
    ds_read_b128 v[10:13], v3 offset:50176
    s_waitcnt lgkmcnt(7)
    v_mfma_f32_16x16x32_bf16 v[46:49], v[14:17], a[40:43], v[46:49]
    buffer_load_dwordx4 v250, s[16:19], s36 offen offset:2048 sc1 lds
    v_mfma_f32_16x16x32_bf16 v[78:81], v[14:17], a[44:47], v[78:81]
    ds_read_b128 v[14:17], v3 offset:51200
    s_waitcnt lgkmcnt(7)
    v_mfma_f32_16x16x32_bf16 v[50:53], v[18:21], a[40:43], v[50:53]
    buffer_load_dwordx4 v250, s[16:19], s36 offen offset:3072 sc1 lds
    s_add_u32 s36, s36, 16384
    v_mfma_f32_16x16x32_bf16 v[82:85], v[18:21], a[44:47], v[82:85]
    ds_read_b128 v[18:21], v3 offset:52224
    s_waitcnt lgkmcnt(7)
    v_mfma_f32_16x16x32_bf16 v[54:57], v[22:25], a[40:43], v[54:57]
    buffer_load_dwordx4 a[32:35], v1, s[12:15], s35 offen sc1
    v_mfma_f32_16x16x32_bf16 v[86:89], v[22:25], a[44:47], v[86:89]
    ds_read_b128 v[22:25], v3 offset:53248
    s_waitcnt lgkmcnt(7)
    v_mfma_f32_16x16x32_bf16 v[58:61], v[26:29], a[40:43], v[58:61]
    buffer_load_dwordx4 a[36:39], v2, s[12:15], s35 offen sc1
    v_mfma_f32_16x16x32_bf16 v[90:93], v[26:29], a[44:47], v[90:93]
    ds_read_b128 v[26:29], v3 offset:54272
    s_waitcnt lgkmcnt(7)
    v_mfma_f32_16x16x32_bf16 v[62:65], v[30:33], a[40:43], v[62:65]
    v_mfma_f32_16x16x32_bf16 v[94:97], v[30:33], a[44:47], v[94:97]
    ds_read_b128 v[30:33], v3 offset:55296
    s_waitcnt lgkmcnt(7)
    v_mfma_f32_16x16x32_bf16 v[66:69], v[34:37], a[40:43], v[66:69]
    v_mfma_f32_16x16x32_bf16 v[98:101], v[34:37], a[44:47], v[98:101]
    ds_read_b128 v[34:37], v3 offset:56320
    s_waitcnt lgkmcnt(7)
    v_mfma_f32_16x16x32_bf16 v[38:41], v[6:9], a[48:51], v[38:41]
    buffer_load_dwordx4 a[40:43], v1, s[12:15], s35 offen offset:1024 sc1
    v_mfma_f32_16x16x32_bf16 v[70:73], v[6:9], a[52:55], v[70:73]
    ds_read_b128 v[6:9], v3 offset:57344
    s_waitcnt lgkmcnt(7)
    v_mfma_f32_16x16x32_bf16 v[42:45], v[10:13], a[48:51], v[42:45]
    buffer_load_dwordx4 a[44:47], v2, s[12:15], s35 offen offset:1024 sc1
    s_add_u32 s35, s35, 2048
    v_mfma_f32_16x16x32_bf16 v[74:77], v[10:13], a[52:55], v[74:77]
    ds_read_b128 v[10:13], v3 offset:58368
    s_waitcnt lgkmcnt(7)
    v_mfma_f32_16x16x32_bf16 v[46:49], v[14:17], a[48:51], v[46:49]
    v_mfma_f32_16x16x32_bf16 v[78:81], v[14:17], a[52:55], v[78:81]
    ds_read_b128 v[14:17], v3 offset:59392
    s_waitcnt lgkmcnt(7)
    v_mfma_f32_16x16x32_bf16 v[50:53], v[18:21], a[48:51], v[50:53]
    v_mfma_f32_16x16x32_bf16 v[82:85], v[18:21], a[52:55], v[82:85]
    ds_read_b128 v[18:21], v3 offset:60416
    s_waitcnt lgkmcnt(7)
    v_mfma_f32_16x16x32_bf16 v[54:57], v[22:25], a[48:51], v[54:57]
    v_mfma_f32_16x16x32_bf16 v[86:89], v[22:25], a[52:55], v[86:89]
    ds_read_b128 v[22:25], v3 offset:61440
    s_waitcnt lgkmcnt(7)
    v_mfma_f32_16x16x32_bf16 v[58:61], v[26:29], a[48:51], v[58:61]
    v_mfma_f32_16x16x32_bf16 v[90:93], v[26:29], a[52:55], v[90:93]
    ds_read_b128 v[26:29], v3 offset:62464
    s_waitcnt lgkmcnt(7)
    v_mfma_f32_16x16x32_bf16 v[62:65], v[30:33], a[48:51], v[62:65]
    v_mfma_f32_16x16x32_bf16 v[94:97], v[30:33], a[52:55], v[94:97]
    ds_read_b128 v[30:33], v3 offset:63488
    s_waitcnt lgkmcnt(7)
    v_mfma_f32_16x16x32_bf16 v[66:69], v[34:37], a[48:51], v[66:69]
    v_mfma_f32_16x16x32_bf16 v[98:101], v[34:37], a[52:55], v[98:101]
    ds_read_b128 v[34:37], v3 offset:64512
    s_waitcnt vmcnt(36)
    s_barrier
    s_waitcnt lgkmcnt(7)
    v_mfma_f32_16x16x32_bf16 v[38:41], v[6:9], a[56:59], v[38:41]
    s_add_u32 m0, s37, 32768
    s_nop 0
    buffer_load_dwordx4 v250, s[16:19], s36 offen sc1 lds
    v_mfma_f32_16x16x32_bf16 v[70:73], v[6:9], a[60:63], v[70:73]
    ds_read_b128 v[6:9], v4 offset:0
    s_waitcnt lgkmcnt(7)
    v_mfma_f32_16x16x32_bf16 v[42:45], v[10:13], a[56:59], v[42:45]
    buffer_load_dwordx4 v250, s[16:19], s36 offen offset:1024 sc1 lds
    v_mfma_f32_16x16x32_bf16 v[74:77], v[10:13], a[60:63], v[74:77]
    ds_read_b128 v[10:13], v4 offset:1024
    s_waitcnt lgkmcnt(7)
    v_mfma_f32_16x16x32_bf16 v[46:49], v[14:17], a[56:59], v[46:49]
    buffer_load_dwordx4 v250, s[16:19], s36 offen offset:2048 sc1 lds
    v_mfma_f32_16x16x32_bf16 v[78:81], v[14:17], a[60:63], v[78:81]
    ds_read_b128 v[14:17], v4 offset:2048
    s_waitcnt lgkmcnt(7)
    v_mfma_f32_16x16x32_bf16 v[50:53], v[18:21], a[56:59], v[50:53]
    buffer_load_dwordx4 v250, s[16:19], s36 offen offset:3072 sc1 lds
    s_add_u32 s36, s36, 16384
    v_mfma_f32_16x16x32_bf16 v[82:85], v[18:21], a[60:63], v[82:85]
    ds_read_b128 v[18:21], v4 offset:3072
    s_waitcnt lgkmcnt(7)
    v_mfma_f32_16x16x32_bf16 v[54:57], v[22:25], a[56:59], v[54:57]
    buffer_load_dwordx4 a[48:51], v1, s[12:15], s35 offen sc1
    v_mfma_f32_16x16x32_bf16 v[86:89], v[22:25], a[60:63], v[86:89]
    ds_read_b128 v[22:25], v4 offset:4096
    s_waitcnt lgkmcnt(7)
    v_mfma_f32_16x16x32_bf16 v[58:61], v[26:29], a[56:59], v[58:61]
    buffer_load_dwordx4 a[52:55], v2, s[12:15], s35 offen sc1
    v_mfma_f32_16x16x32_bf16 v[90:93], v[26:29], a[60:63], v[90:93]
    ds_read_b128 v[26:29], v4 offset:5120
    s_waitcnt lgkmcnt(7)
    v_mfma_f32_16x16x32_bf16 v[62:65], v[30:33], a[56:59], v[62:65]
    v_mfma_f32_16x16x32_bf16 v[94:97], v[30:33], a[60:63], v[94:97]
    ds_read_b128 v[30:33], v4 offset:6144
    s_waitcnt lgkmcnt(7)
    v_mfma_f32_16x16x32_bf16 v[66:69], v[34:37], a[56:59], v[66:69]
    v_mfma_f32_16x16x32_bf16 v[98:101], v[34:37], a[60:63], v[98:101]
    ds_read_b128 v[34:37], v4 offset:7168
    s_waitcnt lgkmcnt(7)
    v_mfma_f32_16x16x32_bf16 v[38:41], v[6:9], a[64:67], v[38:41]
    buffer_load_dwordx4 a[56:59], v1, s[12:15], s35 offen offset:1024 sc1
    v_mfma_f32_16x16x32_bf16 v[70:73], v[6:9], a[68:71], v[70:73]
    ds_read_b128 v[6:9], v4 offset:8192
    s_waitcnt lgkmcnt(7)
    v_mfma_f32_16x16x32_bf16 v[42:45], v[10:13], a[64:67], v[42:45]
    buffer_load_dwordx4 a[60:63], v2, s[12:15], s35 offen offset:1024 sc1
    s_add_u32 s35, s35, 2048
    v_mfma_f32_16x16x32_bf16 v[74:77], v[10:13], a[68:71], v[74:77]
    ds_read_b128 v[10:13], v4 offset:9216
    s_waitcnt lgkmcnt(7)
    v_mfma_f32_16x16x32_bf16 v[46:49], v[14:17], a[64:67], v[46:49]
    v_mfma_f32_16x16x32_bf16 v[78:81], v[14:17], a[68:71], v[78:81]
    ds_read_b128 v[14:17], v4 offset:10240
    s_waitcnt lgkmcnt(7)
    v_mfma_f32_16x16x32_bf16 v[50:53], v[18:21], a[64:67], v[50:53]
    v_mfma_f32_16x16x32_bf16 v[82:85], v[18:21], a[68:71], v[82:85]
    ds_read_b128 v[18:21], v4 offset:11264
    s_waitcnt lgkmcnt(7)
    v_mfma_f32_16x16x32_bf16 v[54:57], v[22:25], a[64:67], v[54:57]
    v_mfma_f32_16x16x32_bf16 v[86:89], v[22:25], a[68:71], v[86:89]
    ds_read_b128 v[22:25], v4 offset:12288
    s_waitcnt lgkmcnt(7)
    v_mfma_f32_16x16x32_bf16 v[58:61], v[26:29], a[64:67], v[58:61]
    v_mfma_f32_16x16x32_bf16 v[90:93], v[26:29], a[68:71], v[90:93]
    ds_read_b128 v[26:29], v4 offset:13312
    s_waitcnt lgkmcnt(7)
    v_mfma_f32_16x16x32_bf16 v[62:65], v[30:33], a[64:67], v[62:65]
    v_mfma_f32_16x16x32_bf16 v[94:97], v[30:33], a[68:71], v[94:97]
    ds_read_b128 v[30:33], v4 offset:14336
    s_waitcnt lgkmcnt(7)
    v_mfma_f32_16x16x32_bf16 v[66:69], v[34:37], a[64:67], v[66:69]
    v_mfma_f32_16x16x32_bf16 v[98:101], v[34:37], a[68:71], v[98:101]
    ds_read_b128 v[34:37], v4 offset:15360
    s_waitcnt vmcnt(36)
    s_barrier
    s_waitcnt lgkmcnt(7)
    v_mfma_f32_16x16x32_bf16 v[38:41], v[6:9], a[72:75], v[38:41]
    s_add_u32 m0, s37, 49152
    s_nop 0
    buffer_load_dwordx4 v250, s[16:19], s36 offen sc1 lds
    v_mfma_f32_16x16x32_bf16 v[70:73], v[6:9], a[76:79], v[70:73]
    ds_read_b128 v[6:9], v4 offset:16384
    s_waitcnt lgkmcnt(7)
    v_mfma_f32_16x16x32_bf16 v[42:45], v[10:13], a[72:75], v[42:45]
    buffer_load_dwordx4 v250, s[16:19], s36 offen offset:1024 sc1 lds
    v_mfma_f32_16x16x32_bf16 v[74:77], v[10:13], a[76:79], v[74:77]
    ds_read_b128 v[10:13], v4 offset:17408
    s_waitcnt lgkmcnt(7)
    v_mfma_f32_16x16x32_bf16 v[46:49], v[14:17], a[72:75], v[46:49]
    buffer_load_dwordx4 v250, s[16:19], s36 offen offset:2048 sc1 lds
    v_mfma_f32_16x16x32_bf16 v[78:81], v[14:17], a[76:79], v[78:81]
    ds_read_b128 v[14:17], v4 offset:18432
    s_waitcnt lgkmcnt(7)
    v_mfma_f32_16x16x32_bf16 v[50:53], v[18:21], a[72:75], v[50:53]
    buffer_load_dwordx4 v250, s[16:19], s36 offen offset:3072 sc1 lds
    s_add_u32 s36, s36, 16384
    v_mfma_f32_16x16x32_bf16 v[82:85], v[18:21], a[76:79], v[82:85]
    ds_read_b128 v[18:21], v4 offset:19456
    s_waitcnt lgkmcnt(7)
    v_mfma_f32_16x16x32_bf16 v[54:57], v[22:25], a[72:75], v[54:57]
    buffer_load_dwordx4 a[64:67], v1, s[12:15], s35 offen sc1
    v_mfma_f32_16x16x32_bf16 v[86:89], v[22:25], a[76:79], v[86:89]
    ds_read_b128 v[22:25], v4 offset:20480
    s_waitcnt lgkmcnt(7)
    v_mfma_f32_16x16x32_bf16 v[58:61], v[26:29], a[72:75], v[58:61]
    buffer_load_dwordx4 a[68:71], v2, s[12:15], s35 offen sc1
    v_mfma_f32_16x16x32_bf16 v[90:93], v[26:29], a[76:79], v[90:93]
    ds_read_b128 v[26:29], v4 offset:21504
    s_waitcnt lgkmcnt(7)
    v_mfma_f32_16x16x32_bf16 v[62:65], v[30:33], a[72:75], v[62:65]
    v_mfma_f32_16x16x32_bf16 v[94:97], v[30:33], a[76:79], v[94:97]
    ds_read_b128 v[30:33], v4 offset:22528
    s_waitcnt lgkmcnt(7)
    v_mfma_f32_16x16x32_bf16 v[66:69], v[34:37], a[72:75], v[66:69]
    v_mfma_f32_16x16x32_bf16 v[98:101], v[34:37], a[76:79], v[98:101]
    ds_read_b128 v[34:37], v4 offset:23552
    s_waitcnt lgkmcnt(7)
    v_mfma_f32_16x16x32_bf16 v[38:41], v[6:9], a[80:83], v[38:41]
    buffer_load_dwordx4 a[72:75], v1, s[12:15], s35 offen offset:1024 sc1
    v_mfma_f32_16x16x32_bf16 v[70:73], v[6:9], a[84:87], v[70:73]
    ds_read_b128 v[6:9], v4 offset:24576
    s_waitcnt lgkmcnt(7)
    v_mfma_f32_16x16x32_bf16 v[42:45], v[10:13], a[80:83], v[42:45]
    buffer_load_dwordx4 a[76:79], v2, s[12:15], s35 offen offset:1024 sc1
    s_add_u32 s35, s35, 2048
    v_mfma_f32_16x16x32_bf16 v[74:77], v[10:13], a[84:87], v[74:77]
    ds_read_b128 v[10:13], v4 offset:25600
    s_waitcnt lgkmcnt(7)
    v_mfma_f32_16x16x32_bf16 v[46:49], v[14:17], a[80:83], v[46:49]
    v_mfma_f32_16x16x32_bf16 v[78:81], v[14:17], a[84:87], v[78:81]
    ds_read_b128 v[14:17], v4 offset:26624
    s_waitcnt lgkmcnt(7)
    v_mfma_f32_16x16x32_bf16 v[50:53], v[18:21], a[80:83], v[50:53]
    v_mfma_f32_16x16x32_bf16 v[82:85], v[18:21], a[84:87], v[82:85]
    ds_read_b128 v[18:21], v4 offset:27648
    s_waitcnt lgkmcnt(7)
    v_mfma_f32_16x16x32_bf16 v[54:57], v[22:25], a[80:83], v[54:57]
    v_mfma_f32_16x16x32_bf16 v[86:89], v[22:25], a[84:87], v[86:89]
    ds_read_b128 v[22:25], v4 offset:28672
    s_waitcnt lgkmcnt(7)
    v_mfma_f32_16x16x32_bf16 v[58:61], v[26:29], a[80:83], v[58:61]
    v_mfma_f32_16x16x32_bf16 v[90:93], v[26:29], a[84:87], v[90:93]
    ds_read_b128 v[26:29], v4 offset:29696
    s_waitcnt lgkmcnt(7)
    v_mfma_f32_16x16x32_bf16 v[62:65], v[30:33], a[80:83], v[62:65]
    v_mfma_f32_16x16x32_bf16 v[94:97], v[30:33], a[84:87], v[94:97]
    ds_read_b128 v[30:33], v4 offset:30720
    s_waitcnt lgkmcnt(7)
    v_mfma_f32_16x16x32_bf16 v[66:69], v[34:37], a[80:83], v[66:69]
    v_mfma_f32_16x16x32_bf16 v[98:101], v[34:37], a[84:87], v[98:101]
    ds_read_b128 v[34:37], v4 offset:31744
    s_waitcnt vmcnt(36)
    s_barrier
    s_waitcnt lgkmcnt(7)
    v_mfma_f32_16x16x32_bf16 v[38:41], v[6:9], a[88:91], v[38:41]
    s_add_u32 m0, s37, 65536
    s_nop 0
    buffer_load_dwordx4 v250, s[16:19], s36 offen sc1 lds
    v_mfma_f32_16x16x32_bf16 v[70:73], v[6:9], a[92:95], v[70:73]
    ds_read_b128 v[6:9], v4 offset:32768
    s_waitcnt lgkmcnt(7)
    v_mfma_f32_16x16x32_bf16 v[42:45], v[10:13], a[88:91], v[42:45]
    buffer_load_dwordx4 v250, s[16:19], s36 offen offset:1024 sc1 lds
    v_mfma_f32_16x16x32_bf16 v[74:77], v[10:13], a[92:95], v[74:77]
    ds_read_b128 v[10:13], v4 offset:33792
    s_waitcnt lgkmcnt(7)
    v_mfma_f32_16x16x32_bf16 v[46:49], v[14:17], a[88:91], v[46:49]
    buffer_load_dwordx4 v250, s[16:19], s36 offen offset:2048 sc1 lds
    v_mfma_f32_16x16x32_bf16 v[78:81], v[14:17], a[92:95], v[78:81]
    ds_read_b128 v[14:17], v4 offset:34816
    s_waitcnt lgkmcnt(7)
    v_mfma_f32_16x16x32_bf16 v[50:53], v[18:21], a[88:91], v[50:53]
    buffer_load_dwordx4 v250, s[16:19], s36 offen offset:3072 sc1 lds
    s_add_u32 s36, s36, 16384
    v_mfma_f32_16x16x32_bf16 v[82:85], v[18:21], a[92:95], v[82:85]
    ds_read_b128 v[18:21], v4 offset:35840
    s_waitcnt lgkmcnt(7)
    v_mfma_f32_16x16x32_bf16 v[54:57], v[22:25], a[88:91], v[54:57]
    buffer_load_dwordx4 a[80:83], v1, s[12:15], s35 offen sc1
    v_mfma_f32_16x16x32_bf16 v[86:89], v[22:25], a[92:95], v[86:89]
    ds_read_b128 v[22:25], v4 offset:36864
    s_waitcnt lgkmcnt(7)
    v_mfma_f32_16x16x32_bf16 v[58:61], v[26:29], a[88:91], v[58:61]
    buffer_load_dwordx4 a[84:87], v2, s[12:15], s35 offen sc1
    v_mfma_f32_16x16x32_bf16 v[90:93], v[26:29], a[92:95], v[90:93]
    ds_read_b128 v[26:29], v4 offset:37888
    s_waitcnt lgkmcnt(7)
    v_mfma_f32_16x16x32_bf16 v[62:65], v[30:33], a[88:91], v[62:65]
    v_mfma_f32_16x16x32_bf16 v[94:97], v[30:33], a[92:95], v[94:97]
    ds_read_b128 v[30:33], v4 offset:38912
    s_waitcnt lgkmcnt(7)
    v_mfma_f32_16x16x32_bf16 v[66:69], v[34:37], a[88:91], v[66:69]
    v_mfma_f32_16x16x32_bf16 v[98:101], v[34:37], a[92:95], v[98:101]
    ds_read_b128 v[34:37], v4 offset:39936
    s_waitcnt lgkmcnt(7)
    v_mfma_f32_16x16x32_bf16 v[38:41], v[6:9], a[96:99], v[38:41]
    buffer_load_dwordx4 a[88:91], v1, s[12:15], s35 offen offset:1024 sc1
    v_mfma_f32_16x16x32_bf16 v[70:73], v[6:9], a[100:103], v[70:73]
    ds_read_b128 v[6:9], v4 offset:40960
    s_waitcnt lgkmcnt(7)
    v_mfma_f32_16x16x32_bf16 v[42:45], v[10:13], a[96:99], v[42:45]
    buffer_load_dwordx4 a[92:95], v2, s[12:15], s35 offen offset:1024 sc1
    s_add_u32 s35, s35, 2048
    v_mfma_f32_16x16x32_bf16 v[74:77], v[10:13], a[100:103], v[74:77]
    ds_read_b128 v[10:13], v4 offset:41984
    s_waitcnt lgkmcnt(7)
    v_mfma_f32_16x16x32_bf16 v[46:49], v[14:17], a[96:99], v[46:49]
    v_mfma_f32_16x16x32_bf16 v[78:81], v[14:17], a[100:103], v[78:81]
    ds_read_b128 v[14:17], v4 offset:43008
    s_waitcnt lgkmcnt(7)
    v_mfma_f32_16x16x32_bf16 v[50:53], v[18:21], a[96:99], v[50:53]
    v_mfma_f32_16x16x32_bf16 v[82:85], v[18:21], a[100:103], v[82:85]
    ds_read_b128 v[18:21], v4 offset:44032
    s_waitcnt lgkmcnt(7)
    v_mfma_f32_16x16x32_bf16 v[54:57], v[22:25], a[96:99], v[54:57]
    v_mfma_f32_16x16x32_bf16 v[86:89], v[22:25], a[100:103], v[86:89]
    ds_read_b128 v[22:25], v4 offset:45056
    s_waitcnt lgkmcnt(7)
    v_mfma_f32_16x16x32_bf16 v[58:61], v[26:29], a[96:99], v[58:61]
    v_mfma_f32_16x16x32_bf16 v[90:93], v[26:29], a[100:103], v[90:93]
    ds_read_b128 v[26:29], v4 offset:46080
    s_waitcnt lgkmcnt(7)
    v_mfma_f32_16x16x32_bf16 v[62:65], v[30:33], a[96:99], v[62:65]
    v_mfma_f32_16x16x32_bf16 v[94:97], v[30:33], a[100:103], v[94:97]
    ds_read_b128 v[30:33], v4 offset:47104
    s_waitcnt lgkmcnt(7)
    v_mfma_f32_16x16x32_bf16 v[66:69], v[34:37], a[96:99], v[66:69]
    v_mfma_f32_16x16x32_bf16 v[98:101], v[34:37], a[100:103], v[98:101]
    ds_read_b128 v[34:37], v4 offset:48128
    s_waitcnt vmcnt(36)
    s_barrier
    s_waitcnt lgkmcnt(7)
    v_mfma_f32_16x16x32_bf16 v[38:41], v[6:9], a[104:107], v[38:41]
    s_add_u32 m0, s37, 81920
    s_nop 0
    buffer_load_dwordx4 v250, s[16:19], s36 offen sc1 lds
    v_mfma_f32_16x16x32_bf16 v[70:73], v[6:9], a[108:111], v[70:73]
    ds_read_b128 v[6:9], v3 offset:0
    s_waitcnt lgkmcnt(7)
    v_mfma_f32_16x16x32_bf16 v[42:45], v[10:13], a[104:107], v[42:45]
    buffer_load_dwordx4 v250, s[16:19], s36 offen offset:1024 sc1 lds
    v_mfma_f32_16x16x32_bf16 v[74:77], v[10:13], a[108:111], v[74:77]
    ds_read_b128 v[10:13], v3 offset:1024
    s_waitcnt lgkmcnt(7)
    v_mfma_f32_16x16x32_bf16 v[46:49], v[14:17], a[104:107], v[46:49]
    buffer_load_dwordx4 v250, s[16:19], s36 offen offset:2048 sc1 lds
    v_mfma_f32_16x16x32_bf16 v[78:81], v[14:17], a[108:111], v[78:81]
    ds_read_b128 v[14:17], v3 offset:2048
    s_waitcnt lgkmcnt(7)
    v_mfma_f32_16x16x32_bf16 v[50:53], v[18:21], a[104:107], v[50:53]
    buffer_load_dwordx4 v250, s[16:19], s36 offen offset:3072 sc1 lds
    s_add_u32 s36, s36, 16384
    v_mfma_f32_16x16x32_bf16 v[82:85], v[18:21], a[108:111], v[82:85]
    ds_read_b128 v[18:21], v3 offset:3072
    s_waitcnt lgkmcnt(7)
    v_mfma_f32_16x16x32_bf16 v[54:57], v[22:25], a[104:107], v[54:57]
    buffer_load_dwordx4 a[96:99], v1, s[12:15], s35 offen sc1
    v_mfma_f32_16x16x32_bf16 v[86:89], v[22:25], a[108:111], v[86:89]
    ds_read_b128 v[22:25], v3 offset:4096
    s_waitcnt lgkmcnt(7)
    v_mfma_f32_16x16x32_bf16 v[58:61], v[26:29], a[104:107], v[58:61]
    buffer_load_dwordx4 a[100:103], v2, s[12:15], s35 offen sc1
    v_mfma_f32_16x16x32_bf16 v[90:93], v[26:29], a[108:111], v[90:93]
    ds_read_b128 v[26:29], v3 offset:5120
    s_waitcnt lgkmcnt(7)
    v_mfma_f32_16x16x32_bf16 v[62:65], v[30:33], a[104:107], v[62:65]
    v_mfma_f32_16x16x32_bf16 v[94:97], v[30:33], a[108:111], v[94:97]
    ds_read_b128 v[30:33], v3 offset:6144
    s_waitcnt lgkmcnt(7)
    v_mfma_f32_16x16x32_bf16 v[66:69], v[34:37], a[104:107], v[66:69]
    v_mfma_f32_16x16x32_bf16 v[98:101], v[34:37], a[108:111], v[98:101]
    ds_read_b128 v[34:37], v3 offset:7168
    s_sub_u32 s41, s41, 1
    s_cmp_lg_u32 s41, 0
    s_cbranch_scc1 L_g4_kernel_loop
    s_waitcnt lgkmcnt(7)
    v_mfma_f32_16x16x32_bf16 v[38:41], v[6:9], a[0:3], v[38:41]
    buffer_load_dwordx4 a[104:107], v1, s[12:15], s35 offen offset:1024 sc1
    v_mfma_f32_16x16x32_bf16 v[70:73], v[6:9], a[4:7], v[70:73]
    ds_read_b128 v[6:9], v3 offset:8192
    s_waitcnt lgkmcnt(7)
    v_mfma_f32_16x16x32_bf16 v[42:45], v[10:13], a[0:3], v[42:45]
    buffer_load_dwordx4 a[108:111], v2, s[12:15], s35 offen offset:1024 sc1
    s_add_u32 s35, s35, 2048
    v_mfma_f32_16x16x32_bf16 v[74:77], v[10:13], a[4:7], v[74:77]
    ds_read_b128 v[10:13], v3 offset:9216
    s_waitcnt lgkmcnt(7)
    v_mfma_f32_16x16x32_bf16 v[46:49], v[14:17], a[0:3], v[46:49]
    v_mfma_f32_16x16x32_bf16 v[78:81], v[14:17], a[4:7], v[78:81]
    ds_read_b128 v[14:17], v3 offset:10240
    s_waitcnt lgkmcnt(7)
    v_mfma_f32_16x16x32_bf16 v[50:53], v[18:21], a[0:3], v[50:53]
    v_mfma_f32_16x16x32_bf16 v[82:85], v[18:21], a[4:7], v[82:85]
    ds_read_b128 v[18:21], v3 offset:11264
    s_waitcnt lgkmcnt(7)
    v_mfma_f32_16x16x32_bf16 v[54:57], v[22:25], a[0:3], v[54:57]
    v_mfma_f32_16x16x32_bf16 v[86:89], v[22:25], a[4:7], v[86:89]
    ds_read_b128 v[22:25], v3 offset:12288
    s_waitcnt lgkmcnt(7)
    v_mfma_f32_16x16x32_bf16 v[58:61], v[26:29], a[0:3], v[58:61]
    v_mfma_f32_16x16x32_bf16 v[90:93], v[26:29], a[4:7], v[90:93]
    ds_read_b128 v[26:29], v3 offset:13312
    s_waitcnt lgkmcnt(7)
    v_mfma_f32_16x16x32_bf16 v[62:65], v[30:33], a[0:3], v[62:65]
    v_mfma_f32_16x16x32_bf16 v[94:97], v[30:33], a[4:7], v[94:97]
    ds_read_b128 v[30:33], v3 offset:14336
    s_waitcnt lgkmcnt(7)
    v_mfma_f32_16x16x32_bf16 v[66:69], v[34:37], a[0:3], v[66:69]
    v_mfma_f32_16x16x32_bf16 v[98:101], v[34:37], a[4:7], v[98:101]
    ds_read_b128 v[34:37], v3 offset:15360
    s_waitcnt vmcnt(36)
    s_barrier
    s_waitcnt lgkmcnt(7)
    v_mfma_f32_16x16x32_bf16 v[38:41], v[6:9], a[8:11], v[38:41]
    s_add_u32 m0, s37, 98304
    s_nop 0
    buffer_load_dwordx4 v250, s[16:19], s36 offen sc1 lds
    v_mfma_f32_16x16x32_bf16 v[70:73], v[6:9], a[12:15], v[70:73]
    ds_read_b128 v[6:9], v3 offset:20480
    s_waitcnt lgkmcnt(7)
    v_mfma_f32_16x16x32_bf16 v[42:45], v[10:13], a[8:11], v[42:45]
    buffer_load_dwordx4 v250, s[16:19], s36 offen offset:1024 sc1 lds
    v_mfma_f32_16x16x32_bf16 v[74:77], v[10:13], a[12:15], v[74:77]
    ds_read_b128 v[10:13], v3 offset:21504
    s_waitcnt lgkmcnt(7)
    v_mfma_f32_16x16x32_bf16 v[46:49], v[14:17], a[8:11], v[46:49]
    buffer_load_dwordx4 v250, s[16:19], s36 offen offset:2048 sc1 lds
    v_mfma_f32_16x16x32_bf16 v[78:81], v[14:17], a[12:15], v[78:81]
    ds_read_b128 v[14:17], v3 offset:22528
    s_waitcnt lgkmcnt(7)
    v_mfma_f32_16x16x32_bf16 v[50:53], v[18:21], a[8:11], v[50:53]
    buffer_load_dwordx4 v250, s[16:19], s36 offen offset:3072 sc1 lds
    s_add_u32 s36, s36, 16384
    v_mfma_f32_16x16x32_bf16 v[82:85], v[18:21], a[12:15], v[82:85]
    ds_read_b128 v[18:21], v3 offset:23552
    s_waitcnt lgkmcnt(7)
    v_mfma_f32_16x16x32_bf16 v[54:57], v[22:25], a[8:11], v[54:57]
    v_mfma_f32_16x16x32_bf16 v[86:89], v[22:25], a[12:15], v[86:89]
    s_waitcnt lgkmcnt(6)
    v_mfma_f32_16x16x32_bf16 v[58:61], v[26:29], a[8:11], v[58:61]
    v_mfma_f32_16x16x32_bf16 v[90:93], v[26:29], a[12:15], v[90:93]
    s_waitcnt lgkmcnt(5)
    v_mfma_f32_16x16x32_bf16 v[62:65], v[30:33], a[8:11], v[62:65]
    v_mfma_f32_16x16x32_bf16 v[94:97], v[30:33], a[12:15], v[94:97]
    s_waitcnt lgkmcnt(4)
    v_mfma_f32_16x16x32_bf16 v[66:69], v[34:37], a[8:11], v[66:69]
    v_mfma_f32_16x16x32_bf16 v[98:101], v[34:37], a[12:15], v[98:101]
    buffer_load_dwordx4 v[112:115], v109, s[24:27], 0 offen offset:0 sc1
    buffer_load_dwordx4 v[128:131], v109, s[28:31], 0 offen offset:0 sc1
    buffer_load_dwordx4 v[116:119], v109, s[24:27], 0 offen offset:1024 sc1
    buffer_load_dwordx4 v[132:135], v109, s[28:31], 0 offen offset:1024 sc1
    buffer_load_dwordx4 v[120:123], v110, s[24:27], 0 offen offset:0 sc1
    buffer_load_dwordx4 v[136:139], v110, s[28:31], 0 offen offset:0 sc1
    buffer_load_dwordx4 v[124:127], v110, s[24:27], 0 offen offset:1024 sc1
    buffer_load_dwordx4 v[140:143], v110, s[28:31], 0 offen offset:1024 sc1
    s_waitcnt lgkmcnt(3)
    v_mfma_f32_16x16x32_bf16 v[54:57], v[6:9], a[16:19], v[54:57]
    v_mfma_f32_16x16x32_bf16 v[86:89], v[6:9], a[20:23], v[86:89]
    ds_read_b128 v[6:9], v3 offset:28672
    s_waitcnt lgkmcnt(3)
    v_mfma_f32_16x16x32_bf16 v[58:61], v[10:13], a[16:19], v[58:61]
    v_mfma_f32_16x16x32_bf16 v[90:93], v[10:13], a[20:23], v[90:93]
    ds_read_b128 v[10:13], v3 offset:29696
    s_waitcnt lgkmcnt(3)
    v_mfma_f32_16x16x32_bf16 v[62:65], v[14:17], a[16:19], v[62:65]
    v_mfma_f32_16x16x32_bf16 v[94:97], v[14:17], a[20:23], v[94:97]
    ds_read_b128 v[14:17], v3 offset:30720
    s_waitcnt lgkmcnt(3)
    v_mfma_f32_16x16x32_bf16 v[66:69], v[18:21], a[16:19], v[66:69]
    v_mfma_f32_16x16x32_bf16 v[98:101], v[18:21], a[20:23], v[98:101]
    ds_read_b128 v[18:21], v3 offset:31744
    s_waitcnt vmcnt(40)
    s_barrier
    s_waitcnt lgkmcnt(3)
    v_mfma_f32_16x16x32_bf16 v[54:57], v[6:9], a[24:27], v[54:57]
    v_mfma_f32_16x16x32_bf16 v[86:89], v[6:9], a[28:31], v[86:89]
    ds_read_b128 v[6:9], v3 offset:36864
    s_waitcnt lgkmcnt(3)
    v_mfma_f32_16x16x32_bf16 v[58:61], v[10:13], a[24:27], v[58:61]
    v_mfma_f32_16x16x32_bf16 v[90:93], v[10:13], a[28:31], v[90:93]
    ds_read_b128 v[10:13], v3 offset:37888
    s_waitcnt lgkmcnt(3)
    v_mfma_f32_16x16x32_bf16 v[62:65], v[14:17], a[24:27], v[62:65]
    v_mfma_f32_16x16x32_bf16 v[94:97], v[14:17], a[28:31], v[94:97]
    ds_read_b128 v[14:17], v3 offset:38912
    s_waitcnt lgkmcnt(3)
    v_mfma_f32_16x16x32_bf16 v[66:69], v[18:21], a[24:27], v[66:69]
    v_mfma_f32_16x16x32_bf16 v[98:101], v[18:21], a[28:31], v[98:101]
    ds_read_b128 v[18:21], v3 offset:39936
    s_waitcnt lgkmcnt(3)
    v_mfma_f32_16x16x32_bf16 v[54:57], v[6:9], a[32:35], v[54:57]
    v_mfma_f32_16x16x32_bf16 v[86:89], v[6:9], a[36:39], v[86:89]
    ds_read_b128 v[6:9], v3 offset:45056
    s_waitcnt lgkmcnt(3)
    v_mfma_f32_16x16x32_bf16 v[58:61], v[10:13], a[32:35], v[58:61]
    v_mfma_f32_16x16x32_bf16 v[90:93], v[10:13], a[36:39], v[90:93]
    ds_read_b128 v[10:13], v3 offset:46080
    s_waitcnt lgkmcnt(3)
    v_mfma_f32_16x16x32_bf16 v[62:65], v[14:17], a[32:35], v[62:65]
    v_mfma_f32_16x16x32_bf16 v[94:97], v[14:17], a[36:39], v[94:97]
    ds_read_b128 v[14:17], v3 offset:47104
    s_waitcnt lgkmcnt(3)
    v_mfma_f32_16x16x32_bf16 v[66:69], v[18:21], a[32:35], v[66:69]
    v_mfma_f32_16x16x32_bf16 v[98:101], v[18:21], a[36:39], v[98:101]
    ds_read_b128 v[18:21], v3 offset:48128
    s_waitcnt vmcnt(32)
    s_barrier
    s_waitcnt lgkmcnt(3)
    v_mfma_f32_16x16x32_bf16 v[54:57], v[6:9], a[40:43], v[54:57]
    v_mfma_f32_16x16x32_bf16 v[86:89], v[6:9], a[44:47], v[86:89]
    ds_read_b128 v[6:9], v3 offset:53248
    s_waitcnt lgkmcnt(3)
    v_mfma_f32_16x16x32_bf16 v[58:61], v[10:13], a[40:43], v[58:61]
    v_mfma_f32_16x16x32_bf16 v[90:93], v[10:13], a[44:47], v[90:93]
    ds_read_b128 v[10:13], v3 offset:54272
    s_waitcnt lgkmcnt(3)
    v_mfma_f32_16x16x32_bf16 v[62:65], v[14:17], a[40:43], v[62:65]
    v_mfma_f32_16x16x32_bf16 v[94:97], v[14:17], a[44:47], v[94:97]
    ds_read_b128 v[14:17], v3 offset:55296
    s_waitcnt lgkmcnt(3)
    v_mfma_f32_16x16x32_bf16 v[66:69], v[18:21], a[40:43], v[66:69]
    v_mfma_f32_16x16x32_bf16 v[98:101], v[18:21], a[44:47], v[98:101]
    ds_read_b128 v[18:21], v3 offset:56320
    s_waitcnt lgkmcnt(3)
    v_mfma_f32_16x16x32_bf16 v[54:57], v[6:9], a[48:51], v[54:57]
    v_mfma_f32_16x16x32_bf16 v[86:89], v[6:9], a[52:55], v[86:89]
    ds_read_b128 v[6:9], v3 offset:61440
    s_waitcnt lgkmcnt(3)
    v_mfma_f32_16x16x32_bf16 v[58:61], v[10:13], a[48:51], v[58:61]
    v_mfma_f32_16x16x32_bf16 v[90:93], v[10:13], a[52:55], v[90:93]
    ds_read_b128 v[10:13], v3 offset:62464
    s_waitcnt lgkmcnt(3)
    v_mfma_f32_16x16x32_bf16 v[62:65], v[14:17], a[48:51], v[62:65]
    v_mfma_f32_16x16x32_bf16 v[94:97], v[14:17], a[52:55], v[94:97]
    ds_read_b128 v[14:17], v3 offset:63488
    s_waitcnt lgkmcnt(3)
    v_mfma_f32_16x16x32_bf16 v[66:69], v[18:21], a[48:51], v[66:69]
    v_mfma_f32_16x16x32_bf16 v[98:101], v[18:21], a[52:55], v[98:101]
    ds_read_b128 v[18:21], v3 offset:64512
    s_waitcnt vmcnt(24)
    s_barrier
    s_waitcnt lgkmcnt(3)
    v_mfma_f32_16x16x32_bf16 v[54:57], v[6:9], a[56:59], v[54:57]
    v_mfma_f32_16x16x32_bf16 v[86:89], v[6:9], a[60:63], v[86:89]
    ds_read_b128 v[6:9], v4 offset:4096
    s_waitcnt lgkmcnt(3)
    v_mfma_f32_16x16x32_bf16 v[58:61], v[10:13], a[56:59], v[58:61]
    v_mfma_f32_16x16x32_bf16 v[90:93], v[10:13], a[60:63], v[90:93]
    ds_read_b128 v[10:13], v4 offset:5120
    s_waitcnt lgkmcnt(3)
    v_mfma_f32_16x16x32_bf16 v[62:65], v[14:17], a[56:59], v[62:65]
    v_mfma_f32_16x16x32_bf16 v[94:97], v[14:17], a[60:63], v[94:97]
    ds_read_b128 v[14:17], v4 offset:6144
    s_waitcnt lgkmcnt(3)
    v_mfma_f32_16x16x32_bf16 v[66:69], v[18:21], a[56:59], v[66:69]
    v_mfma_f32_16x16x32_bf16 v[98:101], v[18:21], a[60:63], v[98:101]
    ds_read_b128 v[18:21], v4 offset:7168
    s_waitcnt lgkmcnt(3)
    v_mfma_f32_16x16x32_bf16 v[54:57], v[6:9], a[64:67], v[54:57]
    v_mfma_f32_16x16x32_bf16 v[86:89], v[6:9], a[68:71], v[86:89]
    ds_read_b128 v[6:9], v4 offset:12288
    s_waitcnt lgkmcnt(3)
    v_mfma_f32_16x16x32_bf16 v[58:61], v[10:13], a[64:67], v[58:61]
    v_mfma_f32_16x16x32_bf16 v[90:93], v[10:13], a[68:71], v[90:93]
    ds_read_b128 v[10:13], v4 offset:13312
    s_waitcnt lgkmcnt(3)
    v_mfma_f32_16x16x32_bf16 v[62:65], v[14:17], a[64:67], v[62:65]
    v_mfma_f32_16x16x32_bf16 v[94:97], v[14:17], a[68:71], v[94:97]
    ds_read_b128 v[14:17], v4 offset:14336
    s_waitcnt lgkmcnt(3)
    v_mfma_f32_16x16x32_bf16 v[66:69], v[18:21], a[64:67], v[66:69]
    v_mfma_f32_16x16x32_bf16 v[98:101], v[18:21], a[68:71], v[98:101]
    ds_read_b128 v[18:21], v4 offset:15360
    s_waitcnt vmcnt(16)
    s_barrier
    s_waitcnt lgkmcnt(3)
    v_mfma_f32_16x16x32_bf16 v[54:57], v[6:9], a[72:75], v[54:57]
    v_mfma_f32_16x16x32_bf16 v[86:89], v[6:9], a[76:79], v[86:89]
    ds_read_b128 v[6:9], v4 offset:20480
    s_waitcnt lgkmcnt(3)
    v_mfma_f32_16x16x32_bf16 v[58:61], v[10:13], a[72:75], v[58:61]
    v_mfma_f32_16x16x32_bf16 v[90:93], v[10:13], a[76:79], v[90:93]
    ds_read_b128 v[10:13], v4 offset:21504
    s_waitcnt lgkmcnt(3)
    v_mfma_f32_16x16x32_bf16 v[62:65], v[14:17], a[72:75], v[62:65]
    v_mfma_f32_16x16x32_bf16 v[94:97], v[14:17], a[76:79], v[94:97]
    ds_read_b128 v[14:17], v4 offset:22528
    s_waitcnt lgkmcnt(3)
    v_mfma_f32_16x16x32_bf16 v[66:69], v[18:21], a[72:75], v[66:69]
    v_mfma_f32_16x16x32_bf16 v[98:101], v[18:21], a[76:79], v[98:101]
    ds_read_b128 v[18:21], v4 offset:23552
    s_waitcnt lgkmcnt(3)
    v_mfma_f32_16x16x32_bf16 v[54:57], v[6:9], a[80:83], v[54:57]
    v_mfma_f32_16x16x32_bf16 v[86:89], v[6:9], a[84:87], v[86:89]
    ds_read_b128 v[6:9], v4 offset:28672
    s_waitcnt lgkmcnt(3)
    v_mfma_f32_16x16x32_bf16 v[58:61], v[10:13], a[80:83], v[58:61]
    v_mfma_f32_16x16x32_bf16 v[90:93], v[10:13], a[84:87], v[90:93]
    ds_read_b128 v[10:13], v4 offset:29696
    s_waitcnt lgkmcnt(3)
    v_mfma_f32_16x16x32_bf16 v[62:65], v[14:17], a[80:83], v[62:65]
    v_mfma_f32_16x16x32_bf16 v[94:97], v[14:17], a[84:87], v[94:97]
    ds_read_b128 v[14:17], v4 offset:30720
    s_waitcnt lgkmcnt(3)
    v_mfma_f32_16x16x32_bf16 v[66:69], v[18:21], a[80:83], v[66:69]
    v_mfma_f32_16x16x32_bf16 v[98:101], v[18:21], a[84:87], v[98:101]
    ds_read_b128 v[18:21], v4 offset:31744
    s_waitcnt vmcnt(8)
    s_barrier
    s_waitcnt lgkmcnt(3)
    v_mfma_f32_16x16x32_bf16 v[54:57], v[6:9], a[88:91], v[54:57]
    v_mfma_f32_16x16x32_bf16 v[86:89], v[6:9], a[92:95], v[86:89]
    ds_read_b128 v[6:9], v4 offset:36864
    s_waitcnt lgkmcnt(3)
    v_mfma_f32_16x16x32_bf16 v[58:61], v[10:13], a[88:91], v[58:61]
    v_mfma_f32_16x16x32_bf16 v[90:93], v[10:13], a[92:95], v[90:93]
    ds_read_b128 v[10:13], v4 offset:37888
    s_waitcnt lgkmcnt(3)
    v_mfma_f32_16x16x32_bf16 v[62:65], v[14:17], a[88:91], v[62:65]
    v_mfma_f32_16x16x32_bf16 v[94:97], v[14:17], a[92:95], v[94:97]
    ds_read_b128 v[14:17], v4 offset:38912
    s_waitcnt lgkmcnt(3)
    v_mfma_f32_16x16x32_bf16 v[66:69], v[18:21], a[88:91], v[66:69]
    v_mfma_f32_16x16x32_bf16 v[98:101], v[18:21], a[92:95], v[98:101]
    ds_read_b128 v[18:21], v4 offset:39936
    s_waitcnt lgkmcnt(3)
    v_mfma_f32_16x16x32_bf16 v[54:57], v[6:9], a[96:99], v[54:57]
    v_mfma_f32_16x16x32_bf16 v[86:89], v[6:9], a[100:103], v[86:89]
    ds_read_b128 v[6:9], v4 offset:45056
    s_waitcnt lgkmcnt(3)
    v_mfma_f32_16x16x32_bf16 v[58:61], v[10:13], a[96:99], v[58:61]
    v_mfma_f32_16x16x32_bf16 v[90:93], v[10:13], a[100:103], v[90:93]
    ds_read_b128 v[10:13], v4 offset:46080
    s_waitcnt lgkmcnt(3)
    v_mfma_f32_16x16x32_bf16 v[62:65], v[14:17], a[96:99], v[62:65]
    v_mfma_f32_16x16x32_bf16 v[94:97], v[14:17], a[100:103], v[94:97]
    ds_read_b128 v[14:17], v4 offset:47104
    s_waitcnt lgkmcnt(3)
    v_mfma_f32_16x16x32_bf16 v[66:69], v[18:21], a[96:99], v[66:69]
    v_mfma_f32_16x16x32_bf16 v[98:101], v[18:21], a[100:103], v[98:101]
    ds_read_b128 v[18:21], v4 offset:48128
    s_waitcnt lgkmcnt(3)
    v_mfma_f32_16x16x32_bf16 v[54:57], v[6:9], a[104:107], v[54:57]
    v_mfma_f32_16x16x32_bf16 v[86:89], v[6:9], a[108:111], v[86:89]
    ds_read_b128 v[6:9], v3 offset:16384
    s_waitcnt lgkmcnt(3)
    v_mfma_f32_16x16x32_bf16 v[58:61], v[10:13], a[104:107], v[58:61]
    v_mfma_f32_16x16x32_bf16 v[90:93], v[10:13], a[108:111], v[90:93]
    ds_read_b128 v[10:13], v3 offset:17408
    s_waitcnt lgkmcnt(3)
    v_mfma_f32_16x16x32_bf16 v[62:65], v[14:17], a[104:107], v[62:65]
    v_mfma_f32_16x16x32_bf16 v[94:97], v[14:17], a[108:111], v[94:97]
    ds_read_b128 v[14:17], v3 offset:18432
    s_waitcnt lgkmcnt(3)
    v_mfma_f32_16x16x32_bf16 v[66:69], v[18:21], a[104:107], v[66:69]
    v_mfma_f32_16x16x32_bf16 v[98:101], v[18:21], a[108:111], v[98:101]
    ds_read_b128 v[18:21], v3 offset:19456
    v_cvt_pk_bf16_f32 v144, v54, v55
    v_cvt_pk_bf16_f32 v145, v56, v57
    v_cvt_pk_bf16_f32 v146, v58, v59
    v_cvt_pk_bf16_f32 v147, v60, v61
    buffer_store_dwordx4 v[144:147], v182, s[52:55], 0 offen offset:0 sc1
    v_cvt_pk_bf16_f32 v148, v62, v63
    v_cvt_pk_bf16_f32 v149, v64, v65
    v_cvt_pk_bf16_f32 v150, v66, v67
    v_cvt_pk_bf16_f32 v151, v68, v69
    buffer_store_dwordx4 v[148:151], v182, s[52:55], 0 offen offset:1024 sc1
    v_cvt_pk_bf16_f32 v152, v86, v87
    v_cvt_pk_bf16_f32 v153, v88, v89
    v_cvt_pk_bf16_f32 v154, v90, v91
    v_cvt_pk_bf16_f32 v155, v92, v93
    buffer_store_dwordx4 v[152:155], v182, s[52:55], 0 offen offset:2048 sc1
    v_cvt_pk_bf16_f32 v156, v94, v95
    v_cvt_pk_bf16_f32 v157, v96, v97
    v_cvt_pk_bf16_f32 v158, v98, v99
    v_cvt_pk_bf16_f32 v159, v100, v101
    buffer_store_dwordx4 v[156:159], v182, s[52:55], 0 offen offset:3072 sc1
    s_waitcnt lgkmcnt(3)
    v_mfma_f32_16x16x32_bf16 v[38:41], v[6:9], a[16:19], v[38:41]
    v_mfma_f32_16x16x32_bf16 v[70:73], v[6:9], a[20:23], v[70:73]
    ds_read_b128 v[6:9], v3 offset:24576
    s_waitcnt lgkmcnt(3)
    v_mfma_f32_16x16x32_bf16 v[42:45], v[10:13], a[16:19], v[42:45]
    v_mfma_f32_16x16x32_bf16 v[74:77], v[10:13], a[20:23], v[74:77]
    ds_read_b128 v[10:13], v3 offset:25600
    s_waitcnt lgkmcnt(3)
    v_mfma_f32_16x16x32_bf16 v[46:49], v[14:17], a[16:19], v[46:49]
    v_mfma_f32_16x16x32_bf16 v[78:81], v[14:17], a[20:23], v[78:81]
    ds_read_b128 v[14:17], v3 offset:26624
    s_waitcnt lgkmcnt(3)
    v_mfma_f32_16x16x32_bf16 v[50:53], v[18:21], a[16:19], v[50:53]
    v_mfma_f32_16x16x32_bf16 v[82:85], v[18:21], a[20:23], v[82:85]
    ds_read_b128 v[18:21], v3 offset:27648
    s_waitcnt lgkmcnt(3)
    v_mfma_f32_16x16x32_bf16 v[38:41], v[6:9], a[24:27], v[38:41]
    v_mfma_f32_16x16x32_bf16 v[70:73], v[6:9], a[28:31], v[70:73]
    ds_read_b128 v[6:9], v3 offset:32768
    s_waitcnt lgkmcnt(3)
    v_mfma_f32_16x16x32_bf16 v[42:45], v[10:13], a[24:27], v[42:45]
    v_mfma_f32_16x16x32_bf16 v[74:77], v[10:13], a[28:31], v[74:77]
    ds_read_b128 v[10:13], v3 offset:33792
    s_waitcnt lgkmcnt(3)
    v_mfma_f32_16x16x32_bf16 v[46:49], v[14:17], a[24:27], v[46:49]
    v_mfma_f32_16x16x32_bf16 v[78:81], v[14:17], a[28:31], v[78:81]
    ds_read_b128 v[14:17], v3 offset:34816
    s_waitcnt lgkmcnt(3)
    v_mfma_f32_16x16x32_bf16 v[50:53], v[18:21], a[24:27], v[50:53]
    v_mfma_f32_16x16x32_bf16 v[82:85], v[18:21], a[28:31], v[82:85]
    ds_read_b128 v[18:21], v3 offset:35840
    s_waitcnt lgkmcnt(3)
    v_mfma_f32_16x16x32_bf16 v[38:41], v[6:9], a[32:35], v[38:41]
    v_mfma_f32_16x16x32_bf16 v[70:73], v[6:9], a[36:39], v[70:73]
    ds_read_b128 v[6:9], v3 offset:40960
    s_waitcnt lgkmcnt(3)
    v_mfma_f32_16x16x32_bf16 v[42:45], v[10:13], a[32:35], v[42:45]
    v_mfma_f32_16x16x32_bf16 v[74:77], v[10:13], a[36:39], v[74:77]
    ds_read_b128 v[10:13], v3 offset:41984
    s_waitcnt lgkmcnt(3)
    v_mfma_f32_16x16x32_bf16 v[46:49], v[14:17], a[32:35], v[46:49]
    v_mfma_f32_16x16x32_bf16 v[78:81], v[14:17], a[36:39], v[78:81]
    ds_read_b128 v[14:17], v3 offset:43008
    s_waitcnt lgkmcnt(3)
    v_mfma_f32_16x16x32_bf16 v[50:53], v[18:21], a[32:35], v[50:53]
    v_mfma_f32_16x16x32_bf16 v[82:85], v[18:21], a[36:39], v[82:85]
    ds_read_b128 v[18:21], v3 offset:44032
    s_waitcnt lgkmcnt(3)
    v_mfma_f32_16x16x32_bf16 v[38:41], v[6:9], a[40:43], v[38:41]
    v_mfma_f32_16x16x32_bf16 v[70:73], v[6:9], a[44:47], v[70:73]
    ds_read_b128 v[6:9], v3 offset:49152
    s_waitcnt lgkmcnt(3)
    v_mfma_f32_16x16x32_bf16 v[42:45], v[10:13], a[40:43], v[42:45]
    v_mfma_f32_16x16x32_bf16 v[74:77], v[10:13], a[44:47], v[74:77]
    ds_read_b128 v[10:13], v3 offset:50176
    s_waitcnt lgkmcnt(3)
    v_mfma_f32_16x16x32_bf16 v[46:49], v[14:17], a[40:43], v[46:49]
    v_mfma_f32_16x16x32_bf16 v[78:81], v[14:17], a[44:47], v[78:81]
    ds_read_b128 v[14:17], v3 offset:51200
    s_waitcnt lgkmcnt(3)
    v_mfma_f32_16x16x32_bf16 v[50:53], v[18:21], a[40:43], v[50:53]
    v_mfma_f32_16x16x32_bf16 v[82:85], v[18:21], a[44:47], v[82:85]
    ds_read_b128 v[18:21], v3 offset:52224
    s_waitcnt lgkmcnt(3)
    v_mfma_f32_16x16x32_bf16 v[38:41], v[6:9], a[48:51], v[38:41]
    v_mfma_f32_16x16x32_bf16 v[70:73], v[6:9], a[52:55], v[70:73]
    ds_read_b128 v[6:9], v3 offset:57344
    s_waitcnt lgkmcnt(3)
    v_mfma_f32_16x16x32_bf16 v[42:45], v[10:13], a[48:51], v[42:45]
    v_mfma_f32_16x16x32_bf16 v[74:77], v[10:13], a[52:55], v[74:77]
    ds_read_b128 v[10:13], v3 offset:58368
    s_waitcnt lgkmcnt(3)
    v_mfma_f32_16x16x32_bf16 v[46:49], v[14:17], a[48:51], v[46:49]
    v_mfma_f32_16x16x32_bf16 v[78:81], v[14:17], a[52:55], v[78:81]
    ds_read_b128 v[14:17], v3 offset:59392
    s_waitcnt lgkmcnt(3)
    v_mfma_f32_16x16x32_bf16 v[50:53], v[18:21], a[48:51], v[50:53]
    v_mfma_f32_16x16x32_bf16 v[82:85], v[18:21], a[52:55], v[82:85]
    ds_read_b128 v[18:21], v3 offset:60416
    s_waitcnt lgkmcnt(3)
    v_mfma_f32_16x16x32_bf16 v[38:41], v[6:9], a[56:59], v[38:41]
    v_mfma_f32_16x16x32_bf16 v[70:73], v[6:9], a[60:63], v[70:73]
    ds_read_b128 v[6:9], v4 offset:0
    s_waitcnt lgkmcnt(3)
    v_mfma_f32_16x16x32_bf16 v[42:45], v[10:13], a[56:59], v[42:45]
    v_mfma_f32_16x16x32_bf16 v[74:77], v[10:13], a[60:63], v[74:77]
    ds_read_b128 v[10:13], v4 offset:1024
    s_waitcnt lgkmcnt(3)
    v_mfma_f32_16x16x32_bf16 v[46:49], v[14:17], a[56:59], v[46:49]
    v_mfma_f32_16x16x32_bf16 v[78:81], v[14:17], a[60:63], v[78:81]
    ds_read_b128 v[14:17], v4 offset:2048
    s_waitcnt lgkmcnt(3)
    v_mfma_f32_16x16x32_bf16 v[50:53], v[18:21], a[56:59], v[50:53]
    v_mfma_f32_16x16x32_bf16 v[82:85], v[18:21], a[60:63], v[82:85]
    ds_read_b128 v[18:21], v4 offset:3072
    v_mov_b32 v187, 1
    s_waitcnt vmcnt(0)
    buffer_store_dword v187, v184, s[56:59], 0 offen sc1
    s_waitcnt lgkmcnt(3)
    v_mfma_f32_16x16x32_bf16 v[38:41], v[6:9], a[64:67], v[38:41]
    v_mfma_f32_16x16x32_bf16 v[70:73], v[6:9], a[68:71], v[70:73]
    ds_read_b128 v[6:9], v4 offset:8192
    s_waitcnt lgkmcnt(3)
    v_mfma_f32_16x16x32_bf16 v[42:45], v[10:13], a[64:67], v[42:45]
    v_mfma_f32_16x16x32_bf16 v[74:77], v[10:13], a[68:71], v[74:77]
    ds_read_b128 v[10:13], v4 offset:9216
    s_waitcnt lgkmcnt(3)
    v_mfma_f32_16x16x32_bf16 v[46:49], v[14:17], a[64:67], v[46:49]
    v_mfma_f32_16x16x32_bf16 v[78:81], v[14:17], a[68:71], v[78:81]
    ds_read_b128 v[14:17], v4 offset:10240
    s_waitcnt lgkmcnt(3)
    v_mfma_f32_16x16x32_bf16 v[50:53], v[18:21], a[64:67], v[50:53]
    v_mfma_f32_16x16x32_bf16 v[82:85], v[18:21], a[68:71], v[82:85]
    ds_read_b128 v[18:21], v4 offset:11264
    s_waitcnt lgkmcnt(3)
    v_mfma_f32_16x16x32_bf16 v[38:41], v[6:9], a[72:75], v[38:41]
    v_mfma_f32_16x16x32_bf16 v[70:73], v[6:9], a[76:79], v[70:73]
    ds_read_b128 v[6:9], v4 offset:16384
    s_waitcnt lgkmcnt(3)
    v_mfma_f32_16x16x32_bf16 v[42:45], v[10:13], a[72:75], v[42:45]
    v_mfma_f32_16x16x32_bf16 v[74:77], v[10:13], a[76:79], v[74:77]
    ds_read_b128 v[10:13], v4 offset:17408
    s_waitcnt lgkmcnt(3)
    v_mfma_f32_16x16x32_bf16 v[46:49], v[14:17], a[72:75], v[46:49]
    v_mfma_f32_16x16x32_bf16 v[78:81], v[14:17], a[76:79], v[78:81]
    ds_read_b128 v[14:17], v4 offset:18432
    s_waitcnt lgkmcnt(3)
    v_mfma_f32_16x16x32_bf16 v[50:53], v[18:21], a[72:75], v[50:53]
    v_mfma_f32_16x16x32_bf16 v[82:85], v[18:21], a[76:79], v[82:85]
    ds_read_b128 v[18:21], v4 offset:19456
    s_waitcnt lgkmcnt(3)
    v_mfma_f32_16x16x32_bf16 v[38:41], v[6:9], a[80:83], v[38:41]
    v_mfma_f32_16x16x32_bf16 v[70:73], v[6:9], a[84:87], v[70:73]
    ds_read_b128 v[6:9], v4 offset:24576
    s_waitcnt lgkmcnt(3)
    v_mfma_f32_16x16x32_bf16 v[42:45], v[10:13], a[80:83], v[42:45]
    v_mfma_f32_16x16x32_bf16 v[74:77], v[10:13], a[84:87], v[74:77]
    ds_read_b128 v[10:13], v4 offset:25600
    s_waitcnt lgkmcnt(3)
    v_mfma_f32_16x16x32_bf16 v[46:49], v[14:17], a[80:83], v[46:49]
    v_mfma_f32_16x16x32_bf16 v[78:81], v[14:17], a[84:87], v[78:81]
    ds_read_b128 v[14:17], v4 offset:26624
    s_waitcnt lgkmcnt(3)
    v_mfma_f32_16x16x32_bf16 v[50:53], v[18:21], a[80:83], v[50:53]
    v_mfma_f32_16x16x32_bf16 v[82:85], v[18:21], a[84:87], v[82:85]
    ds_read_b128 v[18:21], v4 offset:27648
    s_waitcnt lgkmcnt(3)
    v_mfma_f32_16x16x32_bf16 v[38:41], v[6:9], a[88:91], v[38:41]
    v_mfma_f32_16x16x32_bf16 v[70:73], v[6:9], a[92:95], v[70:73]
    ds_read_b128 v[6:9], v4 offset:32768
    s_waitcnt lgkmcnt(3)
    v_mfma_f32_16x16x32_bf16 v[42:45], v[10:13], a[88:91], v[42:45]
    v_mfma_f32_16x16x32_bf16 v[74:77], v[10:13], a[92:95], v[74:77]
    ds_read_b128 v[10:13], v4 offset:33792
    s_waitcnt lgkmcnt(3)
    v_mfma_f32_16x16x32_bf16 v[46:49], v[14:17], a[88:91], v[46:49]
    v_mfma_f32_16x16x32_bf16 v[78:81], v[14:17], a[92:95], v[78:81]
    ds_read_b128 v[14:17], v4 offset:34816
    s_waitcnt lgkmcnt(3)
    v_mfma_f32_16x16x32_bf16 v[50:53], v[18:21], a[88:91], v[50:53]
    v_mfma_f32_16x16x32_bf16 v[82:85], v[18:21], a[92:95], v[82:85]
    ds_read_b128 v[18:21], v4 offset:35840
    s_waitcnt lgkmcnt(3)
    v_mfma_f32_16x16x32_bf16 v[38:41], v[6:9], a[96:99], v[38:41]
    v_mfma_f32_16x16x32_bf16 v[70:73], v[6:9], a[100:103], v[70:73]
    ds_read_b128 v[6:9], v4 offset:40960
    s_waitcnt lgkmcnt(3)
    v_mfma_f32_16x16x32_bf16 v[42:45], v[10:13], a[96:99], v[42:45]
    v_mfma_f32_16x16x32_bf16 v[74:77], v[10:13], a[100:103], v[74:77]
    ds_read_b128 v[10:13], v4 offset:41984
    s_waitcnt lgkmcnt(3)
    v_mfma_f32_16x16x32_bf16 v[46:49], v[14:17], a[96:99], v[46:49]
    v_mfma_f32_16x16x32_bf16 v[78:81], v[14:17], a[100:103], v[78:81]
    ds_read_b128 v[14:17], v4 offset:43008
    s_waitcnt lgkmcnt(3)
    v_mfma_f32_16x16x32_bf16 v[50:53], v[18:21], a[96:99], v[50:53]
    v_mfma_f32_16x16x32_bf16 v[82:85], v[18:21], a[100:103], v[82:85]
    ds_read_b128 v[18:21], v4 offset:44032
    buffer_load_dword v186, v185, s[56:59], 0 offen sc1
    s_waitcnt lgkmcnt(3)
    v_mfma_f32_16x16x32_bf16 v[38:41], v[6:9], a[104:107], v[38:41]
    v_mfma_f32_16x16x32_bf16 v[70:73], v[6:9], a[108:111], v[70:73]
    s_waitcnt lgkmcnt(2)
    v_mfma_f32_16x16x32_bf16 v[42:45], v[10:13], a[104:107], v[42:45]
    v_mfma_f32_16x16x32_bf16 v[74:77], v[10:13], a[108:111], v[74:77]
    s_waitcnt lgkmcnt(1)
    v_mfma_f32_16x16x32_bf16 v[46:49], v[14:17], a[104:107], v[46:49]
    v_mfma_f32_16x16x32_bf16 v[78:81], v[14:17], a[108:111], v[78:81]
    s_waitcnt lgkmcnt(0)
    v_mfma_f32_16x16x32_bf16 v[50:53], v[18:21], a[104:107], v[50:53]
    v_mfma_f32_16x16x32_bf16 v[82:85], v[18:21], a[108:111], v[82:85]
    s_mov_b32 s41, 0x80000
    s_waitcnt vmcnt(0)
    v_readfirstlane_b32 s39, v186
    s_nop 0
    s_cmp_eq_u32 s39, 1
    s_cbranch_scc1 L_g4_go
    s_nop 4
L_g4_poll:
    buffer_load_dword v186, v185, s[56:59], 0 offen sc1
    s_sub_u32 s41, s41, 1
    s_waitcnt vmcnt(0)
    v_readfirstlane_b32 s39, v186
    s_cmp_eq_u32 s41, 0
    s_cbranch_scc1 L_g4_go
    s_cmp_eq_u32 s39, 1
    s_cbranch_scc0 L_g4_poll
L_g4_go:
    s_nop 4
    buffer_load_dwordx4 v[144:147], v183, s[52:55], 0 offen offset:0 sc1
    buffer_load_dwordx4 v[148:151], v183, s[52:55], 0 offen offset:1024 sc1
    buffer_load_dwordx4 v[152:155], v183, s[52:55], 0 offen offset:2048 sc1
    buffer_load_dwordx4 v[156:159], v183, s[52:55], 0 offen offset:3072 sc1
    v_lshlrev_b32 v190, 16, v112
    v_and_b32 v191, 0xffff0000, v112
    v_lshlrev_b32 v192, 16, v113
    v_and_b32 v193, 0xffff0000, v113
    v_lshlrev_b32 v194, 16, v114
    v_and_b32 v195, 0xffff0000, v114
    v_lshlrev_b32 v196, 16, v115
    v_and_b32 v197, 0xffff0000, v115
    v_pk_add_f32 v[38:39], v[38:39], v[190:191]
    v_pk_add_f32 v[40:41], v[40:41], v[192:193]
    v_pk_add_f32 v[42:43], v[42:43], v[194:195]
    v_pk_add_f32 v[44:45], v[44:45], v[196:197]
    v_lshlrev_b32 v190, 16, v128
    v_and_b32 v191, 0xffff0000, v128
    v_lshlrev_b32 v192, 16, v129
    v_and_b32 v193, 0xffff0000, v129
    v_lshlrev_b32 v194, 16, v130
    v_and_b32 v195, 0xffff0000, v130
    v_lshlrev_b32 v196, 16, v131
    v_and_b32 v197, 0xffff0000, v131
    v_pk_add_f32 v[38:39], v[38:39], v[190:191]
    v_pk_add_f32 v[40:41], v[40:41], v[192:193]
    v_pk_add_f32 v[42:43], v[42:43], v[194:195]
    v_pk_add_f32 v[44:45], v[44:45], v[196:197]
    v_lshlrev_b32 v190, 16, v116
    v_and_b32 v191, 0xffff0000, v116
    v_lshlrev_b32 v192, 16, v117
    v_and_b32 v193, 0xffff0000, v117
    v_lshlrev_b32 v194, 16, v118
    v_and_b32 v195, 0xffff0000, v118
    v_lshlrev_b32 v196, 16, v119
    v_and_b32 v197, 0xffff0000, v119
    v_pk_add_f32 v[46:47], v[46:47], v[190:191]
    v_pk_add_f32 v[48:49], v[48:49], v[192:193]
    v_pk_add_f32 v[50:51], v[50:51], v[194:195]
    v_pk_add_f32 v[52:53], v[52:53], v[196:197]
    v_lshlrev_b32 v190, 16, v132
    v_and_b32 v191, 0xffff0000, v132
    v_lshlrev_b32 v192, 16, v133
    v_and_b32 v193, 0xffff0000, v133
    v_lshlrev_b32 v194, 16, v134
    v_and_b32 v195, 0xffff0000, v134
    v_lshlrev_b32 v196, 16, v135
    v_and_b32 v197, 0xffff0000, v135
    v_pk_add_f32 v[46:47], v[46:47], v[190:191]
    v_pk_add_f32 v[48:49], v[48:49], v[192:193]
    v_pk_add_f32 v[50:51], v[50:51], v[194:195]
    v_pk_add_f32 v[52:53], v[52:53], v[196:197]
    v_lshlrev_b32 v190, 16, v120
    v_and_b32 v191, 0xffff0000, v120
    v_lshlrev_b32 v192, 16, v121
    v_and_b32 v193, 0xffff0000, v121
    v_lshlrev_b32 v194, 16, v122
    v_and_b32 v195, 0xffff0000, v122
    v_lshlrev_b32 v196, 16, v123
    v_and_b32 v197, 0xffff0000, v123
    v_pk_add_f32 v[70:71], v[70:71], v[190:191]
    v_pk_add_f32 v[72:73], v[72:73], v[192:193]
    v_pk_add_f32 v[74:75], v[74:75], v[194:195]
    v_pk_add_f32 v[76:77], v[76:77], v[196:197]
    v_lshlrev_b32 v190, 16, v136
    v_and_b32 v191, 0xffff0000, v136
    v_lshlrev_b32 v192, 16, v137
    v_and_b32 v193, 0xffff0000, v137
    v_lshlrev_b32 v194, 16, v138
    v_and_b32 v195, 0xffff0000, v138
    v_lshlrev_b32 v196, 16, v139
    v_and_b32 v197, 0xffff0000, v139
    v_pk_add_f32 v[70:71], v[70:71], v[190:191]
    v_pk_add_f32 v[72:73], v[72:73], v[192:193]
    v_pk_add_f32 v[74:75], v[74:75], v[194:195]
    v_pk_add_f32 v[76:77], v[76:77], v[196:197]
    v_lshlrev_b32 v190, 16, v124
    v_and_b32 v191, 0xffff0000, v124
    v_lshlrev_b32 v192, 16, v125
    v_and_b32 v193, 0xffff0000, v125
    v_lshlrev_b32 v194, 16, v126
    v_and_b32 v195, 0xffff0000, v126
    v_lshlrev_b32 v196, 16, v127
    v_and_b32 v197, 0xffff0000, v127
    v_pk_add_f32 v[78:79], v[78:79], v[190:191]
    v_pk_add_f32 v[80:81], v[80:81], v[192:193]
    v_pk_add_f32 v[82:83], v[82:83], v[194:195]
    v_pk_add_f32 v[84:85], v[84:85], v[196:197]
    v_lshlrev_b32 v190, 16, v140
    v_and_b32 v191, 0xffff0000, v140
    v_lshlrev_b32 v192, 16, v141
    v_and_b32 v193, 0xffff0000, v141
    v_lshlrev_b32 v194, 16, v142
    v_and_b32 v195, 0xffff0000, v142
    v_lshlrev_b32 v196, 16, v143
    v_and_b32 v197, 0xffff0000, v143
    v_pk_add_f32 v[78:79], v[78:79], v[190:191]
    v_pk_add_f32 v[80:81], v[80:81], v[192:193]
    v_pk_add_f32 v[82:83], v[82:83], v[194:195]
    v_pk_add_f32 v[84:85], v[84:85], v[196:197]
    s_waitcnt vmcnt(3)
    v_lshlrev_b32 v190, 16, v144
    v_and_b32 v191, 0xffff0000, v144
    v_pk_add_f32 v[38:39], v[38:39], v[190:191]
    v_lshlrev_b32 v192, 16, v145
    v_and_b32 v193, 0xffff0000, v145
    v_pk_add_f32 v[40:41], v[40:41], v[192:193]
    v_lshlrev_b32 v194, 16, v146
    v_and_b32 v195, 0xffff0000, v146
    v_pk_add_f32 v[42:43], v[42:43], v[194:195]
    v_lshlrev_b32 v196, 16, v147
    v_and_b32 v197, 0xffff0000, v147
    v_pk_add_f32 v[44:45], v[44:45], v[196:197]
    v_cvt_pk_bf16_f32 v198, v38, v39
    v_cvt_pk_bf16_f32 v199, v40, v41
    v_cvt_pk_bf16_f32 v200, v42, v43
    v_cvt_pk_bf16_f32 v201, v44, v45
    ds_write_b64 v177, v[198:199] offset:0
    ds_write_b64 v178, v[200:201] offset:0
    s_waitcnt vmcnt(2)
    v_lshlrev_b32 v190, 16, v148
    v_and_b32 v191, 0xffff0000, v148
    v_pk_add_f32 v[46:47], v[46:47], v[190:191]
    v_lshlrev_b32 v192, 16, v149
    v_and_b32 v193, 0xffff0000, v149
    v_pk_add_f32 v[48:49], v[48:49], v[192:193]
    v_lshlrev_b32 v194, 16, v150
    v_and_b32 v195, 0xffff0000, v150
    v_pk_add_f32 v[50:51], v[50:51], v[194:195]
    v_lshlrev_b32 v196, 16, v151
    v_and_b32 v197, 0xffff0000, v151
    v_pk_add_f32 v[52:53], v[52:53], v[196:197]
    v_cvt_pk_bf16_f32 v202, v46, v47
    v_cvt_pk_bf16_f32 v203, v48, v49
    v_cvt_pk_bf16_f32 v204, v50, v51
    v_cvt_pk_bf16_f32 v205, v52, v53
    ds_write_b64 v179, v[202:203] offset:0
    ds_write_b64 v180, v[204:205] offset:0
    s_waitcnt vmcnt(1)
    v_lshlrev_b32 v190, 16, v152
    v_and_b32 v191, 0xffff0000, v152
    v_pk_add_f32 v[70:71], v[70:71], v[190:191]
    v_lshlrev_b32 v192, 16, v153
    v_and_b32 v193, 0xffff0000, v153
    v_pk_add_f32 v[72:73], v[72:73], v[192:193]
    v_lshlrev_b32 v194, 16, v154
    v_and_b32 v195, 0xffff0000, v154
    v_pk_add_f32 v[74:75], v[74:75], v[194:195]
    v_lshlrev_b32 v196, 16, v155
    v_and_b32 v197, 0xffff0000, v155
    v_pk_add_f32 v[76:77], v[76:77], v[196:197]
    v_cvt_pk_bf16_f32 v206, v70, v71
    v_cvt_pk_bf16_f32 v207, v72, v73
    v_cvt_pk_bf16_f32 v208, v74, v75
    v_cvt_pk_bf16_f32 v209, v76, v77
    ds_write_b64 v177, v[206:207] offset:2048
    ds_write_b64 v178, v[208:209] offset:2048
    s_waitcnt vmcnt(0)
    v_lshlrev_b32 v190, 16, v156
    v_and_b32 v191, 0xffff0000, v156
    v_pk_add_f32 v[78:79], v[78:79], v[190:191]
    v_lshlrev_b32 v192, 16, v157
    v_and_b32 v193, 0xffff0000, v157
    v_pk_add_f32 v[80:81], v[80:81], v[192:193]
    v_lshlrev_b32 v194, 16, v158
    v_and_b32 v195, 0xffff0000, v158
    v_pk_add_f32 v[82:83], v[82:83], v[194:195]
    v_lshlrev_b32 v196, 16, v159
    v_and_b32 v197, 0xffff0000, v159
    v_pk_add_f32 v[84:85], v[84:85], v[196:197]
    v_cvt_pk_bf16_f32 v210, v78, v79
    v_cvt_pk_bf16_f32 v211, v80, v81
    v_cvt_pk_bf16_f32 v212, v82, v83
    v_cvt_pk_bf16_f32 v213, v84, v85
    ds_write_b64 v179, v[210:211] offset:2048
    ds_write_b64 v180, v[212:213] offset:2048
    s_waitcnt lgkmcnt(0)
    ds_read_b128 v[144:147], v181 offset:0
    ds_read_b128 v[148:151], v181 offset:1024
    ds_read_b128 v[152:155], v181 offset:2048
    ds_read_b128 v[156:159], v181 offset:3072
    s_mov_b32 s38, 0
    s_waitcnt lgkmcnt(3)
    buffer_store_dwordx4 v[144:147], v176, s[20:23], s38 offen nt
    s_add_u32 s38, s38, 16384
    s_waitcnt lgkmcnt(2)
    buffer_store_dwordx4 v[148:151], v176, s[20:23], s38 offen nt
    s_add_u32 s38, s38, 16384
    s_waitcnt lgkmcnt(1)
    buffer_store_dwordx4 v[152:155], v176, s[20:23], s38 offen nt
    s_add_u32 s38, s38, 16384
    s_waitcnt lgkmcnt(0)
    buffer_store_dwordx4 v[156:159], v176, s[20:23], s38 offen nt
L_k1_kernel_end:
    s_endpgm
L_g3_kernel_helper:
    s_sub_u32 s39, s39, 28
    s_lshl_b32 s39, s39, 3
    s_add_u32 s38, s38, s39
    s_and_b32 s33, s38, 3
    s_lshr_b32 s34, s38, 2
    s_mul_i32 s35, s33, 28
    s_mul_i32 s36, s32, 7
    s_add_u32 s35, s35, s36
    s_lshl_b32 s36, s35, 16
    s_lshl_b32 s39, s34, 8
    s_add_u32 s36, s36, s39
    s_mov_b32 s43, s34
    s_mul_i32 s34, s34, 112
    s_add_u32 s35, s35, s34
    s_lshl_b32 s35, s35, 13
    s_lshr_b32 s33, s33, 1
    s_lshl_b32 s33, s33, 2
    s_lshl_b32 s37, s32, 15
    v_lshrrev_b32 v1, 4, v0
    v_and_b32 v2, 15, v0
    v_add_u32 v3, 0, v1
    v_lshlrev_b32 v3, 1, v3
    v_xor_b32 v3, v3, v2
    v_lshlrev_b32 v3, 4, v3
    v_lshl_add_u32 v3, v1, 11, v3
    v_add_u32 v8, 0, v3
    v_add_u32 v10, 14336, v3
    v_add_u32 v12, 32768, v3
    v_add_u32 v14, 47104, v3
    v_add_u32 v3, 4, v1
    v_lshlrev_b32 v3, 1, v3
    v_xor_b32 v3, v3, v2
    v_lshlrev_b32 v3, 4, v3
    v_lshl_add_u32 v3, v1, 11, v3
    v_add_u32 v9, 7168, v3
    v_add_u32 v11, 21504, v3
    v_add_u32 v13, 39936, v3
    v_add_u32 v15, 54272, v3
    v_lshrrev_b32 v1, 2, v0
    v_and_b32 v2, 7, v1
    v_xor_b32 v2, s33, v2
    v_lshlrev_b32 v1, 8, v1
    v_and_b32 v3, 3, v0
    v_lshl_add_u32 v1, v3, 3, v1
    v_add_u32 v1, s37, v1
    v_xor_b32 v3, 0, v2
    v_lshl_add_u32 v16, v3, 5, v1
    v_xor_b32 v3, 1, v2
    v_lshl_add_u32 v17, v3, 5, v1
    v_xor_b32 v3, 2, v2
    v_lshl_add_u32 v18, v3, 5, v1
    v_xor_b32 v3, 3, v2
    v_lshl_add_u32 v19, v3, 5, v1
    v_xor_b32 v3, 4, v2
    v_lshl_add_u32 v20, v3, 5, v1
    v_xor_b32 v3, 5, v2
    v_lshl_add_u32 v21, v3, 5, v1
    v_xor_b32 v3, 6, v2
    v_lshl_add_u32 v22, v3, 5, v1
    v_xor_b32 v3, 7, v2
    v_lshl_add_u32 v23, v3, 5, v1
    v_lshlrev_b32 v4, 4, v0
    s_waitcnt lgkmcnt(0)
    s_mov_b32 s12, s8
    s_mov_b32 s13, s9
    s_mov_b32 s14, 7340032
    s_mov_b32 s15, 0x20000
    s_add_u32 s16, s6, 52428800
    s_addc_u32 s17, s7, 0
    s_mov_b32 s18, 7340032
    s_mov_b32 s19, 0x20000
    s_add_u32 m0, s37, 0
    s_nop 0
    buffer_load_dwordx4 v8, s[12:15], s36 offen offset:0 nt lds
    buffer_load_dwordx4 v9, s[12:15], s36 offen offset:1024 nt lds
    buffer_load_dwordx4 v10, s[12:15], s36 offen offset:2048 nt lds
    buffer_load_dwordx4 v11, s[12:15], s36 offen offset:3072 nt lds
    s_add_u32 m0, s37, 4096
    s_nop 0
    buffer_load_dwordx4 v12, s[12:15], s36 offen offset:0 nt lds
    buffer_load_dwordx4 v13, s[12:15], s36 offen offset:1024 nt lds
    buffer_load_dwordx4 v14, s[12:15], s36 offen offset:2048 nt lds
    buffer_load_dwordx4 v15, s[12:15], s36 offen offset:3072 nt lds
    s_add_u32 s36, s36, 65536
    s_add_u32 m0, s37, 8192
    s_nop 0
    buffer_load_dwordx4 v8, s[12:15], s36 offen offset:0 nt lds
    buffer_load_dwordx4 v9, s[12:15], s36 offen offset:1024 nt lds
    buffer_load_dwordx4 v10, s[12:15], s36 offen offset:2048 nt lds
    buffer_load_dwordx4 v11, s[12:15], s36 offen offset:3072 nt lds
    s_add_u32 m0, s37, 12288
    s_nop 0
    buffer_load_dwordx4 v12, s[12:15], s36 offen offset:0 nt lds
    buffer_load_dwordx4 v13, s[12:15], s36 offen offset:1024 nt lds
    buffer_load_dwordx4 v14, s[12:15], s36 offen offset:2048 nt lds
    buffer_load_dwordx4 v15, s[12:15], s36 offen offset:3072 nt lds
    s_add_u32 s36, s36, 65536
    s_add_u32 m0, s37, 16384
    s_nop 0
    buffer_load_dwordx4 v8, s[12:15], s36 offen offset:0 nt lds
    buffer_load_dwordx4 v9, s[12:15], s36 offen offset:1024 nt lds
    buffer_load_dwordx4 v10, s[12:15], s36 offen offset:2048 nt lds
    buffer_load_dwordx4 v11, s[12:15], s36 offen offset:3072 nt lds
    s_add_u32 m0, s37, 20480
    s_nop 0
    buffer_load_dwordx4 v12, s[12:15], s36 offen offset:0 nt lds
    buffer_load_dwordx4 v13, s[12:15], s36 offen offset:1024 nt lds
    buffer_load_dwordx4 v14, s[12:15], s36 offen offset:2048 nt lds
    buffer_load_dwordx4 v15, s[12:15], s36 offen offset:3072 nt lds
    s_add_u32 s36, s36, 65536
    s_add_u32 m0, s37, 24576
    s_nop 0
    buffer_load_dwordx4 v8, s[12:15], s36 offen offset:0 nt lds
    buffer_load_dwordx4 v9, s[12:15], s36 offen offset:1024 nt lds
    buffer_load_dwordx4 v10, s[12:15], s36 offen offset:2048 nt lds
    buffer_load_dwordx4 v11, s[12:15], s36 offen offset:3072 nt lds
    s_add_u32 m0, s37, 28672
    s_nop 0
    buffer_load_dwordx4 v12, s[12:15], s36 offen offset:0 nt lds
    buffer_load_dwordx4 v13, s[12:15], s36 offen offset:1024 nt lds
    buffer_load_dwordx4 v14, s[12:15], s36 offen offset:2048 nt lds
    buffer_load_dwordx4 v15, s[12:15], s36 offen offset:3072 nt lds
    s_add_u32 s36, s36, 65536
    s_waitcnt vmcnt(24)
    ds_read_b64_tr_b16 v[24:25], v16 offset:0
    ds_read_b64_tr_b16 v[26:27], v16 offset:4096
    ds_read_b64_tr_b16 v[28:29], v17 offset:0
    ds_read_b64_tr_b16 v[30:31], v17 offset:4096
    ds_read_b64_tr_b16 v[32:33], v18 offset:0
    ds_read_b64_tr_b16 v[34:35], v18 offset:4096
    ds_read_b64_tr_b16 v[36:37], v19 offset:0
    ds_read_b64_tr_b16 v[38:39], v19 offset:4096
    ds_read_b64_tr_b16 v[40:41], v20 offset:0
    ds_read_b64_tr_b16 v[42:43], v20 offset:4096
    ds_read_b64_tr_b16 v[44:45], v21 offset:0
    ds_read_b64_tr_b16 v[46:47], v21 offset:4096
    ds_read_b64_tr_b16 v[48:49], v22 offset:0
    ds_read_b64_tr_b16 v[50:51], v22 offset:4096
    ds_read_b64_tr_b16 v[52:53], v23 offset:0
    ds_read_b64_tr_b16 v[54:55], v23 offset:4096
    s_waitcnt lgkmcnt(0)
    s_add_u32 m0, s37, 0
    s_nop 0
    buffer_load_dwordx4 v8, s[12:15], s36 offen offset:0 nt lds
    buffer_load_dwordx4 v9, s[12:15], s36 offen offset:1024 nt lds
    buffer_load_dwordx4 v10, s[12:15], s36 offen offset:2048 nt lds
    buffer_load_dwordx4 v11, s[12:15], s36 offen offset:3072 nt lds
    s_add_u32 m0, s37, 4096
    s_nop 0
    buffer_load_dwordx4 v12, s[12:15], s36 offen offset:0 nt lds
    buffer_load_dwordx4 v13, s[12:15], s36 offen offset:1024 nt lds
    buffer_load_dwordx4 v14, s[12:15], s36 offen offset:2048 nt lds
    buffer_load_dwordx4 v15, s[12:15], s36 offen offset:3072 nt lds
    s_add_u32 s36, s36, 65536
    buffer_store_dwordx4 v[24:27], v4, s[16:19], s35 offen offset:0 sc1
    buffer_store_dwordx4 v[28:31], v4, s[16:19], s35 offen offset:1024 sc1
    buffer_store_dwordx4 v[32:35], v4, s[16:19], s35 offen offset:2048 sc1
    buffer_store_dwordx4 v[36:39], v4, s[16:19], s35 offen offset:3072 sc1
    s_add_u32 s35, s35, 4096
    buffer_store_dwordx4 v[40:43], v4, s[16:19], s35 offen offset:0 sc1
    buffer_store_dwordx4 v[44:47], v4, s[16:19], s35 offen offset:1024 sc1
    buffer_store_dwordx4 v[48:51], v4, s[16:19], s35 offen offset:2048 sc1
    buffer_store_dwordx4 v[52:55], v4, s[16:19], s35 offen offset:3072 sc1
    s_add_u32 s35, s35, 4096
    s_waitcnt vmcnt(32)
    ds_read_b64_tr_b16 v[56:57], v16 offset:8192
    ds_read_b64_tr_b16 v[58:59], v16 offset:12288
    ds_read_b64_tr_b16 v[60:61], v17 offset:8192
    ds_read_b64_tr_b16 v[62:63], v17 offset:12288
    ds_read_b64_tr_b16 v[64:65], v18 offset:8192
    ds_read_b64_tr_b16 v[66:67], v18 offset:12288
    ds_read_b64_tr_b16 v[68:69], v19 offset:8192
    ds_read_b64_tr_b16 v[70:71], v19 offset:12288
    ds_read_b64_tr_b16 v[72:73], v20 offset:8192
    ds_read_b64_tr_b16 v[74:75], v20 offset:12288
    ds_read_b64_tr_b16 v[76:77], v21 offset:8192
    ds_read_b64_tr_b16 v[78:79], v21 offset:12288
    ds_read_b64_tr_b16 v[80:81], v22 offset:8192
    ds_read_b64_tr_b16 v[82:83], v22 offset:12288
    ds_read_b64_tr_b16 v[84:85], v23 offset:8192
    ds_read_b64_tr_b16 v[86:87], v23 offset:12288
    s_waitcnt lgkmcnt(0)
    s_add_u32 m0, s37, 8192
    s_nop 0
    buffer_load_dwordx4 v8, s[12:15], s36 offen offset:0 nt lds
    buffer_load_dwordx4 v9, s[12:15], s36 offen offset:1024 nt lds
    buffer_load_dwordx4 v10, s[12:15], s36 offen offset:2048 nt lds
    buffer_load_dwordx4 v11, s[12:15], s36 offen offset:3072 nt lds
    s_add_u32 m0, s37, 12288
    s_nop 0
    buffer_load_dwordx4 v12, s[12:15], s36 offen offset:0 nt lds
    buffer_load_dwordx4 v13, s[12:15], s36 offen offset:1024 nt lds
    buffer_load_dwordx4 v14, s[12:15], s36 offen offset:2048 nt lds
    buffer_load_dwordx4 v15, s[12:15], s36 offen offset:3072 nt lds
    s_add_u32 s36, s36, 65536
    buffer_store_dwordx4 v[56:59], v4, s[16:19], s35 offen offset:0 sc1
    buffer_store_dwordx4 v[60:63], v4, s[16:19], s35 offen offset:1024 sc1
    buffer_store_dwordx4 v[64:67], v4, s[16:19], s35 offen offset:2048 sc1
    buffer_store_dwordx4 v[68:71], v4, s[16:19], s35 offen offset:3072 sc1
    s_add_u32 s35, s35, 4096
    buffer_store_dwordx4 v[72:75], v4, s[16:19], s35 offen offset:0 sc1
    buffer_store_dwordx4 v[76:79], v4, s[16:19], s35 offen offset:1024 sc1
    buffer_store_dwordx4 v[80:83], v4, s[16:19], s35 offen offset:2048 sc1
    buffer_store_dwordx4 v[84:87], v4, s[16:19], s35 offen offset:3072 sc1
    s_add_u32 s35, s35, 4096
    s_waitcnt vmcnt(40)
    ds_read_b64_tr_b16 v[24:25], v16 offset:16384
    ds_read_b64_tr_b16 v[26:27], v16 offset:20480
    ds_read_b64_tr_b16 v[28:29], v17 offset:16384
    ds_read_b64_tr_b16 v[30:31], v17 offset:20480
    ds_read_b64_tr_b16 v[32:33], v18 offset:16384
    ds_read_b64_tr_b16 v[34:35], v18 offset:20480
    ds_read_b64_tr_b16 v[36:37], v19 offset:16384
    ds_read_b64_tr_b16 v[38:39], v19 offset:20480
    ds_read_b64_tr_b16 v[40:41], v20 offset:16384
    ds_read_b64_tr_b16 v[42:43], v20 offset:20480
    ds_read_b64_tr_b16 v[44:45], v21 offset:16384
    ds_read_b64_tr_b16 v[46:47], v21 offset:20480
    ds_read_b64_tr_b16 v[48:49], v22 offset:16384
    ds_read_b64_tr_b16 v[50:51], v22 offset:20480
    ds_read_b64_tr_b16 v[52:53], v23 offset:16384
    ds_read_b64_tr_b16 v[54:55], v23 offset:20480
    s_waitcnt lgkmcnt(0)
    s_add_u32 m0, s37, 16384
    s_nop 0
    buffer_load_dwordx4 v8, s[12:15], s36 offen offset:0 nt lds
    buffer_load_dwordx4 v9, s[12:15], s36 offen offset:1024 nt lds
    buffer_load_dwordx4 v10, s[12:15], s36 offen offset:2048 nt lds
    buffer_load_dwordx4 v11, s[12:15], s36 offen offset:3072 nt lds
    s_add_u32 m0, s37, 20480
    s_nop 0
    buffer_load_dwordx4 v12, s[12:15], s36 offen offset:0 nt lds
    buffer_load_dwordx4 v13, s[12:15], s36 offen offset:1024 nt lds
    buffer_load_dwordx4 v14, s[12:15], s36 offen offset:2048 nt lds
    buffer_load_dwordx4 v15, s[12:15], s36 offen offset:3072 nt lds
    s_add_u32 s36, s36, 65536
    buffer_store_dwordx4 v[24:27], v4, s[16:19], s35 offen offset:0 sc1
    buffer_store_dwordx4 v[28:31], v4, s[16:19], s35 offen offset:1024 sc1
    buffer_store_dwordx4 v[32:35], v4, s[16:19], s35 offen offset:2048 sc1
    buffer_store_dwordx4 v[36:39], v4, s[16:19], s35 offen offset:3072 sc1
    s_add_u32 s35, s35, 4096
    buffer_store_dwordx4 v[40:43], v4, s[16:19], s35 offen offset:0 sc1
    buffer_store_dwordx4 v[44:47], v4, s[16:19], s35 offen offset:1024 sc1
    buffer_store_dwordx4 v[48:51], v4, s[16:19], s35 offen offset:2048 sc1
    buffer_store_dwordx4 v[52:55], v4, s[16:19], s35 offen offset:3072 sc1
    s_add_u32 s35, s35, 4096
    s_waitcnt vmcnt(48)
    ds_read_b64_tr_b16 v[56:57], v16 offset:24576
    ds_read_b64_tr_b16 v[58:59], v16 offset:28672
    ds_read_b64_tr_b16 v[60:61], v17 offset:24576
    ds_read_b64_tr_b16 v[62:63], v17 offset:28672
    ds_read_b64_tr_b16 v[64:65], v18 offset:24576
    ds_read_b64_tr_b16 v[66:67], v18 offset:28672
    ds_read_b64_tr_b16 v[68:69], v19 offset:24576
    ds_read_b64_tr_b16 v[70:71], v19 offset:28672
    ds_read_b64_tr_b16 v[72:73], v20 offset:24576
    ds_read_b64_tr_b16 v[74:75], v20 offset:28672
    ds_read_b64_tr_b16 v[76:77], v21 offset:24576
    ds_read_b64_tr_b16 v[78:79], v21 offset:28672
    ds_read_b64_tr_b16 v[80:81], v22 offset:24576
    ds_read_b64_tr_b16 v[82:83], v22 offset:28672
    ds_read_b64_tr_b16 v[84:85], v23 offset:24576
    ds_read_b64_tr_b16 v[86:87], v23 offset:28672
    s_waitcnt lgkmcnt(0)
    buffer_store_dwordx4 v[56:59], v4, s[16:19], s35 offen offset:0 sc1
    buffer_store_dwordx4 v[60:63], v4, s[16:19], s35 offen offset:1024 sc1
    buffer_store_dwordx4 v[64:67], v4, s[16:19], s35 offen offset:2048 sc1
    buffer_store_dwordx4 v[68:71], v4, s[16:19], s35 offen offset:3072 sc1
    s_add_u32 s35, s35, 4096
    buffer_store_dwordx4 v[72:75], v4, s[16:19], s35 offen offset:0 sc1
    buffer_store_dwordx4 v[76:79], v4, s[16:19], s35 offen offset:1024 sc1
    buffer_store_dwordx4 v[80:83], v4, s[16:19], s35 offen offset:2048 sc1
    buffer_store_dwordx4 v[84:87], v4, s[16:19], s35 offen offset:3072 sc1
    s_add_u32 s35, s35, 4096
    s_waitcnt vmcnt(48)
    ds_read_b64_tr_b16 v[24:25], v16 offset:0
    ds_read_b64_tr_b16 v[26:27], v16 offset:4096
    ds_read_b64_tr_b16 v[28:29], v17 offset:0
    ds_read_b64_tr_b16 v[30:31], v17 offset:4096
    ds_read_b64_tr_b16 v[32:33], v18 offset:0
    ds_read_b64_tr_b16 v[34:35], v18 offset:4096
    ds_read_b64_tr_b16 v[36:37], v19 offset:0
    ds_read_b64_tr_b16 v[38:39], v19 offset:4096
    ds_read_b64_tr_b16 v[40:41], v20 offset:0
    ds_read_b64_tr_b16 v[42:43], v20 offset:4096
    ds_read_b64_tr_b16 v[44:45], v21 offset:0
    ds_read_b64_tr_b16 v[46:47], v21 offset:4096
    ds_read_b64_tr_b16 v[48:49], v22 offset:0
    ds_read_b64_tr_b16 v[50:51], v22 offset:4096
    ds_read_b64_tr_b16 v[52:53], v23 offset:0
    ds_read_b64_tr_b16 v[54:55], v23 offset:4096
    s_waitcnt lgkmcnt(0)
    buffer_store_dwordx4 v[24:27], v4, s[16:19], s35 offen offset:0 sc1
    buffer_store_dwordx4 v[28:31], v4, s[16:19], s35 offen offset:1024 sc1
    buffer_store_dwordx4 v[32:35], v4, s[16:19], s35 offen offset:2048 sc1
    buffer_store_dwordx4 v[36:39], v4, s[16:19], s35 offen offset:3072 sc1
    s_add_u32 s35, s35, 4096
    buffer_store_dwordx4 v[40:43], v4, s[16:19], s35 offen offset:0 sc1
    buffer_store_dwordx4 v[44:47], v4, s[16:19], s35 offen offset:1024 sc1
    buffer_store_dwordx4 v[48:51], v4, s[16:19], s35 offen offset:2048 sc1
    buffer_store_dwordx4 v[52:55], v4, s[16:19], s35 offen offset:3072 sc1
    s_add_u32 s35, s35, 4096
    s_waitcnt vmcnt(40)
    ds_read_b64_tr_b16 v[56:57], v16 offset:8192
    ds_read_b64_tr_b16 v[58:59], v16 offset:12288
    ds_read_b64_tr_b16 v[60:61], v17 offset:8192
    ds_read_b64_tr_b16 v[62:63], v17 offset:12288
    ds_read_b64_tr_b16 v[64:65], v18 offset:8192
    ds_read_b64_tr_b16 v[66:67], v18 offset:12288
    ds_read_b64_tr_b16 v[68:69], v19 offset:8192
    ds_read_b64_tr_b16 v[70:71], v19 offset:12288
    ds_read_b64_tr_b16 v[72:73], v20 offset:8192
    ds_read_b64_tr_b16 v[74:75], v20 offset:12288
    ds_read_b64_tr_b16 v[76:77], v21 offset:8192
    ds_read_b64_tr_b16 v[78:79], v21 offset:12288
    ds_read_b64_tr_b16 v[80:81], v22 offset:8192
    ds_read_b64_tr_b16 v[82:83], v22 offset:12288
    ds_read_b64_tr_b16 v[84:85], v23 offset:8192
    ds_read_b64_tr_b16 v[86:87], v23 offset:12288
    s_waitcnt lgkmcnt(0)
    buffer_store_dwordx4 v[56:59], v4, s[16:19], s35 offen offset:0 sc1
    buffer_store_dwordx4 v[60:63], v4, s[16:19], s35 offen offset:1024 sc1
    buffer_store_dwordx4 v[64:67], v4, s[16:19], s35 offen offset:2048 sc1
    buffer_store_dwordx4 v[68:71], v4, s[16:19], s35 offen offset:3072 sc1
    s_add_u32 s35, s35, 4096
    buffer_store_dwordx4 v[72:75], v4, s[16:19], s35 offen offset:0 sc1
    buffer_store_dwordx4 v[76:79], v4, s[16:19], s35 offen offset:1024 sc1
    buffer_store_dwordx4 v[80:83], v4, s[16:19], s35 offen offset:2048 sc1
    buffer_store_dwordx4 v[84:87], v4, s[16:19], s35 offen offset:3072 sc1
    s_add_u32 s35, s35, 4096
    s_waitcnt vmcnt(32)
    ds_read_b64_tr_b16 v[24:25], v16 offset:16384
    ds_read_b64_tr_b16 v[26:27], v16 offset:20480
    ds_read_b64_tr_b16 v[28:29], v17 offset:16384
    ds_read_b64_tr_b16 v[30:31], v17 offset:20480
    ds_read_b64_tr_b16 v[32:33], v18 offset:16384
    ds_read_b64_tr_b16 v[34:35], v18 offset:20480
    ds_read_b64_tr_b16 v[36:37], v19 offset:16384
    ds_read_b64_tr_b16 v[38:39], v19 offset:20480
    ds_read_b64_tr_b16 v[40:41], v20 offset:16384
    ds_read_b64_tr_b16 v[42:43], v20 offset:20480
    ds_read_b64_tr_b16 v[44:45], v21 offset:16384
    ds_read_b64_tr_b16 v[46:47], v21 offset:20480
    ds_read_b64_tr_b16 v[48:49], v22 offset:16384
    ds_read_b64_tr_b16 v[50:51], v22 offset:20480
    ds_read_b64_tr_b16 v[52:53], v23 offset:16384
    ds_read_b64_tr_b16 v[54:55], v23 offset:20480
    s_waitcnt lgkmcnt(0)
    buffer_store_dwordx4 v[24:27], v4, s[16:19], s35 offen offset:0 sc1
    buffer_store_dwordx4 v[28:31], v4, s[16:19], s35 offen offset:1024 sc1
    buffer_store_dwordx4 v[32:35], v4, s[16:19], s35 offen offset:2048 sc1
    buffer_store_dwordx4 v[36:39], v4, s[16:19], s35 offen offset:3072 sc1
    s_add_u32 s35, s35, 4096
    buffer_store_dwordx4 v[40:43], v4, s[16:19], s35 offen offset:0 sc1
    buffer_store_dwordx4 v[44:47], v4, s[16:19], s35 offen offset:1024 sc1
    buffer_store_dwordx4 v[48:51], v4, s[16:19], s35 offen offset:2048 sc1
    buffer_store_dwordx4 v[52:55], v4, s[16:19], s35 offen offset:3072 sc1
    s_add_u32 s35, s35, 4096
    s_waitcnt vmcnt(0)
    s_barrier
    s_lshl_b32 s90, s43, 1
    s_lshr_b32 s33, s33, 2
    s_add_u32 s90, s90, s33
    s_add_u32 s90, s90, 88
    s_lshl_b32 s90, s90, 8
    s_add_u32 s96, s84, 47513600
    s_addc_u32 s97, s85, 0
    s_mov_b32 s98, 32768
    s_mov_b32 s99, 0x20000
    s_cmp_eq_u32 s32, 0
    s_cselect_b32 s98, s98, 0
    v_mov_b32 v1, s90
    v_mov_b32 v2, 1
    s_mov_b64 exec, 1
    buffer_atomic_add v2, v1, s[96:99], 0 offen sc1
    s_mov_b64 exec, -1
    s_branch L_g4_kernel_entry
L_text_end:
    s_endpgm
.section .rodata,"a"
.p2align 6
.amdhsa_kernel sequential_preLN__spectral_gfnet__mixer_s_mlp__prompt_kernel
  .amdhsa_next_free_vgpr 512
  .amdhsa_next_free_sgpr 102
  .amdhsa_accum_offset 256
  .amdhsa_group_segment_fixed_size 0
  .amdhsa_kernarg_size 88
  .amdhsa_user_sgpr_count 2
  .amdhsa_user_sgpr_kernarg_segment_ptr 1
  .amdhsa_system_sgpr_workgroup_id_x 1
  .amdhsa_float_denorm_mode_32 3
.end_amdhsa_kernel
```
